```python
import torch

def _softmax(x, axis=-1):
    return torch.softmax(x, dim=axis)
def _gelu(x):
    return torch.nn.functional.gelu(x, approximate="tanh")
def _silu(x):
    return torch.nn.functional.silu(x)
def _sigmoid(x):
    return torch.sigmoid(x)
def _layernorm(x, axis=-1, eps=1e-5):
    m = x.mean(dim=axis, keepdim=True)
    v = x.var(dim=axis, keepdim=True, unbiased=False)
    return (x - m) / torch.sqrt(v + eps)
def _scatter_add(tgt, idx, src, axis=0):
    return tgt.clone().index_add_(axis, idx, src)
def _segment_sum(src, seg, n):
    out = torch.zeros((n,) + src.shape[1:], dtype=src.dtype)
    return out.index_add_(0, seg, src)
def _pad(x, pw):
    flat = tuple(v for pair in reversed(pw) for v in pair)
    return torch.nn.functional.pad(x, flat)

kernel_name = 'standalone__mha_softmax__near_ridge'

def setup_inputs():

    _w = (lambda a: (lambda t: t.to(torch.bfloat16) if t.is_floating_point() else t)(torch.as_tensor(a)))
    B, H, Sq, Sk, D = 8, 32, 496, 512, 192
    return {
        "q": _w((lambda *s: torch.randn(*s, dtype=torch.bfloat16) * 0.8)(B, H, Sq, D)),
        "k": _w((lambda *s: torch.randn(*s, dtype=torch.bfloat16) * 0.8)(B, H, Sk, D)),
        "v": _w((lambda *s: torch.randn(*s, dtype=torch.bfloat16) * 0.05)(B, H, Sk, D)),
    }

def reference(q, k, v):
    scale = q.shape[-1] ** -0.5
    scores = torch.einsum("bhqd,bhkd->bhqk", q, k) * scale
    p = _softmax(scores, axis=-1)
    return torch.einsum("bhqk,bhkd->bhqd", p, v)
```

```asm
; @launch grid=(256,1,1) block=(256,1,1) lds=163840
.amdgcn_target "amdgcn-amd-amdhsa--gfx950"
.text
.globl standalone__mha_softmax__near_ridge_kernel
.p2align 12
.type standalone__mha_softmax__near_ridge_kernel,@function
standalone__mha_softmax__near_ridge_kernel:
  s_getpc_b64 s[60:61]
  s_load_dwordx8 s[44:51], s[0:1], 0
  s_cmp_ge_u32 s2, 0x100
  s_cbranch_scc1 L_end
  s_bfe_u32 s65, s2, 0x20003
  s_lshl_b32 s65, s65, 8
  v_add_u32_e32 v18, s65, v0
  v_lshlrev_b32_e32 v18, 7, v18
  v_min_u32_e32 v19, 62560, v18
  global_load_dword v1, v19, s[60:61]
  v_lshrrev_b32_e32 v14, 6, v0
  v_and_b32_e32 v0, 63, v0
  v_readfirstlane_b32 s52, v14
  s_mov_b32 s53, 0x180
  s_and_b32 s54, s2, 7
  s_lshr_b32 s55, s2, 4
  s_lshl_b32 s55, s55, 3
  s_add_u32 s54, s54, s55
  s_bfe_u32 s55, s2, 0x10003
  s_mul_i32 s56, s54, 393216
  s_mul_i32 s57, s54, 380928
  s_mul_i32 s34, s52, 3072
  v_and_b32_e32 v22, 7, v0
  v_lshrrev_b32_e32 v18, 3, v0
  v_mul_u32_u24_e32 v21, s53, v18
  v_and_b32_e32 v19, 6, v18
  v_xor_b32_e32 v19, v19, v22
  v_lshl_add_u32 v11, v19, 4, v21
  s_mul_i32 s58, s52, 24576
  s_mul_i32 s59, s55, 98304
  s_add_u32 s80, s58, s59
  s_add_u32 s81, s80, 6144
  s_add_u32 s82, s80, 12288
  s_add_u32 s83, s80, 18432
  s_lshl_b32 s28, s52, 14
  s_add_u32 s28, s28, 98304
  s_mov_b32 s62, 43691
  v_add_u32_e32 v16, 0, v0
  v_mul_u32_u24_e32 v16, s62, v16
  v_lshrrev_b32_e32 v16, 20, v16
  v_and_b32_e32 v16, 6, v16
  v_xor_b32_e32 v16, v0, v16
  v_lshl_add_u32 v8, v16, 4, s34
  v_add_u32_e32 v16, 64, v0
  v_mul_u32_u24_e32 v16, s62, v16
  v_lshrrev_b32_e32 v16, 20, v16
  v_and_b32_e32 v16, 6, v16
  v_xor_b32_e32 v16, v0, v16
  v_lshl_add_u32 v9, v16, 4, s34
  v_add_u32_e32 v16, 128, v0
  v_mul_u32_u24_e32 v16, s62, v16
  v_lshrrev_b32_e32 v16, 20, v16
  v_and_b32_e32 v16, 6, v16
  v_xor_b32_e32 v16, v0, v16
  v_lshl_add_u32 v10, v16, 4, s34
  s_waitcnt lgkmcnt(0)
  s_add_u32 s8, s46, s56
  s_addc_u32 s9, s47, 0
  s_mov_b32 s10, 393216
  s_mov_b32 s11, 0x20000
  s_add_u32 s4, s44, s57
  s_addc_u32 s5, s45, 0
  s_mov_b32 s6, 190464
  s_mov_b32 s7, 0x20000
  s_add_u32 m0, s34, 0
  s_mov_b32 s32, 0
  buffer_load_dwordx4 v8, s[8:11], s32 offen nt lds
  buffer_load_dwordx4 v9, s[8:11], s32 offen offset:1024 nt lds
  buffer_load_dwordx4 v10, s[8:11], s32 offen offset:2048 nt lds
  s_add_u32 m0, s34, 12288
  s_mov_b32 s32, 12288
  buffer_load_dwordx4 v8, s[8:11], s32 offen nt lds
  buffer_load_dwordx4 v9, s[8:11], s32 offen offset:1024 nt lds
  buffer_load_dwordx4 v10, s[8:11], s32 offen offset:2048 nt lds
  s_add_u32 m0, s28, 0
  s_lshl_b32 s29, s52, 13
  buffer_load_dwordx4 v11, s[4:7], s80 offen nt lds
  s_add_u32 m0, s28, 0xfffff800
  s_add_u32 s29, s29, 65536
  buffer_load_dwordx4 v11, s[4:7], s80 offen offset:3072 nt lds
  s_add_u32 m0, s28, 2048
  s_cmp_eq_u32 s52, 0
  s_cselect_b32 s29, 36864, s29
  buffer_load_dwordx4 v11, s[4:7], s81 offen nt lds
  s_add_u32 m0, s28, 0
  v_and_b32_e32 v15, 15, v0
  buffer_load_dwordx4 v11, s[4:7], s81 offen offset:3072 nt lds
  s_add_u32 m0, s28, 3968
  v_lshrrev_b32_e32 v16, 4, v0
  buffer_load_dwordx4 v11, s[4:7], s80 offen offset:128 nt lds
  s_add_u32 m0, s28, 1920
  v_and_b32_e32 v17, 6, v15
  buffer_load_dwordx4 v11, s[4:7], s80 offen offset:3200 nt lds
  s_add_u32 m0, s28, 6016
  v_xor_b32_e32 v17, v16, v17
  buffer_load_dwordx4 v11, s[4:7], s81 offen offset:128 nt lds
  s_add_u32 m0, s28, 3968
  v_lshlrev_b32_e32 v17, 4, v17
  buffer_load_dwordx4 v11, s[4:7], s81 offen offset:3200 nt lds
  s_add_u32 m0, s28, 7936
  v_mad_u32_u24 v2, v15, s53, v17
  buffer_load_dwordx4 v11, s[4:7], s80 offen offset:256 nt lds
  s_add_u32 m0, s28, 5888
  v_xor_b32_e32 v3, 64, v2
  buffer_load_dwordx4 v11, s[4:7], s80 offen offset:3328 nt lds
  s_add_u32 m0, s28, 9984
  v_lshl_add_u32 v17, v15, 7, v17
  buffer_load_dwordx4 v11, s[4:7], s81 offen offset:256 nt lds
  s_add_u32 m0, s28, 7936
  v_add_u32_e32 v12, s28, v17
  buffer_load_dwordx4 v11, s[4:7], s81 offen offset:3328 nt lds
  s_add_u32 m0, s28, 12288
  v_xor_b32_e32 v13, 64, v12
  buffer_load_dwordx4 v11, s[4:7], s82 offen nt lds
  s_add_u32 m0, s28, 10240
  v_lshrrev_b32_e32 v18, 2, v0
  buffer_load_dwordx4 v11, s[4:7], s82 offen offset:3072 nt lds
  s_add_u32 m0, s28, 14336
  v_mul_u32_u24_e32 v18, s53, v18
  buffer_load_dwordx4 v11, s[4:7], s83 offen nt lds
  s_add_u32 m0, s28, 12288
  v_bfe_u32 v19, v0, 3, 2
  buffer_load_dwordx4 v11, s[4:7], s83 offen offset:3072 nt lds
  s_waitcnt vmcnt(22)
  s_mov_b64 exec, 0
  s_cmp_eq_u32 s52, 0
  s_cbranch_scc1 L_hop0
  s_cmp_eq_u32 s52, 1
  s_cbranch_scc1 L_hop1
  s_cmp_eq_u32 s52, 2
  s_cbranch_scc1 L_hop2
  s_branch L_hop3
L_walkdone:
  s_mov_b64 exec, -1
  s_add_u32 m0, s29, 0xffffff80
  v_lshl_add_u32 v18, v19, 5, v18
  buffer_load_dwordx4 v11, s[4:7], s82 offen offset:128 nt lds
  s_add_u32 m0, s29, 0xfffff780
  v_and_b32_e32 v19, 3, v0
  buffer_load_dwordx4 v11, s[4:7], s82 offen offset:3200 nt lds
  s_add_u32 m0, s29, 1920
  v_lshl_add_u32 v18, v19, 3, v18
  buffer_load_dwordx4 v11, s[4:7], s83 offen offset:128 nt lds
  s_add_u32 m0, s29, 0xffffff80
  v_add_u32_e32 v4, 49152, v18
  buffer_load_dwordx4 v11, s[4:7], s83 offen offset:3200 nt lds
  v_xor_b32_e32 v5, 32, v4
  v_xor_b32_e32 v6, 64, v4
  v_xor_b32_e32 v7, 96, v4
  s_add_u32 s12, s48, s56
  s_addc_u32 s13, s49, 0
  s_mov_b32 s14, 393216
  s_mov_b32 s15, 0x20000
  s_sub_u32 s30, s29, s28
  s_add_u32 s24, s44, s57
  s_addc_u32 s25, s45, 0
  s_add_u32 s24, s24, 190464
  s_addc_u32 s25, s25, 0
  s_mov_b32 s26, 190464
  s_mov_b32 s27, 0x20000
  s_add_u32 s16, s50, s57
  s_addc_u32 s17, s51, 0
  s_mov_b32 s18, 190464
  s_mov_b32 s19, 0x20000
  s_add_u32 s20, s50, s57
  s_addc_u32 s21, s51, 0
  s_add_u32 s20, s20, 190464
  s_addc_u32 s21, s21, 0
  s_mov_b32 s22, 190464
  s_mov_b32 s23, 0x20000
  s_xor_b32 s59, s59, 98304
  s_add_u32 s84, s58, s59
  s_add_u32 s85, s84, 6144
  s_add_u32 s86, s84, 12288
  s_add_u32 s87, s84, 18432
  s_mov_b32 s35, 0x3dd53b95
  s_mov_b32 s36, 0x4e800000
  s_mov_b64 s[42:43], 0
  s_mov_b32 s64, 144
  v_mov_b32_e32 v18, 0x3f803f80
  v_mov_b32_e32 v19, 0x3f803f80
  v_mov_b32_e32 v20, 0x3f803f80
  v_mov_b32_e32 v21, 0x3f803f80
  v_add_u32_e32 v22, s30, v12
  v_add_u32_e32 v23, s30, v13
  s_waitcnt vmcnt(20)
  s_barrier
  ds_read_b128 a[160:163], v2 offset:0
  ds_read_b128 a[164:167], v3 offset:0
  ds_read_b128 a[168:171], v2 offset:128
  s_waitcnt vmcnt(16)
  ds_read_b128 a[32:35], v12 offset:0
  ds_read_b128 a[36:39], v13 offset:0
  ds_read_b128 a[56:59], v12 offset:2048
  ds_read_b128 a[60:63], v13 offset:2048
  s_waitcnt vmcnt(12)
  ds_read_b128 a[40:43], v12 offset:4096
  ds_read_b128 a[44:47], v13 offset:4096
  ds_read_b128 a[64:67], v12 offset:6144
  ds_read_b128 a[68:71], v13 offset:6144
  s_waitcnt vmcnt(8)
  ds_read_b128 a[48:51], v12 offset:8192
  ds_read_b128 a[52:55], v13 offset:8192
  ds_read_b128 a[72:75], v12 offset:10240
  ds_read_b128 a[76:79], v13 offset:10240
  s_waitcnt lgkmcnt(10)
  ds_read_b128 a[172:175], v3 offset:128
  ds_read_b128 a[176:179], v2 offset:256
  ds_read_b128 a[180:183], v3 offset:256
  ds_read_b128 a[184:187], v2 offset:6144
  ds_read_b128 a[188:191], v3 offset:6144
  s_waitcnt lgkmcnt(10)
  ds_read_b128 a[192:195], v2 offset:6272
  v_mfma_f32_16x16x32_bf16 v[32:35], a[160:163], a[32:35], 0
  s_add_u32 m0, s29, 3840
  v_mfma_f32_16x16x32_bf16 v[32:35], a[164:167], a[36:39], v[32:35]
  ds_read_b128 a[196:199], v3 offset:6272
  v_mfma_f32_16x16x32_bf16 v[32:35], a[168:171], a[40:43], v[32:35]
  buffer_load_dwordx4 v11, s[4:7], s82 offen offset:256 nt lds
  s_waitcnt lgkmcnt(6)
  v_mfma_f32_16x16x32_bf16 v[32:35], a[172:175], a[44:47], v[32:35]
  s_add_u32 m0, s29, 1792
  ds_read_b128 a[200:203], v2 offset:6400
  s_waitcnt lgkmcnt(6)
  v_mfma_f32_16x16x32_bf16 v[32:35], a[176:179], a[48:51], v[32:35]
  s_waitcnt lgkmcnt(4)
  buffer_load_dwordx4 v11, s[4:7], s82 offen offset:3328 nt lds
  v_mfma_f32_16x16x32_bf16 v[32:35], a[180:183], a[52:55], v[32:35]
  s_add_u32 m0, s29, 5888
  ds_read_b128 a[204:207], v3 offset:6400
  v_mfma_f32_16x16x32_bf16 v[40:43], a[160:163], a[56:59], 0
  buffer_load_dwordx4 v11, s[4:7], s83 offen offset:256 nt lds
  v_mfma_f32_16x16x32_bf16 v[40:43], a[164:167], a[60:63], v[40:43]
  s_add_u32 m0, s29, 3840
  ds_read_b128 a[160:163], v2 offset:12288
  v_mfma_f32_16x16x32_bf16 v[40:43], a[168:171], a[64:67], v[40:43]
  buffer_load_dwordx4 v11, s[4:7], s83 offen offset:3328 nt lds
  v_mfma_f32_16x16x32_bf16 v[40:43], a[172:175], a[68:71], v[40:43]
  s_add_u32 m0, s34, 49152
  ds_read_b128 a[164:167], v3 offset:12288
  v_mfma_f32_16x16x32_bf16 v[40:43], a[176:179], a[72:75], v[40:43]
  s_mov_b32 s33, 0
  v_max3_f32 v14, v32, v33, v34
  v_mfma_f32_16x16x32_bf16 v[40:43], a[180:183], a[76:79], v[40:43]
  ds_read_b128 a[168:171], v2 offset:12416
  v_mfma_f32_16x16x32_bf16 v[36:39], a[184:187], a[32:35], 0
  s_waitcnt lgkmcnt(4)
  buffer_load_dwordx4 v8, s[12:15], s33 offen nt lds
  v_mfma_f32_16x16x32_bf16 v[36:39], a[188:191], a[36:39], v[36:39]
  ds_read_b128 a[172:175], v3 offset:12416
  v_mfma_f32_16x16x32_bf16 v[36:39], a[192:195], a[40:43], v[36:39]
  buffer_load_dwordx4 v9, s[12:15], s33 offen offset:1024 nt lds
  v_mfma_f32_16x16x32_bf16 v[36:39], a[196:199], a[44:47], v[36:39]
  ds_read_b128 a[176:179], v2 offset:12544
  v_mfma_f32_16x16x32_bf16 v[36:39], a[200:203], a[48:51], v[36:39]
  s_waitcnt lgkmcnt(4)
  buffer_load_dwordx4 v10, s[12:15], s33 offen offset:2048 nt lds
  v_mfma_f32_16x16x32_bf16 v[36:39], a[204:207], a[52:55], v[36:39]
  s_add_u32 m0, s34, 24576
  ds_read_b128 a[180:183], v3 offset:12544
  v_max3_f32 v15, v40, v41, v42
  v_mfma_f32_16x16x32_bf16 v[44:47], a[184:187], a[56:59], 0
  s_mov_b32 s32, 24576
  v_mfma_f32_16x16x32_bf16 v[44:47], a[188:191], a[60:63], v[44:47]
  ds_read_b128 a[184:187], v2 offset:18432
  v_mfma_f32_16x16x32_bf16 v[44:47], a[192:195], a[64:67], v[44:47]
  buffer_load_dwordx4 v8, s[8:11], s32 offen nt lds
  v_mfma_f32_16x16x32_bf16 v[44:47], a[196:199], a[68:71], v[44:47]
  ds_read_b128 a[188:191], v3 offset:18432
  v_mfma_f32_16x16x32_bf16 v[44:47], a[200:203], a[72:75], v[44:47]
  buffer_load_dwordx4 v9, s[8:11], s32 offen offset:1024 nt lds
  v_mfma_f32_16x16x32_bf16 v[44:47], a[204:207], a[76:79], v[44:47]
  ds_read_b128 a[192:195], v2 offset:18560
  v_max3_f32 v14, v14, v35, v36
  v_mfma_f32_16x16x32_bf16 v[64:67], a[160:163], a[32:35], 0
  s_waitcnt lgkmcnt(4)
  buffer_load_dwordx4 v10, s[8:11], s32 offen offset:2048 nt lds
  v_mfma_f32_16x16x32_bf16 v[64:67], a[164:167], a[36:39], v[64:67]
  s_add_u32 m0, s34, 61440
  ds_read_b128 a[196:199], v3 offset:18560
  v_max3_f32 v14, v14, v37, v38
  v_mfma_f32_16x16x32_bf16 v[64:67], a[168:171], a[40:43], v[64:67]
  s_mov_b32 s33, 12288
  v_max_f32_e32 v14, v14, v39
  v_mov_b32_e32 v26, v14
  v_mfma_f32_16x16x32_bf16 v[64:67], a[172:175], a[44:47], v[64:67]
  ds_read_b128 a[200:203], v2 offset:18688
  v_mfma_f32_16x16x32_bf16 v[64:67], a[176:179], a[48:51], v[64:67]
  s_waitcnt lgkmcnt(4)
  buffer_load_dwordx4 v8, s[12:15], s33 offen nt lds
  v_mfma_f32_16x16x32_bf16 v[64:67], a[180:183], a[52:55], v[64:67]
  ds_read_b128 a[204:207], v3 offset:18688
  v_max3_f32 v15, v15, v43, v44
  v_mfma_f32_16x16x32_bf16 v[72:75], a[160:163], a[56:59], 0
  buffer_load_dwordx4 v9, s[12:15], s33 offen offset:1024 nt lds
  v_mfma_f32_16x16x32_bf16 v[72:75], a[164:167], a[60:63], v[72:75]
  ds_read_b128 a[160:163], v2 offset:0
  v_max3_f32 v15, v15, v45, v46
  v_mfma_f32_16x16x32_bf16 v[72:75], a[168:171], a[64:67], v[72:75]
  buffer_load_dwordx4 v10, s[12:15], s33 offen offset:2048 nt lds
  v_mfma_f32_16x16x32_bf16 v[72:75], a[172:175], a[68:71], v[72:75]
  ds_read_b128 a[164:167], v3 offset:0
  v_permlane32_swap_b32_e32 v14, v26
  v_max_f32_e32 v14, v14, v26
  v_mov_b32_e32 v26, v14
  v_max_f32_e32 v15, v15, v47
  v_mov_b32_e32 v27, v15
  v_mfma_f32_16x16x32_bf16 v[72:75], a[176:179], a[72:75], v[72:75]
  v_permlane16_swap_b32_e32 v14, v26
  v_mfma_f32_16x16x32_bf16 v[72:75], a[180:183], a[76:79], v[72:75]
  ds_read_b128 a[168:171], v2 offset:128
  v_max_f32_e32 v14, v14, v26
  v_mfma_f32_16x16x32_bf16 v[68:71], a[184:187], a[32:35], 0
  s_waitcnt lgkmcnt(4)
  v_permlane32_swap_b32_e32 v15, v27
  v_mfma_f32_16x16x32_bf16 v[68:71], a[188:191], a[36:39], v[68:71]
  ds_read_b128 a[172:175], v3 offset:128
  v_mul_f32_e32 v14, s35, v14
  v_fma_f32 v32, v32, s35, -v14
  v_exp_f32_e32 v32, v32
  v_fma_f32 v33, v33, s35, -v14
  v_exp_f32_e32 v33, v33
  v_fma_f32 v34, v34, s35, -v14
  v_exp_f32_e32 v34, v34
  v_fma_f32 v35, v35, s35, -v14
  v_exp_f32_e32 v35, v35
  v_fma_f32 v36, v36, s35, -v14
  v_exp_f32_e32 v36, v36
  v_fma_f32 v37, v37, s35, -v14
  v_exp_f32_e32 v37, v37
  v_fma_f32 v38, v38, s35, -v14
  v_exp_f32_e32 v38, v38
  v_fma_f32 v39, v39, s35, -v14
  v_exp_f32_e32 v39, v39
  v_cvt_pk_bf16_f32 v32, v32, v33
  v_cvt_pk_bf16_f32 v33, v34, v35
  v_cvt_pk_bf16_f32 v34, v36, v37
  v_cvt_pk_bf16_f32 v35, v38, v39
  v_max_f32_e32 v15, v15, v27
  v_mov_b32_e32 v27, v15
  v_fma_f32 v64, v64, s35, -v14
  v_exp_f32_e32 v64, v64
  v_fma_f32 v65, v65, s35, -v14
  v_exp_f32_e32 v65, v65
  v_fma_f32 v66, v66, s35, -v14
  v_exp_f32_e32 v66, v66
  v_fma_f32 v67, v67, s35, -v14
  v_exp_f32_e32 v67, v67
  v_cvt_pk_bf16_f32 v64, v64, v65
  v_cvt_pk_bf16_f32 v65, v66, v67
  v_mfma_f32_16x16x32_bf16 v[68:71], a[192:195], a[40:43], v[68:71]
  s_waitcnt vmcnt(17)
  ds_read_b128 a[80:83], v12 offset:12288
  ds_read_b128 a[84:87], v13 offset:12288
  v_mfma_f32_16x16x32_bf16 v[68:71], a[196:199], a[44:47], v[68:71]
  ds_read_b128 a[176:179], v2 offset:256
  ds_read_b128 a[104:107], v12 offset:14336
  ds_read_b128 a[108:111], v13 offset:14336
  v_mfma_f32_16x16x32_bf16 v[68:71], a[200:203], a[48:51], v[68:71]
  s_waitcnt lgkmcnt(8)
  s_waitcnt vmcnt(13)
  ds_read_b128 a[88:91], v22 offset:0
  ds_read_b128 a[92:95], v23 offset:0
  v_mfma_f32_16x16x32_bf16 v[68:71], a[204:207], a[52:55], v[68:71]
  ds_read_b128 a[180:183], v3 offset:256
  ds_read_b128 a[112:115], v22 offset:2048
  ds_read_b128 a[116:119], v23 offset:2048
  v_permlane16_swap_b32_e32 v15, v27
  v_mfma_f32_16x16x32_bf16 v[76:79], a[184:187], a[56:59], 0
  v_max_f32_e32 v15, v15, v27
  v_mul_f32_e32 v15, s35, v15
  v_mfma_f32_16x16x32_bf16 v[76:79], a[188:191], a[60:63], v[76:79]
  ds_read_b128 a[184:187], v2 offset:6144
  v_fma_f32 v40, v40, s35, -v15
  v_exp_f32_e32 v40, v40
  v_fma_f32 v41, v41, s35, -v15
  v_exp_f32_e32 v41, v41
  v_fma_f32 v42, v42, s35, -v15
  v_exp_f32_e32 v42, v42
  v_fma_f32 v43, v43, s35, -v15
  v_exp_f32_e32 v43, v43
  v_fma_f32 v44, v44, s35, -v15
  v_exp_f32_e32 v44, v44
  v_fma_f32 v45, v45, s35, -v15
  v_exp_f32_e32 v45, v45
  v_fma_f32 v46, v46, s35, -v15
  v_exp_f32_e32 v46, v46
  v_fma_f32 v47, v47, s35, -v15
  v_exp_f32_e32 v47, v47
  v_mov_b32_e32 v0, v40
  v_add_f32_e32 v0, v0, v41
  v_cvt_pk_bf16_f32 v40, v40, v41
  v_add_f32_e32 v0, v0, v42
  v_add_f32_e32 v0, v0, v43
  v_cvt_pk_bf16_f32 v41, v42, v43
  v_cvt_pk_bf16_f32 v42, v44, v45
  v_cvt_pk_bf16_f32 v43, v46, v47
  v_add_f32_e32 v0, v0, v44
  v_add_f32_e32 v0, v0, v45
  v_add_f32_e32 v0, v0, v46
  v_add_f32_e32 v0, v0, v47
  v_fma_f32 v72, v72, s35, -v15
  v_exp_f32_e32 v72, v72
  v_fma_f32 v73, v73, s35, -v15
  v_exp_f32_e32 v73, v73
  v_mfma_f32_16x16x32_bf16 v[76:79], a[192:195], a[64:67], v[76:79]
  s_waitcnt vmcnt(9)
  ds_read_b128 a[96:99], v22 offset:4096
  s_waitcnt lgkmcnt(10)
  ds_read_b128 a[100:103], v23 offset:4096
  v_mfma_f32_16x16x32_bf16 v[76:79], a[196:199], a[68:71], v[76:79]
  ds_read_b128 a[188:191], v3 offset:6144
  ds_read_b128 a[120:123], v22 offset:6144
  ds_read_b128 a[124:127], v23 offset:6144
  v_fma_f32 v74, v74, s35, -v15
  v_mfma_f32_16x16x32_bf16 v[76:79], a[200:203], a[72:75], v[76:79]
  v_exp_f32_e32 v74, v74
  v_fma_f32 v68, v68, s35, -v14
  v_mfma_f32_16x16x32_bf16 v[76:79], a[204:207], a[76:79], v[76:79]
  ds_read_b128 a[192:195], v2 offset:6272
  v_exp_f32_e32 v68, v68
  v_mfma_f32_16x16x32_bf16 v[48:51], a[160:163], a[80:83], 0
  s_waitcnt lgkmcnt(14)
  v_fma_f32 v69, v69, s35, -v14
  v_fma_f32 v70, v70, s35, -v14
  v_mfma_f32_16x16x32_bf16 v[48:51], a[164:167], a[84:87], v[48:51]
  ds_read_b128 a[196:199], v3 offset:6272
  v_exp_f32_e32 v69, v69
  s_waitcnt lgkmcnt(12)
  v_mfma_f32_16x16x32_bf16 v[48:51], a[168:171], a[88:91], v[48:51]
  v_exp_f32_e32 v70, v70
  v_fma_f32 v71, v71, s35, -v14
  s_waitcnt lgkmcnt(11)
  v_mfma_f32_16x16x32_bf16 v[48:51], a[172:175], a[92:95], v[48:51]
  ds_read_b128 a[200:203], v2 offset:6400
  v_exp_f32_e32 v71, v71
  s_waitcnt lgkmcnt(7)
  v_mfma_f32_16x16x32_bf16 v[48:51], a[176:179], a[96:99], v[48:51]
  s_waitcnt lgkmcnt(3)
  s_barrier
  v_cvt_pk_bf16_f32 v66, v68, v69
  v_mfma_f32_16x16x32_bf16 v[48:51], a[180:183], a[100:103], v[48:51]
  s_add_u32 m0, s34, 36864
  ds_read_b128 a[204:207], v3 offset:6400
  v_cvt_pk_bf16_f32 v67, v70, v71
  v_fma_f32 v75, v75, s35, -v15
  v_mfma_f32_16x16x32_bf16 v[56:59], a[160:163], a[104:107], 0
  s_mov_b32 s32, 36864
  v_exp_f32_e32 v75, v75
  v_fma_f32 v76, v76, s35, -v15
  v_mfma_f32_16x16x32_bf16 v[56:59], a[164:167], a[108:111], v[56:59]
  ds_read_b128 a[160:163], v2 offset:12288
  v_exp_f32_e32 v76, v76
  v_mfma_f32_16x16x32_bf16 v[56:59], a[168:171], a[112:115], v[56:59]
  buffer_load_dwordx4 v8, s[8:11], s32 offen nt lds
  v_fma_f32 v77, v77, s35, -v15
  v_mfma_f32_16x16x32_bf16 v[56:59], a[172:175], a[116:119], v[56:59]
  ds_read_b128 a[164:167], v3 offset:12288
  v_exp_f32_e32 v77, v77
  v_fma_f32 v78, v78, s35, -v15
  v_mfma_f32_16x16x32_bf16 v[56:59], a[176:179], a[120:123], v[56:59]
  buffer_load_dwordx4 v9, s[8:11], s32 offen offset:1024 nt lds
  v_max3_f32 v16, v48, v49, v50
  v_mfma_f32_16x16x32_bf16 v[56:59], a[180:183], a[124:127], v[56:59]
  ds_read_b128 a[168:171], v2 offset:12416
  v_exp_f32_e32 v78, v78
  v_mfma_f32_16x16x32_bf16 v[52:55], a[184:187], a[80:83], 0
  s_waitcnt lgkmcnt(4)
  buffer_load_dwordx4 v10, s[8:11], s32 offen offset:2048 nt lds
  v_fma_f32 v79, v79, s35, -v15
  v_add_f32_e32 v0, v0, v72
  v_mfma_f32_16x16x32_bf16 v[52:55], a[188:191], a[84:87], v[52:55]
  s_add_u32 m0, s34, 73728
  ds_read_b128 a[172:175], v3 offset:12416
  v_exp_f32_e32 v79, v79
  v_mfma_f32_16x16x32_bf16 v[52:55], a[192:195], a[88:91], v[52:55]
  s_mov_b32 s33, 24576
  v_add_f32_e32 v0, v0, v73
  v_cvt_pk_bf16_f32 v72, v72, v73
  v_add_f32_e32 v0, v0, v74
  v_mfma_f32_16x16x32_bf16 v[52:55], a[196:199], a[92:95], v[52:55]
  ds_read_b128 a[176:179], v2 offset:12544
  v_add_f32_e32 v0, v0, v75
  v_cvt_pk_bf16_f32 v73, v74, v75
  v_cvt_pk_bf16_f32 v74, v76, v77
  v_mfma_f32_16x16x32_bf16 v[52:55], a[200:203], a[96:99], v[52:55]
  s_waitcnt lgkmcnt(4)
  buffer_load_dwordx4 v8, s[12:15], s33 offen nt lds
  v_max3_f32 v17, v56, v57, v58
  v_cvt_pk_bf16_f32 v75, v78, v79
  v_mfma_f32_16x16x32_bf16 v[52:55], a[204:207], a[100:103], v[52:55]
  ds_read_b128 a[180:183], v3 offset:12544
  v_add_f32_e32 v0, v0, v76
  v_add_f32_e32 v0, v0, v77
  v_mfma_f32_16x16x32_bf16 v[60:63], a[184:187], a[104:107], 0
  buffer_load_dwordx4 v9, s[12:15], s33 offen offset:1024 nt lds
  v_add_f32_e32 v0, v0, v78
  v_add_f32_e32 v0, v0, v79
  v_mfma_f32_16x16x32_bf16 v[60:63], a[188:191], a[108:111], v[60:63]
  ds_read_b128 a[184:187], v2 offset:18432
  v_mfma_f32_16x16x32_bf16 v[60:63], a[192:195], a[112:115], v[60:63]
  buffer_load_dwordx4 v10, s[12:15], s33 offen offset:2048 nt lds
  v_mfma_f32_16x16x32_bf16 v[60:63], a[196:199], a[116:119], v[60:63]
  ds_read_b128 a[188:191], v3 offset:18432
  v_mfma_f32_16x16x32_bf16 v[60:63], a[200:203], a[120:123], v[60:63]
  v_max3_f32 v16, v16, v51, v52
  v_max3_f32 v16, v16, v53, v54
  v_max_f32_e32 v16, v16, v55
  v_mov_b32_e32 v28, v16
  v_mfma_f32_16x16x32_bf16 v[60:63], a[204:207], a[124:127], v[60:63]
  ds_read_b128 a[192:195], v2 offset:18560
  v_permlane32_swap_b32_e32 v16, v28
  v_max_f32_e32 v16, v16, v28
  v_mov_b32_e32 v28, v16
  v_mfma_f32_16x16x32_bf16 v[80:83], a[160:163], a[80:83], 0
  s_waitcnt lgkmcnt(4)
  v_permlane16_swap_b32_e32 v16, v28
  v_max_f32_e32 v16, v16, v28
  v_mul_f32_e32 v16, s35, v16
  v_mfma_f32_16x16x32_bf16 v[80:83], a[164:167], a[84:87], v[80:83]
  ds_read_b128 a[196:199], v3 offset:18560
  v_fma_f32 v48, v48, s35, -v16
  v_exp_f32_e32 v48, v48
  v_mfma_f32_16x16x32_bf16 v[80:83], a[168:171], a[88:91], v[80:83]
  v_fma_f32 v49, v49, s35, -v16
  v_exp_f32_e32 v49, v49
  v_fma_f32 v50, v50, s35, -v16
  v_mfma_f32_16x16x32_bf16 v[80:83], a[172:175], a[92:95], v[80:83]
  ds_read_b128 a[200:203], v2 offset:18688
  v_exp_f32_e32 v50, v50
  v_fma_f32 v51, v51, s35, -v16
  v_mfma_f32_16x16x32_bf16 v[80:83], a[176:179], a[96:99], v[80:83]
  s_waitcnt lgkmcnt(4)
  v_exp_f32_e32 v51, v51
  v_fma_f32 v52, v52, s35, -v16
  v_fma_f32 v53, v53, s35, -v16
  v_mfma_f32_16x16x32_bf16 v[80:83], a[180:183], a[100:103], v[80:83]
  ds_read_b128 a[204:207], v3 offset:18688
  v_exp_f32_e32 v52, v52
  v_fma_f32 v54, v54, s35, -v16
  v_mfma_f32_16x16x32_bf16 v[88:91], a[160:163], a[104:107], 0
  v_exp_f32_e32 v53, v53
  v_exp_f32_e32 v54, v54
  v_mfma_f32_16x16x32_bf16 v[88:91], a[164:167], a[108:111], v[88:91]
  s_waitcnt vmcnt(9)
  s_barrier
  v_fma_f32 v55, v55, s35, -v16
  v_mov_b32_e32 v30, v48
  v_mfma_f32_16x16x32_bf16 v[88:91], a[168:171], a[112:115], v[88:91]
  s_add_u32 m0, s34, 0
  ds_read_b64_tr_b16 a[160:161], v4 offset:0
  v_exp_f32_e32 v55, v55
  v_add_f32_e32 v30, v30, v49
  v_mfma_f32_16x16x32_bf16 v[88:91], a[172:175], a[116:119], v[88:91]
  s_mov_b32 s32, 49152
  v_cvt_pk_bf16_f32 v48, v48, v49
  v_add_f32_e32 v30, v30, v50
  v_add_f32_e32 v30, v30, v51
  v_cvt_pk_bf16_f32 v49, v50, v51
  v_mfma_f32_16x16x32_bf16 v[88:91], a[176:179], a[120:123], v[88:91]
  ds_read_b64_tr_b16 a[162:163], v4 offset:6144
  v_cvt_pk_bf16_f32 v50, v52, v53
  v_cvt_pk_bf16_f32 v51, v54, v55
  v_max3_f32 v17, v17, v59, v60
  v_mfma_f32_16x16x32_bf16 v[88:91], a[180:183], a[124:127], v[88:91]
  buffer_load_dwordx4 v8, s[8:11], s32 offen nt lds
  v_max3_f32 v17, v17, v61, v62
  v_max_f32_e32 v17, v17, v63
  v_mfma_f32_16x16x32_bf16 v[84:87], a[184:187], a[80:83], 0
  s_waitcnt lgkmcnt(3)
  ds_read_b64_tr_b16 a[164:165], v5 offset:0
  v_mov_b32_e32 v29, v17
  v_add_f32_e32 v30, v30, v52
  v_add_f32_e32 v30, v30, v53
  v_mfma_f32_16x16x32_bf16 v[84:87], a[188:191], a[84:87], v[84:87]
  buffer_load_dwordx4 v9, s[8:11], s32 offen offset:1024 nt lds
  v_permlane32_swap_b32_e32 v17, v29
  v_mfma_f32_16x16x32_bf16 v[84:87], a[192:195], a[88:91], v[84:87]
  ds_read_b64_tr_b16 a[166:167], v5 offset:6144
  v_max_f32_e32 v17, v17, v29
  v_mov_b32_e32 v29, v17
  v_add_f32_e32 v30, v30, v54
  v_mfma_f32_16x16x32_bf16 v[84:87], a[196:199], a[92:95], v[84:87]
  buffer_load_dwordx4 v10, s[8:11], s32 offen offset:2048 nt lds
  v_permlane16_swap_b32_e32 v17, v29
  v_mfma_f32_16x16x32_bf16 v[84:87], a[200:203], a[96:99], v[84:87]
  s_waitcnt lgkmcnt(4)
  ds_read_b64_tr_b16 a[168:169], v6 offset:0
  v_max_f32_e32 v17, v17, v29
  v_mul_f32_e32 v17, s35, v17
  v_fma_f32 v56, v56, s35, -v17
  v_mfma_f32_16x16x32_bf16 v[84:87], a[204:207], a[100:103], v[84:87]
  s_add_u32 m0, s34, 86016
  v_exp_f32_e32 v56, v56
  v_fma_f32 v57, v57, s35, -v17
  v_exp_f32_e32 v57, v57
  v_mfma_f32_16x16x32_bf16 v[92:95], a[184:187], a[104:107], 0
  s_mov_b32 s33, 36864
  ds_read_b64_tr_b16 a[170:171], v6 offset:6144
  v_fma_f32 v58, v58, s35, -v17
  v_exp_f32_e32 v58, v58
  v_mfma_f32_16x16x32_bf16 v[92:95], a[188:191], a[108:111], v[92:95]
  buffer_load_dwordx4 v8, s[12:15], s33 offen nt lds
  v_fma_f32 v59, v59, s35, -v17
  v_fma_f32 v60, v60, s35, -v17
  v_mfma_f32_16x16x32_bf16 v[92:95], a[192:195], a[112:115], v[92:95]
  ds_read_b64_tr_b16 a[172:173], v7 offset:0
  v_exp_f32_e32 v59, v59
  v_fma_f32 v61, v61, s35, -v17
  v_mfma_f32_16x16x32_bf16 v[92:95], a[196:199], a[116:119], v[92:95]
  buffer_load_dwordx4 v9, s[12:15], s33 offen offset:1024 nt lds
  v_exp_f32_e32 v60, v60
  v_mfma_f32_16x16x32_bf16 v[92:95], a[200:203], a[120:123], v[92:95]
  ds_read_b64_tr_b16 a[174:175], v7 offset:6144
  v_exp_f32_e32 v61, v61
  v_fma_f32 v62, v62, s35, -v17
  v_mfma_f32_16x16x32_bf16 v[92:95], a[204:207], a[124:127], v[92:95]
  buffer_load_dwordx4 v10, s[12:15], s33 offen offset:2048 nt lds
  v_exp_f32_e32 v62, v62
  v_fma_f32 v63, v63, s35, -v17
  v_mfma_f32_16x16x32_bf16 a[240:243], v[18:21], v[32:35], 0
  s_waitcnt lgkmcnt(4)
  ds_read_b64_tr_b16 a[176:177], v4 offset:128
  v_exp_f32_e32 v63, v63
L_hop0:
  s_cbranch_execz L_hop4
  v_mov_b32_e32 v31, v56
  v_mfma_f32_16x16x32_bf16 v[96:99], a[160:163], v[32:35], 0
  v_add_f32_e32 v31, v31, v57
  v_cvt_pk_bf16_f32 v56, v56, v57
  v_add_f32_e32 v31, v31, v58
  v_add_f32_e32 v31, v31, v59
  v_mfma_f32_16x16x32_bf16 v[100:103], a[160:163], v[40:43], 0
  ds_read_b64_tr_b16 a[178:179], v4 offset:6272
  v_cvt_pk_bf16_f32 v57, v58, v59
  v_cvt_pk_bf16_f32 v58, v60, v61
  v_cvt_pk_bf16_f32 v59, v62, v63
  v_mfma_f32_16x16x32_bf16 v[104:107], a[160:163], v[48:51], 0
  v_add_f32_e32 v30, v30, v55
  v_add_f32_e32 v31, v31, v60
  v_mfma_f32_16x16x32_bf16 v[108:111], a[160:163], v[56:59], 0
  ds_read_b64_tr_b16 a[180:181], v5 offset:128
  v_add_f32_e32 v31, v31, v61
  v_mfma_f32_16x16x32_bf16 v[112:115], a[164:167], v[32:35], 0
  v_add_f32_e32 v31, v31, v62
  v_add_f32_e32 v31, v31, v63
  v_mfma_f32_16x16x32_bf16 v[116:119], a[164:167], v[40:43], 0
  ds_read_b64_tr_b16 a[182:183], v5 offset:6272
  v_fma_f32 v80, v80, s35, -v16
  v_mfma_f32_16x16x32_bf16 v[120:123], a[164:167], v[48:51], 0
  v_exp_f32_e32 v80, v80
  v_mfma_f32_16x16x32_bf16 v[124:127], a[164:167], v[56:59], 0
  s_waitcnt lgkmcnt(4)
  ds_read_b64_tr_b16 a[184:185], v6 offset:128
  v_fma_f32 v81, v81, s35, -v16
  v_mfma_f32_16x16x32_bf16 v[128:131], a[168:171], v[32:35], 0
  v_exp_f32_e32 v81, v81
  v_mfma_f32_16x16x32_bf16 v[132:135], a[168:171], v[40:43], 0
  ds_read_b64_tr_b16 a[186:187], v6 offset:6272
  v_fma_f32 v82, v82, s35, -v16
  v_mfma_f32_16x16x32_bf16 v[136:139], a[168:171], v[48:51], 0
  v_exp_f32_e32 v82, v82
  v_mfma_f32_16x16x32_bf16 v[140:143], a[168:171], v[56:59], 0
  ds_read_b64_tr_b16 a[188:189], v7 offset:128
  v_fma_f32 v83, v83, s35, -v16
  v_mfma_f32_16x16x32_bf16 v[144:147], a[172:175], v[32:35], 0
  v_exp_f32_e32 v83, v83
  v_mfma_f32_16x16x32_bf16 v[148:151], a[172:175], v[40:43], 0
  ds_read_b64_tr_b16 a[190:191], v7 offset:6272
  v_fma_f32 v84, v84, s35, -v16
  v_mfma_f32_16x16x32_bf16 v[152:155], a[172:175], v[48:51], 0
  v_exp_f32_e32 v84, v84
  v_mfma_f32_16x16x32_bf16 v[156:159], a[172:175], v[56:59], 0
  s_waitcnt lgkmcnt(4)
  ds_read_b64_tr_b16 a[192:193], v4 offset:256
  v_fma_f32 v85, v85, s35, -v16
  v_mfma_f32_16x16x32_bf16 v[160:163], a[176:179], v[32:35], 0
  v_exp_f32_e32 v85, v85
  v_mfma_f32_16x16x32_bf16 v[164:167], a[176:179], v[40:43], 0
  ds_read_b64_tr_b16 a[194:195], v4 offset:6400
  v_fma_f32 v86, v86, s35, -v16
  v_mfma_f32_16x16x32_bf16 v[168:171], a[176:179], v[48:51], 0
  v_exp_f32_e32 v86, v86
  v_mfma_f32_16x16x32_bf16 v[172:175], a[176:179], v[56:59], 0
  ds_read_b64_tr_b16 a[196:197], v5 offset:256
  v_fma_f32 v87, v87, s35, -v16
  v_mfma_f32_16x16x32_bf16 v[176:179], a[180:183], v[32:35], 0
  v_exp_f32_e32 v87, v87
  v_mfma_f32_16x16x32_bf16 v[180:183], a[180:183], v[40:43], 0
  ds_read_b64_tr_b16 a[198:199], v5 offset:6400
  v_add_f32_e32 v30, v30, v80
  v_mfma_f32_16x16x32_bf16 v[184:187], a[180:183], v[48:51], 0
  v_add_f32_e32 v30, v30, v81
  v_cvt_pk_bf16_f32 v80, v80, v81
  v_mfma_f32_16x16x32_bf16 v[188:191], a[180:183], v[56:59], 0
  s_waitcnt lgkmcnt(4)
  ds_read_b64_tr_b16 a[200:201], v6 offset:256
  v_add_f32_e32 v30, v30, v82
  v_mfma_f32_16x16x32_bf16 v[192:195], a[184:187], v[32:35], 0
  v_add_f32_e32 v30, v30, v83
  v_cvt_pk_bf16_f32 v81, v82, v83
  v_mfma_f32_16x16x32_bf16 v[196:199], a[184:187], v[40:43], 0
  ds_read_b64_tr_b16 a[202:203], v6 offset:6400
  v_cvt_pk_bf16_f32 v82, v84, v85
  v_mfma_f32_16x16x32_bf16 v[200:203], a[184:187], v[48:51], 0
  v_cvt_pk_bf16_f32 v83, v86, v87
  v_fma_f32 v88, v88, s35, -v17
  v_mfma_f32_16x16x32_bf16 v[204:207], a[184:187], v[56:59], 0
  ds_read_b64_tr_b16 a[204:205], v7 offset:256
  v_fma_f32 v89, v89, s35, -v17
  v_mfma_f32_16x16x32_bf16 v[208:211], a[188:191], v[32:35], 0
  v_exp_f32_e32 v88, v88
  v_mfma_f32_16x16x32_bf16 v[212:215], a[188:191], v[40:43], 0
  ds_read_b64_tr_b16 a[206:207], v7 offset:6400
  v_fma_f32 v90, v90, s35, -v17
  v_mfma_f32_16x16x32_bf16 v[216:219], a[188:191], v[48:51], 0
  v_exp_f32_e32 v89, v89
  v_mfma_f32_16x16x32_bf16 v[220:223], a[188:191], v[56:59], 0
  s_waitcnt lgkmcnt(4)
  ds_read_b128 a[160:163], v2 offset:24576
  v_fma_f32 v91, v91, s35, -v17
  v_mfma_f32_16x16x32_bf16 v[224:227], a[192:195], v[32:35], 0
  v_exp_f32_e32 v90, v90
  v_mfma_f32_16x16x32_bf16 v[228:231], a[192:195], v[40:43], 0
  ds_read_b128 a[164:167], v3 offset:24576
  v_fma_f32 v92, v92, s35, -v17
  v_mfma_f32_16x16x32_bf16 v[232:235], a[192:195], v[48:51], 0
  v_exp_f32_e32 v91, v91
  v_mfma_f32_16x16x32_bf16 v[236:239], a[192:195], v[56:59], 0
  ds_read_b128 a[168:171], v2 offset:24704
  v_fma_f32 v93, v93, s35, -v17
  v_mfma_f32_16x16x32_bf16 v[240:243], a[196:199], v[32:35], 0
  v_exp_f32_e32 v92, v92
  v_mfma_f32_16x16x32_bf16 v[244:247], a[196:199], v[40:43], 0
  ds_read_b128 a[172:175], v3 offset:24704
  v_fma_f32 v94, v94, s35, -v17
  v_mfma_f32_16x16x32_bf16 v[248:251], a[196:199], v[48:51], 0
  v_exp_f32_e32 v93, v93
  v_mfma_f32_16x16x32_bf16 v[252:255], a[196:199], v[56:59], 0
  s_waitcnt lgkmcnt(3)
  ds_read_b128 a[176:179], v2 offset:24832
  v_fma_f32 v95, v95, s35, -v17
  v_mfma_f32_16x16x32_bf16 a[0:3], a[200:203], v[32:35], 0
  v_exp_f32_e32 v94, v94
  v_mfma_f32_16x16x32_bf16 a[4:7], a[200:203], v[40:43], 0
  ds_read_b128 a[180:183], v3 offset:24832
  v_add_f32_e32 v31, v31, v88
  v_mfma_f32_16x16x32_bf16 a[8:11], a[200:203], v[48:51], 0
  v_exp_f32_e32 v95, v95
  v_mfma_f32_16x16x32_bf16 a[12:15], a[200:203], v[56:59], 0
  v_add_f32_e32 v31, v31, v89
  v_cvt_pk_bf16_f32 v88, v88, v89
  v_mfma_f32_16x16x32_bf16 a[16:19], a[204:207], v[32:35], 0
  v_add_f32_e32 v31, v31, v90
  v_add_f32_e32 v31, v31, v91
  v_mfma_f32_16x16x32_bf16 a[20:23], a[204:207], v[40:43], 0
  v_cvt_pk_bf16_f32 v89, v90, v91
  v_cvt_pk_bf16_f32 v90, v92, v93
  v_mfma_f32_16x16x32_bf16 a[24:27], a[204:207], v[48:51], 0
  v_cvt_pk_bf16_f32 v91, v94, v95
  v_add_f32_e32 v30, v30, v84
  v_mfma_f32_16x16x32_bf16 a[28:31], a[204:207], v[56:59], 0
  v_add_f32_e32 v30, v30, v85
  v_add_f32_e32 v30, v30, v86
  v_mfma_f32_16x16x32_bf16 v[32:35], a[160:163], a[32:35], 0
  s_waitcnt lgkmcnt(1)
  v_add_f32_e32 v30, v30, v87
  v_add_f32_e32 v31, v31, v92
  v_mfma_f32_16x16x32_bf16 v[32:35], a[164:167], a[36:39], v[32:35]
  v_add_f32_e32 v31, v31, v93
  v_add_f32_e32 v31, v31, v94
  v_mfma_f32_16x16x32_bf16 v[32:35], a[168:171], a[40:43], v[32:35]
  v_add_f32_e32 v31, v31, v95
  v_mfma_f32_16x16x32_bf16 v[32:35], a[172:175], a[44:47], v[32:35]
  v_mfma_f32_16x16x32_bf16 v[32:35], a[176:179], a[48:51], v[32:35]
  s_waitcnt lgkmcnt(0)
  v_mfma_f32_16x16x32_bf16 v[32:35], a[180:183], a[52:55], v[32:35]
  v_mfma_f32_16x16x32_bf16 v[40:43], a[160:163], a[56:59], 0
  v_mfma_f32_16x16x32_bf16 v[40:43], a[164:167], a[60:63], v[40:43]
  ds_read_b128 a[184:187], v2 offset:30720
  v_mfma_f32_16x16x32_bf16 v[40:43], a[168:171], a[64:67], v[40:43]
  v_mfma_f32_16x16x32_bf16 v[40:43], a[172:175], a[68:71], v[40:43]
  ds_read_b128 a[188:191], v3 offset:30720
  v_mfma_f32_16x16x32_bf16 v[40:43], a[176:179], a[72:75], v[40:43]
  s_nop 0
  v_fma_f32 v32, v32, s35, -v14
  v_fma_f32 v33, v33, s35, -v14
  v_mfma_f32_16x16x32_bf16 v[40:43], a[180:183], a[76:79], v[40:43]
  ds_read_b128 a[192:195], v2 offset:30848
  v_fma_f32 v34, v34, s35, -v14
  v_mfma_f32_16x16x32_bf16 v[48:51], a[160:163], a[80:83], 0
  v_exp_f32_e32 v32, v32
  v_mfma_f32_16x16x32_bf16 v[48:51], a[164:167], a[84:87], v[48:51]
  ds_read_b128 a[196:199], v3 offset:30848
  v_fma_f32 v35, v35, s35, -v14
  v_mfma_f32_16x16x32_bf16 v[48:51], a[168:171], a[88:91], v[48:51]
  v_exp_f32_e32 v33, v33
  v_mfma_f32_16x16x32_bf16 v[48:51], a[172:175], a[92:95], v[48:51]
  ds_read_b128 a[200:203], v2 offset:30976
  v_cvt_pk_bf16_f32 v32, v32, v33
  v_mfma_f32_16x16x32_bf16 v[48:51], a[176:179], a[96:99], v[48:51]
  v_exp_f32_e32 v34, v34
  v_mfma_f32_16x16x32_bf16 v[48:51], a[180:183], a[100:103], v[48:51]
  ds_read_b128 a[204:207], v3 offset:30976
  v_fma_f32 v40, v40, s35, -v15
  v_mfma_f32_16x16x32_bf16 v[56:59], a[160:163], a[104:107], 0
  s_waitcnt vmcnt(9)
  s_barrier
  v_mfma_f32_16x16x32_bf16 v[56:59], a[164:167], a[108:111], v[56:59]
  s_add_u32 m0, s34, 12288
  v_exp_f32_e32 v35, v35
  v_mfma_f32_16x16x32_bf16 v[56:59], a[168:171], a[112:115], v[56:59]
  s_mov_b32 s32, 61440
  v_exp_f32_e32 v40, v40
  v_mfma_f32_16x16x32_bf16 v[56:59], a[172:175], a[116:119], v[56:59]
  buffer_load_dwordx4 v8, s[8:11], s32 offen nt lds
  v_mfma_f32_16x16x32_bf16 v[56:59], a[176:179], a[120:123], v[56:59]
  v_cvt_pk_bf16_f32 v33, v34, v35
  v_fma_f32 v41, v41, s35, -v15
  v_mfma_f32_16x16x32_bf16 v[56:59], a[180:183], a[124:127], v[56:59]
  s_waitcnt lgkmcnt(1)
  v_exp_f32_e32 v41, v41
  v_mfma_f32_16x16x32_bf16 v[36:39], a[184:187], a[32:35], 0
  v_fma_f32 v42, v42, s35, -v15
  v_fma_f32 v43, v43, s35, -v15
  v_mfma_f32_16x16x32_bf16 v[36:39], a[188:191], a[36:39], v[36:39]
  v_exp_f32_e32 v42, v42
  v_mfma_f32_16x16x32_bf16 v[36:39], a[192:195], a[40:43], v[36:39]
  v_exp_f32_e32 v43, v43
  v_mfma_f32_16x16x32_bf16 v[36:39], a[196:199], a[44:47], v[36:39]
  v_add_f32_e32 v0, v0, v40
  v_add_f32_e32 v0, v0, v41
  v_mfma_f32_16x16x32_bf16 v[36:39], a[200:203], a[48:51], v[36:39]
  s_waitcnt lgkmcnt(0)
  v_cvt_pk_bf16_f32 v40, v40, v41
  v_add_f32_e32 v0, v0, v42
  v_mfma_f32_16x16x32_bf16 v[36:39], a[204:207], a[52:55], v[36:39]
  v_add_f32_e32 v0, v0, v43
  v_cvt_pk_bf16_f32 v41, v42, v43
  v_mfma_f32_16x16x32_bf16 v[44:47], a[184:187], a[56:59], 0
  v_fma_f32 v48, v48, s35, -v16
  v_fma_f32 v49, v49, s35, -v16
  v_mfma_f32_16x16x32_bf16 v[44:47], a[188:191], a[60:63], v[44:47]
  v_exp_f32_e32 v48, v48
  v_mfma_f32_16x16x32_bf16 v[44:47], a[192:195], a[64:67], v[44:47]
  ds_read_b64_tr_b16 a[160:161], v4 offset:12288
  v_fma_f32 v50, v50, s35, -v16
  v_mfma_f32_16x16x32_bf16 v[44:47], a[196:199], a[68:71], v[44:47]
  buffer_load_dwordx4 v9, s[8:11], s32 offen offset:1024 nt lds
  v_mfma_f32_16x16x32_bf16 v[44:47], a[200:203], a[72:75], v[44:47]
  ds_read_b64_tr_b16 a[162:163], v4 offset:18432
  v_fma_f32 v36, v36, s35, -v14
  v_mfma_f32_16x16x32_bf16 v[44:47], a[204:207], a[76:79], v[44:47]
  v_exp_f32_e32 v36, v36
  v_mfma_f32_16x16x32_bf16 v[52:55], a[184:187], a[80:83], 0
  ds_read_b64_tr_b16 a[164:165], v5 offset:12288
  v_fma_f32 v37, v37, s35, -v14
  v_mfma_f32_16x16x32_bf16 v[52:55], a[188:191], a[84:87], v[52:55]
  v_exp_f32_e32 v37, v37
  v_mfma_f32_16x16x32_bf16 v[52:55], a[192:195], a[88:91], v[52:55]
  ds_read_b64_tr_b16 a[166:167], v5 offset:18432
  v_fma_f32 v38, v38, s35, -v14
  v_mfma_f32_16x16x32_bf16 v[52:55], a[196:199], a[92:95], v[52:55]
  v_exp_f32_e32 v38, v38
  v_mfma_f32_16x16x32_bf16 v[52:55], a[200:203], a[96:99], v[52:55]
  ds_read_b64_tr_b16 a[168:169], v6 offset:12288
  v_fma_f32 v39, v39, s35, -v14
  v_mfma_f32_16x16x32_bf16 v[52:55], a[204:207], a[100:103], v[52:55]
  v_exp_f32_e32 v39, v39
  v_mfma_f32_16x16x32_bf16 v[60:63], a[184:187], a[104:107], 0
  ds_read_b64_tr_b16 a[170:171], v6 offset:18432
  v_cvt_pk_bf16_f32 v34, v36, v37
  v_mfma_f32_16x16x32_bf16 v[60:63], a[188:191], a[108:111], v[60:63]
  v_exp_f32_e32 v49, v49
  v_mfma_f32_16x16x32_bf16 v[60:63], a[192:195], a[112:115], v[60:63]
  ds_read_b64_tr_b16 a[172:173], v7 offset:12288
  v_cvt_pk_bf16_f32 v35, v38, v39
  v_mfma_f32_16x16x32_bf16 v[60:63], a[196:199], a[116:119], v[60:63]
  buffer_load_dwordx4 v10, s[8:11], s32 offen offset:2048 nt lds
  v_mfma_f32_16x16x32_bf16 v[60:63], a[200:203], a[120:123], v[60:63]
  ds_read_b64_tr_b16 a[174:175], v7 offset:18432
  v_fma_f32 v44, v44, s35, -v15
  v_mfma_f32_16x16x32_bf16 v[60:63], a[204:207], a[124:127], v[60:63]
  v_exp_f32_e32 v44, v44
  v_mfma_f32_16x16x32_bf16 a[240:243], v[18:21], v[64:67], a[240:243]
  s_waitcnt lgkmcnt(4)
  ds_read_b64_tr_b16 a[176:177], v4 offset:12416
  v_fma_f32 v45, v45, s35, -v15
  v_mfma_f32_16x16x32_bf16 v[96:99], a[160:163], v[64:67], v[96:99]
  v_exp_f32_e32 v45, v45
  v_mfma_f32_16x16x32_bf16 v[100:103], a[160:163], v[72:75], v[100:103]
  ds_read_b64_tr_b16 a[178:179], v4 offset:18560
  v_fma_f32 v46, v46, s35, -v15
  v_mfma_f32_16x16x32_bf16 v[104:107], a[160:163], v[80:83], v[104:107]
  v_exp_f32_e32 v46, v46
  v_mfma_f32_16x16x32_bf16 v[108:111], a[160:163], v[88:91], v[108:111]
  ds_read_b64_tr_b16 a[180:181], v5 offset:12416
  v_fma_f32 v47, v47, s35, -v15
  v_mfma_f32_16x16x32_bf16 v[112:115], a[164:167], v[64:67], v[112:115]
  v_exp_f32_e32 v47, v47
  v_mfma_f32_16x16x32_bf16 v[116:119], a[164:167], v[72:75], v[116:119]
  ds_read_b64_tr_b16 a[182:183], v5 offset:18560
  v_cvt_pk_bf16_f32 v42, v44, v45
  v_mfma_f32_16x16x32_bf16 v[120:123], a[164:167], v[80:83], v[120:123]
  s_add_u32 m0, s34, 49152
  v_exp_f32_e32 v50, v50
  v_mfma_f32_16x16x32_bf16 v[124:127], a[164:167], v[88:91], v[124:127]
  s_waitcnt lgkmcnt(4)
  ds_read_b64_tr_b16 a[184:185], v6 offset:12416
  v_cvt_pk_bf16_f32 v43, v46, v47
  v_mfma_f32_16x16x32_bf16 v[128:131], a[168:171], v[64:67], v[128:131]
  s_mov_b32 s33, 49152
  v_fma_f32 v51, v51, s35, -v16
  v_fma_f32 v52, v52, s35, -v16
  v_mfma_f32_16x16x32_bf16 v[132:135], a[168:171], v[72:75], v[132:135]
  ds_read_b64_tr_b16 a[186:187], v6 offset:18560
  v_fma_f32 v53, v53, s35, -v16
  v_mfma_f32_16x16x32_bf16 v[136:139], a[168:171], v[80:83], v[136:139]
  buffer_load_dwordx4 v8, s[12:15], s33 offen nt lds
  v_mfma_f32_16x16x32_bf16 v[140:143], a[168:171], v[88:91], v[140:143]
  ds_read_b64_tr_b16 a[188:189], v7 offset:12416
  v_fma_f32 v54, v54, s35, -v16
  v_mfma_f32_16x16x32_bf16 v[144:147], a[172:175], v[64:67], v[144:147]
  v_exp_f32_e32 v51, v51
  v_mfma_f32_16x16x32_bf16 v[148:151], a[172:175], v[72:75], v[148:151]
  ds_read_b64_tr_b16 a[190:191], v7 offset:18560
  v_fma_f32 v55, v55, s35, -v16
  v_mfma_f32_16x16x32_bf16 v[152:155], a[172:175], v[80:83], v[152:155]
  v_exp_f32_e32 v52, v52
  v_mfma_f32_16x16x32_bf16 v[156:159], a[172:175], v[88:91], v[156:159]
  s_waitcnt lgkmcnt(4)
  ds_read_b64_tr_b16 a[192:193], v4 offset:12544
  v_add_f32_e32 v30, v30, v48
  v_mfma_f32_16x16x32_bf16 v[160:163], a[176:179], v[64:67], v[160:163]
  v_exp_f32_e32 v53, v53
  v_mfma_f32_16x16x32_bf16 v[164:167], a[176:179], v[72:75], v[164:167]
  ds_read_b64_tr_b16 a[194:195], v4 offset:18688
  v_add_f32_e32 v30, v30, v49
  v_mfma_f32_16x16x32_bf16 v[168:171], a[176:179], v[80:83], v[168:171]
  v_exp_f32_e32 v54, v54
  v_mfma_f32_16x16x32_bf16 v[172:175], a[176:179], v[88:91], v[172:175]
  ds_read_b64_tr_b16 a[196:197], v5 offset:12544
  v_cvt_pk_bf16_f32 v48, v48, v49
  v_mfma_f32_16x16x32_bf16 v[176:179], a[180:183], v[64:67], v[176:179]
  v_exp_f32_e32 v55, v55
  v_mfma_f32_16x16x32_bf16 v[180:183], a[180:183], v[72:75], v[180:183]
  ds_read_b64_tr_b16 a[198:199], v5 offset:18688
  v_add_f32_e32 v30, v30, v50
  v_mfma_f32_16x16x32_bf16 v[184:187], a[180:183], v[80:83], v[184:187]
  buffer_load_dwordx4 v9, s[12:15], s33 offen offset:1024 nt lds
  v_mfma_f32_16x16x32_bf16 v[188:191], a[180:183], v[88:91], v[188:191]
  s_waitcnt lgkmcnt(4)
  ds_read_b64_tr_b16 a[200:201], v6 offset:12544
  v_add_f32_e32 v30, v30, v51
  v_mfma_f32_16x16x32_bf16 v[192:195], a[184:187], v[64:67], v[192:195]
  v_cvt_pk_bf16_f32 v49, v50, v51
  v_cvt_pk_bf16_f32 v50, v52, v53
  v_mfma_f32_16x16x32_bf16 v[196:199], a[184:187], v[72:75], v[196:199]
  ds_read_b64_tr_b16 a[202:203], v6 offset:18688
  v_cvt_pk_bf16_f32 v51, v54, v55
  v_mfma_f32_16x16x32_bf16 v[200:203], a[184:187], v[80:83], v[200:203]
  v_fma_f32 v56, v56, s35, -v17
  v_fma_f32 v57, v57, s35, -v17
  v_mfma_f32_16x16x32_bf16 v[204:207], a[184:187], v[88:91], v[204:207]
  ds_read_b64_tr_b16 a[204:205], v7 offset:12544
  v_fma_f32 v58, v58, s35, -v17
  v_mfma_f32_16x16x32_bf16 v[208:211], a[188:191], v[64:67], v[208:211]
  v_exp_f32_e32 v56, v56
  v_mfma_f32_16x16x32_bf16 v[212:215], a[188:191], v[72:75], v[212:215]
  ds_read_b64_tr_b16 a[206:207], v7 offset:18688
  v_fma_f32 v59, v59, s35, -v17
  v_mfma_f32_16x16x32_bf16 v[216:219], a[188:191], v[80:83], v[216:219]
  v_exp_f32_e32 v57, v57
  v_mfma_f32_16x16x32_bf16 v[220:223], a[188:191], v[88:91], v[220:223]
  s_waitcnt lgkmcnt(4)
  ds_read_b128 a[160:163], v2 offset:36864
  v_fma_f32 v60, v60, s35, -v17
  v_mfma_f32_16x16x32_bf16 v[224:227], a[192:195], v[64:67], v[224:227]
  v_exp_f32_e32 v58, v58
  v_mfma_f32_16x16x32_bf16 v[228:231], a[192:195], v[72:75], v[228:231]
  ds_read_b128 a[164:167], v3 offset:36864
  v_fma_f32 v61, v61, s35, -v17
  v_mfma_f32_16x16x32_bf16 v[232:235], a[192:195], v[80:83], v[232:235]
  buffer_load_dwordx4 v10, s[12:15], s33 offen offset:2048 nt lds
  v_mfma_f32_16x16x32_bf16 v[236:239], a[192:195], v[88:91], v[236:239]
  ds_read_b128 a[168:171], v2 offset:36992
  v_fma_f32 v62, v62, s35, -v17
  v_mfma_f32_16x16x32_bf16 v[240:243], a[196:199], v[64:67], v[240:243]
  v_exp_f32_e32 v59, v59
  v_mfma_f32_16x16x32_bf16 v[244:247], a[196:199], v[72:75], v[244:247]
  ds_read_b128 a[172:175], v3 offset:36992
  v_fma_f32 v63, v63, s35, -v17
  v_mfma_f32_16x16x32_bf16 v[248:251], a[196:199], v[80:83], v[248:251]
  v_exp_f32_e32 v60, v60
  v_mfma_f32_16x16x32_bf16 v[252:255], a[196:199], v[88:91], v[252:255]
  s_waitcnt lgkmcnt(3)
  ds_read_b128 a[176:179], v2 offset:37120
  v_add_f32_e32 v31, v31, v56
  v_mfma_f32_16x16x32_bf16 a[0:3], a[200:203], v[64:67], a[0:3]
  v_exp_f32_e32 v61, v61
  v_mfma_f32_16x16x32_bf16 a[4:7], a[200:203], v[72:75], a[4:7]
  ds_read_b128 a[180:183], v3 offset:37120
  v_add_f32_e32 v31, v31, v57
  v_mfma_f32_16x16x32_bf16 a[8:11], a[200:203], v[80:83], a[8:11]
  v_exp_f32_e32 v62, v62
  v_mfma_f32_16x16x32_bf16 a[12:15], a[200:203], v[88:91], a[12:15]
  v_exp_f32_e32 v63, v63
  v_mfma_f32_16x16x32_bf16 a[16:19], a[204:207], v[64:67], a[16:19]
  v_cvt_pk_bf16_f32 v56, v56, v57
  v_add_f32_e32 v31, v31, v58
  v_mfma_f32_16x16x32_bf16 a[20:23], a[204:207], v[72:75], a[20:23]
  s_add_u32 m0, s28, 0xffffff00
  v_add_f32_e32 v31, v31, v59
  v_cvt_pk_bf16_f32 v57, v58, v59
  v_mfma_f32_16x16x32_bf16 a[24:27], a[204:207], v[80:83], a[24:27]
  buffer_load_dwordx4 v11, s[24:27], s84 offen offset:256 nt lds
  v_mfma_f32_16x16x32_bf16 a[28:31], a[204:207], v[88:91], a[28:31]
  v_cvt_pk_bf16_f32 v58, v60, v61
  v_cvt_pk_bf16_f32 v59, v62, v63
  v_mfma_f32_16x16x32_bf16 v[64:67], a[160:163], a[32:35], 0
  s_waitcnt lgkmcnt(1)
  v_add_f32_e32 v0, v0, v44
  v_add_f32_e32 v0, v0, v45
  v_mfma_f32_16x16x32_bf16 v[64:67], a[164:167], a[36:39], v[64:67]
  v_add_f32_e32 v0, v0, v46
  v_add_f32_e32 v0, v0, v47
  v_mfma_f32_16x16x32_bf16 v[64:67], a[168:171], a[40:43], v[64:67]
  v_add_f32_e32 v30, v30, v52
  v_add_f32_e32 v30, v30, v53
  v_mfma_f32_16x16x32_bf16 v[64:67], a[172:175], a[44:47], v[64:67]
  v_add_f32_e32 v30, v30, v54
  v_add_f32_e32 v30, v30, v55
  v_mfma_f32_16x16x32_bf16 v[64:67], a[176:179], a[48:51], v[64:67]
  s_waitcnt lgkmcnt(0)
  v_add_f32_e32 v31, v31, v60
  v_add_f32_e32 v31, v31, v61
  v_mfma_f32_16x16x32_bf16 v[64:67], a[180:183], a[52:55], v[64:67]
  v_add_f32_e32 v31, v31, v62
  v_add_f32_e32 v31, v31, v63
  v_mfma_f32_16x16x32_bf16 v[72:75], a[160:163], a[56:59], 0
  v_mfma_f32_16x16x32_bf16 v[72:75], a[164:167], a[60:63], v[72:75]
  ds_read_b128 a[184:187], v2 offset:43008
  v_mfma_f32_16x16x32_bf16 v[72:75], a[168:171], a[64:67], v[72:75]
  v_mfma_f32_16x16x32_bf16 v[72:75], a[172:175], a[68:71], v[72:75]
  s_add_u32 m0, s28, 0xfffff700
  ds_read_b128 a[188:191], v3 offset:43008
  v_mfma_f32_16x16x32_bf16 v[72:75], a[176:179], a[72:75], v[72:75]
  buffer_load_dwordx4 v11, s[24:27], s84 offen offset:3328 nt lds
  v_mfma_f32_16x16x32_bf16 v[72:75], a[180:183], a[76:79], v[72:75]
  ds_read_b128 a[192:195], v2 offset:43136
  v_fma_f32 v64, v64, s35, -v14
  v_mfma_f32_16x16x32_bf16 v[80:83], a[160:163], a[80:83], 0
  v_exp_f32_e32 v64, v64
  v_mfma_f32_16x16x32_bf16 v[80:83], a[164:167], a[84:87], v[80:83]
  ds_read_b128 a[196:199], v3 offset:43136
  v_fma_f32 v65, v65, s35, -v14
  v_mfma_f32_16x16x32_bf16 v[80:83], a[168:171], a[88:91], v[80:83]
  v_exp_f32_e32 v65, v65
  v_mfma_f32_16x16x32_bf16 v[80:83], a[172:175], a[92:95], v[80:83]
  ds_read_b128 a[200:203], v2 offset:43264
  v_fma_f32 v66, v66, s35, -v14
  v_mfma_f32_16x16x32_bf16 v[80:83], a[176:179], a[96:99], v[80:83]
  v_exp_f32_e32 v66, v66
  v_mfma_f32_16x16x32_bf16 v[80:83], a[180:183], a[100:103], v[80:83]
  ds_read_b128 a[204:207], v3 offset:43264
  v_fma_f32 v67, v67, s35, -v14
  v_mfma_f32_16x16x32_bf16 v[88:91], a[160:163], a[104:107], 0
  s_waitcnt vmcnt(11)
  s_barrier
  v_mfma_f32_16x16x32_bf16 v[88:91], a[164:167], a[108:111], v[88:91]
  v_exp_f32_e32 v67, v67
  v_mfma_f32_16x16x32_bf16 v[88:91], a[168:171], a[112:115], v[88:91]
  s_add_u32 m0, s34, 24576
  v_cvt_pk_bf16_f32 v64, v64, v65
  v_cvt_pk_bf16_f32 v65, v66, v67
  v_mfma_f32_16x16x32_bf16 v[88:91], a[172:175], a[116:119], v[88:91]
  s_mov_b32 s32, 73728
  v_fma_f32 v72, v72, s35, -v15
  v_fma_f32 v73, v73, s35, -v15
  v_mfma_f32_16x16x32_bf16 v[88:91], a[176:179], a[120:123], v[88:91]
  buffer_load_dwordx4 v8, s[8:11], s32 offen nt lds
  v_mfma_f32_16x16x32_bf16 v[88:91], a[180:183], a[124:127], v[88:91]
  s_waitcnt lgkmcnt(1)
  v_exp_f32_e32 v72, v72
  v_mfma_f32_16x16x32_bf16 v[68:71], a[184:187], a[32:35], 0
  v_exp_f32_e32 v73, v73
  v_mfma_f32_16x16x32_bf16 v[68:71], a[188:191], a[36:39], v[68:71]
  v_fma_f32 v74, v74, s35, -v15
  v_fma_f32 v75, v75, s35, -v15
  v_mfma_f32_16x16x32_bf16 v[68:71], a[192:195], a[40:43], v[68:71]
  v_exp_f32_e32 v74, v74
  v_mfma_f32_16x16x32_bf16 v[68:71], a[196:199], a[44:47], v[68:71]
  v_exp_f32_e32 v75, v75
  v_mfma_f32_16x16x32_bf16 v[68:71], a[200:203], a[48:51], v[68:71]
  s_waitcnt lgkmcnt(0)
  v_add_f32_e32 v0, v0, v72
  v_add_f32_e32 v0, v0, v73
  v_mfma_f32_16x16x32_bf16 v[68:71], a[204:207], a[52:55], v[68:71]
  v_cvt_pk_bf16_f32 v72, v72, v73
  v_add_f32_e32 v0, v0, v74
  v_mfma_f32_16x16x32_bf16 v[76:79], a[184:187], a[56:59], 0
  v_add_f32_e32 v0, v0, v75
  v_cvt_pk_bf16_f32 v73, v74, v75
  v_mfma_f32_16x16x32_bf16 v[76:79], a[188:191], a[60:63], v[76:79]
  v_fma_f32 v80, v80, s35, -v16
  v_fma_f32 v81, v81, s35, -v16
  v_mfma_f32_16x16x32_bf16 v[76:79], a[192:195], a[64:67], v[76:79]
  ds_read_b64_tr_b16 a[160:161], v4 offset:24576
  v_fma_f32 v82, v82, s35, -v16
  v_mfma_f32_16x16x32_bf16 v[76:79], a[196:199], a[68:71], v[76:79]
  v_exp_f32_e32 v80, v80
  v_mfma_f32_16x16x32_bf16 v[76:79], a[200:203], a[72:75], v[76:79]
  ds_read_b64_tr_b16 a[162:163], v4 offset:30720
  v_fma_f32 v68, v68, s35, -v14
  v_mfma_f32_16x16x32_bf16 v[76:79], a[204:207], a[76:79], v[76:79]
  buffer_load_dwordx4 v9, s[8:11], s32 offen offset:1024 nt lds
  v_mfma_f32_16x16x32_bf16 v[84:87], a[184:187], a[80:83], 0
  ds_read_b64_tr_b16 a[164:165], v5 offset:24576
  v_fma_f32 v69, v69, s35, -v14
  v_mfma_f32_16x16x32_bf16 v[84:87], a[188:191], a[84:87], v[84:87]
  v_exp_f32_e32 v68, v68
  v_mfma_f32_16x16x32_bf16 v[84:87], a[192:195], a[88:91], v[84:87]
  ds_read_b64_tr_b16 a[166:167], v5 offset:30720
  v_fma_f32 v70, v70, s35, -v14
  v_mfma_f32_16x16x32_bf16 v[84:87], a[196:199], a[92:95], v[84:87]
  v_exp_f32_e32 v69, v69
  v_mfma_f32_16x16x32_bf16 v[84:87], a[200:203], a[96:99], v[84:87]
  ds_read_b64_tr_b16 a[168:169], v6 offset:24576
  v_fma_f32 v71, v71, s35, -v14
  v_mfma_f32_16x16x32_bf16 v[84:87], a[204:207], a[100:103], v[84:87]
  v_exp_f32_e32 v70, v70
  v_mfma_f32_16x16x32_bf16 v[92:95], a[184:187], a[104:107], 0
  ds_read_b64_tr_b16 a[170:171], v6 offset:30720
  v_cvt_pk_bf16_f32 v66, v68, v69
  v_mfma_f32_16x16x32_bf16 v[92:95], a[188:191], a[108:111], v[92:95]
  v_exp_f32_e32 v71, v71
  v_mfma_f32_16x16x32_bf16 v[92:95], a[192:195], a[112:115], v[92:95]
  ds_read_b64_tr_b16 a[172:173], v7 offset:24576
  v_cvt_pk_bf16_f32 v67, v70, v71
  v_mfma_f32_16x16x32_bf16 v[92:95], a[196:199], a[116:119], v[92:95]
  v_exp_f32_e32 v81, v81
  v_mfma_f32_16x16x32_bf16 v[92:95], a[200:203], a[120:123], v[92:95]
  ds_read_b64_tr_b16 a[174:175], v7 offset:30720
  v_fma_f32 v76, v76, s35, -v15
  v_mfma_f32_16x16x32_bf16 v[92:95], a[204:207], a[124:127], v[92:95]
  buffer_load_dwordx4 v10, s[8:11], s32 offen offset:2048 nt lds
  v_mfma_f32_16x16x32_bf16 a[240:243], v[18:21], v[32:35], a[240:243]
  s_waitcnt lgkmcnt(4)
  ds_read_b64_tr_b16 a[176:177], v4 offset:24704
  v_fma_f32 v77, v77, s35, -v15
  v_mfma_f32_16x16x32_bf16 v[96:99], a[160:163], v[32:35], v[96:99]
  v_exp_f32_e32 v76, v76
  v_mfma_f32_16x16x32_bf16 v[100:103], a[160:163], v[40:43], v[100:103]
  ds_read_b64_tr_b16 a[178:179], v4 offset:30848
  v_fma_f32 v78, v78, s35, -v15
  v_mfma_f32_16x16x32_bf16 v[104:107], a[160:163], v[48:51], v[104:107]
  v_exp_f32_e32 v77, v77
  v_mfma_f32_16x16x32_bf16 v[108:111], a[160:163], v[56:59], v[108:111]
  ds_read_b64_tr_b16 a[180:181], v5 offset:24704
  v_fma_f32 v79, v79, s35, -v15
  v_mfma_f32_16x16x32_bf16 v[112:115], a[164:167], v[32:35], v[112:115]
  v_exp_f32_e32 v78, v78
  v_mfma_f32_16x16x32_bf16 v[116:119], a[164:167], v[40:43], v[116:119]
  ds_read_b64_tr_b16 a[182:183], v5 offset:30848
  v_cvt_pk_bf16_f32 v74, v76, v77
  v_mfma_f32_16x16x32_bf16 v[120:123], a[164:167], v[48:51], v[120:123]
  v_exp_f32_e32 v79, v79
  v_mfma_f32_16x16x32_bf16 v[124:127], a[164:167], v[56:59], v[124:127]
  s_waitcnt lgkmcnt(4)
  ds_read_b64_tr_b16 a[184:185], v6 offset:24704
  v_cvt_pk_bf16_f32 v75, v78, v79
  v_mfma_f32_16x16x32_bf16 v[128:131], a[168:171], v[32:35], v[128:131]
  s_add_u32 m0, s34, 61440
  v_exp_f32_e32 v82, v82
  v_mfma_f32_16x16x32_bf16 v[132:135], a[168:171], v[40:43], v[132:135]
  s_mov_b32 s33, 61440
  ds_read_b64_tr_b16 a[186:187], v6 offset:30848
  v_fma_f32 v83, v83, s35, -v16
  v_mfma_f32_16x16x32_bf16 v[136:139], a[168:171], v[48:51], v[136:139]
  buffer_load_dwordx4 v8, s[12:15], s33 offen nt lds
  v_mfma_f32_16x16x32_bf16 v[140:143], a[168:171], v[56:59], v[140:143]
  ds_read_b64_tr_b16 a[188:189], v7 offset:24704
  v_fma_f32 v84, v84, s35, -v16
  v_mfma_f32_16x16x32_bf16 v[144:147], a[172:175], v[32:35], v[144:147]
  v_exp_f32_e32 v83, v83
  v_mfma_f32_16x16x32_bf16 v[148:151], a[172:175], v[40:43], v[148:151]
  ds_read_b64_tr_b16 a[190:191], v7 offset:30848
  v_fma_f32 v85, v85, s35, -v16
  v_mfma_f32_16x16x32_bf16 v[152:155], a[172:175], v[48:51], v[152:155]
  v_exp_f32_e32 v84, v84
  v_mfma_f32_16x16x32_bf16 v[156:159], a[172:175], v[56:59], v[156:159]
  s_waitcnt lgkmcnt(4)
  ds_read_b64_tr_b16 a[192:193], v4 offset:24832
  v_fma_f32 v86, v86, s35, -v16
  v_mfma_f32_16x16x32_bf16 v[160:163], a[176:179], v[32:35], v[160:163]
  v_exp_f32_e32 v85, v85
  v_mfma_f32_16x16x32_bf16 v[164:167], a[176:179], v[40:43], v[164:167]
  ds_read_b64_tr_b16 a[194:195], v4 offset:30976
  v_fma_f32 v87, v87, s35, -v16
  v_mfma_f32_16x16x32_bf16 v[168:171], a[176:179], v[48:51], v[168:171]
  v_exp_f32_e32 v86, v86
  v_mfma_f32_16x16x32_bf16 v[172:175], a[176:179], v[56:59], v[172:175]
  ds_read_b64_tr_b16 a[196:197], v5 offset:24832
  v_add_f32_e32 v30, v30, v80
  v_mfma_f32_16x16x32_bf16 v[176:179], a[180:183], v[32:35], v[176:179]
  v_exp_f32_e32 v87, v87
  v_mfma_f32_16x16x32_bf16 v[180:183], a[180:183], v[40:43], v[180:183]
  ds_read_b64_tr_b16 a[198:199], v5 offset:30976
  v_add_f32_e32 v30, v30, v81
  v_mfma_f32_16x16x32_bf16 v[184:187], a[180:183], v[48:51], v[184:187]
  buffer_load_dwordx4 v9, s[12:15], s33 offen offset:1024 nt lds
  v_mfma_f32_16x16x32_bf16 v[188:191], a[180:183], v[56:59], v[188:191]
  s_waitcnt lgkmcnt(4)
  ds_read_b64_tr_b16 a[200:201], v6 offset:24832
  v_cvt_pk_bf16_f32 v80, v80, v81
L_hop1:
  s_cbranch_execz L_hop5
  v_mfma_f32_16x16x32_bf16 v[192:195], a[184:187], v[32:35], v[192:195]
  v_add_f32_e32 v30, v30, v82
  v_add_f32_e32 v30, v30, v83
  v_mfma_f32_16x16x32_bf16 v[196:199], a[184:187], v[40:43], v[196:199]
  ds_read_b64_tr_b16 a[202:203], v6 offset:30976
  v_cvt_pk_bf16_f32 v81, v82, v83
  v_mfma_f32_16x16x32_bf16 v[200:203], a[184:187], v[48:51], v[200:203]
  v_cvt_pk_bf16_f32 v82, v84, v85
  v_cvt_pk_bf16_f32 v83, v86, v87
  v_mfma_f32_16x16x32_bf16 v[204:207], a[184:187], v[56:59], v[204:207]
  ds_read_b64_tr_b16 a[204:205], v7 offset:24832
  v_fma_f32 v88, v88, s35, -v17
  v_mfma_f32_16x16x32_bf16 v[208:211], a[188:191], v[32:35], v[208:211]
  v_exp_f32_e32 v88, v88
  v_mfma_f32_16x16x32_bf16 v[212:215], a[188:191], v[40:43], v[212:215]
  ds_read_b64_tr_b16 a[206:207], v7 offset:30976
  v_fma_f32 v89, v89, s35, -v17
  v_mfma_f32_16x16x32_bf16 v[216:219], a[188:191], v[48:51], v[216:219]
  v_exp_f32_e32 v89, v89
  v_mfma_f32_16x16x32_bf16 v[220:223], a[188:191], v[56:59], v[220:223]
  s_waitcnt lgkmcnt(4)
  ds_read_b128 a[160:163], v2 offset:0
  v_fma_f32 v90, v90, s35, -v17
  v_mfma_f32_16x16x32_bf16 v[224:227], a[192:195], v[32:35], v[224:227]
  v_exp_f32_e32 v90, v90
  v_mfma_f32_16x16x32_bf16 v[228:231], a[192:195], v[40:43], v[228:231]
  ds_read_b128 a[164:167], v3 offset:0
  v_fma_f32 v91, v91, s35, -v17
  v_mfma_f32_16x16x32_bf16 v[232:235], a[192:195], v[48:51], v[232:235]
  buffer_load_dwordx4 v10, s[12:15], s33 offen offset:2048 nt lds
  v_mfma_f32_16x16x32_bf16 v[236:239], a[192:195], v[56:59], v[236:239]
  ds_read_b128 a[168:171], v2 offset:128
  v_fma_f32 v92, v92, s35, -v17
  v_mfma_f32_16x16x32_bf16 v[240:243], a[196:199], v[32:35], v[240:243]
  v_exp_f32_e32 v91, v91
  v_mfma_f32_16x16x32_bf16 v[244:247], a[196:199], v[40:43], v[244:247]
  ds_read_b128 a[172:175], v3 offset:128
  v_fma_f32 v93, v93, s35, -v17
  v_mfma_f32_16x16x32_bf16 v[248:251], a[196:199], v[48:51], v[248:251]
  v_exp_f32_e32 v92, v92
  v_mfma_f32_16x16x32_bf16 v[252:255], a[196:199], v[56:59], v[252:255]
  s_waitcnt lgkmcnt(3)
  ds_read_b128 a[176:179], v2 offset:256
  v_fma_f32 v94, v94, s35, -v17
  v_mfma_f32_16x16x32_bf16 a[0:3], a[200:203], v[32:35], a[0:3]
  v_exp_f32_e32 v93, v93
  v_mfma_f32_16x16x32_bf16 a[4:7], a[200:203], v[40:43], a[4:7]
  ds_read_b128 a[180:183], v3 offset:256
  v_fma_f32 v95, v95, s35, -v17
  v_mfma_f32_16x16x32_bf16 a[8:11], a[200:203], v[48:51], a[8:11]
  v_exp_f32_e32 v94, v94
  v_mfma_f32_16x16x32_bf16 a[12:15], a[200:203], v[56:59], a[12:15]
  v_exp_f32_e32 v95, v95
  v_mfma_f32_16x16x32_bf16 a[16:19], a[204:207], v[32:35], a[16:19]
  v_add_f32_e32 v31, v31, v88
  v_add_f32_e32 v31, v31, v89
  v_mfma_f32_16x16x32_bf16 a[20:23], a[204:207], v[40:43], a[20:23]
  s_add_u32 m0, s28, 1792
  v_cvt_pk_bf16_f32 v88, v88, v89
  v_add_f32_e32 v31, v31, v90
  v_mfma_f32_16x16x32_bf16 a[24:27], a[204:207], v[48:51], a[24:27]
  buffer_load_dwordx4 v11, s[24:27], s85 offen offset:256 nt lds
  v_mfma_f32_16x16x32_bf16 a[28:31], a[204:207], v[56:59], a[28:31]
  v_add_f32_e32 v31, v31, v91
  v_cvt_pk_bf16_f32 v89, v90, v91
  v_mfma_f32_16x16x32_bf16 v[32:35], a[160:163], a[32:35], 0
  s_waitcnt lgkmcnt(1)
  v_cvt_pk_bf16_f32 v90, v92, v93
  v_cvt_pk_bf16_f32 v91, v94, v95
  v_mfma_f32_16x16x32_bf16 v[32:35], a[164:167], a[36:39], v[32:35]
  v_add_f32_e32 v0, v0, v76
  v_add_f32_e32 v0, v0, v77
  v_mfma_f32_16x16x32_bf16 v[32:35], a[168:171], a[40:43], v[32:35]
  v_add_f32_e32 v0, v0, v78
  v_add_f32_e32 v0, v0, v79
  v_mfma_f32_16x16x32_bf16 v[32:35], a[172:175], a[44:47], v[32:35]
  v_add_f32_e32 v30, v30, v84
  v_add_f32_e32 v30, v30, v85
  v_mfma_f32_16x16x32_bf16 v[32:35], a[176:179], a[48:51], v[32:35]
  s_waitcnt lgkmcnt(0)
  v_add_f32_e32 v30, v30, v86
  v_add_f32_e32 v30, v30, v87
  v_mfma_f32_16x16x32_bf16 v[32:35], a[180:183], a[52:55], v[32:35]
  v_add_f32_e32 v31, v31, v92
  v_add_f32_e32 v31, v31, v93
  v_mfma_f32_16x16x32_bf16 v[40:43], a[160:163], a[56:59], 0
  v_add_f32_e32 v31, v31, v94
  v_add_f32_e32 v31, v31, v95
  v_mfma_f32_16x16x32_bf16 v[40:43], a[164:167], a[60:63], v[40:43]
  ds_read_b128 a[184:187], v2 offset:6144
  v_mfma_f32_16x16x32_bf16 v[40:43], a[168:171], a[64:67], v[40:43]
  v_mfma_f32_16x16x32_bf16 v[40:43], a[172:175], a[68:71], v[40:43]
  s_add_u32 m0, s28, 0xffffff00
  ds_read_b128 a[188:191], v3 offset:6144
  v_mfma_f32_16x16x32_bf16 v[40:43], a[176:179], a[72:75], v[40:43]
  buffer_load_dwordx4 v11, s[24:27], s85 offen offset:3328 nt lds
  v_mfma_f32_16x16x32_bf16 v[40:43], a[180:183], a[76:79], v[40:43]
  ds_read_b128 a[192:195], v2 offset:6272
  v_fma_f32 v32, v32, s35, -v14
  v_mfma_f32_16x16x32_bf16 v[48:51], a[160:163], a[80:83], 0
  v_exp_f32_e32 v32, v32
  v_mfma_f32_16x16x32_bf16 v[48:51], a[164:167], a[84:87], v[48:51]
  ds_read_b128 a[196:199], v3 offset:6272
  v_fma_f32 v33, v33, s35, -v14
  v_mfma_f32_16x16x32_bf16 v[48:51], a[168:171], a[88:91], v[48:51]
  v_exp_f32_e32 v33, v33
  v_mfma_f32_16x16x32_bf16 v[48:51], a[172:175], a[92:95], v[48:51]
  ds_read_b128 a[200:203], v2 offset:6400
  v_fma_f32 v34, v34, s35, -v14
  v_mfma_f32_16x16x32_bf16 v[48:51], a[176:179], a[96:99], v[48:51]
  v_exp_f32_e32 v34, v34
  v_mfma_f32_16x16x32_bf16 v[48:51], a[180:183], a[100:103], v[48:51]
  ds_read_b128 a[204:207], v3 offset:6400
  v_fma_f32 v35, v35, s35, -v14
  v_mfma_f32_16x16x32_bf16 v[56:59], a[160:163], a[104:107], 0
  s_waitcnt vmcnt(13)
  s_barrier
  v_mfma_f32_16x16x32_bf16 v[56:59], a[164:167], a[108:111], v[56:59]
  v_exp_f32_e32 v35, v35
  v_mfma_f32_16x16x32_bf16 v[56:59], a[168:171], a[112:115], v[56:59]
  s_add_u32 m0, s34, 36864
  v_cvt_pk_bf16_f32 v32, v32, v33
  v_cvt_pk_bf16_f32 v33, v34, v35
  v_mfma_f32_16x16x32_bf16 v[56:59], a[172:175], a[116:119], v[56:59]
  s_mov_b32 s32, 86016
  v_fma_f32 v40, v40, s35, -v15
  v_fma_f32 v41, v41, s35, -v15
  v_mfma_f32_16x16x32_bf16 v[56:59], a[176:179], a[120:123], v[56:59]
  buffer_load_dwordx4 v8, s[8:11], s32 offen nt lds
  v_mfma_f32_16x16x32_bf16 v[56:59], a[180:183], a[124:127], v[56:59]
  s_waitcnt lgkmcnt(1)
  v_exp_f32_e32 v40, v40
  v_mfma_f32_16x16x32_bf16 v[36:39], a[184:187], a[32:35], 0
  v_exp_f32_e32 v41, v41
  v_mfma_f32_16x16x32_bf16 v[36:39], a[188:191], a[36:39], v[36:39]
  v_fma_f32 v42, v42, s35, -v15
  v_fma_f32 v43, v43, s35, -v15
  v_mfma_f32_16x16x32_bf16 v[36:39], a[192:195], a[40:43], v[36:39]
  v_exp_f32_e32 v42, v42
  v_mfma_f32_16x16x32_bf16 v[36:39], a[196:199], a[44:47], v[36:39]
  v_exp_f32_e32 v43, v43
  v_mfma_f32_16x16x32_bf16 v[36:39], a[200:203], a[48:51], v[36:39]
  s_waitcnt lgkmcnt(0)
  v_add_f32_e32 v0, v0, v40
  v_add_f32_e32 v0, v0, v41
  v_mfma_f32_16x16x32_bf16 v[36:39], a[204:207], a[52:55], v[36:39]
  v_cvt_pk_bf16_f32 v40, v40, v41
  v_add_f32_e32 v0, v0, v42
  v_mfma_f32_16x16x32_bf16 v[44:47], a[184:187], a[56:59], 0
  v_add_f32_e32 v0, v0, v43
  v_cvt_pk_bf16_f32 v41, v42, v43
  v_mfma_f32_16x16x32_bf16 v[44:47], a[188:191], a[60:63], v[44:47]
  v_fma_f32 v48, v48, s35, -v16
  v_fma_f32 v49, v49, s35, -v16
  v_mfma_f32_16x16x32_bf16 v[44:47], a[192:195], a[64:67], v[44:47]
  ds_read_b64_tr_b16 a[160:161], v4 offset:36864
  v_fma_f32 v50, v50, s35, -v16
  v_mfma_f32_16x16x32_bf16 v[44:47], a[196:199], a[68:71], v[44:47]
  v_exp_f32_e32 v48, v48
  v_mfma_f32_16x16x32_bf16 v[44:47], a[200:203], a[72:75], v[44:47]
  ds_read_b64_tr_b16 a[162:163], v4 offset:43008
  v_fma_f32 v36, v36, s35, -v14
  v_mfma_f32_16x16x32_bf16 v[44:47], a[204:207], a[76:79], v[44:47]
  buffer_load_dwordx4 v9, s[8:11], s32 offen offset:1024 nt lds
  v_mfma_f32_16x16x32_bf16 v[52:55], a[184:187], a[80:83], 0
  ds_read_b64_tr_b16 a[164:165], v5 offset:36864
  v_fma_f32 v37, v37, s35, -v14
  v_mfma_f32_16x16x32_bf16 v[52:55], a[188:191], a[84:87], v[52:55]
  v_exp_f32_e32 v36, v36
  v_mfma_f32_16x16x32_bf16 v[52:55], a[192:195], a[88:91], v[52:55]
  ds_read_b64_tr_b16 a[166:167], v5 offset:43008
  v_fma_f32 v38, v38, s35, -v14
  v_mfma_f32_16x16x32_bf16 v[52:55], a[196:199], a[92:95], v[52:55]
  v_exp_f32_e32 v37, v37
  v_mfma_f32_16x16x32_bf16 v[52:55], a[200:203], a[96:99], v[52:55]
  ds_read_b64_tr_b16 a[168:169], v6 offset:36864
  v_fma_f32 v39, v39, s35, -v14
  v_mfma_f32_16x16x32_bf16 v[52:55], a[204:207], a[100:103], v[52:55]
  v_exp_f32_e32 v38, v38
  v_mfma_f32_16x16x32_bf16 v[60:63], a[184:187], a[104:107], 0
  ds_read_b64_tr_b16 a[170:171], v6 offset:43008
  v_cvt_pk_bf16_f32 v34, v36, v37
  v_mfma_f32_16x16x32_bf16 v[60:63], a[188:191], a[108:111], v[60:63]
  v_exp_f32_e32 v39, v39
  v_mfma_f32_16x16x32_bf16 v[60:63], a[192:195], a[112:115], v[60:63]
  ds_read_b64_tr_b16 a[172:173], v7 offset:36864
  v_cvt_pk_bf16_f32 v35, v38, v39
  v_mfma_f32_16x16x32_bf16 v[60:63], a[196:199], a[116:119], v[60:63]
  v_exp_f32_e32 v49, v49
  v_mfma_f32_16x16x32_bf16 v[60:63], a[200:203], a[120:123], v[60:63]
  ds_read_b64_tr_b16 a[174:175], v7 offset:43008
  v_fma_f32 v44, v44, s35, -v15
  v_mfma_f32_16x16x32_bf16 v[60:63], a[204:207], a[124:127], v[60:63]
  buffer_load_dwordx4 v10, s[8:11], s32 offen offset:2048 nt lds
  v_mfma_f32_16x16x32_bf16 a[240:243], v[18:21], v[64:67], a[240:243]
  s_waitcnt lgkmcnt(4)
  ds_read_b64_tr_b16 a[176:177], v4 offset:36992
  v_fma_f32 v45, v45, s35, -v15
  v_mfma_f32_16x16x32_bf16 v[96:99], a[160:163], v[64:67], v[96:99]
  v_exp_f32_e32 v44, v44
  v_mfma_f32_16x16x32_bf16 v[100:103], a[160:163], v[72:75], v[100:103]
  ds_read_b64_tr_b16 a[178:179], v4 offset:43136
  v_fma_f32 v46, v46, s35, -v15
  v_mfma_f32_16x16x32_bf16 v[104:107], a[160:163], v[80:83], v[104:107]
  v_exp_f32_e32 v45, v45
  v_mfma_f32_16x16x32_bf16 v[108:111], a[160:163], v[88:91], v[108:111]
  ds_read_b64_tr_b16 a[180:181], v5 offset:36992
  v_fma_f32 v47, v47, s35, -v15
  v_mfma_f32_16x16x32_bf16 v[112:115], a[164:167], v[64:67], v[112:115]
  v_exp_f32_e32 v46, v46
  v_mfma_f32_16x16x32_bf16 v[116:119], a[164:167], v[72:75], v[116:119]
  ds_read_b64_tr_b16 a[182:183], v5 offset:43136
  v_cvt_pk_bf16_f32 v42, v44, v45
  v_mfma_f32_16x16x32_bf16 v[120:123], a[164:167], v[80:83], v[120:123]
  v_exp_f32_e32 v47, v47
  v_mfma_f32_16x16x32_bf16 v[124:127], a[164:167], v[88:91], v[124:127]
  s_waitcnt lgkmcnt(4)
  ds_read_b64_tr_b16 a[184:185], v6 offset:36992
  v_cvt_pk_bf16_f32 v43, v46, v47
  v_mfma_f32_16x16x32_bf16 v[128:131], a[168:171], v[64:67], v[128:131]
  s_add_u32 m0, s34, 73728
  v_exp_f32_e32 v50, v50
  v_mfma_f32_16x16x32_bf16 v[132:135], a[168:171], v[72:75], v[132:135]
  s_mov_b32 s33, 73728
  ds_read_b64_tr_b16 a[186:187], v6 offset:43136
  v_fma_f32 v51, v51, s35, -v16
  v_mfma_f32_16x16x32_bf16 v[136:139], a[168:171], v[80:83], v[136:139]
  buffer_load_dwordx4 v8, s[12:15], s33 offen nt lds
  v_mfma_f32_16x16x32_bf16 v[140:143], a[168:171], v[88:91], v[140:143]
  ds_read_b64_tr_b16 a[188:189], v7 offset:36992
  v_fma_f32 v52, v52, s35, -v16
  v_mfma_f32_16x16x32_bf16 v[144:147], a[172:175], v[64:67], v[144:147]
  v_exp_f32_e32 v51, v51
  v_mfma_f32_16x16x32_bf16 v[148:151], a[172:175], v[72:75], v[148:151]
  ds_read_b64_tr_b16 a[190:191], v7 offset:43136
  v_fma_f32 v53, v53, s35, -v16
  v_mfma_f32_16x16x32_bf16 v[152:155], a[172:175], v[80:83], v[152:155]
  v_exp_f32_e32 v52, v52
  v_mfma_f32_16x16x32_bf16 v[156:159], a[172:175], v[88:91], v[156:159]
  s_waitcnt lgkmcnt(4)
  ds_read_b64_tr_b16 a[192:193], v4 offset:37120
  v_fma_f32 v54, v54, s35, -v16
  v_mfma_f32_16x16x32_bf16 v[160:163], a[176:179], v[64:67], v[160:163]
  v_exp_f32_e32 v53, v53
  v_mfma_f32_16x16x32_bf16 v[164:167], a[176:179], v[72:75], v[164:167]
  ds_read_b64_tr_b16 a[194:195], v4 offset:43264
  v_fma_f32 v55, v55, s35, -v16
  v_mfma_f32_16x16x32_bf16 v[168:171], a[176:179], v[80:83], v[168:171]
  v_exp_f32_e32 v54, v54
  v_mfma_f32_16x16x32_bf16 v[172:175], a[176:179], v[88:91], v[172:175]
  ds_read_b64_tr_b16 a[196:197], v5 offset:37120
  v_add_f32_e32 v30, v30, v48
  v_mfma_f32_16x16x32_bf16 v[176:179], a[180:183], v[64:67], v[176:179]
  v_exp_f32_e32 v55, v55
  v_mfma_f32_16x16x32_bf16 v[180:183], a[180:183], v[72:75], v[180:183]
  ds_read_b64_tr_b16 a[198:199], v5 offset:43264
  v_add_f32_e32 v30, v30, v49
  v_mfma_f32_16x16x32_bf16 v[184:187], a[180:183], v[80:83], v[184:187]
  buffer_load_dwordx4 v9, s[12:15], s33 offen offset:1024 nt lds
  v_mfma_f32_16x16x32_bf16 v[188:191], a[180:183], v[88:91], v[188:191]
  s_waitcnt lgkmcnt(4)
  ds_read_b64_tr_b16 a[200:201], v6 offset:37120
  v_cvt_pk_bf16_f32 v48, v48, v49
  v_mfma_f32_16x16x32_bf16 v[192:195], a[184:187], v[64:67], v[192:195]
  v_add_f32_e32 v30, v30, v50
  v_add_f32_e32 v30, v30, v51
  v_mfma_f32_16x16x32_bf16 v[196:199], a[184:187], v[72:75], v[196:199]
  ds_read_b64_tr_b16 a[202:203], v6 offset:43264
  v_cvt_pk_bf16_f32 v49, v50, v51
  v_mfma_f32_16x16x32_bf16 v[200:203], a[184:187], v[80:83], v[200:203]
  v_cvt_pk_bf16_f32 v50, v52, v53
  v_cvt_pk_bf16_f32 v51, v54, v55
  v_mfma_f32_16x16x32_bf16 v[204:207], a[184:187], v[88:91], v[204:207]
  ds_read_b64_tr_b16 a[204:205], v7 offset:37120
  v_fma_f32 v56, v56, s35, -v17
  v_mfma_f32_16x16x32_bf16 v[208:211], a[188:191], v[64:67], v[208:211]
  v_exp_f32_e32 v56, v56
  v_mfma_f32_16x16x32_bf16 v[212:215], a[188:191], v[72:75], v[212:215]
  ds_read_b64_tr_b16 a[206:207], v7 offset:43264
  v_fma_f32 v57, v57, s35, -v17
  v_mfma_f32_16x16x32_bf16 v[216:219], a[188:191], v[80:83], v[216:219]
  v_exp_f32_e32 v57, v57
  v_mfma_f32_16x16x32_bf16 v[220:223], a[188:191], v[88:91], v[220:223]
  s_waitcnt lgkmcnt(4)
  ds_read_b128 a[160:163], v2 offset:12288
  v_fma_f32 v58, v58, s35, -v17
  v_mfma_f32_16x16x32_bf16 v[224:227], a[192:195], v[64:67], v[224:227]
  v_exp_f32_e32 v58, v58
  v_mfma_f32_16x16x32_bf16 v[228:231], a[192:195], v[72:75], v[228:231]
  ds_read_b128 a[164:167], v3 offset:12288
  v_fma_f32 v59, v59, s35, -v17
  v_mfma_f32_16x16x32_bf16 v[232:235], a[192:195], v[80:83], v[232:235]
  buffer_load_dwordx4 v10, s[12:15], s33 offen offset:2048 nt lds
  v_mfma_f32_16x16x32_bf16 v[236:239], a[192:195], v[88:91], v[236:239]
  ds_read_b128 a[168:171], v2 offset:12416
  v_fma_f32 v60, v60, s35, -v17
  v_mfma_f32_16x16x32_bf16 v[240:243], a[196:199], v[64:67], v[240:243]
  v_exp_f32_e32 v59, v59
  v_mfma_f32_16x16x32_bf16 v[244:247], a[196:199], v[72:75], v[244:247]
  ds_read_b128 a[172:175], v3 offset:12416
  v_fma_f32 v61, v61, s35, -v17
  v_mfma_f32_16x16x32_bf16 v[248:251], a[196:199], v[80:83], v[248:251]
  v_exp_f32_e32 v60, v60
  v_mfma_f32_16x16x32_bf16 v[252:255], a[196:199], v[88:91], v[252:255]
  s_waitcnt lgkmcnt(3)
  ds_read_b128 a[176:179], v2 offset:12544
  v_fma_f32 v62, v62, s35, -v17
  v_mfma_f32_16x16x32_bf16 a[0:3], a[200:203], v[64:67], a[0:3]
  v_exp_f32_e32 v61, v61
  v_mfma_f32_16x16x32_bf16 a[4:7], a[200:203], v[72:75], a[4:7]
  ds_read_b128 a[180:183], v3 offset:12544
  v_fma_f32 v63, v63, s35, -v17
  v_mfma_f32_16x16x32_bf16 a[8:11], a[200:203], v[80:83], a[8:11]
  v_exp_f32_e32 v62, v62
  v_mfma_f32_16x16x32_bf16 a[12:15], a[200:203], v[88:91], a[12:15]
  v_exp_f32_e32 v63, v63
  v_mfma_f32_16x16x32_bf16 a[16:19], a[204:207], v[64:67], a[16:19]
  v_add_f32_e32 v31, v31, v56
  v_add_f32_e32 v31, v31, v57
  v_mfma_f32_16x16x32_bf16 a[20:23], a[204:207], v[72:75], a[20:23]
  s_add_u32 m0, s28, 3840
  v_cvt_pk_bf16_f32 v56, v56, v57
  v_add_f32_e32 v31, v31, v58
  v_mfma_f32_16x16x32_bf16 a[24:27], a[204:207], v[80:83], a[24:27]
  buffer_load_dwordx4 v11, s[24:27], s86 offen offset:256 nt lds
  v_mfma_f32_16x16x32_bf16 a[28:31], a[204:207], v[88:91], a[28:31]
  v_add_f32_e32 v31, v31, v59
  v_cvt_pk_bf16_f32 v57, v58, v59
  v_mfma_f32_16x16x32_bf16 v[64:67], a[160:163], a[32:35], 0
  s_waitcnt lgkmcnt(1)
  v_cvt_pk_bf16_f32 v58, v60, v61
  v_cvt_pk_bf16_f32 v59, v62, v63
  v_mfma_f32_16x16x32_bf16 v[64:67], a[164:167], a[36:39], v[64:67]
  v_add_f32_e32 v0, v0, v44
  v_add_f32_e32 v0, v0, v45
  v_mfma_f32_16x16x32_bf16 v[64:67], a[168:171], a[40:43], v[64:67]
  v_add_f32_e32 v0, v0, v46
  v_add_f32_e32 v0, v0, v47
  v_mfma_f32_16x16x32_bf16 v[64:67], a[172:175], a[44:47], v[64:67]
  v_add_f32_e32 v30, v30, v52
  v_add_f32_e32 v30, v30, v53
  v_mfma_f32_16x16x32_bf16 v[64:67], a[176:179], a[48:51], v[64:67]
  s_waitcnt lgkmcnt(0)
  v_add_f32_e32 v30, v30, v54
  v_add_f32_e32 v30, v30, v55
  v_mfma_f32_16x16x32_bf16 v[64:67], a[180:183], a[52:55], v[64:67]
  v_add_f32_e32 v31, v31, v60
  v_add_f32_e32 v31, v31, v61
  v_mfma_f32_16x16x32_bf16 v[72:75], a[160:163], a[56:59], 0
  v_add_f32_e32 v31, v31, v62
  v_add_f32_e32 v31, v31, v63
  v_mfma_f32_16x16x32_bf16 v[72:75], a[164:167], a[60:63], v[72:75]
  ds_read_b128 a[184:187], v2 offset:18432
  v_mfma_f32_16x16x32_bf16 v[72:75], a[168:171], a[64:67], v[72:75]
  v_mfma_f32_16x16x32_bf16 v[72:75], a[172:175], a[68:71], v[72:75]
  s_add_u32 m0, s28, 1792
  ds_read_b128 a[188:191], v3 offset:18432
  v_mfma_f32_16x16x32_bf16 v[72:75], a[176:179], a[72:75], v[72:75]
  buffer_load_dwordx4 v11, s[24:27], s86 offen offset:3328 nt lds
  v_mfma_f32_16x16x32_bf16 v[72:75], a[180:183], a[76:79], v[72:75]
  ds_read_b128 a[192:195], v2 offset:18560
  v_fma_f32 v64, v64, s35, -v14
  v_mfma_f32_16x16x32_bf16 v[80:83], a[160:163], a[80:83], 0
  v_exp_f32_e32 v64, v64
  v_mfma_f32_16x16x32_bf16 v[80:83], a[164:167], a[84:87], v[80:83]
  ds_read_b128 a[196:199], v3 offset:18560
  v_fma_f32 v65, v65, s35, -v14
  v_mfma_f32_16x16x32_bf16 v[80:83], a[168:171], a[88:91], v[80:83]
  v_exp_f32_e32 v65, v65
  v_mfma_f32_16x16x32_bf16 v[80:83], a[172:175], a[92:95], v[80:83]
  ds_read_b128 a[200:203], v2 offset:18688
  v_fma_f32 v66, v66, s35, -v14
  v_mfma_f32_16x16x32_bf16 v[80:83], a[176:179], a[96:99], v[80:83]
  v_exp_f32_e32 v66, v66
  v_mfma_f32_16x16x32_bf16 v[80:83], a[180:183], a[100:103], v[80:83]
  ds_read_b128 a[204:207], v3 offset:18688
  v_fma_f32 v67, v67, s35, -v14
  v_mfma_f32_16x16x32_bf16 v[88:91], a[160:163], a[104:107], 0
  s_waitcnt vmcnt(13)
  s_barrier
  v_mfma_f32_16x16x32_bf16 v[88:91], a[164:167], a[108:111], v[88:91]
  v_exp_f32_e32 v67, v67
  v_mfma_f32_16x16x32_bf16 v[88:91], a[168:171], a[112:115], v[88:91]
  s_add_u32 m0, s34, 0
  v_cvt_pk_bf16_f32 v64, v64, v65
  v_cvt_pk_bf16_f32 v65, v66, v67
  v_mfma_f32_16x16x32_bf16 v[88:91], a[172:175], a[116:119], v[88:91]
  s_mov_b32 s32, 98304
  v_fma_f32 v72, v72, s35, -v15
  v_fma_f32 v73, v73, s35, -v15
  v_mfma_f32_16x16x32_bf16 v[88:91], a[176:179], a[120:123], v[88:91]
  buffer_load_dwordx4 v8, s[8:11], s32 offen nt lds
  v_mfma_f32_16x16x32_bf16 v[88:91], a[180:183], a[124:127], v[88:91]
  s_waitcnt lgkmcnt(1)
  v_exp_f32_e32 v72, v72
  v_mfma_f32_16x16x32_bf16 v[68:71], a[184:187], a[32:35], 0
  v_exp_f32_e32 v73, v73
  v_mfma_f32_16x16x32_bf16 v[68:71], a[188:191], a[36:39], v[68:71]
  v_fma_f32 v74, v74, s35, -v15
  v_fma_f32 v75, v75, s35, -v15
  v_mfma_f32_16x16x32_bf16 v[68:71], a[192:195], a[40:43], v[68:71]
  v_exp_f32_e32 v74, v74
  v_mfma_f32_16x16x32_bf16 v[68:71], a[196:199], a[44:47], v[68:71]
  v_exp_f32_e32 v75, v75
  v_mfma_f32_16x16x32_bf16 v[68:71], a[200:203], a[48:51], v[68:71]
  s_waitcnt lgkmcnt(0)
  v_add_f32_e32 v0, v0, v72
  v_add_f32_e32 v0, v0, v73
  v_mfma_f32_16x16x32_bf16 v[68:71], a[204:207], a[52:55], v[68:71]
  v_cvt_pk_bf16_f32 v72, v72, v73
  v_add_f32_e32 v0, v0, v74
  v_mfma_f32_16x16x32_bf16 v[76:79], a[184:187], a[56:59], 0
  v_add_f32_e32 v0, v0, v75
  v_cvt_pk_bf16_f32 v73, v74, v75
  v_mfma_f32_16x16x32_bf16 v[76:79], a[188:191], a[60:63], v[76:79]
  v_fma_f32 v80, v80, s35, -v16
  v_fma_f32 v81, v81, s35, -v16
  v_mfma_f32_16x16x32_bf16 v[76:79], a[192:195], a[64:67], v[76:79]
  ds_read_b64_tr_b16 a[160:161], v4 offset:0
  v_fma_f32 v82, v82, s35, -v16
  v_mfma_f32_16x16x32_bf16 v[76:79], a[196:199], a[68:71], v[76:79]
  v_exp_f32_e32 v80, v80
  v_mfma_f32_16x16x32_bf16 v[76:79], a[200:203], a[72:75], v[76:79]
  ds_read_b64_tr_b16 a[162:163], v4 offset:6144
  v_fma_f32 v68, v68, s35, -v14
  v_mfma_f32_16x16x32_bf16 v[76:79], a[204:207], a[76:79], v[76:79]
  buffer_load_dwordx4 v9, s[8:11], s32 offen offset:1024 nt lds
  v_mfma_f32_16x16x32_bf16 v[84:87], a[184:187], a[80:83], 0
  ds_read_b64_tr_b16 a[164:165], v5 offset:0
  v_fma_f32 v69, v69, s35, -v14
  v_mfma_f32_16x16x32_bf16 v[84:87], a[188:191], a[84:87], v[84:87]
  v_exp_f32_e32 v68, v68
  v_mfma_f32_16x16x32_bf16 v[84:87], a[192:195], a[88:91], v[84:87]
  ds_read_b64_tr_b16 a[166:167], v5 offset:6144
  v_fma_f32 v70, v70, s35, -v14
  v_mfma_f32_16x16x32_bf16 v[84:87], a[196:199], a[92:95], v[84:87]
  v_exp_f32_e32 v69, v69
  v_mfma_f32_16x16x32_bf16 v[84:87], a[200:203], a[96:99], v[84:87]
  ds_read_b64_tr_b16 a[168:169], v6 offset:0
  v_fma_f32 v71, v71, s35, -v14
  v_mfma_f32_16x16x32_bf16 v[84:87], a[204:207], a[100:103], v[84:87]
  v_exp_f32_e32 v70, v70
  v_mfma_f32_16x16x32_bf16 v[92:95], a[184:187], a[104:107], 0
  ds_read_b64_tr_b16 a[170:171], v6 offset:6144
  v_cvt_pk_bf16_f32 v66, v68, v69
  v_mfma_f32_16x16x32_bf16 v[92:95], a[188:191], a[108:111], v[92:95]
  v_exp_f32_e32 v71, v71
  v_mfma_f32_16x16x32_bf16 v[92:95], a[192:195], a[112:115], v[92:95]
  ds_read_b64_tr_b16 a[172:173], v7 offset:0
  v_cvt_pk_bf16_f32 v67, v70, v71
  v_mfma_f32_16x16x32_bf16 v[92:95], a[196:199], a[116:119], v[92:95]
  v_exp_f32_e32 v81, v81
  v_mfma_f32_16x16x32_bf16 v[92:95], a[200:203], a[120:123], v[92:95]
  ds_read_b64_tr_b16 a[174:175], v7 offset:6144
  v_fma_f32 v76, v76, s35, -v15
  v_mfma_f32_16x16x32_bf16 v[92:95], a[204:207], a[124:127], v[92:95]
  buffer_load_dwordx4 v10, s[8:11], s32 offen offset:2048 nt lds
  v_mfma_f32_16x16x32_bf16 a[240:243], v[18:21], v[32:35], a[240:243]
  s_waitcnt lgkmcnt(4)
  ds_read_b64_tr_b16 a[176:177], v4 offset:128
  v_fma_f32 v77, v77, s35, -v15
  v_mfma_f32_16x16x32_bf16 v[96:99], a[160:163], v[32:35], v[96:99]
  v_exp_f32_e32 v76, v76
  v_mfma_f32_16x16x32_bf16 v[100:103], a[160:163], v[40:43], v[100:103]
  ds_read_b64_tr_b16 a[178:179], v4 offset:6272
  v_fma_f32 v78, v78, s35, -v15
  v_mfma_f32_16x16x32_bf16 v[104:107], a[160:163], v[48:51], v[104:107]
  v_exp_f32_e32 v77, v77
  v_mfma_f32_16x16x32_bf16 v[108:111], a[160:163], v[56:59], v[108:111]
  ds_read_b64_tr_b16 a[180:181], v5 offset:128
  v_fma_f32 v79, v79, s35, -v15
  v_mfma_f32_16x16x32_bf16 v[112:115], a[164:167], v[32:35], v[112:115]
  v_exp_f32_e32 v78, v78
  v_mfma_f32_16x16x32_bf16 v[116:119], a[164:167], v[40:43], v[116:119]
  ds_read_b64_tr_b16 a[182:183], v5 offset:6272
  v_cvt_pk_bf16_f32 v74, v76, v77
  v_mfma_f32_16x16x32_bf16 v[120:123], a[164:167], v[48:51], v[120:123]
  v_exp_f32_e32 v79, v79
  v_mfma_f32_16x16x32_bf16 v[124:127], a[164:167], v[56:59], v[124:127]
  s_waitcnt lgkmcnt(4)
  ds_read_b64_tr_b16 a[184:185], v6 offset:128
  v_cvt_pk_bf16_f32 v75, v78, v79
  v_mfma_f32_16x16x32_bf16 v[128:131], a[168:171], v[32:35], v[128:131]
  s_add_u32 m0, s34, 86016
  v_exp_f32_e32 v82, v82
  v_mfma_f32_16x16x32_bf16 v[132:135], a[168:171], v[40:43], v[132:135]
  s_mov_b32 s33, 86016
  ds_read_b64_tr_b16 a[186:187], v6 offset:6272
  v_fma_f32 v83, v83, s35, -v16
  v_mfma_f32_16x16x32_bf16 v[136:139], a[168:171], v[48:51], v[136:139]
  buffer_load_dwordx4 v8, s[12:15], s33 offen nt lds
  v_mfma_f32_16x16x32_bf16 v[140:143], a[168:171], v[56:59], v[140:143]
  ds_read_b64_tr_b16 a[188:189], v7 offset:128
  v_fma_f32 v84, v84, s35, -v16
  v_mfma_f32_16x16x32_bf16 v[144:147], a[172:175], v[32:35], v[144:147]
  v_exp_f32_e32 v83, v83
  v_mfma_f32_16x16x32_bf16 v[148:151], a[172:175], v[40:43], v[148:151]
  ds_read_b64_tr_b16 a[190:191], v7 offset:6272
  v_fma_f32 v85, v85, s35, -v16
  v_mfma_f32_16x16x32_bf16 v[152:155], a[172:175], v[48:51], v[152:155]
  v_exp_f32_e32 v84, v84
  v_mfma_f32_16x16x32_bf16 v[156:159], a[172:175], v[56:59], v[156:159]
  s_waitcnt lgkmcnt(4)
  ds_read_b64_tr_b16 a[192:193], v4 offset:256
  v_fma_f32 v86, v86, s35, -v16
  v_mfma_f32_16x16x32_bf16 v[160:163], a[176:179], v[32:35], v[160:163]
  v_exp_f32_e32 v85, v85
  v_mfma_f32_16x16x32_bf16 v[164:167], a[176:179], v[40:43], v[164:167]
  ds_read_b64_tr_b16 a[194:195], v4 offset:6400
  v_fma_f32 v87, v87, s35, -v16
  v_mfma_f32_16x16x32_bf16 v[168:171], a[176:179], v[48:51], v[168:171]
  v_exp_f32_e32 v86, v86
  v_mfma_f32_16x16x32_bf16 v[172:175], a[176:179], v[56:59], v[172:175]
  ds_read_b64_tr_b16 a[196:197], v5 offset:256
  v_add_f32_e32 v30, v30, v80
  v_mfma_f32_16x16x32_bf16 v[176:179], a[180:183], v[32:35], v[176:179]
  v_exp_f32_e32 v87, v87
  v_mfma_f32_16x16x32_bf16 v[180:183], a[180:183], v[40:43], v[180:183]
  ds_read_b64_tr_b16 a[198:199], v5 offset:6400
  v_add_f32_e32 v30, v30, v81
  v_mfma_f32_16x16x32_bf16 v[184:187], a[180:183], v[48:51], v[184:187]
  buffer_load_dwordx4 v9, s[12:15], s33 offen offset:1024 nt lds
  v_mfma_f32_16x16x32_bf16 v[188:191], a[180:183], v[56:59], v[188:191]
  s_waitcnt lgkmcnt(4)
  ds_read_b64_tr_b16 a[200:201], v6 offset:256
  v_cvt_pk_bf16_f32 v80, v80, v81
  v_mfma_f32_16x16x32_bf16 v[192:195], a[184:187], v[32:35], v[192:195]
  v_add_f32_e32 v30, v30, v82
  v_add_f32_e32 v30, v30, v83
  v_mfma_f32_16x16x32_bf16 v[196:199], a[184:187], v[40:43], v[196:199]
  ds_read_b64_tr_b16 a[202:203], v6 offset:6400
  v_cvt_pk_bf16_f32 v81, v82, v83
  v_mfma_f32_16x16x32_bf16 v[200:203], a[184:187], v[48:51], v[200:203]
  v_cvt_pk_bf16_f32 v82, v84, v85
  v_cvt_pk_bf16_f32 v83, v86, v87
  v_mfma_f32_16x16x32_bf16 v[204:207], a[184:187], v[56:59], v[204:207]
  ds_read_b64_tr_b16 a[204:205], v7 offset:256
  v_fma_f32 v88, v88, s35, -v17
  v_mfma_f32_16x16x32_bf16 v[208:211], a[188:191], v[32:35], v[208:211]
  v_exp_f32_e32 v88, v88
  v_mfma_f32_16x16x32_bf16 v[212:215], a[188:191], v[40:43], v[212:215]
  ds_read_b64_tr_b16 a[206:207], v7 offset:6400
  v_fma_f32 v89, v89, s35, -v17
  v_mfma_f32_16x16x32_bf16 v[216:219], a[188:191], v[48:51], v[216:219]
  v_exp_f32_e32 v89, v89
  v_mfma_f32_16x16x32_bf16 v[220:223], a[188:191], v[56:59], v[220:223]
  s_waitcnt lgkmcnt(4)
  ds_read_b128 a[160:163], v2 offset:24576
  v_fma_f32 v90, v90, s35, -v17
  v_mfma_f32_16x16x32_bf16 v[224:227], a[192:195], v[32:35], v[224:227]
  v_exp_f32_e32 v90, v90
  v_mfma_f32_16x16x32_bf16 v[228:231], a[192:195], v[40:43], v[228:231]
  ds_read_b128 a[164:167], v3 offset:24576
  v_fma_f32 v91, v91, s35, -v17
  v_mfma_f32_16x16x32_bf16 v[232:235], a[192:195], v[48:51], v[232:235]
  buffer_load_dwordx4 v10, s[12:15], s33 offen offset:2048 nt lds
  v_mfma_f32_16x16x32_bf16 v[236:239], a[192:195], v[56:59], v[236:239]
  ds_read_b128 a[168:171], v2 offset:24704
  v_fma_f32 v92, v92, s35, -v17
  v_mfma_f32_16x16x32_bf16 v[240:243], a[196:199], v[32:35], v[240:243]
  v_exp_f32_e32 v91, v91
  v_mfma_f32_16x16x32_bf16 v[244:247], a[196:199], v[40:43], v[244:247]
  ds_read_b128 a[172:175], v3 offset:24704
  v_fma_f32 v93, v93, s35, -v17
  v_mfma_f32_16x16x32_bf16 v[248:251], a[196:199], v[48:51], v[248:251]
  v_exp_f32_e32 v92, v92
  v_mfma_f32_16x16x32_bf16 v[252:255], a[196:199], v[56:59], v[252:255]
  s_waitcnt lgkmcnt(3)
  ds_read_b128 a[176:179], v2 offset:24832
  v_fma_f32 v94, v94, s35, -v17
  v_mfma_f32_16x16x32_bf16 a[0:3], a[200:203], v[32:35], a[0:3]
  v_exp_f32_e32 v93, v93
  v_mfma_f32_16x16x32_bf16 a[4:7], a[200:203], v[40:43], a[4:7]
  ds_read_b128 a[180:183], v3 offset:24832
  v_fma_f32 v95, v95, s35, -v17
  v_mfma_f32_16x16x32_bf16 a[8:11], a[200:203], v[48:51], a[8:11]
  v_exp_f32_e32 v94, v94
  v_mfma_f32_16x16x32_bf16 a[12:15], a[200:203], v[56:59], a[12:15]
  v_exp_f32_e32 v95, v95
  v_mfma_f32_16x16x32_bf16 a[16:19], a[204:207], v[32:35], a[16:19]
  v_add_f32_e32 v31, v31, v88
  v_add_f32_e32 v31, v31, v89
  v_mfma_f32_16x16x32_bf16 a[20:23], a[204:207], v[40:43], a[20:23]
  s_add_u32 m0, s28, 5888
  v_cvt_pk_bf16_f32 v88, v88, v89
  v_add_f32_e32 v31, v31, v90
  v_mfma_f32_16x16x32_bf16 a[24:27], a[204:207], v[48:51], a[24:27]
  buffer_load_dwordx4 v11, s[24:27], s87 offen offset:256 nt lds
L_hop2:
  s_cbranch_execz L_hop6
  v_mfma_f32_16x16x32_bf16 a[28:31], a[204:207], v[56:59], a[28:31]
  v_add_f32_e32 v31, v31, v91
  v_cvt_pk_bf16_f32 v89, v90, v91
  v_mfma_f32_16x16x32_bf16 v[32:35], a[160:163], a[32:35], 0
  s_waitcnt lgkmcnt(1)
  v_cvt_pk_bf16_f32 v90, v92, v93
  v_cvt_pk_bf16_f32 v91, v94, v95
  v_mfma_f32_16x16x32_bf16 v[32:35], a[164:167], a[36:39], v[32:35]
  v_add_f32_e32 v0, v0, v76
  v_add_f32_e32 v0, v0, v77
  v_mfma_f32_16x16x32_bf16 v[32:35], a[168:171], a[40:43], v[32:35]
  v_add_f32_e32 v0, v0, v78
  v_add_f32_e32 v0, v0, v79
  v_mfma_f32_16x16x32_bf16 v[32:35], a[172:175], a[44:47], v[32:35]
  v_add_f32_e32 v30, v30, v84
  v_add_f32_e32 v30, v30, v85
  v_mfma_f32_16x16x32_bf16 v[32:35], a[176:179], a[48:51], v[32:35]
  s_waitcnt lgkmcnt(0)
  v_add_f32_e32 v30, v30, v86
  v_add_f32_e32 v30, v30, v87
  v_mfma_f32_16x16x32_bf16 v[32:35], a[180:183], a[52:55], v[32:35]
  v_add_f32_e32 v31, v31, v92
  v_add_f32_e32 v31, v31, v93
  v_mfma_f32_16x16x32_bf16 v[40:43], a[160:163], a[56:59], 0
  v_add_f32_e32 v31, v31, v94
  v_add_f32_e32 v31, v31, v95
  v_mfma_f32_16x16x32_bf16 v[40:43], a[164:167], a[60:63], v[40:43]
  ds_read_b128 a[184:187], v2 offset:30720
  v_mfma_f32_16x16x32_bf16 v[40:43], a[168:171], a[64:67], v[40:43]
  v_mfma_f32_16x16x32_bf16 v[40:43], a[172:175], a[68:71], v[40:43]
  s_add_u32 m0, s28, 3840
  ds_read_b128 a[188:191], v3 offset:30720
  v_mfma_f32_16x16x32_bf16 v[40:43], a[176:179], a[72:75], v[40:43]
  buffer_load_dwordx4 v11, s[24:27], s87 offen offset:3328 nt lds
  v_mfma_f32_16x16x32_bf16 v[40:43], a[180:183], a[76:79], v[40:43]
  ds_read_b128 a[192:195], v2 offset:30848
  v_fma_f32 v32, v32, s35, -v14
  v_mfma_f32_16x16x32_bf16 v[48:51], a[160:163], a[80:83], 0
  v_exp_f32_e32 v32, v32
  v_mfma_f32_16x16x32_bf16 v[48:51], a[164:167], a[84:87], v[48:51]
  ds_read_b128 a[196:199], v3 offset:30848
  v_fma_f32 v33, v33, s35, -v14
  v_mfma_f32_16x16x32_bf16 v[48:51], a[168:171], a[88:91], v[48:51]
  v_exp_f32_e32 v33, v33
  v_mfma_f32_16x16x32_bf16 v[48:51], a[172:175], a[92:95], v[48:51]
  ds_read_b128 a[200:203], v2 offset:30976
  v_fma_f32 v34, v34, s35, -v14
  v_mfma_f32_16x16x32_bf16 v[48:51], a[176:179], a[96:99], v[48:51]
  s_waitcnt vmcnt(16)
  ds_read_b128 a[128:131], v12 offset:0
  v_fma_f32 v35, v35, s35, -v14
  v_mfma_f32_16x16x32_bf16 v[48:51], a[180:183], a[100:103], v[48:51]
  ds_read_b128 a[204:207], v3 offset:30976
  ds_read_b128 a[132:135], v13 offset:0
  v_mfma_f32_16x16x32_bf16 v[56:59], a[160:163], a[104:107], 0
  s_waitcnt vmcnt(13)
  s_barrier
  v_mfma_f32_16x16x32_bf16 v[56:59], a[164:167], a[108:111], v[56:59]
  ds_read_b128 a[136:139], v12 offset:2048
  v_cvt_pk_bf16_f32 v32, v32, v33
  v_mfma_f32_16x16x32_bf16 v[56:59], a[168:171], a[112:115], v[56:59]
  s_add_u32 m0, s34, 12288
  ds_read_b128 a[140:143], v13 offset:2048
  v_fma_f32 v40, v40, s35, -v15
  v_mfma_f32_16x16x32_bf16 v[56:59], a[172:175], a[116:119], v[56:59]
  s_mov_b32 s32, 110592
  v_exp_f32_e32 v34, v34
  v_mfma_f32_16x16x32_bf16 v[56:59], a[176:179], a[120:123], v[56:59]
  buffer_load_dwordx4 v8, s[8:11], s32 offen nt lds
  v_mfma_f32_16x16x32_bf16 v[56:59], a[180:183], a[124:127], v[56:59]
  s_waitcnt lgkmcnt(5)
  v_exp_f32_e32 v35, v35
  v_mfma_f32_16x16x32_bf16 v[36:39], a[184:187], a[32:35], 0
  v_exp_f32_e32 v40, v40
  v_mfma_f32_16x16x32_bf16 v[36:39], a[188:191], a[36:39], v[36:39]
  v_cvt_pk_bf16_f32 v33, v34, v35
  v_fma_f32 v41, v41, s35, -v15
  v_mfma_f32_16x16x32_bf16 v[36:39], a[192:195], a[40:43], v[36:39]
  v_exp_f32_e32 v41, v41
  v_mfma_f32_16x16x32_bf16 v[36:39], a[196:199], a[44:47], v[36:39]
  v_fma_f32 v42, v42, s35, -v15
  v_fma_f32 v43, v43, s35, -v15
  v_mfma_f32_16x16x32_bf16 v[36:39], a[200:203], a[48:51], v[36:39]
  s_waitcnt lgkmcnt(3)
  v_exp_f32_e32 v42, v42
  v_mfma_f32_16x16x32_bf16 v[36:39], a[204:207], a[52:55], v[36:39]
  v_exp_f32_e32 v43, v43
  v_mfma_f32_16x16x32_bf16 v[44:47], a[184:187], a[56:59], 0
  v_add_f32_e32 v0, v0, v40
  v_add_f32_e32 v0, v0, v41
  v_mfma_f32_16x16x32_bf16 v[44:47], a[188:191], a[60:63], v[44:47]
  v_cvt_pk_bf16_f32 v40, v40, v41
  v_add_f32_e32 v0, v0, v42
  v_mfma_f32_16x16x32_bf16 v[44:47], a[192:195], a[64:67], v[44:47]
  ds_read_b64_tr_b16 a[160:161], v4 offset:12288
  v_add_f32_e32 v0, v0, v43
  v_mfma_f32_16x16x32_bf16 v[44:47], a[196:199], a[68:71], v[44:47]
  v_cvt_pk_bf16_f32 v41, v42, v43
  v_fma_f32 v48, v48, s35, -v16
  v_mfma_f32_16x16x32_bf16 v[44:47], a[200:203], a[72:75], v[44:47]
  ds_read_b64_tr_b16 a[162:163], v4 offset:18432
  v_fma_f32 v36, v36, s35, -v14
  v_mfma_f32_16x16x32_bf16 v[44:47], a[204:207], a[76:79], v[44:47]
  buffer_load_dwordx4 v9, s[8:11], s32 offen offset:1024 nt lds
  v_mfma_f32_16x16x32_bf16 v[52:55], a[184:187], a[80:83], 0
  ds_read_b64_tr_b16 a[164:165], v5 offset:12288
  v_fma_f32 v37, v37, s35, -v14
  v_mfma_f32_16x16x32_bf16 v[52:55], a[188:191], a[84:87], v[52:55]
  v_exp_f32_e32 v36, v36
  v_mfma_f32_16x16x32_bf16 v[52:55], a[192:195], a[88:91], v[52:55]
  ds_read_b64_tr_b16 a[166:167], v5 offset:18432
  v_fma_f32 v38, v38, s35, -v14
  v_mfma_f32_16x16x32_bf16 v[52:55], a[196:199], a[92:95], v[52:55]
  v_exp_f32_e32 v37, v37
  v_mfma_f32_16x16x32_bf16 v[52:55], a[200:203], a[96:99], v[52:55]
  ds_read_b64_tr_b16 a[168:169], v6 offset:12288
  v_fma_f32 v39, v39, s35, -v14
  v_mfma_f32_16x16x32_bf16 v[52:55], a[204:207], a[100:103], v[52:55]
  v_exp_f32_e32 v38, v38
  v_mfma_f32_16x16x32_bf16 v[60:63], a[184:187], a[104:107], 0
  ds_read_b64_tr_b16 a[170:171], v6 offset:18432
  v_cvt_pk_bf16_f32 v34, v36, v37
  v_mfma_f32_16x16x32_bf16 v[60:63], a[188:191], a[108:111], v[60:63]
  v_exp_f32_e32 v39, v39
  v_mfma_f32_16x16x32_bf16 v[60:63], a[192:195], a[112:115], v[60:63]
  ds_read_b64_tr_b16 a[172:173], v7 offset:12288
  v_cvt_pk_bf16_f32 v35, v38, v39
  v_mfma_f32_16x16x32_bf16 v[60:63], a[196:199], a[116:119], v[60:63]
  v_exp_f32_e32 v48, v48
  v_mfma_f32_16x16x32_bf16 v[60:63], a[200:203], a[120:123], v[60:63]
  ds_read_b64_tr_b16 a[174:175], v7 offset:18432
  v_fma_f32 v44, v44, s35, -v15
  v_mfma_f32_16x16x32_bf16 v[60:63], a[204:207], a[124:127], v[60:63]
  buffer_load_dwordx4 v10, s[8:11], s32 offen offset:2048 nt lds
  v_mfma_f32_16x16x32_bf16 a[240:243], v[18:21], v[64:67], a[240:243]
  s_waitcnt lgkmcnt(4)
  ds_read_b64_tr_b16 a[176:177], v4 offset:12416
  v_fma_f32 v45, v45, s35, -v15
  v_mfma_f32_16x16x32_bf16 v[96:99], a[160:163], v[64:67], v[96:99]
  v_exp_f32_e32 v44, v44
  v_mfma_f32_16x16x32_bf16 v[100:103], a[160:163], v[72:75], v[100:103]
  ds_read_b64_tr_b16 a[178:179], v4 offset:18560
  v_fma_f32 v46, v46, s35, -v15
  v_mfma_f32_16x16x32_bf16 v[104:107], a[160:163], v[80:83], v[104:107]
  v_exp_f32_e32 v45, v45
  v_mfma_f32_16x16x32_bf16 v[108:111], a[160:163], v[88:91], v[108:111]
  ds_read_b64_tr_b16 a[180:181], v5 offset:12416
  v_fma_f32 v47, v47, s35, -v15
  v_mfma_f32_16x16x32_bf16 v[112:115], a[164:167], v[64:67], v[112:115]
  v_exp_f32_e32 v46, v46
  v_mfma_f32_16x16x32_bf16 v[116:119], a[164:167], v[72:75], v[116:119]
  ds_read_b64_tr_b16 a[182:183], v5 offset:18560
  v_cvt_pk_bf16_f32 v42, v44, v45
  v_mfma_f32_16x16x32_bf16 v[120:123], a[164:167], v[80:83], v[120:123]
  v_exp_f32_e32 v47, v47
  v_mfma_f32_16x16x32_bf16 v[124:127], a[164:167], v[88:91], v[124:127]
  s_waitcnt lgkmcnt(4)
  ds_read_b64_tr_b16 a[184:185], v6 offset:12416
  v_cvt_pk_bf16_f32 v43, v46, v47
  v_mfma_f32_16x16x32_bf16 v[128:131], a[168:171], v[64:67], v[128:131]
  s_add_u32 m0, s34, 49152
  v_fma_f32 v49, v49, s35, -v16
  v_fma_f32 v50, v50, s35, -v16
  v_mfma_f32_16x16x32_bf16 v[132:135], a[168:171], v[72:75], v[132:135]
  s_mov_b32 s33, 98304
  ds_read_b64_tr_b16 a[186:187], v6 offset:18560
  v_fma_f32 v51, v51, s35, -v16
  v_mfma_f32_16x16x32_bf16 v[136:139], a[168:171], v[80:83], v[136:139]
  buffer_load_dwordx4 v8, s[12:15], s33 offen nt lds
  v_mfma_f32_16x16x32_bf16 v[140:143], a[168:171], v[88:91], v[140:143]
  ds_read_b64_tr_b16 a[188:189], v7 offset:12416
  v_fma_f32 v52, v52, s35, -v16
  v_mfma_f32_16x16x32_bf16 v[144:147], a[172:175], v[64:67], v[144:147]
  v_exp_f32_e32 v49, v49
  v_mfma_f32_16x16x32_bf16 v[148:151], a[172:175], v[72:75], v[148:151]
  ds_read_b64_tr_b16 a[190:191], v7 offset:18560
  v_fma_f32 v53, v53, s35, -v16
  v_mfma_f32_16x16x32_bf16 v[152:155], a[172:175], v[80:83], v[152:155]
  v_exp_f32_e32 v50, v50
  v_mfma_f32_16x16x32_bf16 v[156:159], a[172:175], v[88:91], v[156:159]
  s_waitcnt lgkmcnt(4)
  ds_read_b64_tr_b16 a[192:193], v4 offset:12544
  v_fma_f32 v54, v54, s35, -v16
  v_mfma_f32_16x16x32_bf16 v[160:163], a[176:179], v[64:67], v[160:163]
  v_exp_f32_e32 v51, v51
  v_mfma_f32_16x16x32_bf16 v[164:167], a[176:179], v[72:75], v[164:167]
  ds_read_b64_tr_b16 a[194:195], v4 offset:18688
  v_fma_f32 v55, v55, s35, -v16
  v_mfma_f32_16x16x32_bf16 v[168:171], a[176:179], v[80:83], v[168:171]
  v_exp_f32_e32 v52, v52
  v_mfma_f32_16x16x32_bf16 v[172:175], a[176:179], v[88:91], v[172:175]
  ds_read_b64_tr_b16 a[196:197], v5 offset:12544
  v_add_f32_e32 v30, v30, v48
  v_mfma_f32_16x16x32_bf16 v[176:179], a[180:183], v[64:67], v[176:179]
  v_exp_f32_e32 v53, v53
  v_mfma_f32_16x16x32_bf16 v[180:183], a[180:183], v[72:75], v[180:183]
  ds_read_b64_tr_b16 a[198:199], v5 offset:18688
  v_add_f32_e32 v30, v30, v49
  v_mfma_f32_16x16x32_bf16 v[184:187], a[180:183], v[80:83], v[184:187]
  buffer_load_dwordx4 v9, s[12:15], s33 offen offset:1024 nt lds
  v_mfma_f32_16x16x32_bf16 v[188:191], a[180:183], v[88:91], v[188:191]
  s_waitcnt lgkmcnt(4)
  ds_read_b64_tr_b16 a[200:201], v6 offset:12544
  v_cvt_pk_bf16_f32 v48, v48, v49
  v_mfma_f32_16x16x32_bf16 v[192:195], a[184:187], v[64:67], v[192:195]
  v_exp_f32_e32 v54, v54
  v_mfma_f32_16x16x32_bf16 v[196:199], a[184:187], v[72:75], v[196:199]
  ds_read_b64_tr_b16 a[202:203], v6 offset:18688
  v_add_f32_e32 v30, v30, v50
  v_mfma_f32_16x16x32_bf16 v[200:203], a[184:187], v[80:83], v[200:203]
  v_exp_f32_e32 v55, v55
  v_mfma_f32_16x16x32_bf16 v[204:207], a[184:187], v[88:91], v[204:207]
  ds_read_b64_tr_b16 a[204:205], v7 offset:12544
  v_add_f32_e32 v30, v30, v51
  v_mfma_f32_16x16x32_bf16 v[208:211], a[188:191], v[64:67], v[208:211]
  v_cvt_pk_bf16_f32 v49, v50, v51
  v_cvt_pk_bf16_f32 v50, v52, v53
  v_mfma_f32_16x16x32_bf16 v[212:215], a[188:191], v[72:75], v[212:215]
  ds_read_b64_tr_b16 a[206:207], v7 offset:18688
  v_cvt_pk_bf16_f32 v51, v54, v55
  v_mfma_f32_16x16x32_bf16 v[216:219], a[188:191], v[80:83], v[216:219]
  v_fma_f32 v56, v56, s35, -v17
  v_fma_f32 v57, v57, s35, -v17
  v_mfma_f32_16x16x32_bf16 v[220:223], a[188:191], v[88:91], v[220:223]
  s_waitcnt lgkmcnt(4)
  ds_read_b128 a[160:163], v2 offset:36864
  v_fma_f32 v58, v58, s35, -v17
  v_mfma_f32_16x16x32_bf16 v[224:227], a[192:195], v[64:67], v[224:227]
  v_exp_f32_e32 v56, v56
  v_mfma_f32_16x16x32_bf16 v[228:231], a[192:195], v[72:75], v[228:231]
  ds_read_b128 a[164:167], v3 offset:36864
  v_fma_f32 v59, v59, s35, -v17
  v_mfma_f32_16x16x32_bf16 v[232:235], a[192:195], v[80:83], v[232:235]
  buffer_load_dwordx4 v10, s[12:15], s33 offen offset:2048 nt lds
  v_mfma_f32_16x16x32_bf16 v[236:239], a[192:195], v[88:91], v[236:239]
  ds_read_b128 a[168:171], v2 offset:36992
  v_fma_f32 v60, v60, s35, -v17
  v_mfma_f32_16x16x32_bf16 v[240:243], a[196:199], v[64:67], v[240:243]
  v_exp_f32_e32 v57, v57
  v_mfma_f32_16x16x32_bf16 v[244:247], a[196:199], v[72:75], v[244:247]
  ds_read_b128 a[172:175], v3 offset:36992
  v_fma_f32 v61, v61, s35, -v17
  v_mfma_f32_16x16x32_bf16 v[248:251], a[196:199], v[80:83], v[248:251]
  v_exp_f32_e32 v58, v58
  v_mfma_f32_16x16x32_bf16 v[252:255], a[196:199], v[88:91], v[252:255]
  s_waitcnt lgkmcnt(3)
  ds_read_b128 a[176:179], v2 offset:37120
  v_fma_f32 v62, v62, s35, -v17
  v_mfma_f32_16x16x32_bf16 a[0:3], a[200:203], v[64:67], a[0:3]
  v_exp_f32_e32 v59, v59
  v_mfma_f32_16x16x32_bf16 a[4:7], a[200:203], v[72:75], a[4:7]
  ds_read_b128 a[180:183], v3 offset:37120
  v_fma_f32 v63, v63, s35, -v17
  v_mfma_f32_16x16x32_bf16 a[8:11], a[200:203], v[80:83], a[8:11]
  v_exp_f32_e32 v60, v60
  v_mfma_f32_16x16x32_bf16 a[12:15], a[200:203], v[88:91], a[12:15]
  v_exp_f32_e32 v61, v61
  v_mfma_f32_16x16x32_bf16 a[16:19], a[204:207], v[64:67], a[16:19]
  v_exp_f32_e32 v62, v62
  v_mfma_f32_16x16x32_bf16 a[20:23], a[204:207], v[72:75], a[20:23]
  s_add_u32 m0, s28, 8192
  v_exp_f32_e32 v63, v63
  v_mfma_f32_16x16x32_bf16 a[24:27], a[204:207], v[80:83], a[24:27]
  buffer_load_dwordx4 v11, s[24:27], s84 offen nt lds
  v_mfma_f32_16x16x32_bf16 a[28:31], a[204:207], v[88:91], a[28:31]
  v_add_f32_e32 v31, v31, v56
  v_add_f32_e32 v31, v31, v57
  v_mfma_f32_16x16x32_bf16 v[64:67], a[160:163], a[32:35], 0
  s_waitcnt lgkmcnt(1)
  v_cvt_pk_bf16_f32 v56, v56, v57
  v_add_f32_e32 v31, v31, v58
  v_mfma_f32_16x16x32_bf16 v[64:67], a[164:167], a[36:39], v[64:67]
  v_add_f32_e32 v31, v31, v59
  v_cvt_pk_bf16_f32 v57, v58, v59
  v_mfma_f32_16x16x32_bf16 v[64:67], a[168:171], a[40:43], v[64:67]
  v_cvt_pk_bf16_f32 v58, v60, v61
  v_cvt_pk_bf16_f32 v59, v62, v63
  v_mfma_f32_16x16x32_bf16 v[64:67], a[172:175], a[44:47], v[64:67]
  v_add_f32_e32 v0, v0, v44
  v_add_f32_e32 v0, v0, v45
  v_mfma_f32_16x16x32_bf16 v[64:67], a[176:179], a[48:51], v[64:67]
  s_waitcnt lgkmcnt(0)
  v_add_f32_e32 v0, v0, v46
  v_add_f32_e32 v0, v0, v47
  v_mfma_f32_16x16x32_bf16 v[64:67], a[180:183], a[52:55], v[64:67]
  v_add_f32_e32 v30, v30, v52
  v_add_f32_e32 v30, v30, v53
  v_mfma_f32_16x16x32_bf16 v[72:75], a[160:163], a[56:59], 0
  v_add_f32_e32 v30, v30, v54
  v_add_f32_e32 v30, v30, v55
  v_mfma_f32_16x16x32_bf16 v[72:75], a[164:167], a[60:63], v[72:75]
  ds_read_b128 a[184:187], v2 offset:43008
  v_add_f32_e32 v31, v31, v60
  v_mfma_f32_16x16x32_bf16 v[72:75], a[168:171], a[64:67], v[72:75]
  v_add_f32_e32 v31, v31, v61
  v_add_f32_e32 v31, v31, v62
  v_mfma_f32_16x16x32_bf16 v[72:75], a[172:175], a[68:71], v[72:75]
  s_add_u32 m0, s28, 6144
  ds_read_b128 a[188:191], v3 offset:43008
  v_add_f32_e32 v31, v31, v63
  v_mfma_f32_16x16x32_bf16 v[72:75], a[176:179], a[72:75], v[72:75]
  buffer_load_dwordx4 v11, s[24:27], s84 offen offset:3072 nt lds
  v_mfma_f32_16x16x32_bf16 v[72:75], a[180:183], a[76:79], v[72:75]
  ds_read_b128 a[192:195], v2 offset:43136
  v_fma_f32 v64, v64, s35, -v14
  v_mfma_f32_16x16x32_bf16 v[80:83], a[160:163], a[80:83], 0
  v_exp_f32_e32 v64, v64
  v_mfma_f32_16x16x32_bf16 v[80:83], a[164:167], a[84:87], v[80:83]
  ds_read_b128 a[196:199], v3 offset:43136
  v_fma_f32 v65, v65, s35, -v14
  v_mfma_f32_16x16x32_bf16 v[80:83], a[168:171], a[88:91], v[80:83]
  v_exp_f32_e32 v65, v65
  v_mfma_f32_16x16x32_bf16 v[80:83], a[172:175], a[92:95], v[80:83]
  ds_read_b128 a[200:203], v2 offset:43264
  v_fma_f32 v66, v66, s35, -v14
  v_mfma_f32_16x16x32_bf16 v[80:83], a[176:179], a[96:99], v[80:83]
  v_exp_f32_e32 v66, v66
  v_mfma_f32_16x16x32_bf16 v[80:83], a[180:183], a[100:103], v[80:83]
  ds_read_b128 a[204:207], v3 offset:43264
  v_fma_f32 v67, v67, s35, -v14
  v_mfma_f32_16x16x32_bf16 v[88:91], a[160:163], a[104:107], 0
  s_waitcnt vmcnt(13)
  s_barrier
  v_mfma_f32_16x16x32_bf16 v[88:91], a[164:167], a[108:111], v[88:91]
  v_exp_f32_e32 v67, v67
  v_mfma_f32_16x16x32_bf16 v[88:91], a[168:171], a[112:115], v[88:91]
  s_add_u32 m0, s34, 24576
  v_cvt_pk_bf16_f32 v64, v64, v65
  v_cvt_pk_bf16_f32 v65, v66, v67
  v_mfma_f32_16x16x32_bf16 v[88:91], a[172:175], a[116:119], v[88:91]
  s_mov_b32 s32, 122880
  v_fma_f32 v72, v72, s35, -v15
  v_fma_f32 v73, v73, s35, -v15
  v_mfma_f32_16x16x32_bf16 v[88:91], a[176:179], a[120:123], v[88:91]
  buffer_load_dwordx4 v8, s[8:11], s32 offen nt lds
  v_mfma_f32_16x16x32_bf16 v[88:91], a[180:183], a[124:127], v[88:91]
  s_waitcnt lgkmcnt(1)
  v_exp_f32_e32 v72, v72
  v_mfma_f32_16x16x32_bf16 v[68:71], a[184:187], a[32:35], 0
  v_exp_f32_e32 v73, v73
  v_mfma_f32_16x16x32_bf16 v[68:71], a[188:191], a[36:39], v[68:71]
  v_fma_f32 v74, v74, s35, -v15
  v_fma_f32 v75, v75, s35, -v15
  v_mfma_f32_16x16x32_bf16 v[68:71], a[192:195], a[40:43], v[68:71]
  v_exp_f32_e32 v74, v74
  v_mfma_f32_16x16x32_bf16 v[68:71], a[196:199], a[44:47], v[68:71]
  v_exp_f32_e32 v75, v75
  v_mfma_f32_16x16x32_bf16 v[68:71], a[200:203], a[48:51], v[68:71]
  s_waitcnt lgkmcnt(0)
  v_add_f32_e32 v0, v0, v72
  v_add_f32_e32 v0, v0, v73
  v_mfma_f32_16x16x32_bf16 v[68:71], a[204:207], a[52:55], v[68:71]
  v_cvt_pk_bf16_f32 v72, v72, v73
  v_add_f32_e32 v0, v0, v74
  v_mfma_f32_16x16x32_bf16 v[76:79], a[184:187], a[56:59], 0
  v_add_f32_e32 v0, v0, v75
  v_cvt_pk_bf16_f32 v73, v74, v75
  v_mfma_f32_16x16x32_bf16 v[76:79], a[188:191], a[60:63], v[76:79]
  v_fma_f32 v80, v80, s35, -v16
  v_fma_f32 v81, v81, s35, -v16
  v_mfma_f32_16x16x32_bf16 v[76:79], a[192:195], a[64:67], v[76:79]
  ds_read_b64_tr_b16 a[160:161], v4 offset:24576
  v_fma_f32 v82, v82, s35, -v16
  v_mfma_f32_16x16x32_bf16 v[76:79], a[196:199], a[68:71], v[76:79]
  v_exp_f32_e32 v80, v80
  v_mfma_f32_16x16x32_bf16 v[76:79], a[200:203], a[72:75], v[76:79]
  ds_read_b64_tr_b16 a[162:163], v4 offset:30720
  v_fma_f32 v68, v68, s35, -v14
  v_mfma_f32_16x16x32_bf16 v[76:79], a[204:207], a[76:79], v[76:79]
  buffer_load_dwordx4 v9, s[8:11], s32 offen offset:1024 nt lds
  v_mfma_f32_16x16x32_bf16 v[84:87], a[184:187], a[80:83], 0
  ds_read_b64_tr_b16 a[164:165], v5 offset:24576
  v_fma_f32 v69, v69, s35, -v14
  v_mfma_f32_16x16x32_bf16 v[84:87], a[188:191], a[84:87], v[84:87]
  v_exp_f32_e32 v68, v68
  v_mfma_f32_16x16x32_bf16 v[84:87], a[192:195], a[88:91], v[84:87]
  ds_read_b64_tr_b16 a[166:167], v5 offset:30720
  v_fma_f32 v70, v70, s35, -v14
  v_mfma_f32_16x16x32_bf16 v[84:87], a[196:199], a[92:95], v[84:87]
  v_exp_f32_e32 v69, v69
  v_mfma_f32_16x16x32_bf16 v[84:87], a[200:203], a[96:99], v[84:87]
  ds_read_b64_tr_b16 a[168:169], v6 offset:24576
  v_fma_f32 v71, v71, s35, -v14
  v_mfma_f32_16x16x32_bf16 v[84:87], a[204:207], a[100:103], v[84:87]
  v_exp_f32_e32 v70, v70
  v_mfma_f32_16x16x32_bf16 v[92:95], a[184:187], a[104:107], 0
  ds_read_b64_tr_b16 a[170:171], v6 offset:30720
  v_cvt_pk_bf16_f32 v66, v68, v69
  v_mfma_f32_16x16x32_bf16 v[92:95], a[188:191], a[108:111], v[92:95]
  v_exp_f32_e32 v71, v71
  v_mfma_f32_16x16x32_bf16 v[92:95], a[192:195], a[112:115], v[92:95]
  ds_read_b64_tr_b16 a[172:173], v7 offset:24576
  v_cvt_pk_bf16_f32 v67, v70, v71
  v_mfma_f32_16x16x32_bf16 v[92:95], a[196:199], a[116:119], v[92:95]
  v_exp_f32_e32 v81, v81
  v_mfma_f32_16x16x32_bf16 v[92:95], a[200:203], a[120:123], v[92:95]
  ds_read_b64_tr_b16 a[174:175], v7 offset:30720
  v_fma_f32 v76, v76, s35, -v15
  v_mfma_f32_16x16x32_bf16 v[92:95], a[204:207], a[124:127], v[92:95]
  buffer_load_dwordx4 v10, s[8:11], s32 offen offset:2048 nt lds
  v_mfma_f32_16x16x32_bf16 a[240:243], v[18:21], v[32:35], a[240:243]
  s_waitcnt lgkmcnt(4)
  ds_read_b64_tr_b16 a[176:177], v4 offset:24704
  v_fma_f32 v77, v77, s35, -v15
  v_mfma_f32_16x16x32_bf16 v[96:99], a[160:163], v[32:35], v[96:99]
  v_exp_f32_e32 v76, v76
  v_mfma_f32_16x16x32_bf16 v[100:103], a[160:163], v[40:43], v[100:103]
  ds_read_b64_tr_b16 a[178:179], v4 offset:30848
  v_fma_f32 v78, v78, s35, -v15
  v_mfma_f32_16x16x32_bf16 v[104:107], a[160:163], v[48:51], v[104:107]
  v_exp_f32_e32 v77, v77
  v_mfma_f32_16x16x32_bf16 v[108:111], a[160:163], v[56:59], v[108:111]
  ds_read_b64_tr_b16 a[180:181], v5 offset:24704
  v_fma_f32 v79, v79, s35, -v15
  v_mfma_f32_16x16x32_bf16 v[112:115], a[164:167], v[32:35], v[112:115]
  v_exp_f32_e32 v78, v78
  v_mfma_f32_16x16x32_bf16 v[116:119], a[164:167], v[40:43], v[116:119]
  ds_read_b64_tr_b16 a[182:183], v5 offset:30848
  v_cvt_pk_bf16_f32 v74, v76, v77
  v_mfma_f32_16x16x32_bf16 v[120:123], a[164:167], v[48:51], v[120:123]
  v_exp_f32_e32 v79, v79
  v_mfma_f32_16x16x32_bf16 v[124:127], a[164:167], v[56:59], v[124:127]
  s_waitcnt lgkmcnt(4)
  ds_read_b64_tr_b16 a[184:185], v6 offset:24704
  v_cvt_pk_bf16_f32 v75, v78, v79
  v_mfma_f32_16x16x32_bf16 v[128:131], a[168:171], v[32:35], v[128:131]
  s_add_u32 m0, s34, 61440
  v_exp_f32_e32 v82, v82
  v_mfma_f32_16x16x32_bf16 v[132:135], a[168:171], v[40:43], v[132:135]
  s_mov_b32 s33, 110592
  ds_read_b64_tr_b16 a[186:187], v6 offset:30848
  v_fma_f32 v83, v83, s35, -v16
  v_mfma_f32_16x16x32_bf16 v[136:139], a[168:171], v[48:51], v[136:139]
  buffer_load_dwordx4 v8, s[12:15], s33 offen nt lds
  v_mfma_f32_16x16x32_bf16 v[140:143], a[168:171], v[56:59], v[140:143]
  ds_read_b64_tr_b16 a[188:189], v7 offset:24704
  v_fma_f32 v84, v84, s35, -v16
  v_mfma_f32_16x16x32_bf16 v[144:147], a[172:175], v[32:35], v[144:147]
  v_exp_f32_e32 v83, v83
  v_mfma_f32_16x16x32_bf16 v[148:151], a[172:175], v[40:43], v[148:151]
  ds_read_b64_tr_b16 a[190:191], v7 offset:30848
  v_fma_f32 v85, v85, s35, -v16
  v_mfma_f32_16x16x32_bf16 v[152:155], a[172:175], v[48:51], v[152:155]
  v_exp_f32_e32 v84, v84
  v_mfma_f32_16x16x32_bf16 v[156:159], a[172:175], v[56:59], v[156:159]
  s_waitcnt lgkmcnt(4)
  ds_read_b64_tr_b16 a[192:193], v4 offset:24832
  v_fma_f32 v86, v86, s35, -v16
  v_mfma_f32_16x16x32_bf16 v[160:163], a[176:179], v[32:35], v[160:163]
  v_exp_f32_e32 v85, v85
  v_mfma_f32_16x16x32_bf16 v[164:167], a[176:179], v[40:43], v[164:167]
  ds_read_b64_tr_b16 a[194:195], v4 offset:30976
  v_fma_f32 v87, v87, s35, -v16
  v_mfma_f32_16x16x32_bf16 v[168:171], a[176:179], v[48:51], v[168:171]
  v_exp_f32_e32 v86, v86
  v_mfma_f32_16x16x32_bf16 v[172:175], a[176:179], v[56:59], v[172:175]
  ds_read_b64_tr_b16 a[196:197], v5 offset:24832
  v_add_f32_e32 v30, v30, v80
  v_mfma_f32_16x16x32_bf16 v[176:179], a[180:183], v[32:35], v[176:179]
  v_exp_f32_e32 v87, v87
  v_mfma_f32_16x16x32_bf16 v[180:183], a[180:183], v[40:43], v[180:183]
  ds_read_b64_tr_b16 a[198:199], v5 offset:30976
  v_add_f32_e32 v30, v30, v81
  v_mfma_f32_16x16x32_bf16 v[184:187], a[180:183], v[48:51], v[184:187]
  buffer_load_dwordx4 v9, s[12:15], s33 offen offset:1024 nt lds
  v_mfma_f32_16x16x32_bf16 v[188:191], a[180:183], v[56:59], v[188:191]
  s_waitcnt lgkmcnt(4)
  ds_read_b64_tr_b16 a[200:201], v6 offset:24832
  v_cvt_pk_bf16_f32 v80, v80, v81
  v_mfma_f32_16x16x32_bf16 v[192:195], a[184:187], v[32:35], v[192:195]
  v_add_f32_e32 v30, v30, v82
  v_add_f32_e32 v30, v30, v83
  v_mfma_f32_16x16x32_bf16 v[196:199], a[184:187], v[40:43], v[196:199]
  ds_read_b64_tr_b16 a[202:203], v6 offset:30976
  v_cvt_pk_bf16_f32 v81, v82, v83
  v_mfma_f32_16x16x32_bf16 v[200:203], a[184:187], v[48:51], v[200:203]
  v_cvt_pk_bf16_f32 v82, v84, v85
  v_cvt_pk_bf16_f32 v83, v86, v87
  v_mfma_f32_16x16x32_bf16 v[204:207], a[184:187], v[56:59], v[204:207]
  ds_read_b64_tr_b16 a[204:205], v7 offset:24832
  v_fma_f32 v88, v88, s35, -v17
  v_mfma_f32_16x16x32_bf16 v[208:211], a[188:191], v[32:35], v[208:211]
  v_exp_f32_e32 v88, v88
  v_mfma_f32_16x16x32_bf16 v[212:215], a[188:191], v[40:43], v[212:215]
  ds_read_b64_tr_b16 a[206:207], v7 offset:30976
  v_fma_f32 v89, v89, s35, -v17
  v_mfma_f32_16x16x32_bf16 v[216:219], a[188:191], v[48:51], v[216:219]
  v_exp_f32_e32 v89, v89
  v_mfma_f32_16x16x32_bf16 v[220:223], a[188:191], v[56:59], v[220:223]
  s_waitcnt lgkmcnt(4)
  ds_read_b128 a[160:163], v2 offset:0
  v_fma_f32 v90, v90, s35, -v17
  v_mfma_f32_16x16x32_bf16 v[224:227], a[192:195], v[32:35], v[224:227]
  v_exp_f32_e32 v90, v90
  v_mfma_f32_16x16x32_bf16 v[228:231], a[192:195], v[40:43], v[228:231]
  ds_read_b128 a[164:167], v3 offset:0
  v_fma_f32 v91, v91, s35, -v17
  v_mfma_f32_16x16x32_bf16 v[232:235], a[192:195], v[48:51], v[232:235]
  buffer_load_dwordx4 v10, s[12:15], s33 offen offset:2048 nt lds
  v_mfma_f32_16x16x32_bf16 v[236:239], a[192:195], v[56:59], v[236:239]
  ds_read_b128 a[168:171], v2 offset:128
  v_fma_f32 v92, v92, s35, -v17
  v_mfma_f32_16x16x32_bf16 v[240:243], a[196:199], v[32:35], v[240:243]
  v_exp_f32_e32 v91, v91
  v_mfma_f32_16x16x32_bf16 v[244:247], a[196:199], v[40:43], v[244:247]
  ds_read_b128 a[172:175], v3 offset:128
  v_fma_f32 v93, v93, s35, -v17
  v_mfma_f32_16x16x32_bf16 v[248:251], a[196:199], v[48:51], v[248:251]
  v_exp_f32_e32 v92, v92
  v_mfma_f32_16x16x32_bf16 v[252:255], a[196:199], v[56:59], v[252:255]
  s_waitcnt lgkmcnt(3)
  ds_read_b128 a[176:179], v2 offset:256
  v_fma_f32 v94, v94, s35, -v17
  v_mfma_f32_16x16x32_bf16 a[0:3], a[200:203], v[32:35], a[0:3]
  v_exp_f32_e32 v93, v93
  v_mfma_f32_16x16x32_bf16 a[4:7], a[200:203], v[40:43], a[4:7]
  ds_read_b128 a[180:183], v3 offset:256
  v_fma_f32 v95, v95, s35, -v17
  v_mfma_f32_16x16x32_bf16 a[8:11], a[200:203], v[48:51], a[8:11]
  v_exp_f32_e32 v94, v94
  v_mfma_f32_16x16x32_bf16 a[12:15], a[200:203], v[56:59], a[12:15]
  v_exp_f32_e32 v95, v95
  v_mfma_f32_16x16x32_bf16 a[16:19], a[204:207], v[32:35], a[16:19]
  v_add_f32_e32 v31, v31, v88
  v_add_f32_e32 v31, v31, v89
  v_mfma_f32_16x16x32_bf16 a[20:23], a[204:207], v[40:43], a[20:23]
  s_add_u32 m0, s28, 10240
  v_cvt_pk_bf16_f32 v88, v88, v89
  v_add_f32_e32 v31, v31, v90
  v_mfma_f32_16x16x32_bf16 a[24:27], a[204:207], v[48:51], a[24:27]
  buffer_load_dwordx4 v11, s[24:27], s85 offen nt lds
  v_mfma_f32_16x16x32_bf16 a[28:31], a[204:207], v[56:59], a[28:31]
  v_add_f32_e32 v31, v31, v91
  v_cvt_pk_bf16_f32 v89, v90, v91
  v_mfma_f32_16x16x32_bf16 v[32:35], a[160:163], a[32:35], 0
  s_waitcnt lgkmcnt(1)
  v_cvt_pk_bf16_f32 v90, v92, v93
  v_cvt_pk_bf16_f32 v91, v94, v95
  v_mfma_f32_16x16x32_bf16 v[32:35], a[164:167], a[36:39], v[32:35]
  v_add_f32_e32 v0, v0, v76
  v_add_f32_e32 v0, v0, v77
  v_mfma_f32_16x16x32_bf16 v[32:35], a[168:171], a[40:43], v[32:35]
  v_add_f32_e32 v0, v0, v78
  v_add_f32_e32 v0, v0, v79
  v_mfma_f32_16x16x32_bf16 v[32:35], a[172:175], a[44:47], v[32:35]
  v_add_f32_e32 v30, v30, v84
  v_add_f32_e32 v30, v30, v85
  v_mfma_f32_16x16x32_bf16 v[32:35], a[176:179], a[48:51], v[32:35]
  s_waitcnt lgkmcnt(0)
  v_add_f32_e32 v30, v30, v86
  v_add_f32_e32 v30, v30, v87
  v_mfma_f32_16x16x32_bf16 v[32:35], a[180:183], a[52:55], v[32:35]
  v_add_f32_e32 v31, v31, v92
  v_add_f32_e32 v31, v31, v93
  v_mfma_f32_16x16x32_bf16 v[40:43], a[160:163], a[56:59], 0
  v_add_f32_e32 v31, v31, v94
  v_add_f32_e32 v31, v31, v95
  v_mfma_f32_16x16x32_bf16 v[40:43], a[164:167], a[60:63], v[40:43]
  ds_read_b128 a[184:187], v2 offset:6144
  v_mfma_f32_16x16x32_bf16 v[40:43], a[168:171], a[64:67], v[40:43]
  v_mfma_f32_16x16x32_bf16 v[40:43], a[172:175], a[68:71], v[40:43]
  s_add_u32 m0, s28, 8192
  ds_read_b128 a[188:191], v3 offset:6144
  v_mfma_f32_16x16x32_bf16 v[40:43], a[176:179], a[72:75], v[40:43]
  buffer_load_dwordx4 v11, s[24:27], s85 offen offset:3072 nt lds
  v_mfma_f32_16x16x32_bf16 v[40:43], a[180:183], a[76:79], v[40:43]
  ds_read_b128 a[192:195], v2 offset:6272
  v_fma_f32 v32, v32, s35, -v14
  v_mfma_f32_16x16x32_bf16 v[48:51], a[160:163], a[80:83], 0
  v_exp_f32_e32 v32, v32
  v_mfma_f32_16x16x32_bf16 v[48:51], a[164:167], a[84:87], v[48:51]
  ds_read_b128 a[196:199], v3 offset:6272
  v_fma_f32 v33, v33, s35, -v14
  v_mfma_f32_16x16x32_bf16 v[48:51], a[168:171], a[88:91], v[48:51]
  v_exp_f32_e32 v33, v33
  v_mfma_f32_16x16x32_bf16 v[48:51], a[172:175], a[92:95], v[48:51]
  ds_read_b128 a[200:203], v2 offset:6400
  v_fma_f32 v34, v34, s35, -v14
  v_mfma_f32_16x16x32_bf16 v[48:51], a[176:179], a[96:99], v[48:51]
  s_waitcnt vmcnt(16)
  ds_read_b128 a[144:147], v12 offset:4096
  v_fma_f32 v35, v35, s35, -v14
  v_mfma_f32_16x16x32_bf16 v[48:51], a[180:183], a[100:103], v[48:51]
  ds_read_b128 a[204:207], v3 offset:6400
  ds_read_b128 a[148:151], v13 offset:4096
  v_mfma_f32_16x16x32_bf16 v[56:59], a[160:163], a[104:107], 0
  s_waitcnt vmcnt(13)
  s_barrier
  v_mfma_f32_16x16x32_bf16 v[56:59], a[164:167], a[108:111], v[56:59]
  ds_read_b128 a[152:155], v12 offset:6144
L_hop3:
  s_cbranch_execz L_hop7
  v_cvt_pk_bf16_f32 v32, v32, v33
  v_mfma_f32_16x16x32_bf16 v[56:59], a[168:171], a[112:115], v[56:59]
  s_add_u32 m0, s34, 36864
  ds_read_b128 a[156:159], v13 offset:6144
  v_fma_f32 v40, v40, s35, -v15
  v_mfma_f32_16x16x32_bf16 v[56:59], a[172:175], a[116:119], v[56:59]
  s_mov_b32 s32, 135168
  v_exp_f32_e32 v34, v34
  v_mfma_f32_16x16x32_bf16 v[56:59], a[176:179], a[120:123], v[56:59]
  buffer_load_dwordx4 v8, s[8:11], s32 offen nt lds
  v_mfma_f32_16x16x32_bf16 v[56:59], a[180:183], a[124:127], v[56:59]
  s_waitcnt lgkmcnt(5)
  v_exp_f32_e32 v35, v35
  v_mfma_f32_16x16x32_bf16 v[36:39], a[184:187], a[32:35], 0
  v_exp_f32_e32 v40, v40
  v_mfma_f32_16x16x32_bf16 v[36:39], a[188:191], a[36:39], v[36:39]
  v_cvt_pk_bf16_f32 v33, v34, v35
  v_fma_f32 v41, v41, s35, -v15
  v_mfma_f32_16x16x32_bf16 v[36:39], a[192:195], a[40:43], v[36:39]
  v_exp_f32_e32 v41, v41
  v_mfma_f32_16x16x32_bf16 v[36:39], a[196:199], a[44:47], v[36:39]
  v_fma_f32 v42, v42, s35, -v15
  v_fma_f32 v43, v43, s35, -v15
  v_mfma_f32_16x16x32_bf16 v[36:39], a[200:203], a[48:51], v[36:39]
  s_waitcnt lgkmcnt(3)
  v_exp_f32_e32 v42, v42
  v_mfma_f32_16x16x32_bf16 v[36:39], a[204:207], a[52:55], v[36:39]
  v_exp_f32_e32 v43, v43
  v_mfma_f32_16x16x32_bf16 v[44:47], a[184:187], a[56:59], 0
  v_add_f32_e32 v0, v0, v40
  v_add_f32_e32 v0, v0, v41
  v_mfma_f32_16x16x32_bf16 v[44:47], a[188:191], a[60:63], v[44:47]
  v_cvt_pk_bf16_f32 v40, v40, v41
  v_add_f32_e32 v0, v0, v42
  v_mfma_f32_16x16x32_bf16 v[44:47], a[192:195], a[64:67], v[44:47]
  ds_read_b64_tr_b16 a[160:161], v4 offset:36864
  v_add_f32_e32 v0, v0, v43
  v_mfma_f32_16x16x32_bf16 v[44:47], a[196:199], a[68:71], v[44:47]
  v_cvt_pk_bf16_f32 v41, v42, v43
  v_fma_f32 v48, v48, s35, -v16
  v_mfma_f32_16x16x32_bf16 v[44:47], a[200:203], a[72:75], v[44:47]
  ds_read_b64_tr_b16 a[162:163], v4 offset:43008
  v_fma_f32 v36, v36, s35, -v14
  v_mfma_f32_16x16x32_bf16 v[44:47], a[204:207], a[76:79], v[44:47]
  buffer_load_dwordx4 v9, s[8:11], s32 offen offset:1024 nt lds
  v_mfma_f32_16x16x32_bf16 v[52:55], a[184:187], a[80:83], 0
  ds_read_b64_tr_b16 a[164:165], v5 offset:36864
  v_fma_f32 v37, v37, s35, -v14
  v_mfma_f32_16x16x32_bf16 v[52:55], a[188:191], a[84:87], v[52:55]
  v_exp_f32_e32 v36, v36
  v_mfma_f32_16x16x32_bf16 v[52:55], a[192:195], a[88:91], v[52:55]
  ds_read_b64_tr_b16 a[166:167], v5 offset:43008
  v_fma_f32 v38, v38, s35, -v14
  v_mfma_f32_16x16x32_bf16 v[52:55], a[196:199], a[92:95], v[52:55]
  v_exp_f32_e32 v37, v37
  v_mfma_f32_16x16x32_bf16 v[52:55], a[200:203], a[96:99], v[52:55]
  ds_read_b64_tr_b16 a[168:169], v6 offset:36864
  v_fma_f32 v39, v39, s35, -v14
  v_mfma_f32_16x16x32_bf16 v[52:55], a[204:207], a[100:103], v[52:55]
  v_exp_f32_e32 v38, v38
  v_mfma_f32_16x16x32_bf16 v[60:63], a[184:187], a[104:107], 0
  ds_read_b64_tr_b16 a[170:171], v6 offset:43008
  v_cvt_pk_bf16_f32 v34, v36, v37
  v_mfma_f32_16x16x32_bf16 v[60:63], a[188:191], a[108:111], v[60:63]
  v_exp_f32_e32 v39, v39
  v_mfma_f32_16x16x32_bf16 v[60:63], a[192:195], a[112:115], v[60:63]
  ds_read_b64_tr_b16 a[172:173], v7 offset:36864
  v_cvt_pk_bf16_f32 v35, v38, v39
  v_mfma_f32_16x16x32_bf16 v[60:63], a[196:199], a[116:119], v[60:63]
  v_exp_f32_e32 v48, v48
  v_mfma_f32_16x16x32_bf16 v[60:63], a[200:203], a[120:123], v[60:63]
  ds_read_b64_tr_b16 a[174:175], v7 offset:43008
  v_fma_f32 v44, v44, s35, -v15
  v_mfma_f32_16x16x32_bf16 v[60:63], a[204:207], a[124:127], v[60:63]
  buffer_load_dwordx4 v10, s[8:11], s32 offen offset:2048 nt lds
  v_mfma_f32_16x16x32_bf16 a[240:243], v[18:21], v[64:67], a[240:243]
  s_waitcnt lgkmcnt(4)
  ds_read_b64_tr_b16 a[176:177], v4 offset:36992
  v_fma_f32 v45, v45, s35, -v15
  v_mfma_f32_16x16x32_bf16 v[96:99], a[160:163], v[64:67], v[96:99]
  v_exp_f32_e32 v44, v44
  v_mfma_f32_16x16x32_bf16 v[100:103], a[160:163], v[72:75], v[100:103]
  ds_read_b64_tr_b16 a[178:179], v4 offset:43136
  v_fma_f32 v46, v46, s35, -v15
  v_mfma_f32_16x16x32_bf16 v[104:107], a[160:163], v[80:83], v[104:107]
  v_exp_f32_e32 v45, v45
  v_mfma_f32_16x16x32_bf16 v[108:111], a[160:163], v[88:91], v[108:111]
  ds_read_b64_tr_b16 a[180:181], v5 offset:36992
  v_fma_f32 v47, v47, s35, -v15
  v_mfma_f32_16x16x32_bf16 v[112:115], a[164:167], v[64:67], v[112:115]
  v_exp_f32_e32 v46, v46
  v_mfma_f32_16x16x32_bf16 v[116:119], a[164:167], v[72:75], v[116:119]
  ds_read_b64_tr_b16 a[182:183], v5 offset:43136
  v_cvt_pk_bf16_f32 v42, v44, v45
  v_mfma_f32_16x16x32_bf16 v[120:123], a[164:167], v[80:83], v[120:123]
  v_exp_f32_e32 v47, v47
  v_mfma_f32_16x16x32_bf16 v[124:127], a[164:167], v[88:91], v[124:127]
  s_waitcnt lgkmcnt(4)
  ds_read_b64_tr_b16 a[184:185], v6 offset:36992
  v_cvt_pk_bf16_f32 v43, v46, v47
  v_mfma_f32_16x16x32_bf16 v[128:131], a[168:171], v[64:67], v[128:131]
  s_add_u32 m0, s34, 73728
  v_fma_f32 v49, v49, s35, -v16
  v_fma_f32 v50, v50, s35, -v16
  v_mfma_f32_16x16x32_bf16 v[132:135], a[168:171], v[72:75], v[132:135]
  s_mov_b32 s33, 122880
  ds_read_b64_tr_b16 a[186:187], v6 offset:43136
  v_fma_f32 v51, v51, s35, -v16
  v_mfma_f32_16x16x32_bf16 v[136:139], a[168:171], v[80:83], v[136:139]
  buffer_load_dwordx4 v8, s[12:15], s33 offen nt lds
  v_mfma_f32_16x16x32_bf16 v[140:143], a[168:171], v[88:91], v[140:143]
  ds_read_b64_tr_b16 a[188:189], v7 offset:36992
  v_fma_f32 v52, v52, s35, -v16
  v_mfma_f32_16x16x32_bf16 v[144:147], a[172:175], v[64:67], v[144:147]
  v_exp_f32_e32 v49, v49
  v_mfma_f32_16x16x32_bf16 v[148:151], a[172:175], v[72:75], v[148:151]
  ds_read_b64_tr_b16 a[190:191], v7 offset:43136
  v_fma_f32 v53, v53, s35, -v16
  v_mfma_f32_16x16x32_bf16 v[152:155], a[172:175], v[80:83], v[152:155]
  v_exp_f32_e32 v50, v50
  v_mfma_f32_16x16x32_bf16 v[156:159], a[172:175], v[88:91], v[156:159]
  s_waitcnt lgkmcnt(4)
  ds_read_b64_tr_b16 a[192:193], v4 offset:37120
  v_fma_f32 v54, v54, s35, -v16
  v_mfma_f32_16x16x32_bf16 v[160:163], a[176:179], v[64:67], v[160:163]
  v_exp_f32_e32 v51, v51
  v_mfma_f32_16x16x32_bf16 v[164:167], a[176:179], v[72:75], v[164:167]
  ds_read_b64_tr_b16 a[194:195], v4 offset:43264
  v_fma_f32 v55, v55, s35, -v16
  v_mfma_f32_16x16x32_bf16 v[168:171], a[176:179], v[80:83], v[168:171]
  v_exp_f32_e32 v52, v52
  v_mfma_f32_16x16x32_bf16 v[172:175], a[176:179], v[88:91], v[172:175]
  ds_read_b64_tr_b16 a[196:197], v5 offset:37120
  v_add_f32_e32 v30, v30, v48
  v_mfma_f32_16x16x32_bf16 v[176:179], a[180:183], v[64:67], v[176:179]
  v_exp_f32_e32 v53, v53
  v_mfma_f32_16x16x32_bf16 v[180:183], a[180:183], v[72:75], v[180:183]
  ds_read_b64_tr_b16 a[198:199], v5 offset:43264
  v_add_f32_e32 v30, v30, v49
  v_mfma_f32_16x16x32_bf16 v[184:187], a[180:183], v[80:83], v[184:187]
  buffer_load_dwordx4 v9, s[12:15], s33 offen offset:1024 nt lds
  v_mfma_f32_16x16x32_bf16 v[188:191], a[180:183], v[88:91], v[188:191]
  s_waitcnt lgkmcnt(4)
  ds_read_b64_tr_b16 a[200:201], v6 offset:37120
  v_cvt_pk_bf16_f32 v48, v48, v49
  v_mfma_f32_16x16x32_bf16 v[192:195], a[184:187], v[64:67], v[192:195]
  v_exp_f32_e32 v54, v54
  v_mfma_f32_16x16x32_bf16 v[196:199], a[184:187], v[72:75], v[196:199]
  ds_read_b64_tr_b16 a[202:203], v6 offset:43264
  v_add_f32_e32 v30, v30, v50
  v_mfma_f32_16x16x32_bf16 v[200:203], a[184:187], v[80:83], v[200:203]
  v_exp_f32_e32 v55, v55
  v_mfma_f32_16x16x32_bf16 v[204:207], a[184:187], v[88:91], v[204:207]
  ds_read_b64_tr_b16 a[204:205], v7 offset:37120
  v_add_f32_e32 v30, v30, v51
  v_mfma_f32_16x16x32_bf16 v[208:211], a[188:191], v[64:67], v[208:211]
  v_cvt_pk_bf16_f32 v49, v50, v51
  v_cvt_pk_bf16_f32 v50, v52, v53
  v_mfma_f32_16x16x32_bf16 v[212:215], a[188:191], v[72:75], v[212:215]
  ds_read_b64_tr_b16 a[206:207], v7 offset:43264
  v_cvt_pk_bf16_f32 v51, v54, v55
  v_mfma_f32_16x16x32_bf16 v[216:219], a[188:191], v[80:83], v[216:219]
  v_fma_f32 v56, v56, s35, -v17
  v_fma_f32 v57, v57, s35, -v17
  v_mfma_f32_16x16x32_bf16 v[220:223], a[188:191], v[88:91], v[220:223]
  s_waitcnt lgkmcnt(4)
  ds_read_b128 a[160:163], v2 offset:12288
  v_fma_f32 v58, v58, s35, -v17
  v_mfma_f32_16x16x32_bf16 v[224:227], a[192:195], v[64:67], v[224:227]
  v_exp_f32_e32 v56, v56
  v_mfma_f32_16x16x32_bf16 v[228:231], a[192:195], v[72:75], v[228:231]
  ds_read_b128 a[164:167], v3 offset:12288
  v_fma_f32 v59, v59, s35, -v17
  v_mfma_f32_16x16x32_bf16 v[232:235], a[192:195], v[80:83], v[232:235]
  buffer_load_dwordx4 v10, s[12:15], s33 offen offset:2048 nt lds
  v_mfma_f32_16x16x32_bf16 v[236:239], a[192:195], v[88:91], v[236:239]
  ds_read_b128 a[168:171], v2 offset:12416
  v_fma_f32 v60, v60, s35, -v17
  v_mfma_f32_16x16x32_bf16 v[240:243], a[196:199], v[64:67], v[240:243]
  v_exp_f32_e32 v57, v57
  v_mfma_f32_16x16x32_bf16 v[244:247], a[196:199], v[72:75], v[244:247]
  ds_read_b128 a[172:175], v3 offset:12416
  v_fma_f32 v61, v61, s35, -v17
  v_mfma_f32_16x16x32_bf16 v[248:251], a[196:199], v[80:83], v[248:251]
  v_exp_f32_e32 v58, v58
  v_mfma_f32_16x16x32_bf16 v[252:255], a[196:199], v[88:91], v[252:255]
  s_waitcnt lgkmcnt(3)
  ds_read_b128 a[176:179], v2 offset:12544
  v_fma_f32 v62, v62, s35, -v17
  v_mfma_f32_16x16x32_bf16 a[0:3], a[200:203], v[64:67], a[0:3]
  v_exp_f32_e32 v59, v59
  v_mfma_f32_16x16x32_bf16 a[4:7], a[200:203], v[72:75], a[4:7]
  ds_read_b128 a[180:183], v3 offset:12544
  v_fma_f32 v63, v63, s35, -v17
  v_mfma_f32_16x16x32_bf16 a[8:11], a[200:203], v[80:83], a[8:11]
  v_exp_f32_e32 v60, v60
  v_mfma_f32_16x16x32_bf16 a[12:15], a[200:203], v[88:91], a[12:15]
  v_exp_f32_e32 v61, v61
  v_mfma_f32_16x16x32_bf16 a[16:19], a[204:207], v[64:67], a[16:19]
  v_exp_f32_e32 v62, v62
  v_mfma_f32_16x16x32_bf16 a[20:23], a[204:207], v[72:75], a[20:23]
  s_add_u32 m0, s28, 12160
  v_exp_f32_e32 v63, v63
  v_mfma_f32_16x16x32_bf16 a[24:27], a[204:207], v[80:83], a[24:27]
  buffer_load_dwordx4 v11, s[24:27], s84 offen offset:128 nt lds
  v_mfma_f32_16x16x32_bf16 a[28:31], a[204:207], v[88:91], a[28:31]
  v_add_f32_e32 v31, v31, v56
  v_add_f32_e32 v31, v31, v57
  v_mfma_f32_16x16x32_bf16 v[64:67], a[160:163], a[32:35], 0
  s_waitcnt lgkmcnt(1)
  v_cvt_pk_bf16_f32 v56, v56, v57
  v_add_f32_e32 v31, v31, v58
  v_mfma_f32_16x16x32_bf16 v[64:67], a[164:167], a[36:39], v[64:67]
  v_add_f32_e32 v31, v31, v59
  v_cvt_pk_bf16_f32 v57, v58, v59
  v_mfma_f32_16x16x32_bf16 v[64:67], a[168:171], a[40:43], v[64:67]
  v_cvt_pk_bf16_f32 v58, v60, v61
  v_cvt_pk_bf16_f32 v59, v62, v63
  v_mfma_f32_16x16x32_bf16 v[64:67], a[172:175], a[44:47], v[64:67]
  v_add_f32_e32 v0, v0, v44
  v_add_f32_e32 v0, v0, v45
  v_mfma_f32_16x16x32_bf16 v[64:67], a[176:179], a[48:51], v[64:67]
  s_waitcnt lgkmcnt(0)
  v_add_f32_e32 v0, v0, v46
  v_add_f32_e32 v0, v0, v47
  v_mfma_f32_16x16x32_bf16 v[64:67], a[180:183], a[52:55], v[64:67]
  v_add_f32_e32 v30, v30, v52
  v_add_f32_e32 v30, v30, v53
  v_mfma_f32_16x16x32_bf16 v[72:75], a[160:163], a[56:59], 0
  v_add_f32_e32 v30, v30, v54
  v_add_f32_e32 v30, v30, v55
  v_mfma_f32_16x16x32_bf16 v[72:75], a[164:167], a[60:63], v[72:75]
  ds_read_b128 a[184:187], v2 offset:18432
  v_add_f32_e32 v31, v31, v60
  v_mfma_f32_16x16x32_bf16 v[72:75], a[168:171], a[64:67], v[72:75]
  v_add_f32_e32 v31, v31, v61
  v_add_f32_e32 v31, v31, v62
  v_mfma_f32_16x16x32_bf16 v[72:75], a[172:175], a[68:71], v[72:75]
  s_add_u32 m0, s28, 10112
  ds_read_b128 a[188:191], v3 offset:18432
  v_add_f32_e32 v31, v31, v63
  v_mfma_f32_16x16x32_bf16 v[72:75], a[176:179], a[72:75], v[72:75]
  buffer_load_dwordx4 v11, s[24:27], s84 offen offset:3200 nt lds
  v_mfma_f32_16x16x32_bf16 v[72:75], a[180:183], a[76:79], v[72:75]
  ds_read_b128 a[192:195], v2 offset:18560
  v_fma_f32 v64, v64, s35, -v14
  v_mfma_f32_16x16x32_bf16 v[80:83], a[160:163], a[80:83], 0
  v_exp_f32_e32 v64, v64
  v_mfma_f32_16x16x32_bf16 v[80:83], a[164:167], a[84:87], v[80:83]
  ds_read_b128 a[196:199], v3 offset:18560
  v_fma_f32 v65, v65, s35, -v14
  v_mfma_f32_16x16x32_bf16 v[80:83], a[168:171], a[88:91], v[80:83]
  v_exp_f32_e32 v65, v65
  v_mfma_f32_16x16x32_bf16 v[80:83], a[172:175], a[92:95], v[80:83]
  ds_read_b128 a[200:203], v2 offset:18688
  v_fma_f32 v66, v66, s35, -v14
  v_mfma_f32_16x16x32_bf16 v[80:83], a[176:179], a[96:99], v[80:83]
  v_exp_f32_e32 v66, v66
  v_mfma_f32_16x16x32_bf16 v[80:83], a[180:183], a[100:103], v[80:83]
  ds_read_b128 a[204:207], v3 offset:18688
  v_fma_f32 v67, v67, s35, -v14
  v_mfma_f32_16x16x32_bf16 v[88:91], a[160:163], a[104:107], 0
  s_waitcnt vmcnt(13)
  s_barrier
  v_mfma_f32_16x16x32_bf16 v[88:91], a[164:167], a[108:111], v[88:91]
  v_exp_f32_e32 v67, v67
  v_mfma_f32_16x16x32_bf16 v[88:91], a[168:171], a[112:115], v[88:91]
  s_add_u32 m0, s34, 0
  v_cvt_pk_bf16_f32 v64, v64, v65
  v_cvt_pk_bf16_f32 v65, v66, v67
  v_mfma_f32_16x16x32_bf16 v[88:91], a[172:175], a[116:119], v[88:91]
  s_mov_b32 s32, 147456
  v_fma_f32 v72, v72, s35, -v15
  v_fma_f32 v73, v73, s35, -v15
  v_mfma_f32_16x16x32_bf16 v[88:91], a[176:179], a[120:123], v[88:91]
  buffer_load_dwordx4 v8, s[8:11], s32 offen nt lds
  v_mfma_f32_16x16x32_bf16 v[88:91], a[180:183], a[124:127], v[88:91]
  s_waitcnt lgkmcnt(1)
  v_exp_f32_e32 v72, v72
  v_mfma_f32_16x16x32_bf16 v[68:71], a[184:187], a[32:35], 0
  v_exp_f32_e32 v73, v73
  v_mfma_f32_16x16x32_bf16 v[68:71], a[188:191], a[36:39], v[68:71]
  v_fma_f32 v74, v74, s35, -v15
  v_fma_f32 v75, v75, s35, -v15
  v_mfma_f32_16x16x32_bf16 v[68:71], a[192:195], a[40:43], v[68:71]
  v_exp_f32_e32 v74, v74
  v_mfma_f32_16x16x32_bf16 v[68:71], a[196:199], a[44:47], v[68:71]
  v_exp_f32_e32 v75, v75
  v_mfma_f32_16x16x32_bf16 v[68:71], a[200:203], a[48:51], v[68:71]
  s_waitcnt lgkmcnt(0)
  v_add_f32_e32 v0, v0, v72
  v_add_f32_e32 v0, v0, v73
  v_mfma_f32_16x16x32_bf16 v[68:71], a[204:207], a[52:55], v[68:71]
  v_cvt_pk_bf16_f32 v72, v72, v73
  v_add_f32_e32 v0, v0, v74
  v_mfma_f32_16x16x32_bf16 v[76:79], a[184:187], a[56:59], 0
  v_add_f32_e32 v0, v0, v75
  v_cvt_pk_bf16_f32 v73, v74, v75
  v_mfma_f32_16x16x32_bf16 v[76:79], a[188:191], a[60:63], v[76:79]
  v_fma_f32 v80, v80, s35, -v16
  v_fma_f32 v81, v81, s35, -v16
  v_mfma_f32_16x16x32_bf16 v[76:79], a[192:195], a[64:67], v[76:79]
  ds_read_b64_tr_b16 a[160:161], v4 offset:0
  v_fma_f32 v82, v82, s35, -v16
  v_mfma_f32_16x16x32_bf16 v[76:79], a[196:199], a[68:71], v[76:79]
  v_exp_f32_e32 v80, v80
  v_mfma_f32_16x16x32_bf16 v[76:79], a[200:203], a[72:75], v[76:79]
  ds_read_b64_tr_b16 a[162:163], v4 offset:6144
  v_fma_f32 v68, v68, s35, -v14
  v_mfma_f32_16x16x32_bf16 v[76:79], a[204:207], a[76:79], v[76:79]
  buffer_load_dwordx4 v9, s[8:11], s32 offen offset:1024 nt lds
  v_mfma_f32_16x16x32_bf16 v[84:87], a[184:187], a[80:83], 0
  ds_read_b64_tr_b16 a[164:165], v5 offset:0
  v_fma_f32 v69, v69, s35, -v14
  v_mfma_f32_16x16x32_bf16 v[84:87], a[188:191], a[84:87], v[84:87]
  v_exp_f32_e32 v68, v68
  v_mfma_f32_16x16x32_bf16 v[84:87], a[192:195], a[88:91], v[84:87]
  ds_read_b64_tr_b16 a[166:167], v5 offset:6144
  v_fma_f32 v70, v70, s35, -v14
  v_mfma_f32_16x16x32_bf16 v[84:87], a[196:199], a[92:95], v[84:87]
  v_exp_f32_e32 v69, v69
  v_mfma_f32_16x16x32_bf16 v[84:87], a[200:203], a[96:99], v[84:87]
  ds_read_b64_tr_b16 a[168:169], v6 offset:0
  v_fma_f32 v71, v71, s35, -v14
  v_mfma_f32_16x16x32_bf16 v[84:87], a[204:207], a[100:103], v[84:87]
  v_exp_f32_e32 v70, v70
  v_mfma_f32_16x16x32_bf16 v[92:95], a[184:187], a[104:107], 0
  ds_read_b64_tr_b16 a[170:171], v6 offset:6144
  v_cvt_pk_bf16_f32 v66, v68, v69
  v_mfma_f32_16x16x32_bf16 v[92:95], a[188:191], a[108:111], v[92:95]
  v_exp_f32_e32 v71, v71
  v_mfma_f32_16x16x32_bf16 v[92:95], a[192:195], a[112:115], v[92:95]
  ds_read_b64_tr_b16 a[172:173], v7 offset:0
  v_cvt_pk_bf16_f32 v67, v70, v71
  v_mfma_f32_16x16x32_bf16 v[92:95], a[196:199], a[116:119], v[92:95]
  v_exp_f32_e32 v81, v81
  v_mfma_f32_16x16x32_bf16 v[92:95], a[200:203], a[120:123], v[92:95]
  ds_read_b64_tr_b16 a[174:175], v7 offset:6144
  v_fma_f32 v76, v76, s35, -v15
  v_mfma_f32_16x16x32_bf16 v[92:95], a[204:207], a[124:127], v[92:95]
  buffer_load_dwordx4 v10, s[8:11], s32 offen offset:2048 nt lds
  v_mfma_f32_16x16x32_bf16 a[240:243], v[18:21], v[32:35], a[240:243]
  s_waitcnt lgkmcnt(4)
  ds_read_b64_tr_b16 a[176:177], v4 offset:128
  v_fma_f32 v77, v77, s35, -v15
  v_mfma_f32_16x16x32_bf16 v[96:99], a[160:163], v[32:35], v[96:99]
  v_exp_f32_e32 v76, v76
  v_mfma_f32_16x16x32_bf16 v[100:103], a[160:163], v[40:43], v[100:103]
  ds_read_b64_tr_b16 a[178:179], v4 offset:6272
  v_fma_f32 v78, v78, s35, -v15
  v_mfma_f32_16x16x32_bf16 v[104:107], a[160:163], v[48:51], v[104:107]
  v_exp_f32_e32 v77, v77
  v_mfma_f32_16x16x32_bf16 v[108:111], a[160:163], v[56:59], v[108:111]
  ds_read_b64_tr_b16 a[180:181], v5 offset:128
  v_fma_f32 v79, v79, s35, -v15
  v_mfma_f32_16x16x32_bf16 v[112:115], a[164:167], v[32:35], v[112:115]
  v_exp_f32_e32 v78, v78
  v_mfma_f32_16x16x32_bf16 v[116:119], a[164:167], v[40:43], v[116:119]
  ds_read_b64_tr_b16 a[182:183], v5 offset:6272
  v_cvt_pk_bf16_f32 v74, v76, v77
  v_mfma_f32_16x16x32_bf16 v[120:123], a[164:167], v[48:51], v[120:123]
  v_exp_f32_e32 v79, v79
  v_mfma_f32_16x16x32_bf16 v[124:127], a[164:167], v[56:59], v[124:127]
  s_waitcnt lgkmcnt(4)
  ds_read_b64_tr_b16 a[184:185], v6 offset:128
  v_cvt_pk_bf16_f32 v75, v78, v79
  v_mfma_f32_16x16x32_bf16 v[128:131], a[168:171], v[32:35], v[128:131]
  s_add_u32 m0, s34, 86016
  v_exp_f32_e32 v82, v82
  v_mfma_f32_16x16x32_bf16 v[132:135], a[168:171], v[40:43], v[132:135]
  s_mov_b32 s33, 135168
  ds_read_b64_tr_b16 a[186:187], v6 offset:6272
  v_fma_f32 v83, v83, s35, -v16
  v_mfma_f32_16x16x32_bf16 v[136:139], a[168:171], v[48:51], v[136:139]
  buffer_load_dwordx4 v8, s[12:15], s33 offen nt lds
  v_mfma_f32_16x16x32_bf16 v[140:143], a[168:171], v[56:59], v[140:143]
  ds_read_b64_tr_b16 a[188:189], v7 offset:128
  v_fma_f32 v84, v84, s35, -v16
  v_mfma_f32_16x16x32_bf16 v[144:147], a[172:175], v[32:35], v[144:147]
  v_exp_f32_e32 v83, v83
  v_mfma_f32_16x16x32_bf16 v[148:151], a[172:175], v[40:43], v[148:151]
  ds_read_b64_tr_b16 a[190:191], v7 offset:6272
  v_fma_f32 v85, v85, s35, -v16
  v_mfma_f32_16x16x32_bf16 v[152:155], a[172:175], v[48:51], v[152:155]
  v_exp_f32_e32 v84, v84
  v_mfma_f32_16x16x32_bf16 v[156:159], a[172:175], v[56:59], v[156:159]
  s_waitcnt lgkmcnt(4)
  ds_read_b64_tr_b16 a[192:193], v4 offset:256
  v_fma_f32 v86, v86, s35, -v16
  v_mfma_f32_16x16x32_bf16 v[160:163], a[176:179], v[32:35], v[160:163]
  v_exp_f32_e32 v85, v85
  v_mfma_f32_16x16x32_bf16 v[164:167], a[176:179], v[40:43], v[164:167]
  ds_read_b64_tr_b16 a[194:195], v4 offset:6400
  v_fma_f32 v87, v87, s35, -v16
  v_mfma_f32_16x16x32_bf16 v[168:171], a[176:179], v[48:51], v[168:171]
  v_exp_f32_e32 v86, v86
  v_mfma_f32_16x16x32_bf16 v[172:175], a[176:179], v[56:59], v[172:175]
  ds_read_b64_tr_b16 a[196:197], v5 offset:256
  v_add_f32_e32 v30, v30, v80
  v_mfma_f32_16x16x32_bf16 v[176:179], a[180:183], v[32:35], v[176:179]
  v_exp_f32_e32 v87, v87
  v_mfma_f32_16x16x32_bf16 v[180:183], a[180:183], v[40:43], v[180:183]
  ds_read_b64_tr_b16 a[198:199], v5 offset:6400
  v_add_f32_e32 v30, v30, v81
  v_mfma_f32_16x16x32_bf16 v[184:187], a[180:183], v[48:51], v[184:187]
  buffer_load_dwordx4 v9, s[12:15], s33 offen offset:1024 nt lds
  v_mfma_f32_16x16x32_bf16 v[188:191], a[180:183], v[56:59], v[188:191]
  s_waitcnt lgkmcnt(4)
  ds_read_b64_tr_b16 a[200:201], v6 offset:256
  v_cvt_pk_bf16_f32 v80, v80, v81
  v_mfma_f32_16x16x32_bf16 v[192:195], a[184:187], v[32:35], v[192:195]
  v_add_f32_e32 v30, v30, v82
  v_add_f32_e32 v30, v30, v83
  v_mfma_f32_16x16x32_bf16 v[196:199], a[184:187], v[40:43], v[196:199]
  ds_read_b64_tr_b16 a[202:203], v6 offset:6400
  v_cvt_pk_bf16_f32 v81, v82, v83
  v_mfma_f32_16x16x32_bf16 v[200:203], a[184:187], v[48:51], v[200:203]
  v_cvt_pk_bf16_f32 v82, v84, v85
  v_cvt_pk_bf16_f32 v83, v86, v87
  v_mfma_f32_16x16x32_bf16 v[204:207], a[184:187], v[56:59], v[204:207]
  ds_read_b64_tr_b16 a[204:205], v7 offset:256
  v_fma_f32 v88, v88, s35, -v17
  v_mfma_f32_16x16x32_bf16 v[208:211], a[188:191], v[32:35], v[208:211]
  v_exp_f32_e32 v88, v88
  v_mfma_f32_16x16x32_bf16 v[212:215], a[188:191], v[40:43], v[212:215]
  ds_read_b64_tr_b16 a[206:207], v7 offset:6400
  v_fma_f32 v89, v89, s35, -v17
  v_mfma_f32_16x16x32_bf16 v[216:219], a[188:191], v[48:51], v[216:219]
  v_exp_f32_e32 v89, v89
  v_mfma_f32_16x16x32_bf16 v[220:223], a[188:191], v[56:59], v[220:223]
  s_waitcnt lgkmcnt(4)
  ds_read_b128 a[160:163], v2 offset:24576
  v_fma_f32 v90, v90, s35, -v17
  v_mfma_f32_16x16x32_bf16 v[224:227], a[192:195], v[32:35], v[224:227]
  v_exp_f32_e32 v90, v90
  v_mfma_f32_16x16x32_bf16 v[228:231], a[192:195], v[40:43], v[228:231]
  ds_read_b128 a[164:167], v3 offset:24576
  v_fma_f32 v91, v91, s35, -v17
  v_mfma_f32_16x16x32_bf16 v[232:235], a[192:195], v[48:51], v[232:235]
  buffer_load_dwordx4 v10, s[12:15], s33 offen offset:2048 nt lds
  v_mfma_f32_16x16x32_bf16 v[236:239], a[192:195], v[56:59], v[236:239]
  ds_read_b128 a[168:171], v2 offset:24704
  v_fma_f32 v92, v92, s35, -v17
  v_mfma_f32_16x16x32_bf16 v[240:243], a[196:199], v[32:35], v[240:243]
  v_exp_f32_e32 v91, v91
  v_mfma_f32_16x16x32_bf16 v[244:247], a[196:199], v[40:43], v[244:247]
  ds_read_b128 a[172:175], v3 offset:24704
  v_fma_f32 v93, v93, s35, -v17
  v_mfma_f32_16x16x32_bf16 v[248:251], a[196:199], v[48:51], v[248:251]
  v_exp_f32_e32 v92, v92
  v_mfma_f32_16x16x32_bf16 v[252:255], a[196:199], v[56:59], v[252:255]
  s_waitcnt lgkmcnt(3)
  ds_read_b128 a[176:179], v2 offset:24832
  v_fma_f32 v94, v94, s35, -v17
  v_mfma_f32_16x16x32_bf16 a[0:3], a[200:203], v[32:35], a[0:3]
  v_exp_f32_e32 v93, v93
  v_mfma_f32_16x16x32_bf16 a[4:7], a[200:203], v[40:43], a[4:7]
  ds_read_b128 a[180:183], v3 offset:24832
  v_fma_f32 v95, v95, s35, -v17
  v_mfma_f32_16x16x32_bf16 a[8:11], a[200:203], v[48:51], a[8:11]
  v_exp_f32_e32 v94, v94
  v_mfma_f32_16x16x32_bf16 a[12:15], a[200:203], v[56:59], a[12:15]
  v_exp_f32_e32 v95, v95
  v_mfma_f32_16x16x32_bf16 a[16:19], a[204:207], v[32:35], a[16:19]
  v_add_f32_e32 v31, v31, v88
  v_add_f32_e32 v31, v31, v89
  v_mfma_f32_16x16x32_bf16 a[20:23], a[204:207], v[40:43], a[20:23]
  s_add_u32 m0, s28, 14208
  v_cvt_pk_bf16_f32 v88, v88, v89
  v_add_f32_e32 v31, v31, v90
  v_mfma_f32_16x16x32_bf16 a[24:27], a[204:207], v[48:51], a[24:27]
  buffer_load_dwordx4 v11, s[24:27], s85 offen offset:128 nt lds
  v_mfma_f32_16x16x32_bf16 a[28:31], a[204:207], v[56:59], a[28:31]
  v_add_f32_e32 v31, v31, v91
  v_cvt_pk_bf16_f32 v89, v90, v91
  v_mfma_f32_16x16x32_bf16 v[32:35], a[160:163], a[32:35], 0
  s_waitcnt lgkmcnt(1)
  v_cvt_pk_bf16_f32 v90, v92, v93
  v_cvt_pk_bf16_f32 v91, v94, v95
  v_mfma_f32_16x16x32_bf16 v[32:35], a[164:167], a[36:39], v[32:35]
  v_add_f32_e32 v0, v0, v76
  v_add_f32_e32 v0, v0, v77
  v_mfma_f32_16x16x32_bf16 v[32:35], a[168:171], a[40:43], v[32:35]
  v_add_f32_e32 v0, v0, v78
  v_add_f32_e32 v0, v0, v79
  v_mfma_f32_16x16x32_bf16 v[32:35], a[172:175], a[44:47], v[32:35]
  v_add_f32_e32 v30, v30, v84
  v_add_f32_e32 v30, v30, v85
  v_mfma_f32_16x16x32_bf16 v[32:35], a[176:179], a[48:51], v[32:35]
  s_waitcnt lgkmcnt(0)
  v_add_f32_e32 v30, v30, v86
  v_add_f32_e32 v30, v30, v87
  v_mfma_f32_16x16x32_bf16 v[32:35], a[180:183], a[52:55], v[32:35]
  v_add_f32_e32 v31, v31, v92
  v_add_f32_e32 v31, v31, v93
  v_mfma_f32_16x16x32_bf16 v[40:43], a[160:163], a[56:59], 0
  v_add_f32_e32 v31, v31, v94
  v_add_f32_e32 v31, v31, v95
  v_mfma_f32_16x16x32_bf16 v[40:43], a[164:167], a[60:63], v[40:43]
  ds_read_b128 a[184:187], v2 offset:30720
  v_mfma_f32_16x16x32_bf16 v[40:43], a[168:171], a[64:67], v[40:43]
  v_mfma_f32_16x16x32_bf16 v[40:43], a[172:175], a[68:71], v[40:43]
  s_add_u32 m0, s28, 12160
  ds_read_b128 a[188:191], v3 offset:30720
  v_mfma_f32_16x16x32_bf16 v[40:43], a[176:179], a[72:75], v[40:43]
  buffer_load_dwordx4 v11, s[24:27], s85 offen offset:3200 nt lds
  v_mfma_f32_16x16x32_bf16 v[40:43], a[180:183], a[76:79], v[40:43]
  ds_read_b128 a[192:195], v2 offset:30848
  v_fma_f32 v32, v32, s35, -v14
  v_mfma_f32_16x16x32_bf16 v[48:51], a[160:163], a[80:83], 0
  v_exp_f32_e32 v32, v32
  v_mfma_f32_16x16x32_bf16 v[48:51], a[164:167], a[84:87], v[48:51]
  ds_read_b128 a[196:199], v3 offset:30848
  v_fma_f32 v33, v33, s35, -v14
  v_mfma_f32_16x16x32_bf16 v[48:51], a[168:171], a[88:91], v[48:51]
  v_exp_f32_e32 v33, v33
  v_mfma_f32_16x16x32_bf16 v[48:51], a[172:175], a[92:95], v[48:51]
  ds_read_b128 a[200:203], v2 offset:30976
  v_fma_f32 v34, v34, s35, -v14
  v_mfma_f32_16x16x32_bf16 v[48:51], a[176:179], a[96:99], v[48:51]
  v_exp_f32_e32 v34, v34
  v_mfma_f32_16x16x32_bf16 v[48:51], a[180:183], a[100:103], v[48:51]
  ds_read_b128 a[204:207], v3 offset:30976
  v_fma_f32 v35, v35, s35, -v14
  v_mfma_f32_16x16x32_bf16 v[56:59], a[160:163], a[104:107], 0
  s_waitcnt vmcnt(13)
  s_barrier
  v_mfma_f32_16x16x32_bf16 v[56:59], a[164:167], a[108:111], v[56:59]
  v_exp_f32_e32 v35, v35
  v_mfma_f32_16x16x32_bf16 v[56:59], a[168:171], a[112:115], v[56:59]
  s_add_u32 m0, s34, 12288
  v_cvt_pk_bf16_f32 v32, v32, v33
  v_cvt_pk_bf16_f32 v33, v34, v35
  v_mfma_f32_16x16x32_bf16 v[56:59], a[172:175], a[116:119], v[56:59]
  s_mov_b32 s32, 159744
  v_fma_f32 v40, v40, s35, -v15
  v_fma_f32 v41, v41, s35, -v15
  v_mfma_f32_16x16x32_bf16 v[56:59], a[176:179], a[120:123], v[56:59]
  buffer_load_dwordx4 v8, s[8:11], s32 offen nt lds
  v_mfma_f32_16x16x32_bf16 v[56:59], a[180:183], a[124:127], v[56:59]
  s_waitcnt lgkmcnt(1)
  v_exp_f32_e32 v40, v40
  v_mfma_f32_16x16x32_bf16 v[36:39], a[184:187], a[32:35], 0
  v_exp_f32_e32 v41, v41
  v_mfma_f32_16x16x32_bf16 v[36:39], a[188:191], a[36:39], v[36:39]
  v_fma_f32 v42, v42, s35, -v15
  v_fma_f32 v43, v43, s35, -v15
  v_mfma_f32_16x16x32_bf16 v[36:39], a[192:195], a[40:43], v[36:39]
  v_exp_f32_e32 v42, v42
  v_mfma_f32_16x16x32_bf16 v[36:39], a[196:199], a[44:47], v[36:39]
  v_exp_f32_e32 v43, v43
  v_mfma_f32_16x16x32_bf16 v[36:39], a[200:203], a[48:51], v[36:39]
  s_waitcnt lgkmcnt(0)
  v_add_f32_e32 v0, v0, v40
  v_add_f32_e32 v0, v0, v41
  v_mfma_f32_16x16x32_bf16 v[36:39], a[204:207], a[52:55], v[36:39]
  v_cvt_pk_bf16_f32 v40, v40, v41
  v_add_f32_e32 v0, v0, v42
  v_mfma_f32_16x16x32_bf16 v[44:47], a[184:187], a[56:59], 0
  v_add_f32_e32 v0, v0, v43
  v_cvt_pk_bf16_f32 v41, v42, v43
  v_mfma_f32_16x16x32_bf16 v[44:47], a[188:191], a[60:63], v[44:47]
  v_fma_f32 v48, v48, s35, -v16
  v_fma_f32 v49, v49, s35, -v16
  v_mfma_f32_16x16x32_bf16 v[44:47], a[192:195], a[64:67], v[44:47]
  ds_read_b64_tr_b16 a[160:161], v4 offset:12288
  v_fma_f32 v50, v50, s35, -v16
  v_mfma_f32_16x16x32_bf16 v[44:47], a[196:199], a[68:71], v[44:47]
  v_exp_f32_e32 v48, v48
  v_mfma_f32_16x16x32_bf16 v[44:47], a[200:203], a[72:75], v[44:47]
  ds_read_b64_tr_b16 a[162:163], v4 offset:18432
  v_fma_f32 v36, v36, s35, -v14
  v_mfma_f32_16x16x32_bf16 v[44:47], a[204:207], a[76:79], v[44:47]
  buffer_load_dwordx4 v9, s[8:11], s32 offen offset:1024 nt lds
  v_mfma_f32_16x16x32_bf16 v[52:55], a[184:187], a[80:83], 0
  ds_read_b64_tr_b16 a[164:165], v5 offset:12288
  v_fma_f32 v37, v37, s35, -v14
  v_mfma_f32_16x16x32_bf16 v[52:55], a[188:191], a[84:87], v[52:55]
  v_exp_f32_e32 v36, v36
  v_mfma_f32_16x16x32_bf16 v[52:55], a[192:195], a[88:91], v[52:55]
  ds_read_b64_tr_b16 a[166:167], v5 offset:18432
  v_fma_f32 v38, v38, s35, -v14
  v_mfma_f32_16x16x32_bf16 v[52:55], a[196:199], a[92:95], v[52:55]
  v_exp_f32_e32 v37, v37
  v_mfma_f32_16x16x32_bf16 v[52:55], a[200:203], a[96:99], v[52:55]
  ds_read_b64_tr_b16 a[168:169], v6 offset:12288
  v_fma_f32 v39, v39, s35, -v14
L_hop4:
  s_cbranch_execz L_hop8
  v_mfma_f32_16x16x32_bf16 v[52:55], a[204:207], a[100:103], v[52:55]
  v_exp_f32_e32 v38, v38
  v_mfma_f32_16x16x32_bf16 v[60:63], a[184:187], a[104:107], 0
  ds_read_b64_tr_b16 a[170:171], v6 offset:18432
  v_cvt_pk_bf16_f32 v34, v36, v37
  v_mfma_f32_16x16x32_bf16 v[60:63], a[188:191], a[108:111], v[60:63]
  v_exp_f32_e32 v39, v39
  v_mfma_f32_16x16x32_bf16 v[60:63], a[192:195], a[112:115], v[60:63]
  ds_read_b64_tr_b16 a[172:173], v7 offset:12288
  v_cvt_pk_bf16_f32 v35, v38, v39
  v_mfma_f32_16x16x32_bf16 v[60:63], a[196:199], a[116:119], v[60:63]
  v_exp_f32_e32 v49, v49
  v_mfma_f32_16x16x32_bf16 v[60:63], a[200:203], a[120:123], v[60:63]
  ds_read_b64_tr_b16 a[174:175], v7 offset:18432
  v_fma_f32 v44, v44, s35, -v15
  v_mfma_f32_16x16x32_bf16 v[60:63], a[204:207], a[124:127], v[60:63]
  buffer_load_dwordx4 v10, s[8:11], s32 offen offset:2048 nt lds
  v_mfma_f32_16x16x32_bf16 a[240:243], v[18:21], v[64:67], a[240:243]
  s_waitcnt lgkmcnt(4)
  ds_read_b64_tr_b16 a[176:177], v4 offset:12416
  v_fma_f32 v45, v45, s35, -v15
  v_mfma_f32_16x16x32_bf16 v[96:99], a[160:163], v[64:67], v[96:99]
  v_exp_f32_e32 v44, v44
  v_mfma_f32_16x16x32_bf16 v[100:103], a[160:163], v[72:75], v[100:103]
  ds_read_b64_tr_b16 a[178:179], v4 offset:18560
  v_fma_f32 v46, v46, s35, -v15
  v_mfma_f32_16x16x32_bf16 v[104:107], a[160:163], v[80:83], v[104:107]
  v_exp_f32_e32 v45, v45
  v_mfma_f32_16x16x32_bf16 v[108:111], a[160:163], v[88:91], v[108:111]
  ds_read_b64_tr_b16 a[180:181], v5 offset:12416
  v_fma_f32 v47, v47, s35, -v15
  v_mfma_f32_16x16x32_bf16 v[112:115], a[164:167], v[64:67], v[112:115]
  v_exp_f32_e32 v46, v46
  v_mfma_f32_16x16x32_bf16 v[116:119], a[164:167], v[72:75], v[116:119]
  ds_read_b64_tr_b16 a[182:183], v5 offset:18560
  v_cvt_pk_bf16_f32 v42, v44, v45
  v_mfma_f32_16x16x32_bf16 v[120:123], a[164:167], v[80:83], v[120:123]
  v_exp_f32_e32 v47, v47
  v_mfma_f32_16x16x32_bf16 v[124:127], a[164:167], v[88:91], v[124:127]
  s_waitcnt lgkmcnt(4)
  ds_read_b64_tr_b16 a[184:185], v6 offset:12416
  v_cvt_pk_bf16_f32 v43, v46, v47
  v_mfma_f32_16x16x32_bf16 v[128:131], a[168:171], v[64:67], v[128:131]
  s_add_u32 m0, s34, 49152
  v_exp_f32_e32 v50, v50
  v_mfma_f32_16x16x32_bf16 v[132:135], a[168:171], v[72:75], v[132:135]
  s_mov_b32 s33, 147456
  ds_read_b64_tr_b16 a[186:187], v6 offset:18560
  v_fma_f32 v51, v51, s35, -v16
  v_mfma_f32_16x16x32_bf16 v[136:139], a[168:171], v[80:83], v[136:139]
  buffer_load_dwordx4 v8, s[12:15], s33 offen nt lds
  v_mfma_f32_16x16x32_bf16 v[140:143], a[168:171], v[88:91], v[140:143]
  ds_read_b64_tr_b16 a[188:189], v7 offset:12416
  v_fma_f32 v52, v52, s35, -v16
  v_mfma_f32_16x16x32_bf16 v[144:147], a[172:175], v[64:67], v[144:147]
  v_exp_f32_e32 v51, v51
  v_mfma_f32_16x16x32_bf16 v[148:151], a[172:175], v[72:75], v[148:151]
  ds_read_b64_tr_b16 a[190:191], v7 offset:18560
  v_fma_f32 v53, v53, s35, -v16
  v_mfma_f32_16x16x32_bf16 v[152:155], a[172:175], v[80:83], v[152:155]
  v_exp_f32_e32 v52, v52
  v_mfma_f32_16x16x32_bf16 v[156:159], a[172:175], v[88:91], v[156:159]
  s_waitcnt lgkmcnt(4)
  ds_read_b64_tr_b16 a[192:193], v4 offset:12544
  v_fma_f32 v54, v54, s35, -v16
  v_mfma_f32_16x16x32_bf16 v[160:163], a[176:179], v[64:67], v[160:163]
  v_exp_f32_e32 v53, v53
  v_mfma_f32_16x16x32_bf16 v[164:167], a[176:179], v[72:75], v[164:167]
  ds_read_b64_tr_b16 a[194:195], v4 offset:18688
  v_fma_f32 v55, v55, s35, -v16
  v_mfma_f32_16x16x32_bf16 v[168:171], a[176:179], v[80:83], v[168:171]
  v_exp_f32_e32 v54, v54
  v_mfma_f32_16x16x32_bf16 v[172:175], a[176:179], v[88:91], v[172:175]
  ds_read_b64_tr_b16 a[196:197], v5 offset:12544
  v_add_f32_e32 v30, v30, v48
  v_mfma_f32_16x16x32_bf16 v[176:179], a[180:183], v[64:67], v[176:179]
  v_exp_f32_e32 v55, v55
  v_mfma_f32_16x16x32_bf16 v[180:183], a[180:183], v[72:75], v[180:183]
  ds_read_b64_tr_b16 a[198:199], v5 offset:18688
  v_add_f32_e32 v30, v30, v49
  v_mfma_f32_16x16x32_bf16 v[184:187], a[180:183], v[80:83], v[184:187]
  buffer_load_dwordx4 v9, s[12:15], s33 offen offset:1024 nt lds
  v_mfma_f32_16x16x32_bf16 v[188:191], a[180:183], v[88:91], v[188:191]
  s_waitcnt lgkmcnt(4)
  ds_read_b64_tr_b16 a[200:201], v6 offset:12544
  v_cvt_pk_bf16_f32 v48, v48, v49
  v_mfma_f32_16x16x32_bf16 v[192:195], a[184:187], v[64:67], v[192:195]
  v_add_f32_e32 v30, v30, v50
  v_add_f32_e32 v30, v30, v51
  v_mfma_f32_16x16x32_bf16 v[196:199], a[184:187], v[72:75], v[196:199]
  ds_read_b64_tr_b16 a[202:203], v6 offset:18688
  v_cvt_pk_bf16_f32 v49, v50, v51
  v_mfma_f32_16x16x32_bf16 v[200:203], a[184:187], v[80:83], v[200:203]
  v_cvt_pk_bf16_f32 v50, v52, v53
  v_cvt_pk_bf16_f32 v51, v54, v55
  v_mfma_f32_16x16x32_bf16 v[204:207], a[184:187], v[88:91], v[204:207]
  ds_read_b64_tr_b16 a[204:205], v7 offset:12544
  v_fma_f32 v56, v56, s35, -v17
  v_mfma_f32_16x16x32_bf16 v[208:211], a[188:191], v[64:67], v[208:211]
  v_exp_f32_e32 v56, v56
  v_mfma_f32_16x16x32_bf16 v[212:215], a[188:191], v[72:75], v[212:215]
  ds_read_b64_tr_b16 a[206:207], v7 offset:18688
  v_fma_f32 v57, v57, s35, -v17
  v_mfma_f32_16x16x32_bf16 v[216:219], a[188:191], v[80:83], v[216:219]
  v_exp_f32_e32 v57, v57
  v_mfma_f32_16x16x32_bf16 v[220:223], a[188:191], v[88:91], v[220:223]
  s_waitcnt lgkmcnt(4)
  ds_read_b128 a[160:163], v2 offset:36864
  v_fma_f32 v58, v58, s35, -v17
  v_mfma_f32_16x16x32_bf16 v[224:227], a[192:195], v[64:67], v[224:227]
  v_exp_f32_e32 v58, v58
  v_mfma_f32_16x16x32_bf16 v[228:231], a[192:195], v[72:75], v[228:231]
  ds_read_b128 a[164:167], v3 offset:36864
  v_fma_f32 v59, v59, s35, -v17
  v_mfma_f32_16x16x32_bf16 v[232:235], a[192:195], v[80:83], v[232:235]
  buffer_load_dwordx4 v10, s[12:15], s33 offen offset:2048 nt lds
  v_mfma_f32_16x16x32_bf16 v[236:239], a[192:195], v[88:91], v[236:239]
  ds_read_b128 a[168:171], v2 offset:36992
  v_fma_f32 v60, v60, s35, -v17
  v_mfma_f32_16x16x32_bf16 v[240:243], a[196:199], v[64:67], v[240:243]
  v_exp_f32_e32 v59, v59
  v_mfma_f32_16x16x32_bf16 v[244:247], a[196:199], v[72:75], v[244:247]
  ds_read_b128 a[172:175], v3 offset:36992
  v_fma_f32 v61, v61, s35, -v17
  v_mfma_f32_16x16x32_bf16 v[248:251], a[196:199], v[80:83], v[248:251]
  v_exp_f32_e32 v60, v60
  v_mfma_f32_16x16x32_bf16 v[252:255], a[196:199], v[88:91], v[252:255]
  s_waitcnt lgkmcnt(3)
  ds_read_b128 a[176:179], v2 offset:37120
  v_fma_f32 v62, v62, s35, -v17
  v_mfma_f32_16x16x32_bf16 a[0:3], a[200:203], v[64:67], a[0:3]
  v_exp_f32_e32 v61, v61
  v_mfma_f32_16x16x32_bf16 a[4:7], a[200:203], v[72:75], a[4:7]
  ds_read_b128 a[180:183], v3 offset:37120
  v_fma_f32 v63, v63, s35, -v17
  v_mfma_f32_16x16x32_bf16 a[8:11], a[200:203], v[80:83], a[8:11]
  v_exp_f32_e32 v62, v62
  v_mfma_f32_16x16x32_bf16 a[12:15], a[200:203], v[88:91], a[12:15]
  v_exp_f32_e32 v63, v63
  v_mfma_f32_16x16x32_bf16 a[16:19], a[204:207], v[64:67], a[16:19]
  v_add_f32_e32 v31, v31, v56
  v_add_f32_e32 v31, v31, v57
  v_mfma_f32_16x16x32_bf16 a[20:23], a[204:207], v[72:75], a[20:23]
  s_add_u32 m0, s28, 0
  v_cvt_pk_bf16_f32 v56, v56, v57
  v_add_f32_e32 v31, v31, v58
  v_mfma_f32_16x16x32_bf16 a[24:27], a[204:207], v[80:83], a[24:27]
  buffer_load_dwordx4 v11, s[24:27], s86 offen nt lds
  v_mfma_f32_16x16x32_bf16 a[28:31], a[204:207], v[88:91], a[28:31]
  v_add_f32_e32 v31, v31, v59
  v_cvt_pk_bf16_f32 v57, v58, v59
  v_mfma_f32_16x16x32_bf16 v[64:67], a[160:163], a[32:35], 0
  s_waitcnt lgkmcnt(1)
  v_cvt_pk_bf16_f32 v58, v60, v61
  v_cvt_pk_bf16_f32 v59, v62, v63
  v_mfma_f32_16x16x32_bf16 v[64:67], a[164:167], a[36:39], v[64:67]
  v_add_f32_e32 v0, v0, v44
  v_add_f32_e32 v0, v0, v45
  v_mfma_f32_16x16x32_bf16 v[64:67], a[168:171], a[40:43], v[64:67]
  v_add_f32_e32 v0, v0, v46
  v_add_f32_e32 v0, v0, v47
  v_mfma_f32_16x16x32_bf16 v[64:67], a[172:175], a[44:47], v[64:67]
  v_add_f32_e32 v30, v30, v52
  v_add_f32_e32 v30, v30, v53
  v_mfma_f32_16x16x32_bf16 v[64:67], a[176:179], a[48:51], v[64:67]
  s_waitcnt lgkmcnt(0)
  v_add_f32_e32 v30, v30, v54
  v_add_f32_e32 v30, v30, v55
  v_mfma_f32_16x16x32_bf16 v[64:67], a[180:183], a[52:55], v[64:67]
  v_add_f32_e32 v31, v31, v60
  v_add_f32_e32 v31, v31, v61
  v_mfma_f32_16x16x32_bf16 v[72:75], a[160:163], a[56:59], 0
  v_add_f32_e32 v31, v31, v62
  v_add_f32_e32 v31, v31, v63
  v_mfma_f32_16x16x32_bf16 v[72:75], a[164:167], a[60:63], v[72:75]
  ds_read_b128 a[184:187], v2 offset:43008
  v_mfma_f32_16x16x32_bf16 v[72:75], a[168:171], a[64:67], v[72:75]
  v_mfma_f32_16x16x32_bf16 v[72:75], a[172:175], a[68:71], v[72:75]
  s_add_u32 m0, s28, 0xfffff800
  ds_read_b128 a[188:191], v3 offset:43008
  v_mfma_f32_16x16x32_bf16 v[72:75], a[176:179], a[72:75], v[72:75]
  buffer_load_dwordx4 v11, s[24:27], s86 offen offset:3072 nt lds
  v_mfma_f32_16x16x32_bf16 v[72:75], a[180:183], a[76:79], v[72:75]
  ds_read_b128 a[192:195], v2 offset:43136
  v_fma_f32 v64, v64, s35, -v14
  v_mfma_f32_16x16x32_bf16 v[80:83], a[160:163], a[80:83], 0
  v_exp_f32_e32 v64, v64
  v_mfma_f32_16x16x32_bf16 v[80:83], a[164:167], a[84:87], v[80:83]
  ds_read_b128 a[196:199], v3 offset:43136
  v_fma_f32 v65, v65, s35, -v14
  v_mfma_f32_16x16x32_bf16 v[80:83], a[168:171], a[88:91], v[80:83]
  v_exp_f32_e32 v65, v65
  v_mfma_f32_16x16x32_bf16 v[80:83], a[172:175], a[92:95], v[80:83]
  ds_read_b128 a[200:203], v2 offset:43264
  v_fma_f32 v66, v66, s35, -v14
  v_mfma_f32_16x16x32_bf16 v[80:83], a[176:179], a[96:99], v[80:83]
  v_exp_f32_e32 v66, v66
  v_mfma_f32_16x16x32_bf16 v[80:83], a[180:183], a[100:103], v[80:83]
  ds_read_b128 a[204:207], v3 offset:43264
  v_fma_f32 v67, v67, s35, -v14
  v_mfma_f32_16x16x32_bf16 v[88:91], a[160:163], a[104:107], 0
  s_waitcnt vmcnt(13)
  s_barrier
  v_mfma_f32_16x16x32_bf16 v[88:91], a[164:167], a[108:111], v[88:91]
  v_exp_f32_e32 v67, v67
  v_mfma_f32_16x16x32_bf16 v[88:91], a[168:171], a[112:115], v[88:91]
  s_add_u32 m0, s34, 24576
  v_cvt_pk_bf16_f32 v64, v64, v65
  v_cvt_pk_bf16_f32 v65, v66, v67
  v_mfma_f32_16x16x32_bf16 v[88:91], a[172:175], a[116:119], v[88:91]
  s_mov_b32 s32, 172032
  v_fma_f32 v72, v72, s35, -v15
  v_fma_f32 v73, v73, s35, -v15
  v_mfma_f32_16x16x32_bf16 v[88:91], a[176:179], a[120:123], v[88:91]
  buffer_load_dwordx4 v8, s[8:11], s32 offen nt lds
  v_mfma_f32_16x16x32_bf16 v[88:91], a[180:183], a[124:127], v[88:91]
  s_waitcnt lgkmcnt(1)
  v_exp_f32_e32 v72, v72
  v_mfma_f32_16x16x32_bf16 v[68:71], a[184:187], a[32:35], 0
  v_exp_f32_e32 v73, v73
  v_mfma_f32_16x16x32_bf16 v[68:71], a[188:191], a[36:39], v[68:71]
  v_fma_f32 v74, v74, s35, -v15
  v_fma_f32 v75, v75, s35, -v15
  v_mfma_f32_16x16x32_bf16 v[68:71], a[192:195], a[40:43], v[68:71]
  v_exp_f32_e32 v74, v74
  v_mfma_f32_16x16x32_bf16 v[68:71], a[196:199], a[44:47], v[68:71]
  v_exp_f32_e32 v75, v75
  v_mfma_f32_16x16x32_bf16 v[68:71], a[200:203], a[48:51], v[68:71]
  s_waitcnt lgkmcnt(0)
  v_add_f32_e32 v0, v0, v72
  v_add_f32_e32 v0, v0, v73
  v_mfma_f32_16x16x32_bf16 v[68:71], a[204:207], a[52:55], v[68:71]
  v_cvt_pk_bf16_f32 v72, v72, v73
  v_add_f32_e32 v0, v0, v74
  v_mfma_f32_16x16x32_bf16 v[76:79], a[184:187], a[56:59], 0
  v_add_f32_e32 v0, v0, v75
  v_cvt_pk_bf16_f32 v73, v74, v75
  v_mfma_f32_16x16x32_bf16 v[76:79], a[188:191], a[60:63], v[76:79]
  v_fma_f32 v80, v80, s35, -v16
  v_fma_f32 v81, v81, s35, -v16
  v_mfma_f32_16x16x32_bf16 v[76:79], a[192:195], a[64:67], v[76:79]
  ds_read_b64_tr_b16 a[160:161], v4 offset:24576
  v_fma_f32 v82, v82, s35, -v16
  v_mfma_f32_16x16x32_bf16 v[76:79], a[196:199], a[68:71], v[76:79]
  v_exp_f32_e32 v80, v80
  v_mfma_f32_16x16x32_bf16 v[76:79], a[200:203], a[72:75], v[76:79]
  ds_read_b64_tr_b16 a[162:163], v4 offset:30720
  v_fma_f32 v68, v68, s35, -v14
  v_mfma_f32_16x16x32_bf16 v[76:79], a[204:207], a[76:79], v[76:79]
  buffer_load_dwordx4 v9, s[8:11], s32 offen offset:1024 nt lds
  v_mfma_f32_16x16x32_bf16 v[84:87], a[184:187], a[80:83], 0
  ds_read_b64_tr_b16 a[164:165], v5 offset:24576
  v_fma_f32 v69, v69, s35, -v14
  v_mfma_f32_16x16x32_bf16 v[84:87], a[188:191], a[84:87], v[84:87]
  v_exp_f32_e32 v68, v68
  v_mfma_f32_16x16x32_bf16 v[84:87], a[192:195], a[88:91], v[84:87]
  ds_read_b64_tr_b16 a[166:167], v5 offset:30720
  v_fma_f32 v70, v70, s35, -v14
  v_mfma_f32_16x16x32_bf16 v[84:87], a[196:199], a[92:95], v[84:87]
  v_exp_f32_e32 v69, v69
  v_mfma_f32_16x16x32_bf16 v[84:87], a[200:203], a[96:99], v[84:87]
  ds_read_b64_tr_b16 a[168:169], v6 offset:24576
  v_fma_f32 v71, v71, s35, -v14
  v_mfma_f32_16x16x32_bf16 v[84:87], a[204:207], a[100:103], v[84:87]
  v_exp_f32_e32 v70, v70
  v_mfma_f32_16x16x32_bf16 v[92:95], a[184:187], a[104:107], 0
  ds_read_b64_tr_b16 a[170:171], v6 offset:30720
  v_cvt_pk_bf16_f32 v66, v68, v69
  v_mfma_f32_16x16x32_bf16 v[92:95], a[188:191], a[108:111], v[92:95]
  v_exp_f32_e32 v71, v71
  v_mfma_f32_16x16x32_bf16 v[92:95], a[192:195], a[112:115], v[92:95]
  ds_read_b64_tr_b16 a[172:173], v7 offset:24576
  v_cvt_pk_bf16_f32 v67, v70, v71
  v_mfma_f32_16x16x32_bf16 v[92:95], a[196:199], a[116:119], v[92:95]
  v_exp_f32_e32 v81, v81
  v_mfma_f32_16x16x32_bf16 v[92:95], a[200:203], a[120:123], v[92:95]
  ds_read_b64_tr_b16 a[174:175], v7 offset:30720
  v_fma_f32 v76, v76, s35, -v15
  v_mfma_f32_16x16x32_bf16 v[92:95], a[204:207], a[124:127], v[92:95]
  buffer_load_dwordx4 v10, s[8:11], s32 offen offset:2048 nt lds
  v_mfma_f32_16x16x32_bf16 a[240:243], v[18:21], v[32:35], a[240:243]
  s_waitcnt lgkmcnt(4)
  ds_read_b64_tr_b16 a[176:177], v4 offset:24704
  v_fma_f32 v77, v77, s35, -v15
  v_mfma_f32_16x16x32_bf16 v[96:99], a[160:163], v[32:35], v[96:99]
  v_exp_f32_e32 v76, v76
  v_mfma_f32_16x16x32_bf16 v[100:103], a[160:163], v[40:43], v[100:103]
  ds_read_b64_tr_b16 a[178:179], v4 offset:30848
  v_fma_f32 v78, v78, s35, -v15
  v_mfma_f32_16x16x32_bf16 v[104:107], a[160:163], v[48:51], v[104:107]
  v_exp_f32_e32 v77, v77
  v_mfma_f32_16x16x32_bf16 v[108:111], a[160:163], v[56:59], v[108:111]
  ds_read_b64_tr_b16 a[180:181], v5 offset:24704
  v_fma_f32 v79, v79, s35, -v15
  v_mfma_f32_16x16x32_bf16 v[112:115], a[164:167], v[32:35], v[112:115]
  v_exp_f32_e32 v78, v78
  v_mfma_f32_16x16x32_bf16 v[116:119], a[164:167], v[40:43], v[116:119]
  ds_read_b64_tr_b16 a[182:183], v5 offset:30848
  v_cvt_pk_bf16_f32 v74, v76, v77
  v_mfma_f32_16x16x32_bf16 v[120:123], a[164:167], v[48:51], v[120:123]
  v_exp_f32_e32 v79, v79
  v_mfma_f32_16x16x32_bf16 v[124:127], a[164:167], v[56:59], v[124:127]
  s_waitcnt lgkmcnt(4)
  ds_read_b64_tr_b16 a[184:185], v6 offset:24704
  v_cvt_pk_bf16_f32 v75, v78, v79
  v_mfma_f32_16x16x32_bf16 v[128:131], a[168:171], v[32:35], v[128:131]
  s_add_u32 m0, s34, 61440
  v_exp_f32_e32 v82, v82
  v_mfma_f32_16x16x32_bf16 v[132:135], a[168:171], v[40:43], v[132:135]
  s_mov_b32 s33, 159744
  ds_read_b64_tr_b16 a[186:187], v6 offset:30848
  v_fma_f32 v83, v83, s35, -v16
  v_mfma_f32_16x16x32_bf16 v[136:139], a[168:171], v[48:51], v[136:139]
  buffer_load_dwordx4 v8, s[12:15], s33 offen nt lds
  v_mfma_f32_16x16x32_bf16 v[140:143], a[168:171], v[56:59], v[140:143]
  ds_read_b64_tr_b16 a[188:189], v7 offset:24704
  v_fma_f32 v84, v84, s35, -v16
  v_mfma_f32_16x16x32_bf16 v[144:147], a[172:175], v[32:35], v[144:147]
  v_exp_f32_e32 v83, v83
  v_mfma_f32_16x16x32_bf16 v[148:151], a[172:175], v[40:43], v[148:151]
  ds_read_b64_tr_b16 a[190:191], v7 offset:30848
  v_fma_f32 v85, v85, s35, -v16
  v_mfma_f32_16x16x32_bf16 v[152:155], a[172:175], v[48:51], v[152:155]
  v_exp_f32_e32 v84, v84
  v_mfma_f32_16x16x32_bf16 v[156:159], a[172:175], v[56:59], v[156:159]
  s_waitcnt lgkmcnt(4)
  ds_read_b64_tr_b16 a[192:193], v4 offset:24832
  v_fma_f32 v86, v86, s35, -v16
  v_mfma_f32_16x16x32_bf16 v[160:163], a[176:179], v[32:35], v[160:163]
  v_exp_f32_e32 v85, v85
  v_mfma_f32_16x16x32_bf16 v[164:167], a[176:179], v[40:43], v[164:167]
  ds_read_b64_tr_b16 a[194:195], v4 offset:30976
  v_fma_f32 v87, v87, s35, -v16
  v_mfma_f32_16x16x32_bf16 v[168:171], a[176:179], v[48:51], v[168:171]
  v_exp_f32_e32 v86, v86
  v_mfma_f32_16x16x32_bf16 v[172:175], a[176:179], v[56:59], v[172:175]
  ds_read_b64_tr_b16 a[196:197], v5 offset:24832
  v_add_f32_e32 v30, v30, v80
  v_mfma_f32_16x16x32_bf16 v[176:179], a[180:183], v[32:35], v[176:179]
  v_exp_f32_e32 v87, v87
  v_mfma_f32_16x16x32_bf16 v[180:183], a[180:183], v[40:43], v[180:183]
  ds_read_b64_tr_b16 a[198:199], v5 offset:30976
  v_add_f32_e32 v30, v30, v81
  v_mfma_f32_16x16x32_bf16 v[184:187], a[180:183], v[48:51], v[184:187]
  buffer_load_dwordx4 v9, s[12:15], s33 offen offset:1024 nt lds
  v_mfma_f32_16x16x32_bf16 v[188:191], a[180:183], v[56:59], v[188:191]
  s_waitcnt lgkmcnt(4)
  ds_read_b64_tr_b16 a[200:201], v6 offset:24832
  v_cvt_pk_bf16_f32 v80, v80, v81
  v_mfma_f32_16x16x32_bf16 v[192:195], a[184:187], v[32:35], v[192:195]
  v_add_f32_e32 v30, v30, v82
  v_add_f32_e32 v30, v30, v83
  v_mfma_f32_16x16x32_bf16 v[196:199], a[184:187], v[40:43], v[196:199]
  ds_read_b64_tr_b16 a[202:203], v6 offset:30976
  v_cvt_pk_bf16_f32 v81, v82, v83
  v_mfma_f32_16x16x32_bf16 v[200:203], a[184:187], v[48:51], v[200:203]
  v_cvt_pk_bf16_f32 v82, v84, v85
  v_cvt_pk_bf16_f32 v83, v86, v87
  v_mfma_f32_16x16x32_bf16 v[204:207], a[184:187], v[56:59], v[204:207]
  ds_read_b64_tr_b16 a[204:205], v7 offset:24832
  v_fma_f32 v88, v88, s35, -v17
  v_mfma_f32_16x16x32_bf16 v[208:211], a[188:191], v[32:35], v[208:211]
  v_exp_f32_e32 v88, v88
  v_mfma_f32_16x16x32_bf16 v[212:215], a[188:191], v[40:43], v[212:215]
  ds_read_b64_tr_b16 a[206:207], v7 offset:30976
  v_fma_f32 v89, v89, s35, -v17
  v_mfma_f32_16x16x32_bf16 v[216:219], a[188:191], v[48:51], v[216:219]
  v_exp_f32_e32 v89, v89
  v_mfma_f32_16x16x32_bf16 v[220:223], a[188:191], v[56:59], v[220:223]
  s_waitcnt lgkmcnt(4)
  ds_read_b128 a[160:163], v2 offset:0
  v_fma_f32 v90, v90, s35, -v17
  v_mfma_f32_16x16x32_bf16 v[224:227], a[192:195], v[32:35], v[224:227]
  v_exp_f32_e32 v90, v90
  v_mfma_f32_16x16x32_bf16 v[228:231], a[192:195], v[40:43], v[228:231]
  ds_read_b128 a[164:167], v3 offset:0
  v_fma_f32 v91, v91, s35, -v17
  v_mfma_f32_16x16x32_bf16 v[232:235], a[192:195], v[48:51], v[232:235]
  buffer_load_dwordx4 v10, s[12:15], s33 offen offset:2048 nt lds
  v_mfma_f32_16x16x32_bf16 v[236:239], a[192:195], v[56:59], v[236:239]
  ds_read_b128 a[168:171], v2 offset:128
  v_fma_f32 v92, v92, s35, -v17
  v_mfma_f32_16x16x32_bf16 v[240:243], a[196:199], v[32:35], v[240:243]
  v_exp_f32_e32 v91, v91
  v_mfma_f32_16x16x32_bf16 v[244:247], a[196:199], v[40:43], v[244:247]
  ds_read_b128 a[172:175], v3 offset:128
  v_fma_f32 v93, v93, s35, -v17
  v_mfma_f32_16x16x32_bf16 v[248:251], a[196:199], v[48:51], v[248:251]
  v_exp_f32_e32 v92, v92
  v_mfma_f32_16x16x32_bf16 v[252:255], a[196:199], v[56:59], v[252:255]
  s_waitcnt lgkmcnt(3)
  ds_read_b128 a[176:179], v2 offset:256
  v_fma_f32 v94, v94, s35, -v17
  v_mfma_f32_16x16x32_bf16 a[0:3], a[200:203], v[32:35], a[0:3]
  v_exp_f32_e32 v93, v93
  v_mfma_f32_16x16x32_bf16 a[4:7], a[200:203], v[40:43], a[4:7]
  ds_read_b128 a[180:183], v3 offset:256
  v_fma_f32 v95, v95, s35, -v17
  v_mfma_f32_16x16x32_bf16 a[8:11], a[200:203], v[48:51], a[8:11]
  v_exp_f32_e32 v94, v94
  v_mfma_f32_16x16x32_bf16 a[12:15], a[200:203], v[56:59], a[12:15]
  v_exp_f32_e32 v95, v95
  v_mfma_f32_16x16x32_bf16 a[16:19], a[204:207], v[32:35], a[16:19]
  v_add_f32_e32 v31, v31, v88
  v_add_f32_e32 v31, v31, v89
  v_mfma_f32_16x16x32_bf16 a[20:23], a[204:207], v[40:43], a[20:23]
  s_add_u32 m0, s28, 2048
  v_cvt_pk_bf16_f32 v88, v88, v89
  v_add_f32_e32 v31, v31, v90
  v_mfma_f32_16x16x32_bf16 a[24:27], a[204:207], v[48:51], a[24:27]
  buffer_load_dwordx4 v11, s[24:27], s87 offen nt lds
  v_mfma_f32_16x16x32_bf16 a[28:31], a[204:207], v[56:59], a[28:31]
  v_add_f32_e32 v31, v31, v91
  v_cvt_pk_bf16_f32 v89, v90, v91
  v_mfma_f32_16x16x32_bf16 v[32:35], a[160:163], a[32:35], 0
  s_waitcnt lgkmcnt(1)
  v_cvt_pk_bf16_f32 v90, v92, v93
  v_cvt_pk_bf16_f32 v91, v94, v95
  v_mfma_f32_16x16x32_bf16 v[32:35], a[164:167], a[36:39], v[32:35]
  v_add_f32_e32 v0, v0, v76
  v_add_f32_e32 v0, v0, v77
  v_mfma_f32_16x16x32_bf16 v[32:35], a[168:171], a[40:43], v[32:35]
  v_add_f32_e32 v0, v0, v78
  v_add_f32_e32 v0, v0, v79
  v_mfma_f32_16x16x32_bf16 v[32:35], a[172:175], a[44:47], v[32:35]
  v_add_f32_e32 v30, v30, v84
  v_add_f32_e32 v30, v30, v85
  v_mfma_f32_16x16x32_bf16 v[32:35], a[176:179], a[48:51], v[32:35]
  s_waitcnt lgkmcnt(0)
  v_add_f32_e32 v30, v30, v86
  v_add_f32_e32 v30, v30, v87
  v_mfma_f32_16x16x32_bf16 v[32:35], a[180:183], a[52:55], v[32:35]
  v_add_f32_e32 v31, v31, v92
  v_add_f32_e32 v31, v31, v93
  v_mfma_f32_16x16x32_bf16 v[40:43], a[160:163], a[56:59], 0
  v_add_f32_e32 v31, v31, v94
  v_add_f32_e32 v31, v31, v95
  v_mfma_f32_16x16x32_bf16 v[40:43], a[164:167], a[60:63], v[40:43]
  ds_read_b128 a[184:187], v2 offset:6144
  v_mfma_f32_16x16x32_bf16 v[40:43], a[168:171], a[64:67], v[40:43]
  v_mfma_f32_16x16x32_bf16 v[40:43], a[172:175], a[68:71], v[40:43]
  s_add_u32 m0, s28, 0
  ds_read_b128 a[188:191], v3 offset:6144
  v_mfma_f32_16x16x32_bf16 v[40:43], a[176:179], a[72:75], v[40:43]
  buffer_load_dwordx4 v11, s[24:27], s87 offen offset:3072 nt lds
  v_mfma_f32_16x16x32_bf16 v[40:43], a[180:183], a[76:79], v[40:43]
  ds_read_b128 a[192:195], v2 offset:6272
  v_fma_f32 v32, v32, s35, -v14
  v_mfma_f32_16x16x32_bf16 v[48:51], a[160:163], a[80:83], 0
  v_exp_f32_e32 v32, v32
  v_mfma_f32_16x16x32_bf16 v[48:51], a[164:167], a[84:87], v[48:51]
  ds_read_b128 a[196:199], v3 offset:6272
  v_fma_f32 v33, v33, s35, -v14
  v_mfma_f32_16x16x32_bf16 v[48:51], a[168:171], a[88:91], v[48:51]
  v_exp_f32_e32 v33, v33
  v_mfma_f32_16x16x32_bf16 v[48:51], a[172:175], a[92:95], v[48:51]
  ds_read_b128 a[200:203], v2 offset:6400
  v_fma_f32 v34, v34, s35, -v14
  v_mfma_f32_16x16x32_bf16 v[48:51], a[176:179], a[96:99], v[48:51]
  v_exp_f32_e32 v34, v34
  v_mfma_f32_16x16x32_bf16 v[48:51], a[180:183], a[100:103], v[48:51]
  ds_read_b128 a[204:207], v3 offset:6400
  v_fma_f32 v35, v35, s35, -v14
  v_mfma_f32_16x16x32_bf16 v[56:59], a[160:163], a[104:107], 0
  s_waitcnt vmcnt(13)
  s_barrier
  v_mfma_f32_16x16x32_bf16 v[56:59], a[164:167], a[108:111], v[56:59]
  v_exp_f32_e32 v35, v35
  v_mfma_f32_16x16x32_bf16 v[56:59], a[168:171], a[112:115], v[56:59]
  s_add_u32 m0, s34, 36864
  v_cvt_pk_bf16_f32 v32, v32, v33
  v_cvt_pk_bf16_f32 v33, v34, v35
  v_mfma_f32_16x16x32_bf16 v[56:59], a[172:175], a[116:119], v[56:59]
  s_mov_b32 s32, 184320
  v_fma_f32 v40, v40, s35, -v15
  v_fma_f32 v41, v41, s35, -v15
  v_mfma_f32_16x16x32_bf16 v[56:59], a[176:179], a[120:123], v[56:59]
  buffer_load_dwordx4 v8, s[8:11], s32 offen nt lds
  v_mfma_f32_16x16x32_bf16 v[56:59], a[180:183], a[124:127], v[56:59]
  s_waitcnt lgkmcnt(1)
  v_exp_f32_e32 v40, v40
  v_mfma_f32_16x16x32_bf16 v[36:39], a[184:187], a[32:35], 0
  v_exp_f32_e32 v41, v41
  v_mfma_f32_16x16x32_bf16 v[36:39], a[188:191], a[36:39], v[36:39]
  v_fma_f32 v42, v42, s35, -v15
  v_fma_f32 v43, v43, s35, -v15
  v_mfma_f32_16x16x32_bf16 v[36:39], a[192:195], a[40:43], v[36:39]
  v_exp_f32_e32 v42, v42
  v_mfma_f32_16x16x32_bf16 v[36:39], a[196:199], a[44:47], v[36:39]
  v_exp_f32_e32 v43, v43
  v_mfma_f32_16x16x32_bf16 v[36:39], a[200:203], a[48:51], v[36:39]
  s_waitcnt lgkmcnt(0)
  v_add_f32_e32 v0, v0, v40
  v_add_f32_e32 v0, v0, v41
  v_mfma_f32_16x16x32_bf16 v[36:39], a[204:207], a[52:55], v[36:39]
  v_cvt_pk_bf16_f32 v40, v40, v41
  v_add_f32_e32 v0, v0, v42
  v_mfma_f32_16x16x32_bf16 v[44:47], a[184:187], a[56:59], 0
  v_add_f32_e32 v0, v0, v43
  v_cvt_pk_bf16_f32 v41, v42, v43
  v_mfma_f32_16x16x32_bf16 v[44:47], a[188:191], a[60:63], v[44:47]
  v_fma_f32 v48, v48, s35, -v16
  v_fma_f32 v49, v49, s35, -v16
  v_mfma_f32_16x16x32_bf16 v[44:47], a[192:195], a[64:67], v[44:47]
  ds_read_b64_tr_b16 a[160:161], v4 offset:36864
  v_fma_f32 v50, v50, s35, -v16
  v_mfma_f32_16x16x32_bf16 v[44:47], a[196:199], a[68:71], v[44:47]
  v_exp_f32_e32 v48, v48
  v_mfma_f32_16x16x32_bf16 v[44:47], a[200:203], a[72:75], v[44:47]
  ds_read_b64_tr_b16 a[162:163], v4 offset:43008
  v_fma_f32 v36, v36, s35, -v14
  v_mfma_f32_16x16x32_bf16 v[44:47], a[204:207], a[76:79], v[44:47]
  buffer_load_dwordx4 v9, s[8:11], s32 offen offset:1024 nt lds
  v_mfma_f32_16x16x32_bf16 v[52:55], a[184:187], a[80:83], 0
  ds_read_b64_tr_b16 a[164:165], v5 offset:36864
  v_fma_f32 v37, v37, s35, -v14
  v_mfma_f32_16x16x32_bf16 v[52:55], a[188:191], a[84:87], v[52:55]
  v_exp_f32_e32 v36, v36
  v_mfma_f32_16x16x32_bf16 v[52:55], a[192:195], a[88:91], v[52:55]
  ds_read_b64_tr_b16 a[166:167], v5 offset:43008
  v_fma_f32 v38, v38, s35, -v14
  v_mfma_f32_16x16x32_bf16 v[52:55], a[196:199], a[92:95], v[52:55]
  v_exp_f32_e32 v37, v37
  v_mfma_f32_16x16x32_bf16 v[52:55], a[200:203], a[96:99], v[52:55]
  ds_read_b64_tr_b16 a[168:169], v6 offset:36864
  v_fma_f32 v39, v39, s35, -v14
  v_mfma_f32_16x16x32_bf16 v[52:55], a[204:207], a[100:103], v[52:55]
  v_exp_f32_e32 v38, v38
  v_mfma_f32_16x16x32_bf16 v[60:63], a[184:187], a[104:107], 0
  ds_read_b64_tr_b16 a[170:171], v6 offset:43008
  v_cvt_pk_bf16_f32 v34, v36, v37
  v_mfma_f32_16x16x32_bf16 v[60:63], a[188:191], a[108:111], v[60:63]
  v_exp_f32_e32 v39, v39
  v_mfma_f32_16x16x32_bf16 v[60:63], a[192:195], a[112:115], v[60:63]
  ds_read_b64_tr_b16 a[172:173], v7 offset:36864
  v_cvt_pk_bf16_f32 v35, v38, v39
  v_mfma_f32_16x16x32_bf16 v[60:63], a[196:199], a[116:119], v[60:63]
  v_exp_f32_e32 v49, v49
  v_mfma_f32_16x16x32_bf16 v[60:63], a[200:203], a[120:123], v[60:63]
  ds_read_b64_tr_b16 a[174:175], v7 offset:43008
  v_fma_f32 v44, v44, s35, -v15
  v_mfma_f32_16x16x32_bf16 v[60:63], a[204:207], a[124:127], v[60:63]
  buffer_load_dwordx4 v10, s[8:11], s32 offen offset:2048 nt lds
  v_mfma_f32_16x16x32_bf16 a[240:243], v[18:21], v[64:67], a[240:243]
  s_waitcnt lgkmcnt(4)
  ds_read_b64_tr_b16 a[176:177], v4 offset:36992
  v_fma_f32 v45, v45, s35, -v15
  v_mfma_f32_16x16x32_bf16 v[96:99], a[160:163], v[64:67], v[96:99]
  v_exp_f32_e32 v44, v44
  v_mfma_f32_16x16x32_bf16 v[100:103], a[160:163], v[72:75], v[100:103]
  ds_read_b64_tr_b16 a[178:179], v4 offset:43136
  v_fma_f32 v46, v46, s35, -v15
  v_mfma_f32_16x16x32_bf16 v[104:107], a[160:163], v[80:83], v[104:107]
  v_exp_f32_e32 v45, v45
  v_mfma_f32_16x16x32_bf16 v[108:111], a[160:163], v[88:91], v[108:111]
  ds_read_b64_tr_b16 a[180:181], v5 offset:36992
  v_fma_f32 v47, v47, s35, -v15
  v_mfma_f32_16x16x32_bf16 v[112:115], a[164:167], v[64:67], v[112:115]
  v_exp_f32_e32 v46, v46
  v_mfma_f32_16x16x32_bf16 v[116:119], a[164:167], v[72:75], v[116:119]
  ds_read_b64_tr_b16 a[182:183], v5 offset:43136
  v_cvt_pk_bf16_f32 v42, v44, v45
  v_mfma_f32_16x16x32_bf16 v[120:123], a[164:167], v[80:83], v[120:123]
  v_exp_f32_e32 v47, v47
  v_mfma_f32_16x16x32_bf16 v[124:127], a[164:167], v[88:91], v[124:127]
  s_waitcnt lgkmcnt(4)
  ds_read_b64_tr_b16 a[184:185], v6 offset:36992
  v_cvt_pk_bf16_f32 v43, v46, v47
  v_mfma_f32_16x16x32_bf16 v[128:131], a[168:171], v[64:67], v[128:131]
  s_add_u32 m0, s34, 73728
  v_exp_f32_e32 v50, v50
  v_mfma_f32_16x16x32_bf16 v[132:135], a[168:171], v[72:75], v[132:135]
  s_mov_b32 s33, 172032
  ds_read_b64_tr_b16 a[186:187], v6 offset:43136
  v_fma_f32 v51, v51, s35, -v16
  v_mfma_f32_16x16x32_bf16 v[136:139], a[168:171], v[80:83], v[136:139]
  buffer_load_dwordx4 v8, s[12:15], s33 offen nt lds
  v_mfma_f32_16x16x32_bf16 v[140:143], a[168:171], v[88:91], v[140:143]
  ds_read_b64_tr_b16 a[188:189], v7 offset:36992
  v_fma_f32 v52, v52, s35, -v16
  v_mfma_f32_16x16x32_bf16 v[144:147], a[172:175], v[64:67], v[144:147]
  v_exp_f32_e32 v51, v51
  v_mfma_f32_16x16x32_bf16 v[148:151], a[172:175], v[72:75], v[148:151]
  ds_read_b64_tr_b16 a[190:191], v7 offset:43136
  v_fma_f32 v53, v53, s35, -v16
  v_mfma_f32_16x16x32_bf16 v[152:155], a[172:175], v[80:83], v[152:155]
L_hop5:
  s_cbranch_execz L_hop9
  v_exp_f32_e32 v52, v52
  v_mfma_f32_16x16x32_bf16 v[156:159], a[172:175], v[88:91], v[156:159]
  s_waitcnt lgkmcnt(4)
  ds_read_b64_tr_b16 a[192:193], v4 offset:37120
  v_fma_f32 v54, v54, s35, -v16
  v_mfma_f32_16x16x32_bf16 v[160:163], a[176:179], v[64:67], v[160:163]
  v_exp_f32_e32 v53, v53
  v_mfma_f32_16x16x32_bf16 v[164:167], a[176:179], v[72:75], v[164:167]
  ds_read_b64_tr_b16 a[194:195], v4 offset:43264
  v_fma_f32 v55, v55, s35, -v16
  v_mfma_f32_16x16x32_bf16 v[168:171], a[176:179], v[80:83], v[168:171]
  v_exp_f32_e32 v54, v54
  v_mfma_f32_16x16x32_bf16 v[172:175], a[176:179], v[88:91], v[172:175]
  ds_read_b64_tr_b16 a[196:197], v5 offset:37120
  v_add_f32_e32 v30, v30, v48
  v_mfma_f32_16x16x32_bf16 v[176:179], a[180:183], v[64:67], v[176:179]
  v_exp_f32_e32 v55, v55
  v_mfma_f32_16x16x32_bf16 v[180:183], a[180:183], v[72:75], v[180:183]
  ds_read_b64_tr_b16 a[198:199], v5 offset:43264
  v_add_f32_e32 v30, v30, v49
  v_mfma_f32_16x16x32_bf16 v[184:187], a[180:183], v[80:83], v[184:187]
  buffer_load_dwordx4 v9, s[12:15], s33 offen offset:1024 nt lds
  v_mfma_f32_16x16x32_bf16 v[188:191], a[180:183], v[88:91], v[188:191]
  s_waitcnt lgkmcnt(4)
  ds_read_b64_tr_b16 a[200:201], v6 offset:37120
  v_cvt_pk_bf16_f32 v48, v48, v49
  v_mfma_f32_16x16x32_bf16 v[192:195], a[184:187], v[64:67], v[192:195]
  v_add_f32_e32 v30, v30, v50
  v_add_f32_e32 v30, v30, v51
  v_mfma_f32_16x16x32_bf16 v[196:199], a[184:187], v[72:75], v[196:199]
  ds_read_b64_tr_b16 a[202:203], v6 offset:43264
  v_cvt_pk_bf16_f32 v49, v50, v51
  v_mfma_f32_16x16x32_bf16 v[200:203], a[184:187], v[80:83], v[200:203]
  v_cvt_pk_bf16_f32 v50, v52, v53
  v_cvt_pk_bf16_f32 v51, v54, v55
  v_mfma_f32_16x16x32_bf16 v[204:207], a[184:187], v[88:91], v[204:207]
  ds_read_b64_tr_b16 a[204:205], v7 offset:37120
  v_fma_f32 v56, v56, s35, -v17
  v_mfma_f32_16x16x32_bf16 v[208:211], a[188:191], v[64:67], v[208:211]
  v_exp_f32_e32 v56, v56
  v_mfma_f32_16x16x32_bf16 v[212:215], a[188:191], v[72:75], v[212:215]
  ds_read_b64_tr_b16 a[206:207], v7 offset:43264
  v_fma_f32 v57, v57, s35, -v17
  v_mfma_f32_16x16x32_bf16 v[216:219], a[188:191], v[80:83], v[216:219]
  v_exp_f32_e32 v57, v57
  v_mfma_f32_16x16x32_bf16 v[220:223], a[188:191], v[88:91], v[220:223]
  s_waitcnt lgkmcnt(4)
  ds_read_b128 a[160:163], v2 offset:12288
  v_fma_f32 v58, v58, s35, -v17
  v_mfma_f32_16x16x32_bf16 v[224:227], a[192:195], v[64:67], v[224:227]
  v_exp_f32_e32 v58, v58
  v_mfma_f32_16x16x32_bf16 v[228:231], a[192:195], v[72:75], v[228:231]
  ds_read_b128 a[164:167], v3 offset:12288
  v_fma_f32 v59, v59, s35, -v17
  v_mfma_f32_16x16x32_bf16 v[232:235], a[192:195], v[80:83], v[232:235]
  buffer_load_dwordx4 v10, s[12:15], s33 offen offset:2048 nt lds
  v_mfma_f32_16x16x32_bf16 v[236:239], a[192:195], v[88:91], v[236:239]
  ds_read_b128 a[168:171], v2 offset:12416
  v_fma_f32 v60, v60, s35, -v17
  v_mfma_f32_16x16x32_bf16 v[240:243], a[196:199], v[64:67], v[240:243]
  v_exp_f32_e32 v59, v59
  v_mfma_f32_16x16x32_bf16 v[244:247], a[196:199], v[72:75], v[244:247]
  ds_read_b128 a[172:175], v3 offset:12416
  v_fma_f32 v61, v61, s35, -v17
  v_mfma_f32_16x16x32_bf16 v[248:251], a[196:199], v[80:83], v[248:251]
  v_exp_f32_e32 v60, v60
  v_mfma_f32_16x16x32_bf16 v[252:255], a[196:199], v[88:91], v[252:255]
  s_waitcnt lgkmcnt(3)
  ds_read_b128 a[176:179], v2 offset:12544
  v_fma_f32 v62, v62, s35, -v17
  v_mfma_f32_16x16x32_bf16 a[0:3], a[200:203], v[64:67], a[0:3]
  v_exp_f32_e32 v61, v61
  v_mfma_f32_16x16x32_bf16 a[4:7], a[200:203], v[72:75], a[4:7]
  ds_read_b128 a[180:183], v3 offset:12544
  v_fma_f32 v63, v63, s35, -v17
  v_mfma_f32_16x16x32_bf16 a[8:11], a[200:203], v[80:83], a[8:11]
  v_exp_f32_e32 v62, v62
  v_mfma_f32_16x16x32_bf16 a[12:15], a[200:203], v[88:91], a[12:15]
  v_exp_f32_e32 v63, v63
  v_mfma_f32_16x16x32_bf16 a[16:19], a[204:207], v[64:67], a[16:19]
  v_add_f32_e32 v31, v31, v56
  v_add_f32_e32 v31, v31, v57
  v_mfma_f32_16x16x32_bf16 a[20:23], a[204:207], v[72:75], a[20:23]
  s_add_u32 m0, s28, 3968
  v_cvt_pk_bf16_f32 v56, v56, v57
  v_add_f32_e32 v31, v31, v58
  v_mfma_f32_16x16x32_bf16 a[24:27], a[204:207], v[80:83], a[24:27]
  buffer_load_dwordx4 v11, s[24:27], s86 offen offset:128 nt lds
  v_mfma_f32_16x16x32_bf16 a[28:31], a[204:207], v[88:91], a[28:31]
  v_add_f32_e32 v31, v31, v59
  v_cvt_pk_bf16_f32 v57, v58, v59
  v_mfma_f32_16x16x32_bf16 v[64:67], a[160:163], a[32:35], 0
  s_waitcnt lgkmcnt(1)
  v_cvt_pk_bf16_f32 v58, v60, v61
  v_cvt_pk_bf16_f32 v59, v62, v63
  v_mfma_f32_16x16x32_bf16 v[64:67], a[164:167], a[36:39], v[64:67]
  v_add_f32_e32 v0, v0, v44
  v_add_f32_e32 v0, v0, v45
  v_mfma_f32_16x16x32_bf16 v[64:67], a[168:171], a[40:43], v[64:67]
  v_add_f32_e32 v0, v0, v46
  v_add_f32_e32 v0, v0, v47
  v_mfma_f32_16x16x32_bf16 v[64:67], a[172:175], a[44:47], v[64:67]
  v_add_f32_e32 v30, v30, v52
  v_add_f32_e32 v30, v30, v53
  v_mfma_f32_16x16x32_bf16 v[64:67], a[176:179], a[48:51], v[64:67]
  s_waitcnt lgkmcnt(0)
  v_add_f32_e32 v30, v30, v54
  v_add_f32_e32 v30, v30, v55
  v_mfma_f32_16x16x32_bf16 v[64:67], a[180:183], a[52:55], v[64:67]
  v_add_f32_e32 v31, v31, v60
  v_add_f32_e32 v31, v31, v61
  v_mfma_f32_16x16x32_bf16 v[72:75], a[160:163], a[56:59], 0
  v_add_f32_e32 v31, v31, v62
  v_add_f32_e32 v31, v31, v63
  v_mfma_f32_16x16x32_bf16 v[72:75], a[164:167], a[60:63], v[72:75]
  ds_read_b128 a[184:187], v2 offset:18432
  v_mfma_f32_16x16x32_bf16 v[72:75], a[168:171], a[64:67], v[72:75]
  v_mfma_f32_16x16x32_bf16 v[72:75], a[172:175], a[68:71], v[72:75]
  s_add_u32 m0, s28, 1920
  ds_read_b128 a[188:191], v3 offset:18432
  v_mfma_f32_16x16x32_bf16 v[72:75], a[176:179], a[72:75], v[72:75]
  buffer_load_dwordx4 v11, s[24:27], s86 offen offset:3200 nt lds
  v_mfma_f32_16x16x32_bf16 v[72:75], a[180:183], a[76:79], v[72:75]
  ds_read_b128 a[192:195], v2 offset:18560
  v_fma_f32 v64, v64, s35, -v14
  v_mfma_f32_16x16x32_bf16 v[80:83], a[160:163], a[80:83], 0
  v_exp_f32_e32 v64, v64
  v_mfma_f32_16x16x32_bf16 v[80:83], a[164:167], a[84:87], v[80:83]
  ds_read_b128 a[196:199], v3 offset:18560
  v_fma_f32 v65, v65, s35, -v14
  v_mfma_f32_16x16x32_bf16 v[80:83], a[168:171], a[88:91], v[80:83]
  v_exp_f32_e32 v65, v65
  v_mfma_f32_16x16x32_bf16 v[80:83], a[172:175], a[92:95], v[80:83]
  ds_read_b128 a[200:203], v2 offset:18688
  v_fma_f32 v66, v66, s35, -v14
  v_mfma_f32_16x16x32_bf16 v[80:83], a[176:179], a[96:99], v[80:83]
  v_exp_f32_e32 v66, v66
  v_mfma_f32_16x16x32_bf16 v[80:83], a[180:183], a[100:103], v[80:83]
  ds_read_b128 a[204:207], v3 offset:18688
  v_fma_f32 v67, v67, s35, -v14
  v_mfma_f32_16x16x32_bf16 v[88:91], a[160:163], a[104:107], 0
  s_waitcnt vmcnt(13)
  s_barrier
  v_mfma_f32_16x16x32_bf16 v[88:91], a[164:167], a[108:111], v[88:91]
  v_exp_f32_e32 v67, v67
  v_mfma_f32_16x16x32_bf16 v[88:91], a[168:171], a[112:115], v[88:91]
  s_add_u32 m0, s34, 0
  v_cvt_pk_bf16_f32 v64, v64, v65
  v_cvt_pk_bf16_f32 v65, v66, v67
  v_mfma_f32_16x16x32_bf16 v[88:91], a[172:175], a[116:119], v[88:91]
  s_mov_b32 s32, 196608
  v_fma_f32 v72, v72, s35, -v15
  v_fma_f32 v73, v73, s35, -v15
  v_mfma_f32_16x16x32_bf16 v[88:91], a[176:179], a[120:123], v[88:91]
  buffer_load_dwordx4 v8, s[8:11], s32 offen nt lds
  v_mfma_f32_16x16x32_bf16 v[88:91], a[180:183], a[124:127], v[88:91]
  s_waitcnt lgkmcnt(1)
  v_exp_f32_e32 v72, v72
  v_mfma_f32_16x16x32_bf16 v[68:71], a[184:187], a[32:35], 0
  v_exp_f32_e32 v73, v73
  v_mfma_f32_16x16x32_bf16 v[68:71], a[188:191], a[36:39], v[68:71]
  v_fma_f32 v74, v74, s35, -v15
  v_fma_f32 v75, v75, s35, -v15
  v_mfma_f32_16x16x32_bf16 v[68:71], a[192:195], a[40:43], v[68:71]
  v_exp_f32_e32 v74, v74
  v_mfma_f32_16x16x32_bf16 v[68:71], a[196:199], a[44:47], v[68:71]
  v_exp_f32_e32 v75, v75
  v_mfma_f32_16x16x32_bf16 v[68:71], a[200:203], a[48:51], v[68:71]
  s_waitcnt lgkmcnt(0)
  v_add_f32_e32 v0, v0, v72
  v_add_f32_e32 v0, v0, v73
  v_mfma_f32_16x16x32_bf16 v[68:71], a[204:207], a[52:55], v[68:71]
  v_cvt_pk_bf16_f32 v72, v72, v73
  v_add_f32_e32 v0, v0, v74
  v_mfma_f32_16x16x32_bf16 v[76:79], a[184:187], a[56:59], 0
  v_add_f32_e32 v0, v0, v75
  v_cvt_pk_bf16_f32 v73, v74, v75
  v_mfma_f32_16x16x32_bf16 v[76:79], a[188:191], a[60:63], v[76:79]
  v_fma_f32 v80, v80, s35, -v16
  v_fma_f32 v81, v81, s35, -v16
  v_mfma_f32_16x16x32_bf16 v[76:79], a[192:195], a[64:67], v[76:79]
  ds_read_b64_tr_b16 a[160:161], v4 offset:0
  v_fma_f32 v82, v82, s35, -v16
  v_mfma_f32_16x16x32_bf16 v[76:79], a[196:199], a[68:71], v[76:79]
  v_exp_f32_e32 v80, v80
  v_mfma_f32_16x16x32_bf16 v[76:79], a[200:203], a[72:75], v[76:79]
  ds_read_b64_tr_b16 a[162:163], v4 offset:6144
  v_fma_f32 v68, v68, s35, -v14
  v_mfma_f32_16x16x32_bf16 v[76:79], a[204:207], a[76:79], v[76:79]
  buffer_load_dwordx4 v9, s[8:11], s32 offen offset:1024 nt lds
  v_mfma_f32_16x16x32_bf16 v[84:87], a[184:187], a[80:83], 0
  ds_read_b64_tr_b16 a[164:165], v5 offset:0
  v_fma_f32 v69, v69, s35, -v14
  v_mfma_f32_16x16x32_bf16 v[84:87], a[188:191], a[84:87], v[84:87]
  v_exp_f32_e32 v68, v68
  v_mfma_f32_16x16x32_bf16 v[84:87], a[192:195], a[88:91], v[84:87]
  ds_read_b64_tr_b16 a[166:167], v5 offset:6144
  v_fma_f32 v70, v70, s35, -v14
  v_mfma_f32_16x16x32_bf16 v[84:87], a[196:199], a[92:95], v[84:87]
  v_exp_f32_e32 v69, v69
  v_mfma_f32_16x16x32_bf16 v[84:87], a[200:203], a[96:99], v[84:87]
  ds_read_b64_tr_b16 a[168:169], v6 offset:0
  v_fma_f32 v71, v71, s35, -v14
  v_mfma_f32_16x16x32_bf16 v[84:87], a[204:207], a[100:103], v[84:87]
  v_exp_f32_e32 v70, v70
  v_mfma_f32_16x16x32_bf16 v[92:95], a[184:187], a[104:107], 0
  ds_read_b64_tr_b16 a[170:171], v6 offset:6144
  v_cvt_pk_bf16_f32 v66, v68, v69
  v_mfma_f32_16x16x32_bf16 v[92:95], a[188:191], a[108:111], v[92:95]
  v_exp_f32_e32 v71, v71
  v_mfma_f32_16x16x32_bf16 v[92:95], a[192:195], a[112:115], v[92:95]
  ds_read_b64_tr_b16 a[172:173], v7 offset:0
  v_cvt_pk_bf16_f32 v67, v70, v71
  v_mfma_f32_16x16x32_bf16 v[92:95], a[196:199], a[116:119], v[92:95]
  v_exp_f32_e32 v81, v81
  v_mfma_f32_16x16x32_bf16 v[92:95], a[200:203], a[120:123], v[92:95]
  ds_read_b64_tr_b16 a[174:175], v7 offset:6144
  v_fma_f32 v76, v76, s35, -v15
  v_mfma_f32_16x16x32_bf16 v[92:95], a[204:207], a[124:127], v[92:95]
  buffer_load_dwordx4 v10, s[8:11], s32 offen offset:2048 nt lds
  v_mfma_f32_16x16x32_bf16 a[240:243], v[18:21], v[32:35], a[240:243]
  s_waitcnt lgkmcnt(4)
  ds_read_b64_tr_b16 a[176:177], v4 offset:128
  v_fma_f32 v77, v77, s35, -v15
  v_mfma_f32_16x16x32_bf16 v[96:99], a[160:163], v[32:35], v[96:99]
  v_exp_f32_e32 v76, v76
  v_mfma_f32_16x16x32_bf16 v[100:103], a[160:163], v[40:43], v[100:103]
  ds_read_b64_tr_b16 a[178:179], v4 offset:6272
  v_fma_f32 v78, v78, s35, -v15
  v_mfma_f32_16x16x32_bf16 v[104:107], a[160:163], v[48:51], v[104:107]
  v_exp_f32_e32 v77, v77
  v_mfma_f32_16x16x32_bf16 v[108:111], a[160:163], v[56:59], v[108:111]
  ds_read_b64_tr_b16 a[180:181], v5 offset:128
  v_fma_f32 v79, v79, s35, -v15
  v_mfma_f32_16x16x32_bf16 v[112:115], a[164:167], v[32:35], v[112:115]
  v_exp_f32_e32 v78, v78
  v_mfma_f32_16x16x32_bf16 v[116:119], a[164:167], v[40:43], v[116:119]
  ds_read_b64_tr_b16 a[182:183], v5 offset:6272
  v_cvt_pk_bf16_f32 v74, v76, v77
  v_mfma_f32_16x16x32_bf16 v[120:123], a[164:167], v[48:51], v[120:123]
  v_exp_f32_e32 v79, v79
  v_mfma_f32_16x16x32_bf16 v[124:127], a[164:167], v[56:59], v[124:127]
  s_waitcnt lgkmcnt(4)
  ds_read_b64_tr_b16 a[184:185], v6 offset:128
  v_cvt_pk_bf16_f32 v75, v78, v79
  v_mfma_f32_16x16x32_bf16 v[128:131], a[168:171], v[32:35], v[128:131]
  s_add_u32 m0, s34, 86016
  v_exp_f32_e32 v82, v82
  v_mfma_f32_16x16x32_bf16 v[132:135], a[168:171], v[40:43], v[132:135]
  s_mov_b32 s33, 184320
  ds_read_b64_tr_b16 a[186:187], v6 offset:6272
  v_fma_f32 v83, v83, s35, -v16
  v_mfma_f32_16x16x32_bf16 v[136:139], a[168:171], v[48:51], v[136:139]
  buffer_load_dwordx4 v8, s[12:15], s33 offen nt lds
  v_mfma_f32_16x16x32_bf16 v[140:143], a[168:171], v[56:59], v[140:143]
  ds_read_b64_tr_b16 a[188:189], v7 offset:128
  v_fma_f32 v84, v84, s35, -v16
  v_mfma_f32_16x16x32_bf16 v[144:147], a[172:175], v[32:35], v[144:147]
  v_exp_f32_e32 v83, v83
  v_mfma_f32_16x16x32_bf16 v[148:151], a[172:175], v[40:43], v[148:151]
  ds_read_b64_tr_b16 a[190:191], v7 offset:6272
  v_fma_f32 v85, v85, s35, -v16
  v_mfma_f32_16x16x32_bf16 v[152:155], a[172:175], v[48:51], v[152:155]
  v_exp_f32_e32 v84, v84
  v_mfma_f32_16x16x32_bf16 v[156:159], a[172:175], v[56:59], v[156:159]
  s_waitcnt lgkmcnt(4)
  ds_read_b64_tr_b16 a[192:193], v4 offset:256
  v_fma_f32 v86, v86, s35, -v16
  v_mfma_f32_16x16x32_bf16 v[160:163], a[176:179], v[32:35], v[160:163]
  v_exp_f32_e32 v85, v85
  v_mfma_f32_16x16x32_bf16 v[164:167], a[176:179], v[40:43], v[164:167]
  ds_read_b64_tr_b16 a[194:195], v4 offset:6400
  v_fma_f32 v87, v87, s35, -v16
  v_mfma_f32_16x16x32_bf16 v[168:171], a[176:179], v[48:51], v[168:171]
  v_exp_f32_e32 v86, v86
  v_mfma_f32_16x16x32_bf16 v[172:175], a[176:179], v[56:59], v[172:175]
  ds_read_b64_tr_b16 a[196:197], v5 offset:256
  v_add_f32_e32 v30, v30, v80
  v_mfma_f32_16x16x32_bf16 v[176:179], a[180:183], v[32:35], v[176:179]
  v_exp_f32_e32 v87, v87
  v_mfma_f32_16x16x32_bf16 v[180:183], a[180:183], v[40:43], v[180:183]
  ds_read_b64_tr_b16 a[198:199], v5 offset:6400
  v_add_f32_e32 v30, v30, v81
  v_mfma_f32_16x16x32_bf16 v[184:187], a[180:183], v[48:51], v[184:187]
  buffer_load_dwordx4 v9, s[12:15], s33 offen offset:1024 nt lds
  v_mfma_f32_16x16x32_bf16 v[188:191], a[180:183], v[56:59], v[188:191]
  s_waitcnt lgkmcnt(4)
  ds_read_b64_tr_b16 a[200:201], v6 offset:256
  v_cvt_pk_bf16_f32 v80, v80, v81
  v_mfma_f32_16x16x32_bf16 v[192:195], a[184:187], v[32:35], v[192:195]
  v_add_f32_e32 v30, v30, v82
  v_add_f32_e32 v30, v30, v83
  v_mfma_f32_16x16x32_bf16 v[196:199], a[184:187], v[40:43], v[196:199]
  ds_read_b64_tr_b16 a[202:203], v6 offset:6400
  v_cvt_pk_bf16_f32 v81, v82, v83
  v_mfma_f32_16x16x32_bf16 v[200:203], a[184:187], v[48:51], v[200:203]
  v_cvt_pk_bf16_f32 v82, v84, v85
  v_cvt_pk_bf16_f32 v83, v86, v87
  v_mfma_f32_16x16x32_bf16 v[204:207], a[184:187], v[56:59], v[204:207]
  ds_read_b64_tr_b16 a[204:205], v7 offset:256
  v_fma_f32 v88, v88, s35, -v17
  v_mfma_f32_16x16x32_bf16 v[208:211], a[188:191], v[32:35], v[208:211]
  v_exp_f32_e32 v88, v88
  v_mfma_f32_16x16x32_bf16 v[212:215], a[188:191], v[40:43], v[212:215]
  ds_read_b64_tr_b16 a[206:207], v7 offset:6400
  v_fma_f32 v89, v89, s35, -v17
  v_mfma_f32_16x16x32_bf16 v[216:219], a[188:191], v[48:51], v[216:219]
  v_exp_f32_e32 v89, v89
  v_mfma_f32_16x16x32_bf16 v[220:223], a[188:191], v[56:59], v[220:223]
  s_waitcnt lgkmcnt(4)
  ds_read_b128 a[160:163], v2 offset:24576
  v_fma_f32 v90, v90, s35, -v17
  v_mfma_f32_16x16x32_bf16 v[224:227], a[192:195], v[32:35], v[224:227]
  v_exp_f32_e32 v90, v90
  v_mfma_f32_16x16x32_bf16 v[228:231], a[192:195], v[40:43], v[228:231]
  ds_read_b128 a[164:167], v3 offset:24576
  v_fma_f32 v91, v91, s35, -v17
  v_mfma_f32_16x16x32_bf16 v[232:235], a[192:195], v[48:51], v[232:235]
  buffer_load_dwordx4 v10, s[12:15], s33 offen offset:2048 nt lds
  v_mfma_f32_16x16x32_bf16 v[236:239], a[192:195], v[56:59], v[236:239]
  ds_read_b128 a[168:171], v2 offset:24704
  v_fma_f32 v92, v92, s35, -v17
  v_mfma_f32_16x16x32_bf16 v[240:243], a[196:199], v[32:35], v[240:243]
  v_exp_f32_e32 v91, v91
  v_mfma_f32_16x16x32_bf16 v[244:247], a[196:199], v[40:43], v[244:247]
  ds_read_b128 a[172:175], v3 offset:24704
  v_fma_f32 v93, v93, s35, -v17
  v_mfma_f32_16x16x32_bf16 v[248:251], a[196:199], v[48:51], v[248:251]
  v_exp_f32_e32 v92, v92
  v_mfma_f32_16x16x32_bf16 v[252:255], a[196:199], v[56:59], v[252:255]
  s_waitcnt lgkmcnt(3)
  ds_read_b128 a[176:179], v2 offset:24832
  v_fma_f32 v94, v94, s35, -v17
  v_mfma_f32_16x16x32_bf16 a[0:3], a[200:203], v[32:35], a[0:3]
  v_exp_f32_e32 v93, v93
  v_mfma_f32_16x16x32_bf16 a[4:7], a[200:203], v[40:43], a[4:7]
  ds_read_b128 a[180:183], v3 offset:24832
  v_fma_f32 v95, v95, s35, -v17
  v_mfma_f32_16x16x32_bf16 a[8:11], a[200:203], v[48:51], a[8:11]
  v_exp_f32_e32 v94, v94
  v_mfma_f32_16x16x32_bf16 a[12:15], a[200:203], v[56:59], a[12:15]
  v_exp_f32_e32 v95, v95
  v_mfma_f32_16x16x32_bf16 a[16:19], a[204:207], v[32:35], a[16:19]
  v_add_f32_e32 v31, v31, v88
  v_add_f32_e32 v31, v31, v89
  v_mfma_f32_16x16x32_bf16 a[20:23], a[204:207], v[40:43], a[20:23]
  s_add_u32 m0, s28, 6016
  v_cvt_pk_bf16_f32 v88, v88, v89
  v_add_f32_e32 v31, v31, v90
  v_mfma_f32_16x16x32_bf16 a[24:27], a[204:207], v[48:51], a[24:27]
  buffer_load_dwordx4 v11, s[24:27], s87 offen offset:128 nt lds
  v_mfma_f32_16x16x32_bf16 a[28:31], a[204:207], v[56:59], a[28:31]
  v_add_f32_e32 v31, v31, v91
  v_cvt_pk_bf16_f32 v89, v90, v91
  v_mfma_f32_16x16x32_bf16 v[32:35], a[160:163], a[32:35], 0
  s_waitcnt lgkmcnt(1)
  v_cvt_pk_bf16_f32 v90, v92, v93
  v_cvt_pk_bf16_f32 v91, v94, v95
  v_mfma_f32_16x16x32_bf16 v[32:35], a[164:167], a[36:39], v[32:35]
  v_add_f32_e32 v0, v0, v76
  v_add_f32_e32 v0, v0, v77
  v_mfma_f32_16x16x32_bf16 v[32:35], a[168:171], a[40:43], v[32:35]
  v_add_f32_e32 v0, v0, v78
  v_add_f32_e32 v0, v0, v79
  v_mfma_f32_16x16x32_bf16 v[32:35], a[172:175], a[44:47], v[32:35]
  v_add_f32_e32 v30, v30, v84
  v_add_f32_e32 v30, v30, v85
  v_mfma_f32_16x16x32_bf16 v[32:35], a[176:179], a[48:51], v[32:35]
  s_waitcnt lgkmcnt(0)
  v_add_f32_e32 v30, v30, v86
  v_add_f32_e32 v30, v30, v87
  v_mfma_f32_16x16x32_bf16 v[32:35], a[180:183], a[52:55], v[32:35]
  v_add_f32_e32 v31, v31, v92
  v_add_f32_e32 v31, v31, v93
  v_mfma_f32_16x16x32_bf16 v[40:43], a[160:163], a[56:59], 0
  v_add_f32_e32 v31, v31, v94
  v_add_f32_e32 v31, v31, v95
  v_mfma_f32_16x16x32_bf16 v[40:43], a[164:167], a[60:63], v[40:43]
  ds_read_b128 a[184:187], v2 offset:30720
  v_mfma_f32_16x16x32_bf16 v[40:43], a[168:171], a[64:67], v[40:43]
  v_mfma_f32_16x16x32_bf16 v[40:43], a[172:175], a[68:71], v[40:43]
  s_add_u32 m0, s28, 3968
  ds_read_b128 a[188:191], v3 offset:30720
  v_mfma_f32_16x16x32_bf16 v[40:43], a[176:179], a[72:75], v[40:43]
  buffer_load_dwordx4 v11, s[24:27], s87 offen offset:3200 nt lds
  v_mfma_f32_16x16x32_bf16 v[40:43], a[180:183], a[76:79], v[40:43]
  ds_read_b128 a[192:195], v2 offset:30848
  v_fma_f32 v32, v32, s35, -v14
  v_mfma_f32_16x16x32_bf16 v[48:51], a[160:163], a[80:83], 0
  v_exp_f32_e32 v32, v32
  v_mfma_f32_16x16x32_bf16 v[48:51], a[164:167], a[84:87], v[48:51]
  ds_read_b128 a[196:199], v3 offset:30848
  v_fma_f32 v33, v33, s35, -v14
  v_mfma_f32_16x16x32_bf16 v[48:51], a[168:171], a[88:91], v[48:51]
  v_exp_f32_e32 v33, v33
  v_mfma_f32_16x16x32_bf16 v[48:51], a[172:175], a[92:95], v[48:51]
  ds_read_b128 a[200:203], v2 offset:30976
  v_fma_f32 v34, v34, s35, -v14
  v_mfma_f32_16x16x32_bf16 v[48:51], a[176:179], a[96:99], v[48:51]
  v_exp_f32_e32 v34, v34
  v_mfma_f32_16x16x32_bf16 v[48:51], a[180:183], a[100:103], v[48:51]
  ds_read_b128 a[204:207], v3 offset:30976
  v_fma_f32 v35, v35, s35, -v14
  v_mfma_f32_16x16x32_bf16 v[56:59], a[160:163], a[104:107], 0
  s_waitcnt vmcnt(13)
  s_barrier
  v_mfma_f32_16x16x32_bf16 v[56:59], a[164:167], a[108:111], v[56:59]
  v_exp_f32_e32 v35, v35
  v_mfma_f32_16x16x32_bf16 v[56:59], a[168:171], a[112:115], v[56:59]
  s_add_u32 m0, s34, 12288
  v_cvt_pk_bf16_f32 v32, v32, v33
  v_cvt_pk_bf16_f32 v33, v34, v35
  v_mfma_f32_16x16x32_bf16 v[56:59], a[172:175], a[116:119], v[56:59]
  s_mov_b32 s32, 208896
  v_fma_f32 v40, v40, s35, -v15
  v_fma_f32 v41, v41, s35, -v15
  v_mfma_f32_16x16x32_bf16 v[56:59], a[176:179], a[120:123], v[56:59]
  buffer_load_dwordx4 v8, s[8:11], s32 offen nt lds
  v_mfma_f32_16x16x32_bf16 v[56:59], a[180:183], a[124:127], v[56:59]
  s_waitcnt lgkmcnt(1)
  v_exp_f32_e32 v40, v40
  v_mfma_f32_16x16x32_bf16 v[36:39], a[184:187], a[32:35], 0
  v_exp_f32_e32 v41, v41
  v_mfma_f32_16x16x32_bf16 v[36:39], a[188:191], a[36:39], v[36:39]
  v_fma_f32 v42, v42, s35, -v15
  v_fma_f32 v43, v43, s35, -v15
  v_mfma_f32_16x16x32_bf16 v[36:39], a[192:195], a[40:43], v[36:39]
  v_exp_f32_e32 v42, v42
  v_mfma_f32_16x16x32_bf16 v[36:39], a[196:199], a[44:47], v[36:39]
  v_exp_f32_e32 v43, v43
  v_mfma_f32_16x16x32_bf16 v[36:39], a[200:203], a[48:51], v[36:39]
  s_waitcnt lgkmcnt(0)
  v_add_f32_e32 v0, v0, v40
  v_add_f32_e32 v0, v0, v41
  v_mfma_f32_16x16x32_bf16 v[36:39], a[204:207], a[52:55], v[36:39]
  v_cvt_pk_bf16_f32 v40, v40, v41
  v_add_f32_e32 v0, v0, v42
  v_mfma_f32_16x16x32_bf16 v[44:47], a[184:187], a[56:59], 0
  v_add_f32_e32 v0, v0, v43
  v_cvt_pk_bf16_f32 v41, v42, v43
  v_mfma_f32_16x16x32_bf16 v[44:47], a[188:191], a[60:63], v[44:47]
  v_fma_f32 v48, v48, s35, -v16
  v_fma_f32 v49, v49, s35, -v16
  v_mfma_f32_16x16x32_bf16 v[44:47], a[192:195], a[64:67], v[44:47]
  ds_read_b64_tr_b16 a[160:161], v4 offset:12288
  v_fma_f32 v50, v50, s35, -v16
  v_mfma_f32_16x16x32_bf16 v[44:47], a[196:199], a[68:71], v[44:47]
  v_exp_f32_e32 v48, v48
  v_mfma_f32_16x16x32_bf16 v[44:47], a[200:203], a[72:75], v[44:47]
  ds_read_b64_tr_b16 a[162:163], v4 offset:18432
  v_fma_f32 v36, v36, s35, -v14
  v_mfma_f32_16x16x32_bf16 v[44:47], a[204:207], a[76:79], v[44:47]
  buffer_load_dwordx4 v9, s[8:11], s32 offen offset:1024 nt lds
  v_mfma_f32_16x16x32_bf16 v[52:55], a[184:187], a[80:83], 0
  ds_read_b64_tr_b16 a[164:165], v5 offset:12288
  v_fma_f32 v37, v37, s35, -v14
  v_mfma_f32_16x16x32_bf16 v[52:55], a[188:191], a[84:87], v[52:55]
  v_exp_f32_e32 v36, v36
  v_mfma_f32_16x16x32_bf16 v[52:55], a[192:195], a[88:91], v[52:55]
  ds_read_b64_tr_b16 a[166:167], v5 offset:18432
  v_fma_f32 v38, v38, s35, -v14
  v_mfma_f32_16x16x32_bf16 v[52:55], a[196:199], a[92:95], v[52:55]
  v_exp_f32_e32 v37, v37
  v_mfma_f32_16x16x32_bf16 v[52:55], a[200:203], a[96:99], v[52:55]
  ds_read_b64_tr_b16 a[168:169], v6 offset:12288
  v_fma_f32 v39, v39, s35, -v14
  v_mfma_f32_16x16x32_bf16 v[52:55], a[204:207], a[100:103], v[52:55]
  v_exp_f32_e32 v38, v38
  v_mfma_f32_16x16x32_bf16 v[60:63], a[184:187], a[104:107], 0
  ds_read_b64_tr_b16 a[170:171], v6 offset:18432
  v_cvt_pk_bf16_f32 v34, v36, v37
  v_mfma_f32_16x16x32_bf16 v[60:63], a[188:191], a[108:111], v[60:63]
  v_exp_f32_e32 v39, v39
  v_mfma_f32_16x16x32_bf16 v[60:63], a[192:195], a[112:115], v[60:63]
  ds_read_b64_tr_b16 a[172:173], v7 offset:12288
  v_cvt_pk_bf16_f32 v35, v38, v39
  v_mfma_f32_16x16x32_bf16 v[60:63], a[196:199], a[116:119], v[60:63]
  v_exp_f32_e32 v49, v49
  v_mfma_f32_16x16x32_bf16 v[60:63], a[200:203], a[120:123], v[60:63]
  ds_read_b64_tr_b16 a[174:175], v7 offset:18432
  v_fma_f32 v44, v44, s35, -v15
  v_mfma_f32_16x16x32_bf16 v[60:63], a[204:207], a[124:127], v[60:63]
  buffer_load_dwordx4 v10, s[8:11], s32 offen offset:2048 nt lds
  v_mfma_f32_16x16x32_bf16 a[240:243], v[18:21], v[64:67], a[240:243]
  s_waitcnt lgkmcnt(4)
  ds_read_b64_tr_b16 a[176:177], v4 offset:12416
  v_fma_f32 v45, v45, s35, -v15
  v_mfma_f32_16x16x32_bf16 v[96:99], a[160:163], v[64:67], v[96:99]
  v_exp_f32_e32 v44, v44
  v_mfma_f32_16x16x32_bf16 v[100:103], a[160:163], v[72:75], v[100:103]
  ds_read_b64_tr_b16 a[178:179], v4 offset:18560
  v_fma_f32 v46, v46, s35, -v15
  v_mfma_f32_16x16x32_bf16 v[104:107], a[160:163], v[80:83], v[104:107]
  v_exp_f32_e32 v45, v45
  v_mfma_f32_16x16x32_bf16 v[108:111], a[160:163], v[88:91], v[108:111]
  ds_read_b64_tr_b16 a[180:181], v5 offset:12416
  v_fma_f32 v47, v47, s35, -v15
  v_mfma_f32_16x16x32_bf16 v[112:115], a[164:167], v[64:67], v[112:115]
  v_exp_f32_e32 v46, v46
  v_mfma_f32_16x16x32_bf16 v[116:119], a[164:167], v[72:75], v[116:119]
  ds_read_b64_tr_b16 a[182:183], v5 offset:18560
  v_cvt_pk_bf16_f32 v42, v44, v45
  v_mfma_f32_16x16x32_bf16 v[120:123], a[164:167], v[80:83], v[120:123]
  v_exp_f32_e32 v47, v47
  v_mfma_f32_16x16x32_bf16 v[124:127], a[164:167], v[88:91], v[124:127]
  s_waitcnt lgkmcnt(4)
  ds_read_b64_tr_b16 a[184:185], v6 offset:12416
  v_cvt_pk_bf16_f32 v43, v46, v47
  v_mfma_f32_16x16x32_bf16 v[128:131], a[168:171], v[64:67], v[128:131]
  s_add_u32 m0, s34, 49152
  v_exp_f32_e32 v50, v50
  v_mfma_f32_16x16x32_bf16 v[132:135], a[168:171], v[72:75], v[132:135]
  s_mov_b32 s33, 196608
  ds_read_b64_tr_b16 a[186:187], v6 offset:18560
  v_fma_f32 v51, v51, s35, -v16
  v_mfma_f32_16x16x32_bf16 v[136:139], a[168:171], v[80:83], v[136:139]
  buffer_load_dwordx4 v8, s[12:15], s33 offen nt lds
  v_mfma_f32_16x16x32_bf16 v[140:143], a[168:171], v[88:91], v[140:143]
  ds_read_b64_tr_b16 a[188:189], v7 offset:12416
  v_fma_f32 v52, v52, s35, -v16
  v_mfma_f32_16x16x32_bf16 v[144:147], a[172:175], v[64:67], v[144:147]
  v_exp_f32_e32 v51, v51
  v_mfma_f32_16x16x32_bf16 v[148:151], a[172:175], v[72:75], v[148:151]
  ds_read_b64_tr_b16 a[190:191], v7 offset:18560
  v_fma_f32 v53, v53, s35, -v16
  v_mfma_f32_16x16x32_bf16 v[152:155], a[172:175], v[80:83], v[152:155]
  v_exp_f32_e32 v52, v52
  v_mfma_f32_16x16x32_bf16 v[156:159], a[172:175], v[88:91], v[156:159]
  s_waitcnt lgkmcnt(4)
  ds_read_b64_tr_b16 a[192:193], v4 offset:12544
  v_fma_f32 v54, v54, s35, -v16
  v_mfma_f32_16x16x32_bf16 v[160:163], a[176:179], v[64:67], v[160:163]
  v_exp_f32_e32 v53, v53
  v_mfma_f32_16x16x32_bf16 v[164:167], a[176:179], v[72:75], v[164:167]
  ds_read_b64_tr_b16 a[194:195], v4 offset:18688
  v_fma_f32 v55, v55, s35, -v16
  v_mfma_f32_16x16x32_bf16 v[168:171], a[176:179], v[80:83], v[168:171]
  v_exp_f32_e32 v54, v54
  v_mfma_f32_16x16x32_bf16 v[172:175], a[176:179], v[88:91], v[172:175]
  ds_read_b64_tr_b16 a[196:197], v5 offset:12544
  v_add_f32_e32 v30, v30, v48
  v_mfma_f32_16x16x32_bf16 v[176:179], a[180:183], v[64:67], v[176:179]
  v_exp_f32_e32 v55, v55
  v_mfma_f32_16x16x32_bf16 v[180:183], a[180:183], v[72:75], v[180:183]
  ds_read_b64_tr_b16 a[198:199], v5 offset:18688
  v_add_f32_e32 v30, v30, v49
  v_mfma_f32_16x16x32_bf16 v[184:187], a[180:183], v[80:83], v[184:187]
  buffer_load_dwordx4 v9, s[12:15], s33 offen offset:1024 nt lds
  v_mfma_f32_16x16x32_bf16 v[188:191], a[180:183], v[88:91], v[188:191]
  s_waitcnt lgkmcnt(4)
  ds_read_b64_tr_b16 a[200:201], v6 offset:12544
  v_cvt_pk_bf16_f32 v48, v48, v49
  v_mfma_f32_16x16x32_bf16 v[192:195], a[184:187], v[64:67], v[192:195]
  v_add_f32_e32 v30, v30, v50
  v_add_f32_e32 v30, v30, v51
  v_mfma_f32_16x16x32_bf16 v[196:199], a[184:187], v[72:75], v[196:199]
  ds_read_b64_tr_b16 a[202:203], v6 offset:18688
  v_cvt_pk_bf16_f32 v49, v50, v51
  v_mfma_f32_16x16x32_bf16 v[200:203], a[184:187], v[80:83], v[200:203]
  v_cvt_pk_bf16_f32 v50, v52, v53
  v_cvt_pk_bf16_f32 v51, v54, v55
  v_mfma_f32_16x16x32_bf16 v[204:207], a[184:187], v[88:91], v[204:207]
  ds_read_b64_tr_b16 a[204:205], v7 offset:12544
  v_fma_f32 v56, v56, s35, -v17
  v_mfma_f32_16x16x32_bf16 v[208:211], a[188:191], v[64:67], v[208:211]
  v_exp_f32_e32 v56, v56
  v_mfma_f32_16x16x32_bf16 v[212:215], a[188:191], v[72:75], v[212:215]
  ds_read_b64_tr_b16 a[206:207], v7 offset:18688
  v_fma_f32 v57, v57, s35, -v17
  v_mfma_f32_16x16x32_bf16 v[216:219], a[188:191], v[80:83], v[216:219]
  v_exp_f32_e32 v57, v57
  v_mfma_f32_16x16x32_bf16 v[220:223], a[188:191], v[88:91], v[220:223]
  s_waitcnt lgkmcnt(4)
  ds_read_b128 a[160:163], v2 offset:36864
  v_fma_f32 v58, v58, s35, -v17
  v_mfma_f32_16x16x32_bf16 v[224:227], a[192:195], v[64:67], v[224:227]
  v_exp_f32_e32 v58, v58
  v_mfma_f32_16x16x32_bf16 v[228:231], a[192:195], v[72:75], v[228:231]
  ds_read_b128 a[164:167], v3 offset:36864
  v_fma_f32 v59, v59, s35, -v17
  v_mfma_f32_16x16x32_bf16 v[232:235], a[192:195], v[80:83], v[232:235]
  buffer_load_dwordx4 v10, s[12:15], s33 offen offset:2048 nt lds
  v_mfma_f32_16x16x32_bf16 v[236:239], a[192:195], v[88:91], v[236:239]
  ds_read_b128 a[168:171], v2 offset:36992
  v_fma_f32 v60, v60, s35, -v17
  v_mfma_f32_16x16x32_bf16 v[240:243], a[196:199], v[64:67], v[240:243]
  v_exp_f32_e32 v59, v59
  v_mfma_f32_16x16x32_bf16 v[244:247], a[196:199], v[72:75], v[244:247]
L_hop6:
  s_cbranch_execz L_hop10
  ds_read_b128 a[172:175], v3 offset:36992
  v_fma_f32 v61, v61, s35, -v17
  v_mfma_f32_16x16x32_bf16 v[248:251], a[196:199], v[80:83], v[248:251]
  v_exp_f32_e32 v60, v60
  v_mfma_f32_16x16x32_bf16 v[252:255], a[196:199], v[88:91], v[252:255]
  s_waitcnt lgkmcnt(3)
  ds_read_b128 a[176:179], v2 offset:37120
  v_fma_f32 v62, v62, s35, -v17
  v_mfma_f32_16x16x32_bf16 a[0:3], a[200:203], v[64:67], a[0:3]
  v_exp_f32_e32 v61, v61
  v_mfma_f32_16x16x32_bf16 a[4:7], a[200:203], v[72:75], a[4:7]
  ds_read_b128 a[180:183], v3 offset:37120
  v_fma_f32 v63, v63, s35, -v17
  v_mfma_f32_16x16x32_bf16 a[8:11], a[200:203], v[80:83], a[8:11]
  v_exp_f32_e32 v62, v62
  v_mfma_f32_16x16x32_bf16 a[12:15], a[200:203], v[88:91], a[12:15]
  v_exp_f32_e32 v63, v63
  v_mfma_f32_16x16x32_bf16 a[16:19], a[204:207], v[64:67], a[16:19]
  v_add_f32_e32 v31, v31, v56
  v_add_f32_e32 v31, v31, v57
  v_mfma_f32_16x16x32_bf16 a[20:23], a[204:207], v[72:75], a[20:23]
  v_cvt_pk_bf16_f32 v56, v56, v57
  v_add_f32_e32 v31, v31, v58
  v_mfma_f32_16x16x32_bf16 a[24:27], a[204:207], v[80:83], a[24:27]
  v_add_f32_e32 v31, v31, v59
  v_cvt_pk_bf16_f32 v57, v58, v59
  v_mfma_f32_16x16x32_bf16 a[28:31], a[204:207], v[88:91], a[28:31]
  v_cvt_pk_bf16_f32 v58, v60, v61
  v_cvt_pk_bf16_f32 v59, v62, v63
  v_mfma_f32_16x16x32_bf16 v[64:67], a[160:163], a[32:35], 0
  s_waitcnt lgkmcnt(1)
  v_add_f32_e32 v0, v0, v44
  v_add_f32_e32 v0, v0, v45
  v_mfma_f32_16x16x32_bf16 v[64:67], a[164:167], a[36:39], v[64:67]
  v_add_f32_e32 v0, v0, v46
  v_add_f32_e32 v0, v0, v47
  v_mfma_f32_16x16x32_bf16 v[64:67], a[168:171], a[40:43], v[64:67]
  v_add_f32_e32 v30, v30, v52
  v_add_f32_e32 v30, v30, v53
  v_mfma_f32_16x16x32_bf16 v[64:67], a[172:175], a[44:47], v[64:67]
  v_add_f32_e32 v30, v30, v54
  v_add_f32_e32 v30, v30, v55
  v_mfma_f32_16x16x32_bf16 v[64:67], a[176:179], a[48:51], v[64:67]
  s_waitcnt lgkmcnt(0)
  v_add_f32_e32 v31, v31, v60
  v_add_f32_e32 v31, v31, v61
  v_mfma_f32_16x16x32_bf16 v[64:67], a[180:183], a[52:55], v[64:67]
  v_add_f32_e32 v31, v31, v62
  v_add_f32_e32 v31, v31, v63
  v_mfma_f32_16x16x32_bf16 v[72:75], a[160:163], a[56:59], 0
  v_mbcnt_lo_u32_b32 v22, -1, 0
  v_mbcnt_hi_u32_b32 v22, -1, v22
  v_mfma_f32_16x16x32_bf16 v[72:75], a[164:167], a[60:63], v[72:75]
  ds_read_b128 a[184:187], v2 offset:43008
  v_lshrrev_b32_e32 v23, 3, v22
  v_mfma_f32_16x16x32_bf16 v[72:75], a[168:171], a[64:67], v[72:75]
  v_and_b32_e32 v24, 7, v22
  v_lshlrev_b32_e32 v24, 4, v24
  v_mfma_f32_16x16x32_bf16 v[72:75], a[172:175], a[68:71], v[72:75]
  ds_read_b128 a[188:191], v3 offset:43008
  v_mad_u32_u24 v11, v23, s53, v24
  v_mfma_f32_16x16x32_bf16 v[72:75], a[176:179], a[72:75], v[72:75]
  v_fma_f32 v64, v64, s35, -v14
  v_fma_f32 v65, v65, s35, -v14
  v_mfma_f32_16x16x32_bf16 v[72:75], a[180:183], a[76:79], v[72:75]
  ds_read_b128 a[192:195], v2 offset:43136
  v_fma_f32 v66, v66, s35, -v14
  v_mfma_f32_16x16x32_bf16 v[80:83], a[160:163], a[80:83], 0
  v_exp_f32_e32 v64, v64
  v_mfma_f32_16x16x32_bf16 v[80:83], a[164:167], a[84:87], v[80:83]
  ds_read_b128 a[196:199], v3 offset:43136
  v_fma_f32 v67, v67, s35, -v14
  v_mfma_f32_16x16x32_bf16 v[80:83], a[168:171], a[88:91], v[80:83]
  v_exp_f32_e32 v65, v65
  v_mfma_f32_16x16x32_bf16 v[80:83], a[172:175], a[92:95], v[80:83]
  ds_read_b128 a[200:203], v2 offset:43264
  v_cvt_pk_bf16_f32 v64, v64, v65
  v_mfma_f32_16x16x32_bf16 v[80:83], a[176:179], a[96:99], v[80:83]
  v_exp_f32_e32 v66, v66
  v_mfma_f32_16x16x32_bf16 v[80:83], a[180:183], a[100:103], v[80:83]
  ds_read_b128 a[204:207], v3 offset:43264
  v_fma_f32 v72, v72, s35, -v15
  v_mfma_f32_16x16x32_bf16 v[88:91], a[160:163], a[104:107], 0
  s_waitcnt vmcnt(11)
  s_barrier
  v_mfma_f32_16x16x32_bf16 v[88:91], a[164:167], a[108:111], v[88:91]
  s_add_u32 m0, s34, 24576
  v_exp_f32_e32 v67, v67
  v_mfma_f32_16x16x32_bf16 v[88:91], a[168:171], a[112:115], v[88:91]
  s_mov_b32 s32, 221184
  v_exp_f32_e32 v72, v72
  v_mfma_f32_16x16x32_bf16 v[88:91], a[172:175], a[116:119], v[88:91]
  buffer_load_dwordx4 v8, s[8:11], s32 offen nt lds
  v_mfma_f32_16x16x32_bf16 v[88:91], a[176:179], a[120:123], v[88:91]
  v_cvt_pk_bf16_f32 v65, v66, v67
  v_fma_f32 v73, v73, s35, -v15
  v_mfma_f32_16x16x32_bf16 v[88:91], a[180:183], a[124:127], v[88:91]
  s_waitcnt lgkmcnt(1)
  v_exp_f32_e32 v73, v73
  v_mfma_f32_16x16x32_bf16 v[68:71], a[184:187], a[32:35], 0
  v_fma_f32 v74, v74, s35, -v15
  v_fma_f32 v75, v75, s35, -v15
  v_mfma_f32_16x16x32_bf16 v[68:71], a[188:191], a[36:39], v[68:71]
  ds_read_b128 a[32:35], v12 offset:8192
  v_add_f32_e32 v0, v0, v72
  v_mfma_f32_16x16x32_bf16 v[68:71], a[192:195], a[40:43], v[68:71]
  ds_read_b128 a[36:39], v13 offset:8192
  v_add_f32_e32 v0, v0, v73
  v_mfma_f32_16x16x32_bf16 v[68:71], a[196:199], a[44:47], v[68:71]
  v_exp_f32_e32 v74, v74
  v_mfma_f32_16x16x32_bf16 v[68:71], a[200:203], a[48:51], v[68:71]
  s_waitcnt lgkmcnt(2)
  v_exp_f32_e32 v75, v75
  v_mfma_f32_16x16x32_bf16 v[68:71], a[204:207], a[52:55], v[68:71]
  v_cvt_pk_bf16_f32 v72, v72, v73
  v_add_f32_e32 v0, v0, v74
  v_mfma_f32_16x16x32_bf16 v[76:79], a[184:187], a[56:59], 0
  v_add_f32_e32 v0, v0, v75
  v_cvt_pk_bf16_f32 v73, v74, v75
  v_mfma_f32_16x16x32_bf16 v[76:79], a[188:191], a[60:63], v[76:79]
  ds_read_b128 a[56:59], v12 offset:10240
  v_fma_f32 v80, v80, s35, -v16
  v_mfma_f32_16x16x32_bf16 v[76:79], a[192:195], a[64:67], v[76:79]
  ds_read_b64_tr_b16 a[160:161], v4 offset:24576
  ds_read_b128 a[60:63], v13 offset:10240
  v_mfma_f32_16x16x32_bf16 v[76:79], a[196:199], a[68:71], v[76:79]
  buffer_load_dwordx4 v9, s[8:11], s32 offen offset:1024 nt lds
  v_mfma_f32_16x16x32_bf16 v[76:79], a[200:203], a[72:75], v[76:79]
  ds_read_b64_tr_b16 a[162:163], v4 offset:30720
  ds_read_b128 a[40:43], v12 offset:12288
  v_mfma_f32_16x16x32_bf16 v[76:79], a[204:207], a[76:79], v[76:79]
  ds_read_b128 a[44:47], v13 offset:12288
  v_fma_f32 v68, v68, s35, -v14
  v_mfma_f32_16x16x32_bf16 v[84:87], a[184:187], a[80:83], 0
  ds_read_b64_tr_b16 a[164:165], v5 offset:24576
  ds_read_b128 a[64:67], v12 offset:14336
  v_mfma_f32_16x16x32_bf16 v[84:87], a[188:191], a[84:87], v[84:87]
  ds_read_b128 a[68:71], v13 offset:14336
  v_fma_f32 v69, v69, s35, -v14
  v_mfma_f32_16x16x32_bf16 v[84:87], a[192:195], a[88:91], v[84:87]
  ds_read_b64_tr_b16 a[166:167], v5 offset:30720
  ds_read_b128 a[80:83], v12 offset:0
  v_mfma_f32_16x16x32_bf16 v[84:87], a[196:199], a[92:95], v[84:87]
  ds_read_b128 a[84:87], v13 offset:0
  v_fma_f32 v70, v70, s35, -v14
  v_mfma_f32_16x16x32_bf16 v[84:87], a[200:203], a[96:99], v[84:87]
  ds_read_b64_tr_b16 a[168:169], v6 offset:24576
  v_fma_f32 v71, v71, s35, -v14
  v_mfma_f32_16x16x32_bf16 v[84:87], a[204:207], a[100:103], v[84:87]
  v_exp_f32_e32 v68, v68
  v_mfma_f32_16x16x32_bf16 v[92:95], a[184:187], a[104:107], 0
  s_waitcnt lgkmcnt(10)
  ds_read_b64_tr_b16 a[170:171], v6 offset:30720
  v_fma_f32 v76, v76, s35, -v15
  v_mfma_f32_16x16x32_bf16 v[92:95], a[188:191], a[108:111], v[92:95]
  ds_read_b128 a[104:107], v12 offset:2048
  v_fma_f32 v77, v77, s35, -v15
  v_mfma_f32_16x16x32_bf16 v[92:95], a[192:195], a[112:115], v[92:95]
  ds_read_b64_tr_b16 a[172:173], v7 offset:24576
  ds_read_b128 a[108:111], v13 offset:2048
  v_mfma_f32_16x16x32_bf16 v[92:95], a[196:199], a[116:119], v[92:95]
  buffer_load_dwordx4 v10, s[8:11], s32 offen offset:2048 nt lds
  v_mfma_f32_16x16x32_bf16 v[92:95], a[200:203], a[120:123], v[92:95]
  ds_read_b64_tr_b16 a[174:175], v7 offset:30720
  v_fma_f32 v78, v78, s35, -v15
  v_mfma_f32_16x16x32_bf16 v[92:95], a[204:207], a[124:127], v[92:95]
  v_exp_f32_e32 v69, v69
  v_mfma_f32_16x16x32_bf16 a[240:243], v[18:21], v[32:35], a[240:243]
  s_waitcnt lgkmcnt(8)
  ds_read_b64_tr_b16 a[176:177], v4 offset:24704
  v_cvt_pk_bf16_f32 v66, v68, v69
  v_mfma_f32_16x16x32_bf16 v[96:99], a[160:163], v[32:35], v[96:99]
  v_exp_f32_e32 v70, v70
  v_mfma_f32_16x16x32_bf16 v[100:103], a[160:163], v[40:43], v[100:103]
  ds_read_b64_tr_b16 a[178:179], v4 offset:30848
  v_fma_f32 v79, v79, s35, -v15
  v_mfma_f32_16x16x32_bf16 v[104:107], a[160:163], v[48:51], v[104:107]
  v_exp_f32_e32 v71, v71
  v_mfma_f32_16x16x32_bf16 v[108:111], a[160:163], v[56:59], v[108:111]
  ds_read_b64_tr_b16 a[180:181], v5 offset:24704
  v_cvt_pk_bf16_f32 v67, v70, v71
  v_mfma_f32_16x16x32_bf16 v[112:115], a[164:167], v[32:35], v[112:115]
  v_exp_f32_e32 v76, v76
  v_mfma_f32_16x16x32_bf16 v[116:119], a[164:167], v[40:43], v[116:119]
  ds_read_b64_tr_b16 a[182:183], v5 offset:30848
  v_fma_f32 v81, v81, s35, -v16
  v_mfma_f32_16x16x32_bf16 v[120:123], a[164:167], v[48:51], v[120:123]
  s_add_u32 m0, s34, 61440
  v_exp_f32_e32 v77, v77
  v_mfma_f32_16x16x32_bf16 v[124:127], a[164:167], v[56:59], v[124:127]
  s_waitcnt lgkmcnt(4)
  ds_read_b64_tr_b16 a[184:185], v6 offset:24704
  v_cvt_pk_bf16_f32 v74, v76, v77
  v_mfma_f32_16x16x32_bf16 v[128:131], a[168:171], v[32:35], v[128:131]
  s_mov_b32 s33, 208896
  v_exp_f32_e32 v78, v78
  v_mfma_f32_16x16x32_bf16 v[132:135], a[168:171], v[40:43], v[132:135]
  ds_read_b64_tr_b16 a[186:187], v6 offset:30848
  v_fma_f32 v82, v82, s35, -v16
  v_mfma_f32_16x16x32_bf16 v[136:139], a[168:171], v[48:51], v[136:139]
  buffer_load_dwordx4 v8, s[12:15], s33 offen nt lds
  v_mfma_f32_16x16x32_bf16 v[140:143], a[168:171], v[56:59], v[140:143]
  ds_read_b64_tr_b16 a[188:189], v7 offset:24704
  v_fma_f32 v83, v83, s35, -v16
  v_mfma_f32_16x16x32_bf16 v[144:147], a[172:175], v[32:35], v[144:147]
  v_exp_f32_e32 v79, v79
  v_mfma_f32_16x16x32_bf16 v[148:151], a[172:175], v[40:43], v[148:151]
  ds_read_b64_tr_b16 a[190:191], v7 offset:30848
  v_cvt_pk_bf16_f32 v75, v78, v79
  v_mfma_f32_16x16x32_bf16 v[152:155], a[172:175], v[48:51], v[152:155]
  s_waitcnt vmcnt(10)
  ds_read_b128 a[88:91], v12 offset:4096
  v_fma_f32 v84, v84, s35, -v16
  v_mfma_f32_16x16x32_bf16 v[156:159], a[172:175], v[56:59], v[156:159]
  s_waitcnt lgkmcnt(5)
  ds_read_b64_tr_b16 a[192:193], v4 offset:24832
  ds_read_b128 a[92:95], v13 offset:4096
  v_mfma_f32_16x16x32_bf16 v[160:163], a[176:179], v[32:35], v[160:163]
  ds_read_b128 a[112:115], v12 offset:6144
  v_fma_f32 v85, v85, s35, -v16
  v_mfma_f32_16x16x32_bf16 v[164:167], a[176:179], v[40:43], v[164:167]
  ds_read_b64_tr_b16 a[194:195], v4 offset:30976
  ds_read_b128 a[116:119], v13 offset:6144
  v_mfma_f32_16x16x32_bf16 v[168:171], a[176:179], v[48:51], v[168:171]
  v_exp_f32_e32 v80, v80
  v_mfma_f32_16x16x32_bf16 v[172:175], a[176:179], v[56:59], v[172:175]
  ds_read_b64_tr_b16 a[196:197], v5 offset:24832
  v_fma_f32 v86, v86, s35, -v16
  v_mfma_f32_16x16x32_bf16 v[176:179], a[180:183], v[32:35], v[176:179]
  v_exp_f32_e32 v81, v81
  v_mfma_f32_16x16x32_bf16 v[180:183], a[180:183], v[40:43], v[180:183]
  ds_read_b64_tr_b16 a[198:199], v5 offset:30976
  v_fma_f32 v87, v87, s35, -v16
  v_mfma_f32_16x16x32_bf16 v[184:187], a[180:183], v[48:51], v[184:187]
  buffer_load_dwordx4 v9, s[12:15], s33 offen offset:1024 nt lds
  v_mfma_f32_16x16x32_bf16 v[188:191], a[180:183], v[56:59], v[188:191]
  s_waitcnt lgkmcnt(8)
  ds_read_b64_tr_b16 a[200:201], v6 offset:24832
  v_add_f32_e32 v30, v30, v80
  v_mfma_f32_16x16x32_bf16 v[192:195], a[184:187], v[32:35], v[192:195]
  v_exp_f32_e32 v82, v82
  v_mfma_f32_16x16x32_bf16 v[196:199], a[184:187], v[40:43], v[196:199]
  ds_read_b64_tr_b16 a[202:203], v6 offset:30976
  v_add_f32_e32 v30, v30, v81
  v_mfma_f32_16x16x32_bf16 v[200:203], a[184:187], v[48:51], v[200:203]
  v_exp_f32_e32 v83, v83
  v_mfma_f32_16x16x32_bf16 v[204:207], a[184:187], v[56:59], v[204:207]
  ds_read_b64_tr_b16 a[204:205], v7 offset:24832
  v_cvt_pk_bf16_f32 v80, v80, v81
  v_mfma_f32_16x16x32_bf16 v[208:211], a[188:191], v[32:35], v[208:211]
  v_exp_f32_e32 v84, v84
  v_mfma_f32_16x16x32_bf16 v[212:215], a[188:191], v[40:43], v[212:215]
  ds_read_b64_tr_b16 a[206:207], v7 offset:30976
  v_add_f32_e32 v30, v30, v82
  v_mfma_f32_16x16x32_bf16 v[216:219], a[188:191], v[48:51], v[216:219]
  v_exp_f32_e32 v85, v85
  v_mfma_f32_16x16x32_bf16 v[220:223], a[188:191], v[56:59], v[220:223]
  s_waitcnt lgkmcnt(4)
  ds_read_b128 a[160:163], v2 offset:0
  v_add_f32_e32 v30, v30, v83
  v_mfma_f32_16x16x32_bf16 v[224:227], a[192:195], v[32:35], v[224:227]
  v_exp_f32_e32 v86, v86
  v_mfma_f32_16x16x32_bf16 v[228:231], a[192:195], v[40:43], v[228:231]
  ds_read_b128 a[164:167], v3 offset:0
  v_cvt_pk_bf16_f32 v81, v82, v83
  v_mfma_f32_16x16x32_bf16 v[232:235], a[192:195], v[48:51], v[232:235]
  buffer_load_dwordx4 v10, s[12:15], s33 offen offset:2048 nt lds
  v_mfma_f32_16x16x32_bf16 v[236:239], a[192:195], v[56:59], v[236:239]
  ds_read_b128 a[168:171], v2 offset:128
  v_cvt_pk_bf16_f32 v82, v84, v85
  v_mfma_f32_16x16x32_bf16 v[240:243], a[196:199], v[32:35], v[240:243]
  v_exp_f32_e32 v87, v87
  v_mfma_f32_16x16x32_bf16 v[244:247], a[196:199], v[40:43], v[244:247]
  ds_read_b128 a[172:175], v3 offset:128
  v_cvt_pk_bf16_f32 v83, v86, v87
  v_mfma_f32_16x16x32_bf16 v[248:251], a[196:199], v[48:51], v[248:251]
  v_fma_f32 v88, v88, s35, -v17
  v_fma_f32 v89, v89, s35, -v17
  v_mfma_f32_16x16x32_bf16 v[252:255], a[196:199], v[56:59], v[252:255]
  s_waitcnt lgkmcnt(3)
  ds_read_b128 a[176:179], v2 offset:256
  v_fma_f32 v90, v90, s35, -v17
  v_mfma_f32_16x16x32_bf16 a[0:3], a[200:203], v[32:35], a[0:3]
  v_exp_f32_e32 v88, v88
  v_mfma_f32_16x16x32_bf16 a[4:7], a[200:203], v[40:43], a[4:7]
  ds_read_b128 a[180:183], v3 offset:256
  v_fma_f32 v91, v91, s35, -v17
  v_mfma_f32_16x16x32_bf16 a[8:11], a[200:203], v[48:51], a[8:11]
  v_exp_f32_e32 v89, v89
  v_mfma_f32_16x16x32_bf16 a[12:15], a[200:203], v[56:59], a[12:15]
  v_exp_f32_e32 v90, v90
  v_mfma_f32_16x16x32_bf16 a[16:19], a[204:207], v[32:35], a[16:19]
  v_exp_f32_e32 v91, v91
  v_mfma_f32_16x16x32_bf16 a[20:23], a[204:207], v[40:43], a[20:23]
  v_fma_f32 v92, v92, s35, -v17
  v_fma_f32 v93, v93, s35, -v17
  v_mfma_f32_16x16x32_bf16 a[24:27], a[204:207], v[48:51], a[24:27]
  v_exp_f32_e32 v92, v92
  v_mfma_f32_16x16x32_bf16 a[28:31], a[204:207], v[56:59], a[28:31]
  v_exp_f32_e32 v93, v93
  v_mfma_f32_16x16x32_bf16 v[32:35], a[160:163], a[32:35], 0
  s_waitcnt lgkmcnt(1)
  v_fma_f32 v94, v94, s35, -v17
  v_fma_f32 v95, v95, s35, -v17
  v_mfma_f32_16x16x32_bf16 v[32:35], a[164:167], a[36:39], v[32:35]
  v_exp_f32_e32 v94, v94
  v_mfma_f32_16x16x32_bf16 v[32:35], a[168:171], a[40:43], v[32:35]
  v_exp_f32_e32 v95, v95
  v_mfma_f32_16x16x32_bf16 v[32:35], a[172:175], a[44:47], v[32:35]
  v_add_f32_e32 v31, v31, v88
  v_add_f32_e32 v31, v31, v89
  v_mfma_f32_16x16x32_bf16 v[32:35], a[176:179], a[128:131], v[32:35]
  s_waitcnt lgkmcnt(0)
  v_cvt_pk_bf16_f32 v88, v88, v89
  v_add_f32_e32 v31, v31, v90
  v_mfma_f32_16x16x32_bf16 v[32:35], a[180:183], a[132:135], v[32:35]
  v_add_f32_e32 v31, v31, v91
  v_cvt_pk_bf16_f32 v89, v90, v91
  v_mfma_f32_16x16x32_bf16 v[40:43], a[160:163], a[56:59], 0
  v_cvt_pk_bf16_f32 v90, v92, v93
  v_cvt_pk_bf16_f32 v91, v94, v95
  v_mfma_f32_16x16x32_bf16 v[40:43], a[164:167], a[60:63], v[40:43]
  ds_read_b128 a[184:187], v2 offset:6144
  v_mad_u32_u24 v24, v23, s64, v24
  v_mfma_f32_16x16x32_bf16 v[40:43], a[168:171], a[64:67], v[40:43]
  v_and_b32_e32 v23, 15, v22
  v_lshrrev_b32_e32 v22, 4, v22
  v_mfma_f32_16x16x32_bf16 v[40:43], a[172:175], a[68:71], v[40:43]
  ds_read_b128 a[188:191], v3 offset:6144
  v_lshlrev_b32_e32 v22, 3, v22
  v_mfma_f32_16x16x32_bf16 v[40:43], a[176:179], a[136:139], v[40:43]
  v_mad_u32_u24 v22, v23, s64, v22
  v_add_u32_e32 v12, s28, v22
  v_mfma_f32_16x16x32_bf16 v[40:43], a[180:183], a[140:143], v[40:43]
  ds_read_b128 a[192:195], v2 offset:6272
  v_add_f32_e32 v0, v0, v76
  v_mfma_f32_16x16x32_bf16 v[48:51], a[160:163], a[80:83], 0
  v_add_f32_e32 v0, v0, v77
  v_add_f32_e32 v0, v0, v78
  v_mfma_f32_16x16x32_bf16 v[48:51], a[164:167], a[84:87], v[48:51]
  ds_read_b128 a[196:199], v3 offset:6272
  v_add_f32_e32 v0, v0, v79
  v_mfma_f32_16x16x32_bf16 v[48:51], a[168:171], a[88:91], v[48:51]
  v_mov_b32_e32 v23, v0
  v_mov_b32_e32 v0, v23
  v_mfma_f32_16x16x32_bf16 v[48:51], a[172:175], a[92:95], v[48:51]
  ds_read_b128 a[200:203], v2 offset:6400
  v_add_u32_e32 v13, s28, v24
  v_mfma_f32_16x16x32_bf16 v[48:51], a[176:179], a[144:147], v[48:51]
  v_permlane32_swap_b32_e32 v23, v0
  v_mfma_f32_16x16x32_bf16 v[48:51], a[180:183], a[148:151], v[48:51]
  ds_read_b128 a[204:207], v3 offset:6400
  v_add_f32_e32 v23, v23, v0
  v_mfma_f32_16x16x32_bf16 v[56:59], a[160:163], a[104:107], 0
  s_waitcnt vmcnt(9)
  s_barrier
  v_mfma_f32_16x16x32_bf16 v[56:59], a[164:167], a[108:111], v[56:59]
  s_add_u32 m0, s34, 36864
  v_mov_b32_e32 v0, v23
  v_add_f32_e32 v30, v30, v84
  v_mfma_f32_16x16x32_bf16 v[56:59], a[168:171], a[112:115], v[56:59]
  s_mov_b32 s32, 233472
  v_permlane16_swap_b32_e32 v23, v0
  v_mfma_f32_16x16x32_bf16 v[56:59], a[172:175], a[116:119], v[56:59]
  buffer_load_dwordx4 v8, s[8:11], s32 offen nt lds
  v_mfma_f32_16x16x32_bf16 v[56:59], a[176:179], a[152:155], v[56:59]
  v_add_f32_e32 v23, v23, v0
  v_add_f32_e32 v30, v30, v85
  v_mfma_f32_16x16x32_bf16 v[56:59], a[180:183], a[156:159], v[56:59]
  s_waitcnt lgkmcnt(1)
  v_add_f32_e32 v30, v30, v86
  v_add_f32_e32 v30, v30, v87
  v_mfma_f32_16x16x32_bf16 v[36:39], a[184:187], a[32:35], 0
  v_mov_b32_e32 v24, v30
  v_mov_b32_e32 v30, v24
  v_mfma_f32_16x16x32_bf16 v[36:39], a[188:191], a[36:39], v[36:39]
  s_nop 0
  v_permlane32_swap_b32_e32 v24, v30
  v_mfma_f32_16x16x32_bf16 v[36:39], a[192:195], a[40:43], v[36:39]
  v_add_f32_e32 v24, v24, v30
  v_mov_b32_e32 v30, v24
  v_mfma_f32_16x16x32_bf16 v[36:39], a[196:199], a[44:47], v[36:39]
  s_nop 0
  v_permlane16_swap_b32_e32 v24, v30
  v_mfma_f32_16x16x32_bf16 v[36:39], a[200:203], a[128:131], v[36:39]
  s_waitcnt lgkmcnt(0)
  v_add_f32_e32 v24, v24, v30
  v_add_f32_e32 v31, v31, v92
  v_mfma_f32_16x16x32_bf16 v[36:39], a[204:207], a[132:135], v[36:39]
  v_add_f32_e32 v31, v31, v93
  v_add_f32_e32 v31, v31, v94
  v_mfma_f32_16x16x32_bf16 v[44:47], a[184:187], a[56:59], 0
  v_add_f32_e32 v31, v31, v95
  v_mov_b32_e32 v25, v31
  v_mfma_f32_16x16x32_bf16 v[44:47], a[188:191], a[60:63], v[44:47]
  v_mov_b32_e32 v31, v25
  v_max3_f32 v14, v32, v33, v34
  v_mfma_f32_16x16x32_bf16 v[44:47], a[192:195], a[64:67], v[44:47]
  ds_read_b64_tr_b16 a[160:161], v4 offset:36864
  v_max3_f32 v15, v40, v41, v42
  v_mfma_f32_16x16x32_bf16 v[44:47], a[196:199], a[68:71], v[44:47]
  buffer_load_dwordx4 v9, s[8:11], s32 offen offset:1024 nt lds
  v_mfma_f32_16x16x32_bf16 v[44:47], a[200:203], a[136:139], v[44:47]
  ds_read_b64_tr_b16 a[162:163], v4 offset:43008
  v_max3_f32 v14, v14, v35, v36
  v_mfma_f32_16x16x32_bf16 v[44:47], a[204:207], a[140:143], v[44:47]
  v_permlane32_swap_b32_e32 v25, v31
  v_mfma_f32_16x16x32_bf16 v[52:55], a[184:187], a[80:83], 0
  ds_read_b64_tr_b16 a[164:165], v5 offset:36864
  v_add_f32_e32 v25, v25, v31
  v_mfma_f32_16x16x32_bf16 v[52:55], a[188:191], a[84:87], v[52:55]
  v_mov_b32_e32 v31, v25
  v_max3_f32 v14, v14, v37, v38
  v_mfma_f32_16x16x32_bf16 v[52:55], a[192:195], a[88:91], v[52:55]
  ds_read_b64_tr_b16 a[166:167], v5 offset:43008
  v_max_f32_e32 v14, v14, v39
  v_mfma_f32_16x16x32_bf16 v[52:55], a[196:199], a[92:95], v[52:55]
  v_permlane16_swap_b32_e32 v25, v31
  v_mfma_f32_16x16x32_bf16 v[52:55], a[200:203], a[144:147], v[52:55]
  ds_read_b64_tr_b16 a[168:169], v6 offset:36864
  v_add_f32_e32 v25, v25, v31
  v_mfma_f32_16x16x32_bf16 v[52:55], a[204:207], a[148:151], v[52:55]
  v_mov_b32_e32 v26, v14
  v_max3_f32 v15, v15, v43, v44
  v_mfma_f32_16x16x32_bf16 v[60:63], a[184:187], a[104:107], 0
  ds_read_b64_tr_b16 a[170:171], v6 offset:43008
  v_max3_f32 v15, v15, v45, v46
  v_mfma_f32_16x16x32_bf16 v[60:63], a[188:191], a[108:111], v[60:63]
  v_permlane32_swap_b32_e32 v14, v26
  v_mfma_f32_16x16x32_bf16 v[60:63], a[192:195], a[112:115], v[60:63]
  ds_read_b64_tr_b16 a[172:173], v7 offset:36864
  v_max_f32_e32 v14, v14, v26
  v_mfma_f32_16x16x32_bf16 v[60:63], a[196:199], a[116:119], v[60:63]
  buffer_load_dwordx4 v10, s[8:11], s32 offen offset:2048 nt lds
  v_mfma_f32_16x16x32_bf16 v[60:63], a[200:203], a[152:155], v[60:63]
  ds_read_b64_tr_b16 a[174:175], v7 offset:43008
  v_mov_b32_e32 v26, v14
  v_mfma_f32_16x16x32_bf16 v[60:63], a[204:207], a[156:159], v[60:63]
  s_nop 0
  v_permlane16_swap_b32_e32 v14, v26
  v_mfma_f32_16x16x32_bf16 a[240:243], v[18:21], v[64:67], a[240:243]
  s_waitcnt lgkmcnt(4)
  ds_read_b64_tr_b16 a[176:177], v4 offset:36992
  v_max_f32_e32 v14, v14, v26
  v_mul_f32_e32 v14, s35, v14
  v_mfma_f32_16x16x32_bf16 v[96:99], a[160:163], v[64:67], v[96:99]
  v_fma_f32 v32, v32, s35, -v14
  v_exp_f32_e32 v32, v32
  v_mfma_f32_16x16x32_bf16 v[100:103], a[160:163], v[72:75], v[100:103]
  ds_read_b64_tr_b16 a[178:179], v4 offset:43136
  v_fma_f32 v33, v33, s35, -v14
  v_fma_f32 v34, v34, s35, -v14
  v_mfma_f32_16x16x32_bf16 v[104:107], a[160:163], v[80:83], v[104:107]
  v_exp_f32_e32 v33, v33
  v_fma_f32 v35, v35, s35, -v14
  v_mfma_f32_16x16x32_bf16 v[108:111], a[160:163], v[88:91], v[108:111]
  ds_read_b64_tr_b16 a[180:181], v5 offset:36992
  v_exp_f32_e32 v34, v34
  v_mfma_f32_16x16x32_bf16 v[112:115], a[164:167], v[64:67], v[112:115]
  v_accvgpr_read_b32 v22, a240
  v_cmp_nge_f32_e32 vcc, s36, v22
  v_fma_f32 v36, v36, s35, -v14
  v_mfma_f32_16x16x32_bf16 v[116:119], a[164:167], v[72:75], v[116:119]
  s_or_b64 s[42:43], s[42:43], vcc
  ds_read_b64_tr_b16 a[182:183], v5 offset:43136
  v_rcp_f32_e32 v22, v22
  v_mfma_f32_16x16x32_bf16 v[120:123], a[164:167], v[80:83], v[120:123]
  s_add_u32 m0, s34, 73728
  v_cmp_nge_f32_e32 vcc, s36, v23
  v_rcp_f32_e32 v23, v23
  v_mfma_f32_16x16x32_bf16 v[124:127], a[164:167], v[88:91], v[124:127]
  s_waitcnt lgkmcnt(4)
  s_or_b64 s[42:43], s[42:43], vcc
  ds_read_b64_tr_b16 a[184:185], v6 offset:36992
  v_cmp_nge_f32_e32 vcc, s36, v24
  v_mul_f32_e32 v96, v22, v96
  v_mfma_f32_16x16x32_bf16 v[128:131], a[168:171], v[64:67], v[128:131]
  s_mov_b32 s33, 221184
  s_or_b64 s[42:43], s[42:43], vcc
  v_rcp_f32_e32 v24, v24
  v_mfma_f32_16x16x32_bf16 v[132:135], a[168:171], v[72:75], v[132:135]
  ds_read_b64_tr_b16 a[186:187], v6 offset:43136
  v_cmp_nge_f32_e32 vcc, s36, v25
  v_mul_f32_e32 v97, v22, v97
  v_mfma_f32_16x16x32_bf16 v[136:139], a[168:171], v[80:83], v[136:139]
  s_or_b64 s[42:43], s[42:43], vcc
  buffer_load_dwordx4 v8, s[12:15], s33 offen nt lds
  v_rcp_f32_e32 v25, v25
  v_mfma_f32_16x16x32_bf16 v[140:143], a[168:171], v[88:91], v[140:143]
  ds_read_b64_tr_b16 a[188:189], v7 offset:36992
  v_exp_f32_e32 v35, v35
  v_mfma_f32_16x16x32_bf16 v[144:147], a[172:175], v[64:67], v[144:147]
  v_exp_f32_e32 v36, v36
  v_mul_f32_e32 v98, v22, v98
  v_mul_f32_e32 v99, v22, v99
  v_mfma_f32_16x16x32_bf16 v[148:151], a[172:175], v[72:75], v[148:151]
  ds_read_b64_tr_b16 a[190:191], v7 offset:43136
  v_cvt_pk_bf16_f32 v96, v96, v97
  v_cvt_pk_bf16_f32 v97, v98, v99
  v_fma_f32 v37, v37, s35, -v14
  v_mfma_f32_16x16x32_bf16 v[152:155], a[172:175], v[80:83], v[152:155]
  ds_write_b64 v12, v[96:97] offset:0
  v_fma_f32 v38, v38, s35, -v14
  v_mfma_f32_16x16x32_bf16 v[156:159], a[172:175], v[88:91], v[156:159]
  s_waitcnt lgkmcnt(5)
  ds_read_b64_tr_b16 a[192:193], v4 offset:37120
  v_exp_f32_e32 v37, v37
  v_fma_f32 v39, v39, s35, -v14
  v_mfma_f32_16x16x32_bf16 v[160:163], a[176:179], v[64:67], v[160:163]
  v_exp_f32_e32 v38, v38
  v_exp_f32_e32 v39, v39
  v_mfma_f32_16x16x32_bf16 v[164:167], a[176:179], v[72:75], v[164:167]
  ds_read_b64_tr_b16 a[194:195], v4 offset:43264
  v_cvt_pk_bf16_f32 v32, v32, v33
  v_cvt_pk_bf16_f32 v33, v34, v35
  v_cvt_pk_bf16_f32 v34, v36, v37
  v_mfma_f32_16x16x32_bf16 v[168:171], a[176:179], v[80:83], v[168:171]
  v_cvt_pk_bf16_f32 v35, v38, v39
  v_mul_f32_e32 v100, v23, v100
  v_mul_f32_e32 v101, v23, v101
  v_mul_f32_e32 v102, v23, v102
  v_mfma_f32_16x16x32_bf16 v[172:175], a[176:179], v[88:91], v[172:175]
  ds_read_b64_tr_b16 a[196:197], v5 offset:37120
  v_mul_f32_e32 v103, v23, v103
  v_cvt_pk_bf16_f32 v100, v100, v101
  v_cvt_pk_bf16_f32 v101, v102, v103
  v_mfma_f32_16x16x32_bf16 v[176:179], a[180:183], v[64:67], v[176:179]
  ds_write_b64 v12, v[100:101] offset:2304
  v_mul_f32_e32 v104, v24, v104
  v_mul_f32_e32 v105, v24, v105
  v_mfma_f32_16x16x32_bf16 v[180:183], a[180:183], v[72:75], v[180:183]
  ds_read_b64_tr_b16 a[198:199], v5 offset:43264
  v_mul_f32_e32 v106, v24, v106
  v_mul_f32_e32 v107, v24, v107
  v_cvt_pk_bf16_f32 v104, v104, v105
  v_mfma_f32_16x16x32_bf16 v[184:187], a[180:183], v[80:83], v[184:187]
  buffer_load_dwordx4 v9, s[12:15], s33 offen offset:1024 nt lds
  v_cvt_pk_bf16_f32 v105, v106, v107
  v_max_f32_e32 v15, v15, v47
  v_mov_b32_e32 v27, v15
  v_mfma_f32_16x16x32_bf16 v[188:191], a[180:183], v[88:91], v[188:191]
  s_waitcnt lgkmcnt(6)
  ds_read_b64_tr_b16 a[200:201], v6 offset:37120
  v_permlane32_swap_b32_e32 v15, v27
  v_max_f32_e32 v15, v15, v27
  v_mfma_f32_16x16x32_bf16 v[192:195], a[184:187], v[64:67], v[192:195]
  ds_write_b64 v12, v[104:105] offset:4608
  v_mov_b32_e32 v27, v15
  v_mul_f32_e32 v108, v25, v108
  v_mul_f32_e32 v109, v25, v109
  v_mfma_f32_16x16x32_bf16 v[196:199], a[184:187], v[72:75], v[196:199]
  ds_read_b64_tr_b16 a[202:203], v6 offset:43264
  v_permlane16_swap_b32_e32 v15, v27
  v_max_f32_e32 v15, v15, v27
  v_mul_f32_e32 v15, s35, v15
  v_mfma_f32_16x16x32_bf16 v[200:203], a[184:187], v[80:83], v[200:203]
  v_fma_f32 v40, v40, s35, -v15
  v_exp_f32_e32 v40, v40
  v_fma_f32 v41, v41, s35, -v15
  v_fma_f32 v42, v42, s35, -v15
  v_mfma_f32_16x16x32_bf16 v[204:207], a[184:187], v[88:91], v[204:207]
  ds_read_b64_tr_b16 a[204:205], v7 offset:37120
  v_exp_f32_e32 v41, v41
  v_exp_f32_e32 v42, v42
  v_mfma_f32_16x16x32_bf16 v[208:211], a[188:191], v[64:67], v[208:211]
  v_fma_f32 v43, v43, s35, -v15
  v_exp_f32_e32 v43, v43
  v_fma_f32 v44, v44, s35, -v15
  v_exp_f32_e32 v44, v44
  v_mfma_f32_16x16x32_bf16 v[212:215], a[188:191], v[72:75], v[212:215]
  ds_read_b64_tr_b16 a[206:207], v7 offset:43264
  v_fma_f32 v45, v45, s35, -v15
  v_exp_f32_e32 v45, v45
  v_fma_f32 v46, v46, s35, -v15
  v_mfma_f32_16x16x32_bf16 v[216:219], a[188:191], v[80:83], v[216:219]
  v_exp_f32_e32 v46, v46
  v_fma_f32 v47, v47, s35, -v15
  v_exp_f32_e32 v47, v47
  v_mov_b32_e32 v0, v40
  v_mfma_f32_16x16x32_bf16 v[220:223], a[188:191], v[88:91], v[220:223]
  s_waitcnt lgkmcnt(5)
  ds_read_b128 a[160:163], v2 offset:12288
  v_add_f32_e32 v0, v0, v41
  v_cvt_pk_bf16_f32 v40, v40, v41
  v_add_f32_e32 v0, v0, v42
  v_add_f32_e32 v0, v0, v43
  v_mfma_f32_16x16x32_bf16 v[224:227], a[192:195], v[64:67], v[224:227]
  v_cvt_pk_bf16_f32 v41, v42, v43
  v_cvt_pk_bf16_f32 v42, v44, v45
  v_cvt_pk_bf16_f32 v43, v46, v47
  v_mul_f32_e32 v110, v25, v110
  v_mul_f32_e32 v111, v25, v111
  v_cvt_pk_bf16_f32 v108, v108, v109
  v_mfma_f32_16x16x32_bf16 v[228:231], a[192:195], v[72:75], v[228:231]
  ds_read_b128 a[164:167], v3 offset:12288
  v_cvt_pk_bf16_f32 v109, v110, v111
  v_max3_f32 v16, v48, v49, v50
  v_max3_f32 v16, v16, v51, v52
  v_max3_f32 v16, v16, v53, v54
  v_max_f32_e32 v16, v16, v55
  v_mfma_f32_16x16x32_bf16 v[232:235], a[192:195], v[80:83], v[232:235]
  buffer_load_dwordx4 v10, s[12:15], s33 offen offset:2048 nt lds
  v_mov_b32_e32 v28, v16
  v_mul_f32_e32 v112, v22, v112
  v_mul_f32_e32 v113, v22, v113
  v_mul_f32_e32 v114, v22, v114
  v_mfma_f32_16x16x32_bf16 v[236:239], a[192:195], v[88:91], v[236:239]
  ds_read_b128 a[168:171], v2 offset:12416
  v_permlane32_swap_b32_e32 v16, v28
  v_max_f32_e32 v16, v16, v28
  v_mov_b32_e32 v28, v16
  v_mfma_f32_16x16x32_bf16 v[240:243], a[196:199], v[64:67], v[240:243]
  ds_write_b64 v12, v[108:109] offset:6912
  v_permlane16_swap_b32_e32 v16, v28
  v_max_f32_e32 v16, v16, v28
L_hop7:
  s_cbranch_execz L_hop11
  v_mul_f32_e32 v16, s35, v16
  v_mfma_f32_16x16x32_bf16 v[244:247], a[196:199], v[72:75], v[244:247]
  ds_read_b128 a[172:175], v3 offset:12416
  v_fma_f32 v48, v48, s35, -v16
  v_exp_f32_e32 v48, v48
  v_fma_f32 v49, v49, s35, -v16
  v_fma_f32 v50, v50, s35, -v16
  v_mfma_f32_16x16x32_bf16 v[248:251], a[196:199], v[80:83], v[248:251]
  v_exp_f32_e32 v49, v49
  v_exp_f32_e32 v50, v50
  v_fma_f32 v51, v51, s35, -v16
  v_fma_f32 v52, v52, s35, -v16
  v_mfma_f32_16x16x32_bf16 v[252:255], a[196:199], v[88:91], v[252:255]
  s_waitcnt lgkmcnt(4)
  ds_read_b128 a[176:179], v2 offset:12544
  v_exp_f32_e32 v51, v51
  v_exp_f32_e32 v52, v52
  v_mfma_f32_16x16x32_bf16 a[0:3], a[200:203], v[64:67], a[0:3]
  v_fma_f32 v53, v53, s35, -v16
  v_exp_f32_e32 v53, v53
  v_fma_f32 v54, v54, s35, -v16
  v_exp_f32_e32 v54, v54
  v_mfma_f32_16x16x32_bf16 a[4:7], a[200:203], v[72:75], a[4:7]
  ds_read_b128 a[180:183], v3 offset:12544
  v_fma_f32 v55, v55, s35, -v16
  v_exp_f32_e32 v55, v55
  v_mov_b32_e32 v30, v48
  v_add_f32_e32 v30, v30, v49
  v_mfma_f32_16x16x32_bf16 a[8:11], a[200:203], v[80:83], a[8:11]
  v_cvt_pk_bf16_f32 v48, v48, v49
  v_add_f32_e32 v30, v30, v50
  v_add_f32_e32 v30, v30, v51
  v_cvt_pk_bf16_f32 v49, v50, v51
  v_cvt_pk_bf16_f32 v50, v52, v53
  v_cvt_pk_bf16_f32 v51, v54, v55
  v_mfma_f32_16x16x32_bf16 a[12:15], a[200:203], v[88:91], a[12:15]
  v_mul_f32_e32 v115, v22, v115
  v_cvt_pk_bf16_f32 v112, v112, v113
  v_cvt_pk_bf16_f32 v113, v114, v115
  v_max3_f32 v17, v56, v57, v58
  v_max3_f32 v17, v17, v59, v60
  v_max3_f32 v17, v17, v61, v62
  v_mfma_f32_16x16x32_bf16 a[16:19], a[204:207], v[64:67], a[16:19]
  ds_write_b64 v12, v[112:113] offset:32
  v_max_f32_e32 v17, v17, v63
  v_mov_b32_e32 v29, v17
  v_mul_f32_e32 v116, v23, v116
  v_mfma_f32_16x16x32_bf16 a[20:23], a[204:207], v[72:75], a[20:23]
  v_permlane32_swap_b32_e32 v17, v29
  v_max_f32_e32 v17, v17, v29
  v_mov_b32_e32 v29, v17
  v_mul_f32_e32 v117, v23, v117
  v_mul_f32_e32 v118, v23, v118
  v_mfma_f32_16x16x32_bf16 a[24:27], a[204:207], v[80:83], a[24:27]
  v_permlane16_swap_b32_e32 v17, v29
  v_max_f32_e32 v17, v17, v29
  v_mul_f32_e32 v17, s35, v17
  v_fma_f32 v56, v56, s35, -v17
  v_fma_f32 v57, v57, s35, -v17
  v_mfma_f32_16x16x32_bf16 a[28:31], a[204:207], v[88:91], a[28:31]
  v_exp_f32_e32 v56, v56
  v_exp_f32_e32 v57, v57
  v_fma_f32 v58, v58, s35, -v17
  v_fma_f32 v59, v59, s35, -v17
  v_mfma_f32_16x16x32_bf16 v[64:67], a[160:163], a[32:35], 0
  s_waitcnt lgkmcnt(2)
  v_exp_f32_e32 v58, v58
  v_exp_f32_e32 v59, v59
  v_fma_f32 v60, v60, s35, -v17
  v_mfma_f32_16x16x32_bf16 v[64:67], a[164:167], a[36:39], v[64:67]
  v_exp_f32_e32 v60, v60
  v_fma_f32 v61, v61, s35, -v17
  v_exp_f32_e32 v61, v61
  v_fma_f32 v62, v62, s35, -v17
  v_mfma_f32_16x16x32_bf16 v[64:67], a[168:171], a[40:43], v[64:67]
  v_exp_f32_e32 v62, v62
  v_fma_f32 v63, v63, s35, -v17
  v_exp_f32_e32 v63, v63
  v_mov_b32_e32 v31, v56
  v_mfma_f32_16x16x32_bf16 v[64:67], a[172:175], a[44:47], v[64:67]
  v_add_f32_e32 v31, v31, v57
  v_cvt_pk_bf16_f32 v56, v56, v57
  v_add_f32_e32 v31, v31, v58
  v_add_f32_e32 v31, v31, v59
  v_cvt_pk_bf16_f32 v57, v58, v59
  v_cvt_pk_bf16_f32 v58, v60, v61
  v_mfma_f32_16x16x32_bf16 v[64:67], a[176:179], a[128:131], v[64:67]
  s_waitcnt lgkmcnt(1)
  v_cvt_pk_bf16_f32 v59, v62, v63
  v_mul_f32_e32 v119, v23, v119
  v_cvt_pk_bf16_f32 v116, v116, v117
  v_cvt_pk_bf16_f32 v117, v118, v119
  v_mul_f32_e32 v120, v24, v120
  v_mul_f32_e32 v121, v24, v121
  v_mfma_f32_16x16x32_bf16 v[64:67], a[180:183], a[132:135], v[64:67]
  ds_write_b64 v12, v[116:117] offset:2336
  v_mul_f32_e32 v122, v24, v122
  v_mul_f32_e32 v123, v24, v123
  v_cvt_pk_bf16_f32 v120, v120, v121
  v_mfma_f32_16x16x32_bf16 v[72:75], a[160:163], a[56:59], 0
  v_cvt_pk_bf16_f32 v121, v122, v123
  v_mul_f32_e32 v124, v25, v124
  v_mul_f32_e32 v125, v25, v125
  v_mul_f32_e32 v126, v25, v126
  v_mul_f32_e32 v127, v25, v127
  v_cvt_pk_bf16_f32 v124, v124, v125
  v_mfma_f32_16x16x32_bf16 v[72:75], a[164:167], a[60:63], v[72:75]
  ds_read_b128 a[184:187], v2 offset:18432
  v_cvt_pk_bf16_f32 v125, v126, v127
  v_mul_f32_e32 v128, v22, v128
  v_mul_f32_e32 v129, v22, v129
  v_mul_f32_e32 v130, v22, v130
  v_mul_f32_e32 v131, v22, v131
  v_mfma_f32_16x16x32_bf16 v[72:75], a[168:171], a[64:67], v[72:75]
  ds_write_b64 v12, v[120:121] offset:4640
  v_cvt_pk_bf16_f32 v128, v128, v129
  v_cvt_pk_bf16_f32 v129, v130, v131
  v_mul_f32_e32 v132, v23, v132
  v_mul_f32_e32 v133, v23, v133
  v_mfma_f32_16x16x32_bf16 v[72:75], a[172:175], a[68:71], v[72:75]
  ds_read_b128 a[188:191], v3 offset:18432
  v_mul_f32_e32 v134, v23, v134
  v_mul_f32_e32 v135, v23, v135
  v_cvt_pk_bf16_f32 v132, v132, v133
  v_cvt_pk_bf16_f32 v133, v134, v135
  v_mfma_f32_16x16x32_bf16 v[72:75], a[176:179], a[136:139], v[72:75]
  ds_write_b64 v12, v[124:125] offset:6944
  v_mul_f32_e32 v136, v24, v136
  v_mul_f32_e32 v137, v24, v137
  v_mul_f32_e32 v138, v24, v138
  v_mul_f32_e32 v139, v24, v139
  v_mfma_f32_16x16x32_bf16 v[72:75], a[180:183], a[140:143], v[72:75]
  ds_read_b128 a[192:195], v2 offset:18560
  v_cvt_pk_bf16_f32 v136, v136, v137
  v_cvt_pk_bf16_f32 v137, v138, v139
  v_mul_f32_e32 v140, v25, v140
  v_mul_f32_e32 v141, v25, v141
  v_mul_f32_e32 v142, v25, v142
  v_mfma_f32_16x16x32_bf16 v[80:83], a[160:163], a[80:83], 0
  ds_write_b64 v12, v[128:129] offset:64
  v_mul_f32_e32 v143, v25, v143
  v_cvt_pk_bf16_f32 v140, v140, v141
  v_cvt_pk_bf16_f32 v141, v142, v143
  v_mfma_f32_16x16x32_bf16 v[80:83], a[164:167], a[84:87], v[80:83]
  ds_read_b128 a[196:199], v3 offset:18560
  v_mul_f32_e32 v144, v22, v144
  v_mul_f32_e32 v145, v22, v145
  v_mul_f32_e32 v146, v22, v146
  v_mul_f32_e32 v147, v22, v147
  v_cvt_pk_bf16_f32 v144, v144, v145
  v_mfma_f32_16x16x32_bf16 v[80:83], a[168:171], a[88:91], v[80:83]
  ds_write_b64 v12, v[132:133] offset:2368
  v_cvt_pk_bf16_f32 v145, v146, v147
  v_mul_f32_e32 v148, v23, v148
  v_mul_f32_e32 v149, v23, v149
  v_mul_f32_e32 v150, v23, v150
  v_mfma_f32_16x16x32_bf16 v[80:83], a[172:175], a[92:95], v[80:83]
  ds_read_b128 a[200:203], v2 offset:18688
  v_mul_f32_e32 v151, v23, v151
  v_cvt_pk_bf16_f32 v148, v148, v149
  v_cvt_pk_bf16_f32 v149, v150, v151
  v_mul_f32_e32 v152, v24, v152
  v_mul_f32_e32 v153, v24, v153
  v_mfma_f32_16x16x32_bf16 v[80:83], a[176:179], a[144:147], v[80:83]
  ds_write_b64 v12, v[136:137] offset:4672
  v_mul_f32_e32 v154, v24, v154
  v_mul_f32_e32 v155, v24, v155
  v_cvt_pk_bf16_f32 v152, v152, v153
  v_mfma_f32_16x16x32_bf16 v[80:83], a[180:183], a[148:151], v[80:83]
  ds_read_b128 a[204:207], v3 offset:18688
  v_cvt_pk_bf16_f32 v153, v154, v155
  v_mul_f32_e32 v156, v25, v156
  v_mul_f32_e32 v157, v25, v157
  v_mul_f32_e32 v158, v25, v158
  v_mul_f32_e32 v159, v25, v159
  v_mfma_f32_16x16x32_bf16 v[88:91], a[160:163], a[104:107], 0
  s_waitcnt vmcnt(9)
  s_barrier
  ds_write_b64 v12, v[140:141] offset:6976
  v_cvt_pk_bf16_f32 v156, v156, v157
  v_cvt_pk_bf16_f32 v157, v158, v159
  v_mul_f32_e32 v160, v22, v160
  v_mul_f32_e32 v161, v22, v161
  v_mfma_f32_16x16x32_bf16 v[88:91], a[164:167], a[108:111], v[88:91]
  s_add_u32 m0, s34, 0
  ds_write_b64 v12, v[144:145] offset:96
  v_mul_f32_e32 v162, v22, v162
  v_mul_f32_e32 v163, v22, v163
  v_cvt_pk_bf16_f32 v160, v160, v161
  v_mfma_f32_16x16x32_bf16 v[88:91], a[168:171], a[112:115], v[88:91]
  s_mov_b32 s32, 245760
  s_waitcnt lgkmcnt(10)
  ds_write_b64 v12, v[148:149] offset:2400
  v_cvt_pk_bf16_f32 v161, v162, v163
  v_mul_f32_e32 v164, v23, v164
  v_mul_f32_e32 v165, v23, v165
  v_mul_f32_e32 v166, v23, v166
  v_mfma_f32_16x16x32_bf16 v[88:91], a[172:175], a[116:119], v[88:91]
  buffer_load_dwordx4 v8, s[8:11], s32 offen nt lds
  v_mul_f32_e32 v167, v23, v167
  v_cvt_pk_bf16_f32 v164, v164, v165
  v_cvt_pk_bf16_f32 v165, v166, v167
  v_mul_f32_e32 v168, v24, v168
  v_mfma_f32_16x16x32_bf16 v[88:91], a[176:179], a[152:155], v[88:91]
  ds_write_b64 v12, v[152:153] offset:4704
  v_mul_f32_e32 v169, v24, v169
  v_mul_f32_e32 v170, v24, v170
  v_mul_f32_e32 v171, v24, v171
  v_mfma_f32_16x16x32_bf16 v[88:91], a[180:183], a[156:159], v[88:91]
  s_waitcnt lgkmcnt(6)
  ds_write_b64 v12, v[156:157] offset:7008
  v_cvt_pk_bf16_f32 v168, v168, v169
  v_cvt_pk_bf16_f32 v169, v170, v171
  v_mul_f32_e32 v172, v25, v172
  v_mul_f32_e32 v173, v25, v173
  v_mfma_f32_16x16x32_bf16 v[68:71], a[184:187], a[32:35], 0
  ds_write_b64 v12, v[160:161] offset:9216
  v_mul_f32_e32 v174, v25, v174
  v_mul_f32_e32 v175, v25, v175
  v_cvt_pk_bf16_f32 v172, v172, v173
  v_mfma_f32_16x16x32_bf16 v[68:71], a[188:191], a[36:39], v[68:71]
  ds_read_b128 a[208:211], v13 offset:0
  ds_read_b128 a[212:215], v13 offset:1152
  v_cvt_pk_bf16_f32 v173, v174, v175
  v_mul_f32_e32 v176, v22, v176
  v_mul_f32_e32 v177, v22, v177
  v_mul_f32_e32 v178, v22, v178
  v_mfma_f32_16x16x32_bf16 v[68:71], a[192:195], a[40:43], v[68:71]
  ds_read_b128 a[216:219], v13 offset:2304
  ds_read_b128 a[220:223], v13 offset:3456
  v_mul_f32_e32 v179, v22, v179
  v_cvt_pk_bf16_f32 v176, v176, v177
  v_cvt_pk_bf16_f32 v177, v178, v179
  v_mfma_f32_16x16x32_bf16 v[68:71], a[196:199], a[44:47], v[68:71]
  ds_write_b64 v12, v[164:165] offset:11520
  v_mul_f32_e32 v180, v23, v180
  v_mul_f32_e32 v181, v23, v181
  v_mul_f32_e32 v182, v23, v182
  v_mul_f32_e32 v183, v23, v183
  v_mfma_f32_16x16x32_bf16 v[68:71], a[200:203], a[128:131], v[68:71]
  s_waitcnt lgkmcnt(11)
  ds_write_b64 v12, v[168:169] offset:0
  v_cvt_pk_bf16_f32 v180, v180, v181
  v_cvt_pk_bf16_f32 v181, v182, v183
  v_mul_f32_e32 v184, v24, v184
  v_mfma_f32_16x16x32_bf16 v[68:71], a[204:207], a[132:135], v[68:71]
  ds_write_b64 v12, v[172:173] offset:2304
  v_mul_f32_e32 v185, v24, v185
  v_mul_f32_e32 v186, v24, v186
  v_mul_f32_e32 v187, v24, v187
  v_cvt_pk_bf16_f32 v184, v184, v185
  v_mfma_f32_16x16x32_bf16 v[76:79], a[184:187], a[56:59], 0
  ds_write_b64 v12, v[176:177] offset:9248
  v_cvt_pk_bf16_f32 v185, v186, v187
  v_mul_f32_e32 v188, v25, v188
  v_mul_f32_e32 v189, v25, v189
  v_mul_f32_e32 v190, v25, v190
  v_mfma_f32_16x16x32_bf16 v[76:79], a[188:191], a[60:63], v[76:79]
  ds_write_b64 v12, v[180:181] offset:11552
  v_mul_f32_e32 v191, v25, v191
  v_cvt_pk_bf16_f32 v188, v188, v189
  v_cvt_pk_bf16_f32 v189, v190, v191
  v_mfma_f32_16x16x32_bf16 v[76:79], a[192:195], a[64:67], v[76:79]
  s_waitcnt lgkmcnt(10)
  ds_read_b64_tr_b16 a[160:161], v4 offset:0
  ds_read_b128 a[224:227], v13 offset:4608
  v_mul_f32_e32 v192, v22, v192
  v_mul_f32_e32 v193, v22, v193
  v_mul_f32_e32 v194, v22, v194
  v_mfma_f32_16x16x32_bf16 v[76:79], a[196:199], a[68:71], v[76:79]
  buffer_load_dwordx4 v9, s[8:11], s32 offen offset:1024 nt lds
  v_mul_f32_e32 v195, v22, v195
  v_cvt_pk_bf16_f32 v192, v192, v193
  v_cvt_pk_bf16_f32 v193, v194, v195
  v_mul_f32_e32 v196, v23, v196
  v_mfma_f32_16x16x32_bf16 v[76:79], a[200:203], a[136:139], v[76:79]
  ds_read_b64_tr_b16 a[162:163], v4 offset:6144
  ds_read_b128 a[228:231], v13 offset:5760
  v_mul_f32_e32 v197, v23, v197
  v_mul_f32_e32 v198, v23, v198
  v_mul_f32_e32 v199, v23, v199
  v_mfma_f32_16x16x32_bf16 v[76:79], a[204:207], a[140:143], v[76:79]
  ds_write_b64 v12, v[184:185] offset:32
  v_cvt_pk_bf16_f32 v196, v196, v197
  v_cvt_pk_bf16_f32 v197, v198, v199
  v_mul_f32_e32 v200, v24, v200
  v_mul_f32_e32 v201, v24, v201
  v_mfma_f32_16x16x32_bf16 v[84:87], a[184:187], a[80:83], 0
  s_waitcnt lgkmcnt(10)
  ds_read_b64_tr_b16 a[164:165], v5 offset:0
  ds_read_b128 a[232:235], v13 offset:6912
  v_mul_f32_e32 v202, v24, v202
  v_mul_f32_e32 v203, v24, v203
  v_cvt_pk_bf16_f32 v200, v200, v201
  v_mfma_f32_16x16x32_bf16 v[84:87], a[188:191], a[84:87], v[84:87]
  ds_write_b64 v12, v[188:189] offset:2336
  v_cvt_pk_bf16_f32 v201, v202, v203
  v_mul_f32_e32 v208, v22, v208
  v_mul_f32_e32 v209, v22, v209
  v_mul_f32_e32 v210, v22, v210
  v_mfma_f32_16x16x32_bf16 v[84:87], a[192:195], a[88:91], v[84:87]
  ds_read_b64_tr_b16 a[166:167], v5 offset:6144
  ds_read_b128 a[236:239], v13 offset:8064
  v_mul_f32_e32 v211, v22, v211
  v_cvt_pk_bf16_f32 v208, v208, v209
  v_cvt_pk_bf16_f32 v209, v210, v211
  v_mfma_f32_16x16x32_bf16 v[84:87], a[196:199], a[92:95], v[84:87]
  s_waitcnt lgkmcnt(10)
  ds_write_b64 v12, v[192:193] offset:9280
  v_mul_f32_e32 v204, v25, v204
  v_mul_f32_e32 v205, v25, v205
  v_mul_f32_e32 v206, v25, v206
  v_mul_f32_e32 v207, v25, v207
  v_mfma_f32_16x16x32_bf16 v[84:87], a[200:203], a[144:147], v[84:87]
  ds_read_b64_tr_b16 a[168:169], v6 offset:0
  v_cvt_pk_bf16_f32 v204, v204, v205
  v_cvt_pk_bf16_f32 v205, v206, v207
  v_mul_f32_e32 v212, v23, v212
  v_mul_f32_e32 v213, v23, v213
  v_mfma_f32_16x16x32_bf16 v[84:87], a[204:207], a[148:151], v[84:87]
  ds_write_b64 v12, v[196:197] offset:11584
  v_mul_f32_e32 v214, v23, v214
  v_mul_f32_e32 v215, v23, v215
  v_cvt_pk_bf16_f32 v212, v212, v213
  v_mfma_f32_16x16x32_bf16 v[92:95], a[184:187], a[104:107], 0
  ds_read_b64_tr_b16 a[170:171], v6 offset:6144
  v_cvt_pk_bf16_f32 v213, v214, v215
  v_mul_f32_e32 v224, v22, v224
  v_mul_f32_e32 v225, v22, v225
  v_mul_f32_e32 v226, v22, v226
  v_mul_f32_e32 v227, v22, v227
  v_mfma_f32_16x16x32_bf16 v[92:95], a[188:191], a[108:111], v[92:95]
  ds_write_b64 v12, v[200:201] offset:64
  v_cvt_pk_bf16_f32 v224, v224, v225
  v_cvt_pk_bf16_f32 v225, v226, v227
  v_mul_f32_e32 v228, v23, v228
  v_mfma_f32_16x16x32_bf16 v[92:95], a[192:195], a[112:115], v[92:95]
  s_waitcnt lgkmcnt(10)
  ds_read_b64_tr_b16 a[172:173], v7 offset:0
  v_mul_f32_e32 v229, v23, v229
  v_mul_f32_e32 v230, v23, v230
  v_mul_f32_e32 v231, v23, v231
  v_cvt_pk_bf16_f32 v228, v228, v229
  v_cvt_pk_bf16_f32 v229, v230, v231
  v_mfma_f32_16x16x32_bf16 v[92:95], a[196:199], a[116:119], v[92:95]
  buffer_load_dwordx4 v10, s[8:11], s32 offen offset:2048 nt lds
  v_mul_f32_e32 v216, v24, v216
  v_mul_f32_e32 v217, v24, v217
  v_mul_f32_e32 v218, v24, v218
  v_mfma_f32_16x16x32_bf16 v[92:95], a[200:203], a[152:155], v[92:95]
  ds_read_b64_tr_b16 a[174:175], v7 offset:6144
  v_mul_f32_e32 v219, v24, v219
  v_cvt_pk_bf16_f32 v216, v216, v217
  v_cvt_pk_bf16_f32 v217, v218, v219
  v_mul_f32_e32 v240, v22, v240
  v_mfma_f32_16x16x32_bf16 v[92:95], a[204:207], a[156:159], v[92:95]
  ds_write_b64 v12, v[208:209] offset:9312
  v_mul_f32_e32 v241, v22, v241
  v_mul_f32_e32 v242, v22, v242
  v_mul_f32_e32 v243, v22, v243
  v_cvt_pk_bf16_f32 v240, v240, v241
  v_mfma_f32_16x16x32_bf16 a[240:243], v[18:21], v[32:35], 0
  s_waitcnt lgkmcnt(9)
  ds_read_b64_tr_b16 a[176:177], v4 offset:128
  v_cvt_pk_bf16_f32 v241, v242, v243
  v_mul_f32_e32 v232, v24, v232
  v_mul_f32_e32 v233, v24, v233
  v_mul_f32_e32 v234, v24, v234
  v_mfma_f32_16x16x32_bf16 v[96:99], a[160:163], v[32:35], 0
  ds_write_b64 v12, v[204:205] offset:2368
  v_mul_f32_e32 v235, v24, v235
  v_cvt_pk_bf16_f32 v232, v232, v233
  v_cvt_pk_bf16_f32 v233, v234, v235
  v_mfma_f32_16x16x32_bf16 v[100:103], a[160:163], v[40:43], 0
  ds_read_b64_tr_b16 a[178:179], v4 offset:6272
  v_mul_f32_e32 v220, v25, v220
  v_mul_f32_e32 v221, v25, v221
  v_mul_f32_e32 v222, v25, v222
  v_mul_f32_e32 v223, v25, v223
  v_cvt_pk_bf16_f32 v220, v220, v221
  v_mfma_f32_16x16x32_bf16 v[104:107], a[160:163], v[48:51], 0
  ds_write_b64 v12, v[212:213] offset:11616
  v_cvt_pk_bf16_f32 v221, v222, v223
  v_mul_f32_e32 v244, v23, v244
  v_mul_f32_e32 v245, v23, v245
  v_mfma_f32_16x16x32_bf16 v[108:111], a[160:163], v[56:59], 0
  ds_read_b64_tr_b16 a[180:181], v5 offset:128
  ds_read_b128 a[48:51], v13 offset:9216
  v_mul_f32_e32 v246, v23, v246
  v_mul_f32_e32 v247, v23, v247
  v_cvt_pk_bf16_f32 v244, v244, v245
  v_mfma_f32_16x16x32_bf16 v[112:115], a[164:167], v[32:35], 0
  s_waitcnt lgkmcnt(10)
  ds_write_b64 v12, v[224:225] offset:4608
  v_cvt_pk_bf16_f32 v245, v246, v247
  v_mul_f32_e32 v236, v25, v236
  v_mul_f32_e32 v237, v25, v237
  v_mul_f32_e32 v238, v25, v238
  v_mfma_f32_16x16x32_bf16 v[116:119], a[164:167], v[40:43], 0
  ds_read_b64_tr_b16 a[182:183], v5 offset:6272
  ds_read_b128 a[52:55], v13 offset:10368
  v_mul_f32_e32 v239, v25, v239
  v_cvt_pk_bf16_f32 v236, v236, v237
  v_cvt_pk_bf16_f32 v237, v238, v239
  v_mfma_f32_16x16x32_bf16 v[120:123], a[164:167], v[48:51], 0
  s_add_u32 m0, s34, 86016
  ds_read_b128 a[72:75], v13 offset:11520
  ds_read_b128 a[76:79], v13 offset:12672
  v_accvgpr_read_b32 v224, a0
  v_accvgpr_read_b32 v225, a1
  v_accvgpr_read_b32 v226, a2
  v_mfma_f32_16x16x32_bf16 v[124:127], a[164:167], v[56:59], 0
  s_waitcnt lgkmcnt(12)
  ds_read_b64_tr_b16 a[184:185], v6 offset:128
  v_accvgpr_read_b32 v227, a3
  v_mul_f32_e32 v224, v22, v224
  v_mul_f32_e32 v225, v22, v225
  v_mul_f32_e32 v226, v22, v226
  v_mfma_f32_16x16x32_bf16 v[128:131], a[168:171], v[32:35], 0
  s_mov_b32 s33, 233472
  ds_write_b64 v12, v[228:229] offset:6912
  v_mul_f32_e32 v227, v22, v227
  v_cvt_pk_bf16_f32 v224, v224, v225
  v_cvt_pk_bf16_f32 v225, v226, v227
  v_mul_f32_e32 v248, v24, v248
  v_mfma_f32_16x16x32_bf16 v[132:135], a[168:171], v[40:43], 0
  ds_read_b64_tr_b16 a[186:187], v6 offset:6272
  v_mul_f32_e32 v249, v24, v249
  v_mul_f32_e32 v250, v24, v250
  v_mul_f32_e32 v251, v24, v251
  v_cvt_pk_bf16_f32 v248, v248, v249
  v_mfma_f32_16x16x32_bf16 v[136:139], a[168:171], v[48:51], 0
  buffer_load_dwordx4 v8, s[12:15], s33 offen nt lds
  v_cvt_pk_bf16_f32 v249, v250, v251
  v_accvgpr_read_b32 v228, a4
  v_accvgpr_read_b32 v229, a5
  v_mfma_f32_16x16x32_bf16 v[140:143], a[168:171], v[56:59], 0
  s_waitcnt lgkmcnt(10)
  ds_read_b64_tr_b16 a[188:189], v7 offset:128
  v_accvgpr_read_b32 v230, a6
  v_accvgpr_read_b32 v231, a7
  v_mul_f32_e32 v228, v23, v228
  v_mul_f32_e32 v229, v23, v229
  v_mfma_f32_16x16x32_bf16 v[144:147], a[172:175], v[32:35], 0
  ds_write_b64 v12, v[216:217] offset:96
  v_mul_f32_e32 v230, v23, v230
  v_mul_f32_e32 v231, v23, v231
  v_cvt_pk_bf16_f32 v228, v228, v229
  v_mfma_f32_16x16x32_bf16 v[148:151], a[172:175], v[40:43], 0
  ds_read_b64_tr_b16 a[190:191], v7 offset:6272
  v_cvt_pk_bf16_f32 v229, v230, v231
  v_mul_f32_e32 v252, v25, v252
  v_mul_f32_e32 v253, v25, v253
  v_mul_f32_e32 v254, v25, v254
  v_mul_f32_e32 v255, v25, v255
  v_mfma_f32_16x16x32_bf16 v[152:155], a[172:175], v[48:51], 0
  ds_write_b64 v12, v[240:241] offset:4640
  v_cvt_pk_bf16_f32 v252, v252, v253
  v_cvt_pk_bf16_f32 v253, v254, v255
  v_accvgpr_read_b32 v234, a10
  v_mfma_f32_16x16x32_bf16 v[156:159], a[172:175], v[56:59], 0
  s_waitcnt lgkmcnt(10)
  ds_read_b64_tr_b16 a[192:193], v4 offset:256
  v_accvgpr_read_b32 v235, a11
  v_mul_f32_e32 v234, v24, v234
  v_mul_f32_e32 v235, v24, v235
  v_accvgpr_read_b32 v238, a14
  v_mfma_f32_16x16x32_bf16 v[160:163], a[176:179], v[32:35], 0
  ds_write_b64 v12, v[232:233] offset:9216
  v_accvgpr_read_b32 v232, a8
  v_accvgpr_read_b32 v233, a9
  v_mul_f32_e32 v232, v24, v232
  v_mfma_f32_16x16x32_bf16 v[164:167], a[176:179], v[40:43], 0
  ds_read_b64_tr_b16 a[194:195], v4 offset:6400
  v_mul_f32_e32 v233, v24, v233
  v_cvt_pk_bf16_f32 v232, v232, v233
  v_cvt_pk_bf16_f32 v233, v234, v235
  v_accvgpr_read_b32 v239, a15
  v_mfma_f32_16x16x32_bf16 v[168:171], a[176:179], v[48:51], 0
  ds_write_b64 v12, v[220:221] offset:2400
  v_mul_f32_e32 v238, v25, v238
  v_mul_f32_e32 v239, v25, v239
  v_accvgpr_read_b32 v240, a16
  v_mfma_f32_16x16x32_bf16 v[172:175], a[176:179], v[56:59], 0
  ds_read_b64_tr_b16 a[196:197], v5 offset:256
  s_waitcnt lgkmcnt(10)
  ds_read_b128 a[96:99], v13 offset:0
  v_accvgpr_read_b32 v241, a17
  v_accvgpr_read_b32 v242, a18
  v_accvgpr_read_b32 v243, a19
  v_mfma_f32_16x16x32_bf16 v[176:179], a[180:183], v[32:35], 0
  ds_write_b64 v12, v[244:245] offset:6944
  v_mul_f32_e32 v240, v22, v240
  v_mul_f32_e32 v241, v22, v241
  v_mul_f32_e32 v242, v22, v242
  v_mfma_f32_16x16x32_bf16 v[180:183], a[180:183], v[40:43], 0
  ds_read_b64_tr_b16 a[198:199], v5 offset:6400
  ds_read_b128 a[100:103], v13 offset:1152
  v_mul_f32_e32 v243, v22, v243
  v_cvt_pk_bf16_f32 v240, v240, v241
  v_cvt_pk_bf16_f32 v241, v242, v243
  v_accvgpr_read_b32 v244, a20
  v_mfma_f32_16x16x32_bf16 v[184:187], a[180:183], v[48:51], 0
  buffer_load_dwordx4 v9, s[12:15], s33 offen offset:1024 nt lds
  v_accvgpr_read_b32 v245, a21
  v_accvgpr_read_b32 v246, a22
  v_accvgpr_read_b32 v247, a23
  v_mfma_f32_16x16x32_bf16 v[188:191], a[180:183], v[56:59], 0
  s_waitcnt lgkmcnt(10)
  ds_read_b64_tr_b16 a[200:201], v6 offset:256
  ds_read_b128 a[120:123], v13 offset:2304
  v_mul_f32_e32 v244, v23, v244
  v_mul_f32_e32 v245, v23, v245
  v_mul_f32_e32 v246, v23, v246
  v_mfma_f32_16x16x32_bf16 v[192:195], a[184:187], v[32:35], 0
  ds_write_b64 v12, v[236:237] offset:11520
  v_accvgpr_read_b32 v236, a12
  v_accvgpr_read_b32 v237, a13
  v_mul_f32_e32 v236, v25, v236
  v_mfma_f32_16x16x32_bf16 v[196:199], a[184:187], v[40:43], 0
  ds_read_b64_tr_b16 a[202:203], v6 offset:6400
  ds_read_b128 a[124:127], v13 offset:3456
  v_mul_f32_e32 v237, v25, v237
  v_cvt_pk_bf16_f32 v236, v236, v237
  v_cvt_pk_bf16_f32 v237, v238, v239
  v_mfma_f32_16x16x32_bf16 v[200:203], a[184:187], v[48:51], 0
  s_waitcnt lgkmcnt(10)
  ds_write_b64 v12, v[224:225] offset:4672
  v_mul_f32_e32 v247, v23, v247
  v_cvt_pk_bf16_f32 v244, v244, v245
  v_cvt_pk_bf16_f32 v245, v246, v247
  v_mfma_f32_16x16x32_bf16 v[204:207], a[184:187], v[56:59], 0
  ds_read_b64_tr_b16 a[204:205], v7 offset:256
  v_accvgpr_read_b32 v250, a26
  v_accvgpr_read_b32 v251, a27
  v_mul_f32_e32 v250, v24, v250
  v_mul_f32_e32 v251, v24, v251
  v_mfma_f32_16x16x32_bf16 v[208:211], a[188:191], v[32:35], 0
  ds_write_b64 v12, v[248:249] offset:9248
  v_accvgpr_read_b32 v248, a24
  v_accvgpr_read_b32 v249, a25
  v_mul_f32_e32 v248, v24, v248
  v_mfma_f32_16x16x32_bf16 v[212:215], a[188:191], v[40:43], 0
  ds_read_b64_tr_b16 a[206:207], v7 offset:6400
  v_mul_f32_e32 v249, v24, v249
  v_cvt_pk_bf16_f32 v248, v248, v249
  v_cvt_pk_bf16_f32 v249, v250, v251
  v_accvgpr_read_b32 v254, a30
  v_mfma_f32_16x16x32_bf16 v[216:219], a[188:191], v[48:51], 0
  ds_write_b64 v12, v[228:229] offset:6976
  v_accvgpr_read_b32 v255, a31
  v_mul_f32_e32 v254, v25, v254
  v_mul_f32_e32 v255, v25, v255
  v_mfma_f32_16x16x32_bf16 v[220:223], a[188:191], v[56:59], 0
  s_waitcnt lgkmcnt(11)
  ds_read_b128 a[160:163], v2 offset:24576
  ds_write_b64 v12, v[252:253] offset:11552
  v_accvgpr_read_b32 v252, a28
  v_accvgpr_read_b32 v253, a29
  v_mul_f32_e32 v252, v25, v252
  v_mfma_f32_16x16x32_bf16 v[224:227], a[192:195], v[32:35], 0
  ds_write_b64 v12, v[232:233] offset:9280
  v_mul_f32_e32 v253, v25, v253
  v_cvt_pk_bf16_f32 v252, v252, v253
  v_mfma_f32_16x16x32_bf16 v[228:231], a[192:195], v[40:43], 0
  ds_read_b128 a[164:167], v3 offset:24576
  s_waitcnt lgkmcnt(10)
  ds_write_b64 v12, v[236:237] offset:11584
  v_cvt_pk_bf16_f32 v253, v254, v255
  v_add_f32_e32 v0, v0, v44
  v_mfma_f32_16x16x32_bf16 v[232:235], a[192:195], v[48:51], 0
  buffer_load_dwordx4 v10, s[12:15], s33 offen offset:2048 nt lds
  ds_write_b64 v12, v[240:241] offset:4704
  v_add_f32_e32 v0, v0, v45
  v_mfma_f32_16x16x32_bf16 v[236:239], a[192:195], v[56:59], 0
  ds_read_b128 a[168:171], v2 offset:24704
  ds_write_b64 v12, v[244:245] offset:7008
  v_add_f32_e32 v0, v0, v46
  v_mfma_f32_16x16x32_bf16 v[240:243], a[196:199], v[32:35], 0
  ds_write_b64 v12, v[248:249] offset:9312
  v_add_f32_e32 v0, v0, v47
  v_mfma_f32_16x16x32_bf16 v[244:247], a[196:199], v[40:43], 0
  s_waitcnt lgkmcnt(10)
  ds_read_b128 a[172:175], v3 offset:24704
  ds_write_b64 v12, v[252:253] offset:11616
  v_mfma_f32_16x16x32_bf16 v[248:251], a[196:199], v[48:51], 0
  buffer_store_dwordx4 a[208:211], v11, s[16:19], s80 offen nt
  v_add_f32_e32 v30, v30, v52
  v_mfma_f32_16x16x32_bf16 v[252:255], a[196:199], v[56:59], 0
  s_waitcnt lgkmcnt(10)
  ds_read_b128 a[176:179], v2 offset:24832
  ds_read_b128 a[208:211], v13 offset:4608
  v_add_f32_e32 v30, v30, v53
  v_mfma_f32_16x16x32_bf16 a[0:3], a[200:203], v[32:35], 0
  v_add_f32_e32 v30, v30, v54
  v_add_f32_e32 v30, v30, v55
  v_mfma_f32_16x16x32_bf16 a[4:7], a[200:203], v[40:43], 0
  ds_read_b128 a[180:183], v3 offset:24832
  v_add_f32_e32 v31, v31, v60
  v_add_f32_e32 v31, v31, v61
  v_mfma_f32_16x16x32_bf16 a[8:11], a[200:203], v[48:51], 0
  v_add_f32_e32 v31, v31, v62
  v_add_f32_e32 v31, v31, v63
  v_mfma_f32_16x16x32_bf16 a[12:15], a[200:203], v[56:59], 0
  v_fma_f32 v64, v64, s35, -v14
  v_exp_f32_e32 v64, v64
  v_mfma_f32_16x16x32_bf16 a[16:19], a[204:207], v[32:35], 0
  v_fma_f32 v65, v65, s35, -v14
  v_exp_f32_e32 v65, v65
  v_mfma_f32_16x16x32_bf16 a[20:23], a[204:207], v[40:43], 0
  v_fma_f32 v66, v66, s35, -v14
  v_fma_f32 v67, v67, s35, -v14
  v_mfma_f32_16x16x32_bf16 a[24:27], a[204:207], v[48:51], 0
  v_exp_f32_e32 v66, v66
  v_fma_f32 v68, v68, s35, -v14
  v_mfma_f32_16x16x32_bf16 a[28:31], a[204:207], v[56:59], 0
  v_exp_f32_e32 v67, v67
  v_fma_f32 v69, v69, s35, -v14
  v_mfma_f32_16x16x32_bf16 v[32:35], a[160:163], a[32:35], 0
  s_waitcnt lgkmcnt(2)
  v_exp_f32_e32 v68, v68
  v_mfma_f32_16x16x32_bf16 v[32:35], a[164:167], a[36:39], v[32:35]
  v_exp_f32_e32 v69, v69
  v_fma_f32 v70, v70, s35, -v14
  v_mfma_f32_16x16x32_bf16 v[32:35], a[168:171], a[40:43], v[32:35]
  v_exp_f32_e32 v70, v70
  v_fma_f32 v71, v71, s35, -v14
  v_mfma_f32_16x16x32_bf16 v[32:35], a[172:175], a[44:47], v[32:35]
  v_exp_f32_e32 v71, v71
  v_mfma_f32_16x16x32_bf16 v[32:35], a[176:179], a[128:131], v[32:35]
  s_waitcnt lgkmcnt(0)
  v_cvt_pk_bf16_f32 v64, v64, v65
  v_cvt_pk_bf16_f32 v65, v66, v67
  v_cvt_pk_bf16_f32 v66, v68, v69
  v_mfma_f32_16x16x32_bf16 v[32:35], a[180:183], a[132:135], v[32:35]
  v_cvt_pk_bf16_f32 v67, v70, v71
  v_fma_f32 v72, v72, s35, -v15
  v_mfma_f32_16x16x32_bf16 v[40:43], a[160:163], a[56:59], 0
L_hop8:
  s_cbranch_execz L_hop12
  v_exp_f32_e32 v72, v72
  v_fma_f32 v73, v73, s35, -v15
  v_mfma_f32_16x16x32_bf16 v[40:43], a[164:167], a[60:63], v[40:43]
  ds_read_b128 a[184:187], v2 offset:30720
  v_exp_f32_e32 v73, v73
  v_mfma_f32_16x16x32_bf16 v[40:43], a[168:171], a[64:67], v[40:43]
  v_fma_f32 v74, v74, s35, -v15
  v_fma_f32 v75, v75, s35, -v15
  v_mfma_f32_16x16x32_bf16 v[40:43], a[172:175], a[68:71], v[40:43]
  ds_read_b128 a[188:191], v3 offset:30720
  v_exp_f32_e32 v74, v74
  v_mfma_f32_16x16x32_bf16 v[40:43], a[176:179], a[136:139], v[40:43]
  v_exp_f32_e32 v75, v75
  v_fma_f32 v76, v76, s35, -v15
  v_mfma_f32_16x16x32_bf16 v[40:43], a[180:183], a[140:143], v[40:43]
  ds_read_b128 a[192:195], v2 offset:30848
  v_fma_f32 v77, v77, s35, -v15
  v_mfma_f32_16x16x32_bf16 v[48:51], a[160:163], a[80:83], 0
  v_exp_f32_e32 v76, v76
  v_fma_f32 v78, v78, s35, -v15
  v_mfma_f32_16x16x32_bf16 v[48:51], a[164:167], a[84:87], v[48:51]
  ds_read_b128 a[196:199], v3 offset:30848
  v_exp_f32_e32 v77, v77
  v_mfma_f32_16x16x32_bf16 v[48:51], a[168:171], a[88:91], v[48:51]
  v_exp_f32_e32 v78, v78
  v_mfma_f32_16x16x32_bf16 v[48:51], a[172:175], a[92:95], v[48:51]
  ds_read_b128 a[200:203], v2 offset:30976
  v_fma_f32 v79, v79, s35, -v15
  v_add_f32_e32 v0, v0, v72
  v_mfma_f32_16x16x32_bf16 v[48:51], a[176:179], a[144:147], v[48:51]
  v_exp_f32_e32 v79, v79
  v_mfma_f32_16x16x32_bf16 v[48:51], a[180:183], a[148:151], v[48:51]
  ds_read_b128 a[204:207], v3 offset:30976
  v_add_f32_e32 v0, v0, v73
  v_cvt_pk_bf16_f32 v72, v72, v73
  v_mfma_f32_16x16x32_bf16 v[56:59], a[160:163], a[104:107], 0
  s_waitcnt vmcnt(10)
  s_barrier
  v_add_f32_e32 v0, v0, v74
  v_mfma_f32_16x16x32_bf16 v[56:59], a[164:167], a[108:111], v[56:59]
  s_add_u32 m0, s34, 12288
  v_add_f32_e32 v0, v0, v75
  v_cvt_pk_bf16_f32 v73, v74, v75
  v_mfma_f32_16x16x32_bf16 v[56:59], a[168:171], a[112:115], v[56:59]
  s_mov_b32 s32, 258048
  v_cvt_pk_bf16_f32 v74, v76, v77
  v_cvt_pk_bf16_f32 v75, v78, v79
  v_fma_f32 v80, v80, s35, -v16
  v_mfma_f32_16x16x32_bf16 v[56:59], a[172:175], a[116:119], v[56:59]
  buffer_load_dwordx4 v8, s[8:11], s32 offen nt lds
  v_fma_f32 v81, v81, s35, -v16
  v_mfma_f32_16x16x32_bf16 v[56:59], a[176:179], a[152:155], v[56:59]
  v_exp_f32_e32 v80, v80
  v_mfma_f32_16x16x32_bf16 v[56:59], a[180:183], a[156:159], v[56:59]
  s_waitcnt lgkmcnt(1)
  v_exp_f32_e32 v81, v81
  v_fma_f32 v82, v82, s35, -v16
  v_mfma_f32_16x16x32_bf16 v[36:39], a[184:187], a[32:35], 0
  v_exp_f32_e32 v82, v82
  v_fma_f32 v83, v83, s35, -v16
  v_mfma_f32_16x16x32_bf16 v[36:39], a[188:191], a[36:39], v[36:39]
  v_exp_f32_e32 v83, v83
  v_mfma_f32_16x16x32_bf16 v[36:39], a[192:195], a[40:43], v[36:39]
  v_fma_f32 v84, v84, s35, -v16
  v_exp_f32_e32 v84, v84
  v_mfma_f32_16x16x32_bf16 v[36:39], a[196:199], a[44:47], v[36:39]
  v_fma_f32 v85, v85, s35, -v16
  v_fma_f32 v86, v86, s35, -v16
  v_mfma_f32_16x16x32_bf16 v[36:39], a[200:203], a[128:131], v[36:39]
  s_waitcnt lgkmcnt(0)
  v_exp_f32_e32 v85, v85
  v_fma_f32 v87, v87, s35, -v16
  v_mfma_f32_16x16x32_bf16 v[36:39], a[204:207], a[132:135], v[36:39]
  v_exp_f32_e32 v86, v86
  v_add_f32_e32 v30, v30, v80
  v_mfma_f32_16x16x32_bf16 v[44:47], a[184:187], a[56:59], 0
  v_exp_f32_e32 v87, v87
  v_mfma_f32_16x16x32_bf16 v[44:47], a[188:191], a[60:63], v[44:47]
  v_add_f32_e32 v30, v30, v81
  v_cvt_pk_bf16_f32 v80, v80, v81
  v_add_f32_e32 v30, v30, v82
  v_mfma_f32_16x16x32_bf16 v[44:47], a[192:195], a[64:67], v[44:47]
  ds_read_b64_tr_b16 a[160:161], v4 offset:12288
  v_add_f32_e32 v30, v30, v83
  v_cvt_pk_bf16_f32 v81, v82, v83
  v_mfma_f32_16x16x32_bf16 v[44:47], a[196:199], a[68:71], v[44:47]
  buffer_load_dwordx4 v9, s[8:11], s32 offen offset:1024 nt lds
  v_mfma_f32_16x16x32_bf16 v[44:47], a[200:203], a[136:139], v[44:47]
  ds_read_b64_tr_b16 a[162:163], v4 offset:18432
  v_cvt_pk_bf16_f32 v82, v84, v85
  v_cvt_pk_bf16_f32 v83, v86, v87
  v_mfma_f32_16x16x32_bf16 v[44:47], a[204:207], a[140:143], v[44:47]
  v_fma_f32 v88, v88, s35, -v17
  v_fma_f32 v89, v89, s35, -v17
  v_mfma_f32_16x16x32_bf16 v[52:55], a[184:187], a[80:83], 0
  ds_read_b64_tr_b16 a[164:165], v5 offset:12288
  v_exp_f32_e32 v88, v88
  v_mfma_f32_16x16x32_bf16 v[52:55], a[188:191], a[84:87], v[52:55]
  v_exp_f32_e32 v89, v89
  v_fma_f32 v90, v90, s35, -v17
  v_mfma_f32_16x16x32_bf16 v[52:55], a[192:195], a[88:91], v[52:55]
  ds_read_b64_tr_b16 a[166:167], v5 offset:18432
  v_fma_f32 v91, v91, s35, -v17
  v_mfma_f32_16x16x32_bf16 v[52:55], a[196:199], a[92:95], v[52:55]
  buffer_store_dwordx4 a[212:215], v11, s[16:19], s80 offen offset:3072 nt
  v_fma_f32 v92, v92, s35, -v17
  v_mfma_f32_16x16x32_bf16 v[52:55], a[200:203], a[144:147], v[52:55]
  ds_read_b64_tr_b16 a[168:169], v6 offset:12288
  ds_read_b128 a[212:215], v13 offset:5760
  v_fma_f32 v93, v93, s35, -v17
  v_mfma_f32_16x16x32_bf16 v[52:55], a[204:207], a[148:151], v[52:55]
  v_exp_f32_e32 v90, v90
  v_fma_f32 v94, v94, s35, -v17
  v_mfma_f32_16x16x32_bf16 v[60:63], a[184:187], a[104:107], 0
  ds_read_b64_tr_b16 a[170:171], v6 offset:18432
  v_exp_f32_e32 v91, v91
  v_mfma_f32_16x16x32_bf16 v[60:63], a[188:191], a[108:111], v[60:63]
  v_exp_f32_e32 v92, v92
  v_fma_f32 v95, v95, s35, -v17
  v_mfma_f32_16x16x32_bf16 v[60:63], a[192:195], a[112:115], v[60:63]
  ds_read_b64_tr_b16 a[172:173], v7 offset:12288
  v_exp_f32_e32 v93, v93
  v_mfma_f32_16x16x32_bf16 v[60:63], a[196:199], a[116:119], v[60:63]
  buffer_load_dwordx4 v10, s[8:11], s32 offen offset:2048 nt lds
  v_mfma_f32_16x16x32_bf16 v[60:63], a[200:203], a[152:155], v[60:63]
  ds_read_b64_tr_b16 a[174:175], v7 offset:18432
  v_exp_f32_e32 v94, v94
  v_mfma_f32_16x16x32_bf16 v[60:63], a[204:207], a[156:159], v[60:63]
  v_exp_f32_e32 v95, v95
  v_add_f32_e32 v31, v31, v88
  v_mfma_f32_16x16x32_bf16 a[240:243], v[18:21], v[64:67], a[240:243]
  s_waitcnt lgkmcnt(5)
  ds_read_b64_tr_b16 a[176:177], v4 offset:12416
  v_add_f32_e32 v31, v31, v89
  v_cvt_pk_bf16_f32 v88, v88, v89
  v_mfma_f32_16x16x32_bf16 v[96:99], a[160:163], v[64:67], v[96:99]
  v_add_f32_e32 v31, v31, v90
  v_add_f32_e32 v31, v31, v91
  v_cvt_pk_bf16_f32 v89, v90, v91
  v_mfma_f32_16x16x32_bf16 v[100:103], a[160:163], v[72:75], v[100:103]
  ds_read_b64_tr_b16 a[178:179], v4 offset:18560
  v_cvt_pk_bf16_f32 v90, v92, v93
  v_cvt_pk_bf16_f32 v91, v94, v95
  v_mfma_f32_16x16x32_bf16 v[104:107], a[160:163], v[80:83], v[104:107]
  v_add_f32_e32 v0, v0, v76
  v_add_f32_e32 v0, v0, v77
  v_mfma_f32_16x16x32_bf16 v[108:111], a[160:163], v[88:91], v[108:111]
  ds_read_b64_tr_b16 a[180:181], v5 offset:12416
  v_add_f32_e32 v0, v0, v78
  v_mfma_f32_16x16x32_bf16 v[112:115], a[164:167], v[64:67], v[112:115]
  v_add_f32_e32 v0, v0, v79
  v_add_f32_e32 v30, v30, v84
  v_mfma_f32_16x16x32_bf16 v[116:119], a[164:167], v[72:75], v[116:119]
  ds_read_b64_tr_b16 a[182:183], v5 offset:18560
  v_add_f32_e32 v30, v30, v85
  v_mfma_f32_16x16x32_bf16 v[120:123], a[164:167], v[80:83], v[120:123]
  s_add_u32 m0, s34, 49152
  v_add_f32_e32 v30, v30, v86
  v_add_f32_e32 v30, v30, v87
  v_mfma_f32_16x16x32_bf16 v[124:127], a[164:167], v[88:91], v[124:127]
  s_waitcnt lgkmcnt(4)
  ds_read_b64_tr_b16 a[184:185], v6 offset:12416
  v_add_f32_e32 v31, v31, v92
  v_mfma_f32_16x16x32_bf16 v[128:131], a[168:171], v[64:67], v[128:131]
  s_mov_b32 s33, 245760
  v_add_f32_e32 v31, v31, v93
  v_add_f32_e32 v31, v31, v94
  v_mfma_f32_16x16x32_bf16 v[132:135], a[168:171], v[72:75], v[132:135]
  ds_read_b64_tr_b16 a[186:187], v6 offset:18560
  v_add_f32_e32 v31, v31, v95
  v_mfma_f32_16x16x32_bf16 v[136:139], a[168:171], v[80:83], v[136:139]
  buffer_load_dwordx4 v8, s[12:15], s33 offen nt lds
  v_mfma_f32_16x16x32_bf16 v[140:143], a[168:171], v[88:91], v[140:143]
  ds_read_b64_tr_b16 a[188:189], v7 offset:12416
  v_fma_f32 v32, v32, s35, -v14
  v_mfma_f32_16x16x32_bf16 v[144:147], a[172:175], v[64:67], v[144:147]
  v_exp_f32_e32 v32, v32
  v_mfma_f32_16x16x32_bf16 v[148:151], a[172:175], v[72:75], v[148:151]
  ds_read_b64_tr_b16 a[190:191], v7 offset:18560
  v_fma_f32 v33, v33, s35, -v14
  v_mfma_f32_16x16x32_bf16 v[152:155], a[172:175], v[80:83], v[152:155]
  v_exp_f32_e32 v33, v33
  v_mfma_f32_16x16x32_bf16 v[156:159], a[172:175], v[88:91], v[156:159]
  s_waitcnt lgkmcnt(4)
  ds_read_b64_tr_b16 a[192:193], v4 offset:12544
  v_fma_f32 v34, v34, s35, -v14
  v_mfma_f32_16x16x32_bf16 v[160:163], a[176:179], v[64:67], v[160:163]
  v_exp_f32_e32 v34, v34
  v_mfma_f32_16x16x32_bf16 v[164:167], a[176:179], v[72:75], v[164:167]
  ds_read_b64_tr_b16 a[194:195], v4 offset:18688
  v_fma_f32 v35, v35, s35, -v14
  v_mfma_f32_16x16x32_bf16 v[168:171], a[176:179], v[80:83], v[168:171]
  v_exp_f32_e32 v35, v35
  v_mfma_f32_16x16x32_bf16 v[172:175], a[176:179], v[88:91], v[172:175]
  ds_read_b64_tr_b16 a[196:197], v5 offset:12544
  v_fma_f32 v36, v36, s35, -v14
  v_mfma_f32_16x16x32_bf16 v[176:179], a[180:183], v[64:67], v[176:179]
  v_exp_f32_e32 v36, v36
  v_mfma_f32_16x16x32_bf16 v[180:183], a[180:183], v[72:75], v[180:183]
  ds_read_b64_tr_b16 a[198:199], v5 offset:18688
  v_fma_f32 v37, v37, s35, -v14
  v_mfma_f32_16x16x32_bf16 v[184:187], a[180:183], v[80:83], v[184:187]
  buffer_load_dwordx4 v9, s[12:15], s33 offen offset:1024 nt lds
  v_mfma_f32_16x16x32_bf16 v[188:191], a[180:183], v[88:91], v[188:191]
  s_waitcnt lgkmcnt(4)
  ds_read_b64_tr_b16 a[200:201], v6 offset:12544
  v_fma_f32 v38, v38, s35, -v14
  v_mfma_f32_16x16x32_bf16 v[192:195], a[184:187], v[64:67], v[192:195]
  v_exp_f32_e32 v37, v37
  v_mfma_f32_16x16x32_bf16 v[196:199], a[184:187], v[72:75], v[196:199]
  ds_read_b64_tr_b16 a[202:203], v6 offset:18688
  v_fma_f32 v39, v39, s35, -v14
  v_mfma_f32_16x16x32_bf16 v[200:203], a[184:187], v[80:83], v[200:203]
  v_exp_f32_e32 v38, v38
  v_mfma_f32_16x16x32_bf16 v[204:207], a[184:187], v[88:91], v[204:207]
  ds_read_b64_tr_b16 a[204:205], v7 offset:12544
  v_cvt_pk_bf16_f32 v32, v32, v33
  v_mfma_f32_16x16x32_bf16 v[208:211], a[188:191], v[64:67], v[208:211]
  v_exp_f32_e32 v39, v39
  v_mfma_f32_16x16x32_bf16 v[212:215], a[188:191], v[72:75], v[212:215]
  ds_read_b64_tr_b16 a[206:207], v7 offset:18688
  v_cvt_pk_bf16_f32 v33, v34, v35
  v_mfma_f32_16x16x32_bf16 v[216:219], a[188:191], v[80:83], v[216:219]
  v_cvt_pk_bf16_f32 v34, v36, v37
  v_cvt_pk_bf16_f32 v35, v38, v39
  v_mfma_f32_16x16x32_bf16 v[220:223], a[188:191], v[88:91], v[220:223]
  s_waitcnt lgkmcnt(4)
  ds_read_b128 a[160:163], v2 offset:36864
  v_fma_f32 v40, v40, s35, -v15
  v_mfma_f32_16x16x32_bf16 v[224:227], a[192:195], v[64:67], v[224:227]
  v_exp_f32_e32 v40, v40
  v_mfma_f32_16x16x32_bf16 v[228:231], a[192:195], v[72:75], v[228:231]
  ds_read_b128 a[164:167], v3 offset:36864
  v_fma_f32 v41, v41, s35, -v15
  v_mfma_f32_16x16x32_bf16 v[232:235], a[192:195], v[80:83], v[232:235]
  buffer_load_dwordx4 v10, s[12:15], s33 offen offset:2048 nt lds
  v_mfma_f32_16x16x32_bf16 v[236:239], a[192:195], v[88:91], v[236:239]
  ds_read_b128 a[168:171], v2 offset:36992
  v_fma_f32 v42, v42, s35, -v15
  v_mfma_f32_16x16x32_bf16 v[240:243], a[196:199], v[64:67], v[240:243]
  v_exp_f32_e32 v41, v41
  v_mfma_f32_16x16x32_bf16 v[244:247], a[196:199], v[72:75], v[244:247]
  ds_read_b128 a[172:175], v3 offset:36992
  v_fma_f32 v43, v43, s35, -v15
  v_mfma_f32_16x16x32_bf16 v[248:251], a[196:199], v[80:83], v[248:251]
  buffer_store_dwordx4 a[216:219], v11, s[16:19], s81 offen nt
  v_mfma_f32_16x16x32_bf16 v[252:255], a[196:199], v[88:91], v[252:255]
  s_waitcnt lgkmcnt(3)
  ds_read_b128 a[176:179], v2 offset:37120
  ds_read_b128 a[216:219], v13 offset:6912
  v_mfma_f32_16x16x32_bf16 a[0:3], a[200:203], v[64:67], a[0:3]
  v_exp_f32_e32 v42, v42
  v_mfma_f32_16x16x32_bf16 a[4:7], a[200:203], v[72:75], a[4:7]
  ds_read_b128 a[180:183], v3 offset:37120
  v_fma_f32 v44, v44, s35, -v15
  v_mfma_f32_16x16x32_bf16 a[8:11], a[200:203], v[80:83], a[8:11]
  v_exp_f32_e32 v43, v43
  v_mfma_f32_16x16x32_bf16 a[12:15], a[200:203], v[88:91], a[12:15]
  v_exp_f32_e32 v44, v44
  v_mfma_f32_16x16x32_bf16 a[16:19], a[204:207], v[64:67], a[16:19]
  v_fma_f32 v45, v45, s35, -v15
  v_fma_f32 v46, v46, s35, -v15
  v_mfma_f32_16x16x32_bf16 a[20:23], a[204:207], v[72:75], a[20:23]
  v_exp_f32_e32 v45, v45
  v_mfma_f32_16x16x32_bf16 a[24:27], a[204:207], v[80:83], a[24:27]
  v_exp_f32_e32 v46, v46
  v_mfma_f32_16x16x32_bf16 a[28:31], a[204:207], v[88:91], a[28:31]
  v_fma_f32 v47, v47, s35, -v15
  v_add_f32_e32 v0, v0, v40
  v_mfma_f32_16x16x32_bf16 v[64:67], a[160:163], a[32:35], 0
  s_waitcnt lgkmcnt(2)
  v_exp_f32_e32 v47, v47
  v_mfma_f32_16x16x32_bf16 v[64:67], a[164:167], a[36:39], v[64:67]
  v_add_f32_e32 v0, v0, v41
  v_cvt_pk_bf16_f32 v40, v40, v41
  v_mfma_f32_16x16x32_bf16 v[64:67], a[168:171], a[40:43], v[64:67]
  v_add_f32_e32 v0, v0, v42
  v_add_f32_e32 v0, v0, v43
  v_mfma_f32_16x16x32_bf16 v[64:67], a[172:175], a[44:47], v[64:67]
  v_cvt_pk_bf16_f32 v41, v42, v43
  v_cvt_pk_bf16_f32 v42, v44, v45
  v_mfma_f32_16x16x32_bf16 v[64:67], a[176:179], a[128:131], v[64:67]
  s_waitcnt lgkmcnt(0)
  v_cvt_pk_bf16_f32 v43, v46, v47
  v_fma_f32 v48, v48, s35, -v16
  v_mfma_f32_16x16x32_bf16 v[64:67], a[180:183], a[132:135], v[64:67]
  v_exp_f32_e32 v48, v48
  v_mfma_f32_16x16x32_bf16 v[72:75], a[160:163], a[56:59], 0
  v_fma_f32 v49, v49, s35, -v16
  v_fma_f32 v50, v50, s35, -v16
  v_mfma_f32_16x16x32_bf16 v[72:75], a[164:167], a[60:63], v[72:75]
  ds_read_b128 a[184:187], v2 offset:43008
  v_fma_f32 v51, v51, s35, -v16
  v_mfma_f32_16x16x32_bf16 v[72:75], a[168:171], a[64:67], v[72:75]
  v_exp_f32_e32 v49, v49
  v_mfma_f32_16x16x32_bf16 v[72:75], a[172:175], a[68:71], v[72:75]
  ds_read_b128 a[188:191], v3 offset:43008
  v_fma_f32 v52, v52, s35, -v16
  v_mfma_f32_16x16x32_bf16 v[72:75], a[176:179], a[136:139], v[72:75]
  v_exp_f32_e32 v50, v50
  v_mfma_f32_16x16x32_bf16 v[72:75], a[180:183], a[140:143], v[72:75]
  ds_read_b128 a[192:195], v2 offset:43136
  v_fma_f32 v53, v53, s35, -v16
  v_mfma_f32_16x16x32_bf16 v[80:83], a[160:163], a[80:83], 0
  v_exp_f32_e32 v51, v51
  v_mfma_f32_16x16x32_bf16 v[80:83], a[164:167], a[84:87], v[80:83]
  ds_read_b128 a[196:199], v3 offset:43136
  v_fma_f32 v54, v54, s35, -v16
  v_mfma_f32_16x16x32_bf16 v[80:83], a[168:171], a[88:91], v[80:83]
  v_exp_f32_e32 v52, v52
  v_mfma_f32_16x16x32_bf16 v[80:83], a[172:175], a[92:95], v[80:83]
  ds_read_b128 a[200:203], v2 offset:43264
  v_fma_f32 v55, v55, s35, -v16
  v_mfma_f32_16x16x32_bf16 v[80:83], a[176:179], a[144:147], v[80:83]
  v_exp_f32_e32 v53, v53
  v_mfma_f32_16x16x32_bf16 v[80:83], a[180:183], a[148:151], v[80:83]
  ds_read_b128 a[204:207], v3 offset:43264
  v_add_f32_e32 v30, v30, v48
  v_mfma_f32_16x16x32_bf16 v[88:91], a[160:163], a[104:107], 0
  s_waitcnt vmcnt(12)
  s_barrier
  v_mfma_f32_16x16x32_bf16 v[88:91], a[164:167], a[108:111], v[88:91]
  s_add_u32 m0, s34, 24576
  v_exp_f32_e32 v54, v54
  v_mfma_f32_16x16x32_bf16 v[88:91], a[168:171], a[112:115], v[88:91]
  s_mov_b32 s32, 270336
  v_exp_f32_e32 v55, v55
  v_mfma_f32_16x16x32_bf16 v[88:91], a[172:175], a[116:119], v[88:91]
  buffer_load_dwordx4 v8, s[8:11], s32 offen nt lds
  v_mfma_f32_16x16x32_bf16 v[88:91], a[176:179], a[152:155], v[88:91]
  v_add_f32_e32 v30, v30, v49
  v_cvt_pk_bf16_f32 v48, v48, v49
  v_mfma_f32_16x16x32_bf16 v[88:91], a[180:183], a[156:159], v[88:91]
  s_waitcnt lgkmcnt(1)
  v_add_f32_e32 v30, v30, v50
  v_add_f32_e32 v30, v30, v51
  v_mfma_f32_16x16x32_bf16 v[68:71], a[184:187], a[32:35], 0
  v_cvt_pk_bf16_f32 v49, v50, v51
  v_cvt_pk_bf16_f32 v50, v52, v53
  v_mfma_f32_16x16x32_bf16 v[68:71], a[188:191], a[36:39], v[68:71]
  v_cvt_pk_bf16_f32 v51, v54, v55
  v_fma_f32 v56, v56, s35, -v17
  v_mfma_f32_16x16x32_bf16 v[68:71], a[192:195], a[40:43], v[68:71]
  v_exp_f32_e32 v56, v56
  v_mfma_f32_16x16x32_bf16 v[68:71], a[196:199], a[44:47], v[68:71]
  v_fma_f32 v57, v57, s35, -v17
  v_fma_f32 v58, v58, s35, -v17
  v_mfma_f32_16x16x32_bf16 v[68:71], a[200:203], a[128:131], v[68:71]
  s_waitcnt lgkmcnt(0)
  v_exp_f32_e32 v57, v57
  v_mfma_f32_16x16x32_bf16 v[68:71], a[204:207], a[132:135], v[68:71]
  v_exp_f32_e32 v58, v58
  v_mfma_f32_16x16x32_bf16 v[76:79], a[184:187], a[56:59], 0
  v_fma_f32 v59, v59, s35, -v17
  v_fma_f32 v60, v60, s35, -v17
  v_mfma_f32_16x16x32_bf16 v[76:79], a[188:191], a[60:63], v[76:79]
  v_exp_f32_e32 v59, v59
  v_mfma_f32_16x16x32_bf16 v[76:79], a[192:195], a[64:67], v[76:79]
  ds_read_b64_tr_b16 a[160:161], v4 offset:24576
  v_fma_f32 v61, v61, s35, -v17
  v_mfma_f32_16x16x32_bf16 v[76:79], a[196:199], a[68:71], v[76:79]
  buffer_load_dwordx4 v9, s[8:11], s32 offen offset:1024 nt lds
  v_mfma_f32_16x16x32_bf16 v[76:79], a[200:203], a[136:139], v[76:79]
  ds_read_b64_tr_b16 a[162:163], v4 offset:30720
  v_fma_f32 v62, v62, s35, -v17
  v_mfma_f32_16x16x32_bf16 v[76:79], a[204:207], a[140:143], v[76:79]
  v_exp_f32_e32 v60, v60
  v_mfma_f32_16x16x32_bf16 v[84:87], a[184:187], a[80:83], 0
  ds_read_b64_tr_b16 a[164:165], v5 offset:24576
  v_fma_f32 v63, v63, s35, -v17
  v_mfma_f32_16x16x32_bf16 v[84:87], a[188:191], a[84:87], v[84:87]
  v_exp_f32_e32 v61, v61
  v_mfma_f32_16x16x32_bf16 v[84:87], a[192:195], a[88:91], v[84:87]
  ds_read_b64_tr_b16 a[166:167], v5 offset:30720
  v_add_f32_e32 v31, v31, v56
  v_mfma_f32_16x16x32_bf16 v[84:87], a[196:199], a[92:95], v[84:87]
  buffer_store_dwordx4 a[220:223], v11, s[16:19], s81 offen offset:3072 nt
  v_mfma_f32_16x16x32_bf16 v[84:87], a[200:203], a[144:147], v[84:87]
  ds_read_b64_tr_b16 a[168:169], v6 offset:24576
  ds_read_b128 a[220:223], v13 offset:8064
  v_mfma_f32_16x16x32_bf16 v[84:87], a[204:207], a[148:151], v[84:87]
  v_exp_f32_e32 v62, v62
  v_mfma_f32_16x16x32_bf16 v[92:95], a[184:187], a[104:107], 0
  ds_read_b64_tr_b16 a[170:171], v6 offset:30720
  v_add_f32_e32 v31, v31, v57
  v_mfma_f32_16x16x32_bf16 v[92:95], a[188:191], a[108:111], v[92:95]
  v_exp_f32_e32 v63, v63
  v_mfma_f32_16x16x32_bf16 v[92:95], a[192:195], a[112:115], v[92:95]
  ds_read_b64_tr_b16 a[172:173], v7 offset:24576
  v_cvt_pk_bf16_f32 v56, v56, v57
  v_mfma_f32_16x16x32_bf16 v[92:95], a[196:199], a[116:119], v[92:95]
  buffer_load_dwordx4 v10, s[8:11], s32 offen offset:2048 nt lds
  v_mfma_f32_16x16x32_bf16 v[92:95], a[200:203], a[152:155], v[92:95]
  ds_read_b64_tr_b16 a[174:175], v7 offset:30720
  v_add_f32_e32 v31, v31, v58
  v_mfma_f32_16x16x32_bf16 v[92:95], a[204:207], a[156:159], v[92:95]
  v_add_f32_e32 v31, v31, v59
  v_cvt_pk_bf16_f32 v57, v58, v59
  v_mfma_f32_16x16x32_bf16 a[240:243], v[18:21], v[32:35], a[240:243]
  s_waitcnt lgkmcnt(5)
  ds_read_b64_tr_b16 a[176:177], v4 offset:24704
  v_cvt_pk_bf16_f32 v58, v60, v61
  v_mfma_f32_16x16x32_bf16 v[96:99], a[160:163], v[32:35], v[96:99]
  v_cvt_pk_bf16_f32 v59, v62, v63
  v_add_f32_e32 v0, v0, v44
  v_mfma_f32_16x16x32_bf16 v[100:103], a[160:163], v[40:43], v[100:103]
  ds_read_b64_tr_b16 a[178:179], v4 offset:30848
  v_add_f32_e32 v0, v0, v45
  v_mfma_f32_16x16x32_bf16 v[104:107], a[160:163], v[48:51], v[104:107]
  v_add_f32_e32 v0, v0, v46
  v_add_f32_e32 v0, v0, v47
  v_mfma_f32_16x16x32_bf16 v[108:111], a[160:163], v[56:59], v[108:111]
  ds_read_b64_tr_b16 a[180:181], v5 offset:24704
  v_add_f32_e32 v30, v30, v52
  v_mfma_f32_16x16x32_bf16 v[112:115], a[164:167], v[32:35], v[112:115]
  v_add_f32_e32 v30, v30, v53
  v_add_f32_e32 v30, v30, v54
  v_mfma_f32_16x16x32_bf16 v[116:119], a[164:167], v[40:43], v[116:119]
  ds_read_b64_tr_b16 a[182:183], v5 offset:30848
  v_add_f32_e32 v30, v30, v55
  v_mfma_f32_16x16x32_bf16 v[120:123], a[164:167], v[48:51], v[120:123]
  s_add_u32 m0, s34, 61440
  v_add_f32_e32 v31, v31, v60
  v_add_f32_e32 v31, v31, v61
  v_mfma_f32_16x16x32_bf16 v[124:127], a[164:167], v[56:59], v[124:127]
  s_waitcnt lgkmcnt(4)
  ds_read_b64_tr_b16 a[184:185], v6 offset:24704
  v_add_f32_e32 v31, v31, v62
  v_mfma_f32_16x16x32_bf16 v[128:131], a[168:171], v[32:35], v[128:131]
  s_mov_b32 s33, 258048
  v_add_f32_e32 v31, v31, v63
  v_fma_f32 v64, v64, s35, -v14
  v_mfma_f32_16x16x32_bf16 v[132:135], a[168:171], v[40:43], v[132:135]
  ds_read_b64_tr_b16 a[186:187], v6 offset:30848
  v_fma_f32 v65, v65, s35, -v14
  v_mfma_f32_16x16x32_bf16 v[136:139], a[168:171], v[48:51], v[136:139]
  buffer_load_dwordx4 v8, s[12:15], s33 offen nt lds
  v_mfma_f32_16x16x32_bf16 v[140:143], a[168:171], v[56:59], v[140:143]
  ds_read_b64_tr_b16 a[188:189], v7 offset:24704
  v_fma_f32 v66, v66, s35, -v14
  v_mfma_f32_16x16x32_bf16 v[144:147], a[172:175], v[32:35], v[144:147]
  v_exp_f32_e32 v64, v64
  v_mfma_f32_16x16x32_bf16 v[148:151], a[172:175], v[40:43], v[148:151]
  ds_read_b64_tr_b16 a[190:191], v7 offset:30848
  v_fma_f32 v67, v67, s35, -v14
  v_mfma_f32_16x16x32_bf16 v[152:155], a[172:175], v[48:51], v[152:155]
  v_exp_f32_e32 v65, v65
  v_mfma_f32_16x16x32_bf16 v[156:159], a[172:175], v[56:59], v[156:159]
  s_waitcnt lgkmcnt(4)
  ds_read_b64_tr_b16 a[192:193], v4 offset:24832
  v_fma_f32 v68, v68, s35, -v14
  v_mfma_f32_16x16x32_bf16 v[160:163], a[176:179], v[32:35], v[160:163]
  v_exp_f32_e32 v66, v66
  v_mfma_f32_16x16x32_bf16 v[164:167], a[176:179], v[40:43], v[164:167]
  ds_read_b64_tr_b16 a[194:195], v4 offset:30976
  v_fma_f32 v69, v69, s35, -v14
  v_mfma_f32_16x16x32_bf16 v[168:171], a[176:179], v[48:51], v[168:171]
  v_exp_f32_e32 v67, v67
  v_mfma_f32_16x16x32_bf16 v[172:175], a[176:179], v[56:59], v[172:175]
  ds_read_b64_tr_b16 a[196:197], v5 offset:24832
  v_fma_f32 v70, v70, s35, -v14
  v_mfma_f32_16x16x32_bf16 v[176:179], a[180:183], v[32:35], v[176:179]
  v_exp_f32_e32 v68, v68
  v_mfma_f32_16x16x32_bf16 v[180:183], a[180:183], v[40:43], v[180:183]
  ds_read_b64_tr_b16 a[198:199], v5 offset:30976
  v_fma_f32 v71, v71, s35, -v14
  v_mfma_f32_16x16x32_bf16 v[184:187], a[180:183], v[48:51], v[184:187]
  buffer_load_dwordx4 v9, s[12:15], s33 offen offset:1024 nt lds
  v_mfma_f32_16x16x32_bf16 v[188:191], a[180:183], v[56:59], v[188:191]
  s_waitcnt lgkmcnt(4)
  ds_read_b64_tr_b16 a[200:201], v6 offset:24832
  v_cvt_pk_bf16_f32 v64, v64, v65
  v_mfma_f32_16x16x32_bf16 v[192:195], a[184:187], v[32:35], v[192:195]
  v_exp_f32_e32 v69, v69
  v_mfma_f32_16x16x32_bf16 v[196:199], a[184:187], v[40:43], v[196:199]
  ds_read_b64_tr_b16 a[202:203], v6 offset:30976
  v_cvt_pk_bf16_f32 v65, v66, v67
  v_mfma_f32_16x16x32_bf16 v[200:203], a[184:187], v[48:51], v[200:203]
  v_exp_f32_e32 v70, v70
  v_mfma_f32_16x16x32_bf16 v[204:207], a[184:187], v[56:59], v[204:207]
  ds_read_b64_tr_b16 a[204:205], v7 offset:24832
  v_cvt_pk_bf16_f32 v66, v68, v69
  v_mfma_f32_16x16x32_bf16 v[208:211], a[188:191], v[32:35], v[208:211]
  v_exp_f32_e32 v71, v71
  v_mfma_f32_16x16x32_bf16 v[212:215], a[188:191], v[40:43], v[212:215]
  ds_read_b64_tr_b16 a[206:207], v7 offset:30976
  v_cvt_pk_bf16_f32 v67, v70, v71
  v_mfma_f32_16x16x32_bf16 v[216:219], a[188:191], v[48:51], v[216:219]
  v_fma_f32 v72, v72, s35, -v15
  v_fma_f32 v73, v73, s35, -v15
  v_mfma_f32_16x16x32_bf16 v[220:223], a[188:191], v[56:59], v[220:223]
  s_waitcnt lgkmcnt(4)
  ds_read_b128 a[160:163], v2 offset:0
  v_fma_f32 v74, v74, s35, -v15
  v_mfma_f32_16x16x32_bf16 v[224:227], a[192:195], v[32:35], v[224:227]
  v_exp_f32_e32 v72, v72
  v_mfma_f32_16x16x32_bf16 v[228:231], a[192:195], v[40:43], v[228:231]
  ds_read_b128 a[164:167], v3 offset:0
  v_fma_f32 v75, v75, s35, -v15
  v_mfma_f32_16x16x32_bf16 v[232:235], a[192:195], v[48:51], v[232:235]
  buffer_load_dwordx4 v10, s[12:15], s33 offen offset:2048 nt lds
  v_mfma_f32_16x16x32_bf16 v[236:239], a[192:195], v[56:59], v[236:239]
  ds_read_b128 a[168:171], v2 offset:128
  v_fma_f32 v76, v76, s35, -v15
  v_mfma_f32_16x16x32_bf16 v[240:243], a[196:199], v[32:35], v[240:243]
  v_exp_f32_e32 v73, v73
  v_mfma_f32_16x16x32_bf16 v[244:247], a[196:199], v[40:43], v[244:247]
  ds_read_b128 a[172:175], v3 offset:128
  v_fma_f32 v77, v77, s35, -v15
  v_mfma_f32_16x16x32_bf16 v[248:251], a[196:199], v[48:51], v[248:251]
  buffer_store_dwordx4 a[224:227], v11, s[16:19], s82 offen nt
  v_mfma_f32_16x16x32_bf16 v[252:255], a[196:199], v[56:59], v[252:255]
  s_waitcnt lgkmcnt(3)
  ds_read_b128 a[176:179], v2 offset:256
  ds_read_b128 a[224:227], v13 offset:9216
  v_mfma_f32_16x16x32_bf16 a[0:3], a[200:203], v[32:35], a[0:3]
  v_exp_f32_e32 v74, v74
  v_mfma_f32_16x16x32_bf16 a[4:7], a[200:203], v[40:43], a[4:7]
  ds_read_b128 a[180:183], v3 offset:256
  v_fma_f32 v78, v78, s35, -v15
  v_mfma_f32_16x16x32_bf16 a[8:11], a[200:203], v[48:51], a[8:11]
  v_exp_f32_e32 v75, v75
  v_mfma_f32_16x16x32_bf16 a[12:15], a[200:203], v[56:59], a[12:15]
  v_exp_f32_e32 v76, v76
  v_mfma_f32_16x16x32_bf16 a[16:19], a[204:207], v[32:35], a[16:19]
  v_exp_f32_e32 v77, v77
  v_mfma_f32_16x16x32_bf16 a[20:23], a[204:207], v[40:43], a[20:23]
  v_exp_f32_e32 v78, v78
  v_mfma_f32_16x16x32_bf16 a[24:27], a[204:207], v[48:51], a[24:27]
  v_fma_f32 v79, v79, s35, -v15
  v_add_f32_e32 v0, v0, v72
  v_mfma_f32_16x16x32_bf16 a[28:31], a[204:207], v[56:59], a[28:31]
  v_exp_f32_e32 v79, v79
  v_mfma_f32_16x16x32_bf16 v[32:35], a[160:163], a[32:35], 0
  s_waitcnt lgkmcnt(2)
  v_add_f32_e32 v0, v0, v73
  v_cvt_pk_bf16_f32 v72, v72, v73
  v_mfma_f32_16x16x32_bf16 v[32:35], a[164:167], a[36:39], v[32:35]
  v_add_f32_e32 v0, v0, v74
  v_add_f32_e32 v0, v0, v75
  v_mfma_f32_16x16x32_bf16 v[32:35], a[168:171], a[40:43], v[32:35]
  v_cvt_pk_bf16_f32 v73, v74, v75
  v_cvt_pk_bf16_f32 v74, v76, v77
  v_mfma_f32_16x16x32_bf16 v[32:35], a[172:175], a[44:47], v[32:35]
  v_cvt_pk_bf16_f32 v75, v78, v79
  v_fma_f32 v80, v80, s35, -v16
  v_mfma_f32_16x16x32_bf16 v[32:35], a[176:179], a[128:131], v[32:35]
  s_waitcnt lgkmcnt(0)
  v_exp_f32_e32 v80, v80
  v_mfma_f32_16x16x32_bf16 v[32:35], a[180:183], a[132:135], v[32:35]
  v_fma_f32 v81, v81, s35, -v16
  v_fma_f32 v82, v82, s35, -v16
  v_mfma_f32_16x16x32_bf16 v[40:43], a[160:163], a[56:59], 0
  v_exp_f32_e32 v81, v81
  v_mfma_f32_16x16x32_bf16 v[40:43], a[164:167], a[60:63], v[40:43]
  ds_read_b128 a[184:187], v2 offset:6144
  v_fma_f32 v83, v83, s35, -v16
  v_mfma_f32_16x16x32_bf16 v[40:43], a[168:171], a[64:67], v[40:43]
  v_exp_f32_e32 v82, v82
  v_mfma_f32_16x16x32_bf16 v[40:43], a[172:175], a[68:71], v[40:43]
  ds_read_b128 a[188:191], v3 offset:6144
  v_fma_f32 v84, v84, s35, -v16
  v_mfma_f32_16x16x32_bf16 v[40:43], a[176:179], a[136:139], v[40:43]
  v_exp_f32_e32 v83, v83
  v_mfma_f32_16x16x32_bf16 v[40:43], a[180:183], a[140:143], v[40:43]
  ds_read_b128 a[192:195], v2 offset:6272
  v_fma_f32 v85, v85, s35, -v16
  v_mfma_f32_16x16x32_bf16 v[48:51], a[160:163], a[80:83], 0
  v_exp_f32_e32 v84, v84
  v_mfma_f32_16x16x32_bf16 v[48:51], a[164:167], a[84:87], v[48:51]
  ds_read_b128 a[196:199], v3 offset:6272
  v_fma_f32 v86, v86, s35, -v16
  v_mfma_f32_16x16x32_bf16 v[48:51], a[168:171], a[88:91], v[48:51]
  v_exp_f32_e32 v85, v85
  v_mfma_f32_16x16x32_bf16 v[48:51], a[172:175], a[92:95], v[48:51]
  ds_read_b128 a[200:203], v2 offset:6400
  v_fma_f32 v87, v87, s35, -v16
  v_mfma_f32_16x16x32_bf16 v[48:51], a[176:179], a[144:147], v[48:51]
  v_exp_f32_e32 v86, v86
  v_mfma_f32_16x16x32_bf16 v[48:51], a[180:183], a[148:151], v[48:51]
  ds_read_b128 a[204:207], v3 offset:6400
  v_add_f32_e32 v30, v30, v80
  v_mfma_f32_16x16x32_bf16 v[56:59], a[160:163], a[104:107], 0
  s_waitcnt vmcnt(12)
  s_barrier
  v_mfma_f32_16x16x32_bf16 v[56:59], a[164:167], a[108:111], v[56:59]
  s_add_u32 m0, s34, 36864
  v_exp_f32_e32 v87, v87
  v_mfma_f32_16x16x32_bf16 v[56:59], a[168:171], a[112:115], v[56:59]
  s_mov_b32 s32, 282624
  v_add_f32_e32 v30, v30, v81
  v_cvt_pk_bf16_f32 v80, v80, v81
L_hop9:
  s_cbranch_execz L_hop13
  v_mfma_f32_16x16x32_bf16 v[56:59], a[172:175], a[116:119], v[56:59]
  buffer_load_dwordx4 v8, s[8:11], s32 offen nt lds
  v_mfma_f32_16x16x32_bf16 v[56:59], a[176:179], a[152:155], v[56:59]
  v_add_f32_e32 v30, v30, v82
  v_add_f32_e32 v30, v30, v83
  v_mfma_f32_16x16x32_bf16 v[56:59], a[180:183], a[156:159], v[56:59]
  s_waitcnt lgkmcnt(1)
  v_cvt_pk_bf16_f32 v81, v82, v83
  v_cvt_pk_bf16_f32 v82, v84, v85
  v_mfma_f32_16x16x32_bf16 v[36:39], a[184:187], a[32:35], 0
  v_cvt_pk_bf16_f32 v83, v86, v87
  v_fma_f32 v88, v88, s35, -v17
  v_mfma_f32_16x16x32_bf16 v[36:39], a[188:191], a[36:39], v[36:39]
  v_exp_f32_e32 v88, v88
  v_mfma_f32_16x16x32_bf16 v[36:39], a[192:195], a[40:43], v[36:39]
  v_fma_f32 v89, v89, s35, -v17
  v_fma_f32 v90, v90, s35, -v17
  v_mfma_f32_16x16x32_bf16 v[36:39], a[196:199], a[44:47], v[36:39]
  v_exp_f32_e32 v89, v89
  v_mfma_f32_16x16x32_bf16 v[36:39], a[200:203], a[128:131], v[36:39]
  s_waitcnt lgkmcnt(0)
  v_exp_f32_e32 v90, v90
  v_mfma_f32_16x16x32_bf16 v[36:39], a[204:207], a[132:135], v[36:39]
  v_fma_f32 v91, v91, s35, -v17
  v_fma_f32 v92, v92, s35, -v17
  v_mfma_f32_16x16x32_bf16 v[44:47], a[184:187], a[56:59], 0
  v_exp_f32_e32 v91, v91
  v_mfma_f32_16x16x32_bf16 v[44:47], a[188:191], a[60:63], v[44:47]
  v_exp_f32_e32 v92, v92
  v_mfma_f32_16x16x32_bf16 v[44:47], a[192:195], a[64:67], v[44:47]
  ds_read_b64_tr_b16 a[160:161], v4 offset:36864
  v_fma_f32 v93, v93, s35, -v17
  v_mfma_f32_16x16x32_bf16 v[44:47], a[196:199], a[68:71], v[44:47]
  buffer_load_dwordx4 v9, s[8:11], s32 offen offset:1024 nt lds
  v_mfma_f32_16x16x32_bf16 v[44:47], a[200:203], a[136:139], v[44:47]
  ds_read_b64_tr_b16 a[162:163], v4 offset:43008
  v_fma_f32 v94, v94, s35, -v17
  v_mfma_f32_16x16x32_bf16 v[44:47], a[204:207], a[140:143], v[44:47]
  v_exp_f32_e32 v93, v93
  v_mfma_f32_16x16x32_bf16 v[52:55], a[184:187], a[80:83], 0
  ds_read_b64_tr_b16 a[164:165], v5 offset:36864
  v_fma_f32 v95, v95, s35, -v17
  v_mfma_f32_16x16x32_bf16 v[52:55], a[188:191], a[84:87], v[52:55]
  v_exp_f32_e32 v94, v94
  v_mfma_f32_16x16x32_bf16 v[52:55], a[192:195], a[88:91], v[52:55]
  ds_read_b64_tr_b16 a[166:167], v5 offset:43008
  v_add_f32_e32 v31, v31, v88
  v_mfma_f32_16x16x32_bf16 v[52:55], a[196:199], a[92:95], v[52:55]
  buffer_store_dwordx4 a[228:231], v11, s[16:19], s82 offen offset:3072 nt
  v_mfma_f32_16x16x32_bf16 v[52:55], a[200:203], a[144:147], v[52:55]
  ds_read_b64_tr_b16 a[168:169], v6 offset:36864
  ds_read_b128 a[228:231], v13 offset:10368
  v_mfma_f32_16x16x32_bf16 v[52:55], a[204:207], a[148:151], v[52:55]
  v_exp_f32_e32 v95, v95
  v_mfma_f32_16x16x32_bf16 v[60:63], a[184:187], a[104:107], 0
  ds_read_b64_tr_b16 a[170:171], v6 offset:43008
  v_add_f32_e32 v31, v31, v89
  v_mfma_f32_16x16x32_bf16 v[60:63], a[188:191], a[108:111], v[60:63]
  v_cvt_pk_bf16_f32 v88, v88, v89
  v_add_f32_e32 v31, v31, v90
  v_mfma_f32_16x16x32_bf16 v[60:63], a[192:195], a[112:115], v[60:63]
  ds_read_b64_tr_b16 a[172:173], v7 offset:36864
  v_add_f32_e32 v31, v31, v91
  v_mfma_f32_16x16x32_bf16 v[60:63], a[196:199], a[116:119], v[60:63]
  buffer_load_dwordx4 v10, s[8:11], s32 offen offset:2048 nt lds
  v_mfma_f32_16x16x32_bf16 v[60:63], a[200:203], a[152:155], v[60:63]
  ds_read_b64_tr_b16 a[174:175], v7 offset:43008
  v_cvt_pk_bf16_f32 v89, v90, v91
  v_mfma_f32_16x16x32_bf16 v[60:63], a[204:207], a[156:159], v[60:63]
  v_cvt_pk_bf16_f32 v90, v92, v93
  v_cvt_pk_bf16_f32 v91, v94, v95
  v_mfma_f32_16x16x32_bf16 a[240:243], v[18:21], v[64:67], a[240:243]
  s_waitcnt lgkmcnt(5)
  ds_read_b64_tr_b16 a[176:177], v4 offset:36992
  v_add_f32_e32 v0, v0, v76
  v_mfma_f32_16x16x32_bf16 v[96:99], a[160:163], v[64:67], v[96:99]
  v_add_f32_e32 v0, v0, v77
  v_add_f32_e32 v0, v0, v78
  v_mfma_f32_16x16x32_bf16 v[100:103], a[160:163], v[72:75], v[100:103]
  ds_read_b64_tr_b16 a[178:179], v4 offset:43136
  v_add_f32_e32 v0, v0, v79
  v_mfma_f32_16x16x32_bf16 v[104:107], a[160:163], v[80:83], v[104:107]
  v_add_f32_e32 v30, v30, v84
  v_add_f32_e32 v30, v30, v85
  v_mfma_f32_16x16x32_bf16 v[108:111], a[160:163], v[88:91], v[108:111]
  ds_read_b64_tr_b16 a[180:181], v5 offset:36992
  v_add_f32_e32 v30, v30, v86
  v_mfma_f32_16x16x32_bf16 v[112:115], a[164:167], v[64:67], v[112:115]
  v_add_f32_e32 v30, v30, v87
  v_add_f32_e32 v31, v31, v92
  v_mfma_f32_16x16x32_bf16 v[116:119], a[164:167], v[72:75], v[116:119]
  ds_read_b64_tr_b16 a[182:183], v5 offset:43136
  v_add_f32_e32 v31, v31, v93
  v_mfma_f32_16x16x32_bf16 v[120:123], a[164:167], v[80:83], v[120:123]
  s_add_u32 m0, s34, 73728
  v_add_f32_e32 v31, v31, v94
  v_add_f32_e32 v31, v31, v95
  v_mfma_f32_16x16x32_bf16 v[124:127], a[164:167], v[88:91], v[124:127]
  s_waitcnt lgkmcnt(4)
  ds_read_b64_tr_b16 a[184:185], v6 offset:36992
  v_fma_f32 v32, v32, s35, -v14
  v_mfma_f32_16x16x32_bf16 v[128:131], a[168:171], v[64:67], v[128:131]
  s_mov_b32 s33, 270336
  v_exp_f32_e32 v32, v32
  v_mfma_f32_16x16x32_bf16 v[132:135], a[168:171], v[72:75], v[132:135]
  ds_read_b64_tr_b16 a[186:187], v6 offset:43136
  v_fma_f32 v33, v33, s35, -v14
  v_mfma_f32_16x16x32_bf16 v[136:139], a[168:171], v[80:83], v[136:139]
  buffer_load_dwordx4 v8, s[12:15], s33 offen nt lds
  v_mfma_f32_16x16x32_bf16 v[140:143], a[168:171], v[88:91], v[140:143]
  ds_read_b64_tr_b16 a[188:189], v7 offset:36992
  v_fma_f32 v34, v34, s35, -v14
  v_mfma_f32_16x16x32_bf16 v[144:147], a[172:175], v[64:67], v[144:147]
  v_exp_f32_e32 v33, v33
  v_mfma_f32_16x16x32_bf16 v[148:151], a[172:175], v[72:75], v[148:151]
  ds_read_b64_tr_b16 a[190:191], v7 offset:43136
  v_fma_f32 v35, v35, s35, -v14
  v_mfma_f32_16x16x32_bf16 v[152:155], a[172:175], v[80:83], v[152:155]
  v_exp_f32_e32 v34, v34
  v_mfma_f32_16x16x32_bf16 v[156:159], a[172:175], v[88:91], v[156:159]
  s_waitcnt lgkmcnt(4)
  ds_read_b64_tr_b16 a[192:193], v4 offset:37120
  v_fma_f32 v36, v36, s35, -v14
  v_mfma_f32_16x16x32_bf16 v[160:163], a[176:179], v[64:67], v[160:163]
  v_exp_f32_e32 v35, v35
  v_mfma_f32_16x16x32_bf16 v[164:167], a[176:179], v[72:75], v[164:167]
  ds_read_b64_tr_b16 a[194:195], v4 offset:43264
  v_fma_f32 v37, v37, s35, -v14
  v_mfma_f32_16x16x32_bf16 v[168:171], a[176:179], v[80:83], v[168:171]
  v_exp_f32_e32 v36, v36
  v_mfma_f32_16x16x32_bf16 v[172:175], a[176:179], v[88:91], v[172:175]
  ds_read_b64_tr_b16 a[196:197], v5 offset:37120
  v_fma_f32 v38, v38, s35, -v14
  v_mfma_f32_16x16x32_bf16 v[176:179], a[180:183], v[64:67], v[176:179]
  v_exp_f32_e32 v37, v37
  v_mfma_f32_16x16x32_bf16 v[180:183], a[180:183], v[72:75], v[180:183]
  ds_read_b64_tr_b16 a[198:199], v5 offset:43264
  v_fma_f32 v39, v39, s35, -v14
  v_mfma_f32_16x16x32_bf16 v[184:187], a[180:183], v[80:83], v[184:187]
  buffer_load_dwordx4 v9, s[12:15], s33 offen offset:1024 nt lds
  v_mfma_f32_16x16x32_bf16 v[188:191], a[180:183], v[88:91], v[188:191]
  s_waitcnt lgkmcnt(4)
  ds_read_b64_tr_b16 a[200:201], v6 offset:37120
  v_cvt_pk_bf16_f32 v32, v32, v33
  v_mfma_f32_16x16x32_bf16 v[192:195], a[184:187], v[64:67], v[192:195]
  v_exp_f32_e32 v38, v38
  v_mfma_f32_16x16x32_bf16 v[196:199], a[184:187], v[72:75], v[196:199]
  ds_read_b64_tr_b16 a[202:203], v6 offset:43264
  v_cvt_pk_bf16_f32 v33, v34, v35
  v_mfma_f32_16x16x32_bf16 v[200:203], a[184:187], v[80:83], v[200:203]
  v_exp_f32_e32 v39, v39
  v_mfma_f32_16x16x32_bf16 v[204:207], a[184:187], v[88:91], v[204:207]
  ds_read_b64_tr_b16 a[204:205], v7 offset:37120
  v_cvt_pk_bf16_f32 v34, v36, v37
  v_mfma_f32_16x16x32_bf16 v[208:211], a[188:191], v[64:67], v[208:211]
  v_cvt_pk_bf16_f32 v35, v38, v39
  v_fma_f32 v40, v40, s35, -v15
  v_mfma_f32_16x16x32_bf16 v[212:215], a[188:191], v[72:75], v[212:215]
  ds_read_b64_tr_b16 a[206:207], v7 offset:43264
  v_fma_f32 v41, v41, s35, -v15
  v_mfma_f32_16x16x32_bf16 v[216:219], a[188:191], v[80:83], v[216:219]
  v_exp_f32_e32 v40, v40
  v_mfma_f32_16x16x32_bf16 v[220:223], a[188:191], v[88:91], v[220:223]
  s_waitcnt lgkmcnt(4)
  ds_read_b128 a[160:163], v2 offset:12288
  v_fma_f32 v42, v42, s35, -v15
  v_mfma_f32_16x16x32_bf16 v[224:227], a[192:195], v[64:67], v[224:227]
  v_exp_f32_e32 v41, v41
  v_mfma_f32_16x16x32_bf16 v[228:231], a[192:195], v[72:75], v[228:231]
  ds_read_b128 a[164:167], v3 offset:12288
  v_fma_f32 v43, v43, s35, -v15
  v_mfma_f32_16x16x32_bf16 v[232:235], a[192:195], v[80:83], v[232:235]
  buffer_load_dwordx4 v10, s[12:15], s33 offen offset:2048 nt lds
  v_mfma_f32_16x16x32_bf16 v[236:239], a[192:195], v[88:91], v[236:239]
  ds_read_b128 a[168:171], v2 offset:12416
  v_fma_f32 v44, v44, s35, -v15
  v_mfma_f32_16x16x32_bf16 v[240:243], a[196:199], v[64:67], v[240:243]
  v_exp_f32_e32 v42, v42
  v_mfma_f32_16x16x32_bf16 v[244:247], a[196:199], v[72:75], v[244:247]
  ds_read_b128 a[172:175], v3 offset:12416
  v_fma_f32 v45, v45, s35, -v15
  v_mfma_f32_16x16x32_bf16 v[248:251], a[196:199], v[80:83], v[248:251]
  buffer_store_dwordx4 a[232:235], v11, s[16:19], s83 offen nt
  v_mfma_f32_16x16x32_bf16 v[252:255], a[196:199], v[88:91], v[252:255]
  s_waitcnt lgkmcnt(3)
  ds_read_b128 a[176:179], v2 offset:12544
  ds_read_b128 a[232:235], v13 offset:11520
  v_mfma_f32_16x16x32_bf16 a[0:3], a[200:203], v[64:67], a[0:3]
  v_exp_f32_e32 v43, v43
  v_mfma_f32_16x16x32_bf16 a[4:7], a[200:203], v[72:75], a[4:7]
  ds_read_b128 a[180:183], v3 offset:12544
  v_fma_f32 v46, v46, s35, -v15
  v_mfma_f32_16x16x32_bf16 a[8:11], a[200:203], v[80:83], a[8:11]
  v_exp_f32_e32 v44, v44
  v_mfma_f32_16x16x32_bf16 a[12:15], a[200:203], v[88:91], a[12:15]
  v_exp_f32_e32 v45, v45
  v_mfma_f32_16x16x32_bf16 a[16:19], a[204:207], v[64:67], a[16:19]
  v_exp_f32_e32 v46, v46
  v_mfma_f32_16x16x32_bf16 a[20:23], a[204:207], v[72:75], a[20:23]
  v_fma_f32 v47, v47, s35, -v15
  v_add_f32_e32 v0, v0, v40
  v_mfma_f32_16x16x32_bf16 a[24:27], a[204:207], v[80:83], a[24:27]
  v_exp_f32_e32 v47, v47
  v_mfma_f32_16x16x32_bf16 a[28:31], a[204:207], v[88:91], a[28:31]
  v_add_f32_e32 v0, v0, v41
  v_cvt_pk_bf16_f32 v40, v40, v41
  v_mfma_f32_16x16x32_bf16 v[64:67], a[160:163], a[32:35], 0
  s_waitcnt lgkmcnt(2)
  v_add_f32_e32 v0, v0, v42
  v_add_f32_e32 v0, v0, v43
  v_mfma_f32_16x16x32_bf16 v[64:67], a[164:167], a[36:39], v[64:67]
  v_cvt_pk_bf16_f32 v41, v42, v43
  v_cvt_pk_bf16_f32 v42, v44, v45
  v_mfma_f32_16x16x32_bf16 v[64:67], a[168:171], a[40:43], v[64:67]
  v_cvt_pk_bf16_f32 v43, v46, v47
  v_fma_f32 v48, v48, s35, -v16
  v_mfma_f32_16x16x32_bf16 v[64:67], a[172:175], a[44:47], v[64:67]
  v_exp_f32_e32 v48, v48
  v_mfma_f32_16x16x32_bf16 v[64:67], a[176:179], a[128:131], v[64:67]
  s_waitcnt lgkmcnt(0)
  v_fma_f32 v49, v49, s35, -v16
  v_fma_f32 v50, v50, s35, -v16
  v_mfma_f32_16x16x32_bf16 v[64:67], a[180:183], a[132:135], v[64:67]
  v_exp_f32_e32 v49, v49
  v_mfma_f32_16x16x32_bf16 v[72:75], a[160:163], a[56:59], 0
  v_exp_f32_e32 v50, v50
  v_mfma_f32_16x16x32_bf16 v[72:75], a[164:167], a[60:63], v[72:75]
  ds_read_b128 a[184:187], v2 offset:18432
  v_fma_f32 v51, v51, s35, -v16
  v_mfma_f32_16x16x32_bf16 v[72:75], a[168:171], a[64:67], v[72:75]
  v_exp_f32_e32 v51, v51
  v_mfma_f32_16x16x32_bf16 v[72:75], a[172:175], a[68:71], v[72:75]
  ds_read_b128 a[188:191], v3 offset:18432
  v_fma_f32 v52, v52, s35, -v16
  v_mfma_f32_16x16x32_bf16 v[72:75], a[176:179], a[136:139], v[72:75]
  v_exp_f32_e32 v52, v52
  v_mfma_f32_16x16x32_bf16 v[72:75], a[180:183], a[140:143], v[72:75]
  ds_read_b128 a[192:195], v2 offset:18560
  v_fma_f32 v53, v53, s35, -v16
  v_mfma_f32_16x16x32_bf16 v[80:83], a[160:163], a[80:83], 0
  v_exp_f32_e32 v53, v53
  v_mfma_f32_16x16x32_bf16 v[80:83], a[164:167], a[84:87], v[80:83]
  ds_read_b128 a[196:199], v3 offset:18560
  v_fma_f32 v54, v54, s35, -v16
  v_mfma_f32_16x16x32_bf16 v[80:83], a[168:171], a[88:91], v[80:83]
  v_exp_f32_e32 v54, v54
  v_mfma_f32_16x16x32_bf16 v[80:83], a[172:175], a[92:95], v[80:83]
  ds_read_b128 a[200:203], v2 offset:18688
  v_fma_f32 v55, v55, s35, -v16
  v_mfma_f32_16x16x32_bf16 v[80:83], a[176:179], a[144:147], v[80:83]
  v_exp_f32_e32 v55, v55
  v_mfma_f32_16x16x32_bf16 v[80:83], a[180:183], a[148:151], v[80:83]
  ds_read_b128 a[204:207], v3 offset:18688
  v_add_f32_e32 v30, v30, v48
  v_mfma_f32_16x16x32_bf16 v[88:91], a[160:163], a[104:107], 0
  s_waitcnt vmcnt(12)
  s_barrier
  v_mfma_f32_16x16x32_bf16 v[88:91], a[164:167], a[108:111], v[88:91]
  s_add_u32 m0, s34, 0
  v_add_f32_e32 v30, v30, v49
  v_cvt_pk_bf16_f32 v48, v48, v49
  v_mfma_f32_16x16x32_bf16 v[88:91], a[168:171], a[112:115], v[88:91]
  s_mov_b32 s32, 294912
  v_add_f32_e32 v30, v30, v50
  v_add_f32_e32 v30, v30, v51
  v_mfma_f32_16x16x32_bf16 v[88:91], a[172:175], a[116:119], v[88:91]
  buffer_load_dwordx4 v8, s[8:11], s32 offen nt lds
  v_mfma_f32_16x16x32_bf16 v[88:91], a[176:179], a[152:155], v[88:91]
  v_cvt_pk_bf16_f32 v49, v50, v51
  v_cvt_pk_bf16_f32 v50, v52, v53
  v_mfma_f32_16x16x32_bf16 v[88:91], a[180:183], a[156:159], v[88:91]
  s_waitcnt lgkmcnt(1)
  v_cvt_pk_bf16_f32 v51, v54, v55
  v_fma_f32 v56, v56, s35, -v17
  v_mfma_f32_16x16x32_bf16 v[68:71], a[184:187], a[32:35], 0
  v_exp_f32_e32 v56, v56
  v_mfma_f32_16x16x32_bf16 v[68:71], a[188:191], a[36:39], v[68:71]
  v_fma_f32 v57, v57, s35, -v17
  v_fma_f32 v58, v58, s35, -v17
  v_mfma_f32_16x16x32_bf16 v[68:71], a[192:195], a[40:43], v[68:71]
  v_exp_f32_e32 v57, v57
  v_mfma_f32_16x16x32_bf16 v[68:71], a[196:199], a[44:47], v[68:71]
  v_exp_f32_e32 v58, v58
  v_mfma_f32_16x16x32_bf16 v[68:71], a[200:203], a[128:131], v[68:71]
  s_waitcnt lgkmcnt(0)
  v_fma_f32 v59, v59, s35, -v17
  v_fma_f32 v60, v60, s35, -v17
  v_mfma_f32_16x16x32_bf16 v[68:71], a[204:207], a[132:135], v[68:71]
  v_exp_f32_e32 v59, v59
  v_mfma_f32_16x16x32_bf16 v[76:79], a[184:187], a[56:59], 0
  v_exp_f32_e32 v60, v60
  v_mfma_f32_16x16x32_bf16 v[76:79], a[188:191], a[60:63], v[76:79]
  v_fma_f32 v61, v61, s35, -v17
  v_fma_f32 v62, v62, s35, -v17
  v_mfma_f32_16x16x32_bf16 v[76:79], a[192:195], a[64:67], v[76:79]
  ds_read_b64_tr_b16 a[160:161], v4 offset:0
  v_fma_f32 v63, v63, s35, -v17
  v_mfma_f32_16x16x32_bf16 v[76:79], a[196:199], a[68:71], v[76:79]
  buffer_load_dwordx4 v9, s[8:11], s32 offen offset:1024 nt lds
  v_mfma_f32_16x16x32_bf16 v[76:79], a[200:203], a[136:139], v[76:79]
  ds_read_b64_tr_b16 a[162:163], v4 offset:6144
  v_add_f32_e32 v31, v31, v56
  v_mfma_f32_16x16x32_bf16 v[76:79], a[204:207], a[140:143], v[76:79]
  v_exp_f32_e32 v61, v61
  v_mfma_f32_16x16x32_bf16 v[84:87], a[184:187], a[80:83], 0
  ds_read_b64_tr_b16 a[164:165], v5 offset:0
  v_add_f32_e32 v31, v31, v57
  v_mfma_f32_16x16x32_bf16 v[84:87], a[188:191], a[84:87], v[84:87]
  v_exp_f32_e32 v62, v62
  v_mfma_f32_16x16x32_bf16 v[84:87], a[192:195], a[88:91], v[84:87]
  ds_read_b64_tr_b16 a[166:167], v5 offset:6144
  v_cvt_pk_bf16_f32 v56, v56, v57
  v_mfma_f32_16x16x32_bf16 v[84:87], a[196:199], a[92:95], v[84:87]
  buffer_store_dwordx4 a[236:239], v11, s[16:19], s83 offen offset:3072 nt
  v_mfma_f32_16x16x32_bf16 v[84:87], a[200:203], a[144:147], v[84:87]
  ds_read_b64_tr_b16 a[168:169], v6 offset:0
  ds_read_b128 a[236:239], v13 offset:12672
  v_mfma_f32_16x16x32_bf16 v[84:87], a[204:207], a[148:151], v[84:87]
  v_exp_f32_e32 v63, v63
  v_mfma_f32_16x16x32_bf16 v[92:95], a[184:187], a[104:107], 0
  ds_read_b64_tr_b16 a[170:171], v6 offset:6144
  v_add_f32_e32 v31, v31, v58
  v_mfma_f32_16x16x32_bf16 v[92:95], a[188:191], a[108:111], v[92:95]
  v_add_f32_e32 v31, v31, v59
  v_cvt_pk_bf16_f32 v57, v58, v59
  v_mfma_f32_16x16x32_bf16 v[92:95], a[192:195], a[112:115], v[92:95]
  ds_read_b64_tr_b16 a[172:173], v7 offset:0
  v_cvt_pk_bf16_f32 v58, v60, v61
  v_mfma_f32_16x16x32_bf16 v[92:95], a[196:199], a[116:119], v[92:95]
  buffer_load_dwordx4 v10, s[8:11], s32 offen offset:2048 nt lds
  v_mfma_f32_16x16x32_bf16 v[92:95], a[200:203], a[152:155], v[92:95]
  ds_read_b64_tr_b16 a[174:175], v7 offset:6144
  v_cvt_pk_bf16_f32 v59, v62, v63
  v_mfma_f32_16x16x32_bf16 v[92:95], a[204:207], a[156:159], v[92:95]
  v_add_f32_e32 v0, v0, v44
  v_add_f32_e32 v0, v0, v45
  v_mfma_f32_16x16x32_bf16 a[240:243], v[18:21], v[32:35], a[240:243]
  s_waitcnt lgkmcnt(5)
  ds_read_b64_tr_b16 a[176:177], v4 offset:128
  v_add_f32_e32 v0, v0, v46
  v_mfma_f32_16x16x32_bf16 v[96:99], a[160:163], v[32:35], v[96:99]
  v_add_f32_e32 v0, v0, v47
  v_add_f32_e32 v30, v30, v52
  v_mfma_f32_16x16x32_bf16 v[100:103], a[160:163], v[40:43], v[100:103]
  ds_read_b64_tr_b16 a[178:179], v4 offset:6272
  v_add_f32_e32 v30, v30, v53
  v_mfma_f32_16x16x32_bf16 v[104:107], a[160:163], v[48:51], v[104:107]
  v_add_f32_e32 v30, v30, v54
  v_add_f32_e32 v30, v30, v55
  v_mfma_f32_16x16x32_bf16 v[108:111], a[160:163], v[56:59], v[108:111]
  ds_read_b64_tr_b16 a[180:181], v5 offset:128
  v_add_f32_e32 v31, v31, v60
  v_mfma_f32_16x16x32_bf16 v[112:115], a[164:167], v[32:35], v[112:115]
  v_add_f32_e32 v31, v31, v61
  v_add_f32_e32 v31, v31, v62
  v_mfma_f32_16x16x32_bf16 v[116:119], a[164:167], v[40:43], v[116:119]
  ds_read_b64_tr_b16 a[182:183], v5 offset:6272
  v_add_f32_e32 v31, v31, v63
  v_mfma_f32_16x16x32_bf16 v[120:123], a[164:167], v[48:51], v[120:123]
  s_add_u32 m0, s34, 86016
  v_fma_f32 v64, v64, s35, -v14
  v_fma_f32 v65, v65, s35, -v14
  v_mfma_f32_16x16x32_bf16 v[124:127], a[164:167], v[56:59], v[124:127]
  s_waitcnt lgkmcnt(4)
  ds_read_b64_tr_b16 a[184:185], v6 offset:128
  v_fma_f32 v66, v66, s35, -v14
  v_mfma_f32_16x16x32_bf16 v[128:131], a[168:171], v[32:35], v[128:131]
  s_mov_b32 s33, 282624
  v_exp_f32_e32 v64, v64
  v_mfma_f32_16x16x32_bf16 v[132:135], a[168:171], v[40:43], v[132:135]
  ds_read_b64_tr_b16 a[186:187], v6 offset:6272
  v_fma_f32 v67, v67, s35, -v14
  v_mfma_f32_16x16x32_bf16 v[136:139], a[168:171], v[48:51], v[136:139]
  buffer_load_dwordx4 v8, s[12:15], s33 offen nt lds
  v_mfma_f32_16x16x32_bf16 v[140:143], a[168:171], v[56:59], v[140:143]
  ds_read_b64_tr_b16 a[188:189], v7 offset:128
  v_fma_f32 v68, v68, s35, -v14
  v_mfma_f32_16x16x32_bf16 v[144:147], a[172:175], v[32:35], v[144:147]
  v_exp_f32_e32 v65, v65
  v_mfma_f32_16x16x32_bf16 v[148:151], a[172:175], v[40:43], v[148:151]
  ds_read_b64_tr_b16 a[190:191], v7 offset:6272
  v_fma_f32 v69, v69, s35, -v14
  v_mfma_f32_16x16x32_bf16 v[152:155], a[172:175], v[48:51], v[152:155]
  v_exp_f32_e32 v66, v66
  v_mfma_f32_16x16x32_bf16 v[156:159], a[172:175], v[56:59], v[156:159]
  s_waitcnt lgkmcnt(4)
  ds_read_b64_tr_b16 a[192:193], v4 offset:256
  v_fma_f32 v70, v70, s35, -v14
  v_mfma_f32_16x16x32_bf16 v[160:163], a[176:179], v[32:35], v[160:163]
  v_exp_f32_e32 v67, v67
  v_mfma_f32_16x16x32_bf16 v[164:167], a[176:179], v[40:43], v[164:167]
  ds_read_b64_tr_b16 a[194:195], v4 offset:6400
  v_fma_f32 v71, v71, s35, -v14
  v_mfma_f32_16x16x32_bf16 v[168:171], a[176:179], v[48:51], v[168:171]
  v_exp_f32_e32 v68, v68
  v_mfma_f32_16x16x32_bf16 v[172:175], a[176:179], v[56:59], v[172:175]
  ds_read_b64_tr_b16 a[196:197], v5 offset:256
  v_cvt_pk_bf16_f32 v64, v64, v65
  v_mfma_f32_16x16x32_bf16 v[176:179], a[180:183], v[32:35], v[176:179]
  v_exp_f32_e32 v69, v69
  v_mfma_f32_16x16x32_bf16 v[180:183], a[180:183], v[40:43], v[180:183]
  ds_read_b64_tr_b16 a[198:199], v5 offset:6400
  v_cvt_pk_bf16_f32 v65, v66, v67
  v_mfma_f32_16x16x32_bf16 v[184:187], a[180:183], v[48:51], v[184:187]
  buffer_load_dwordx4 v9, s[12:15], s33 offen offset:1024 nt lds
  v_mfma_f32_16x16x32_bf16 v[188:191], a[180:183], v[56:59], v[188:191]
  s_waitcnt lgkmcnt(4)
  ds_read_b64_tr_b16 a[200:201], v6 offset:256
  v_cvt_pk_bf16_f32 v66, v68, v69
  v_mfma_f32_16x16x32_bf16 v[192:195], a[184:187], v[32:35], v[192:195]
  v_exp_f32_e32 v70, v70
  v_mfma_f32_16x16x32_bf16 v[196:199], a[184:187], v[40:43], v[196:199]
  ds_read_b64_tr_b16 a[202:203], v6 offset:6400
  v_fma_f32 v72, v72, s35, -v15
  v_mfma_f32_16x16x32_bf16 v[200:203], a[184:187], v[48:51], v[200:203]
  v_exp_f32_e32 v71, v71
  v_mfma_f32_16x16x32_bf16 v[204:207], a[184:187], v[56:59], v[204:207]
  ds_read_b64_tr_b16 a[204:205], v7 offset:256
  v_cvt_pk_bf16_f32 v67, v70, v71
  v_mfma_f32_16x16x32_bf16 v[208:211], a[188:191], v[32:35], v[208:211]
  v_exp_f32_e32 v72, v72
  v_mfma_f32_16x16x32_bf16 v[212:215], a[188:191], v[40:43], v[212:215]
  ds_read_b64_tr_b16 a[206:207], v7 offset:6400
  v_fma_f32 v73, v73, s35, -v15
  v_mfma_f32_16x16x32_bf16 v[216:219], a[188:191], v[48:51], v[216:219]
  v_exp_f32_e32 v73, v73
  v_mfma_f32_16x16x32_bf16 v[220:223], a[188:191], v[56:59], v[220:223]
  s_waitcnt lgkmcnt(4)
  ds_read_b128 a[160:163], v2 offset:24576
  v_fma_f32 v74, v74, s35, -v15
  v_mfma_f32_16x16x32_bf16 v[224:227], a[192:195], v[32:35], v[224:227]
  v_exp_f32_e32 v74, v74
  v_mfma_f32_16x16x32_bf16 v[228:231], a[192:195], v[40:43], v[228:231]
  ds_read_b128 a[164:167], v3 offset:24576
  v_fma_f32 v75, v75, s35, -v15
  v_mfma_f32_16x16x32_bf16 v[232:235], a[192:195], v[48:51], v[232:235]
  buffer_load_dwordx4 v10, s[12:15], s33 offen offset:2048 nt lds
  v_mfma_f32_16x16x32_bf16 v[236:239], a[192:195], v[56:59], v[236:239]
  ds_read_b128 a[168:171], v2 offset:24704
  v_fma_f32 v76, v76, s35, -v15
  v_mfma_f32_16x16x32_bf16 v[240:243], a[196:199], v[32:35], v[240:243]
  v_exp_f32_e32 v75, v75
  v_mfma_f32_16x16x32_bf16 v[244:247], a[196:199], v[40:43], v[244:247]
  ds_read_b128 a[172:175], v3 offset:24704
  v_fma_f32 v77, v77, s35, -v15
  v_mfma_f32_16x16x32_bf16 v[248:251], a[196:199], v[48:51], v[248:251]
  buffer_store_dwordx4 a[48:51], v11, s[16:19], s80 offen offset:128 nt
  v_mfma_f32_16x16x32_bf16 v[252:255], a[196:199], v[56:59], v[252:255]
  s_waitcnt lgkmcnt(3)
  ds_read_b128 a[176:179], v2 offset:24832
  v_fma_f32 v78, v78, s35, -v15
  v_mfma_f32_16x16x32_bf16 a[0:3], a[200:203], v[32:35], a[0:3]
  v_exp_f32_e32 v76, v76
  v_mfma_f32_16x16x32_bf16 a[4:7], a[200:203], v[40:43], a[4:7]
  ds_read_b128 a[180:183], v3 offset:24832
  v_fma_f32 v79, v79, s35, -v15
  v_mfma_f32_16x16x32_bf16 a[8:11], a[200:203], v[48:51], a[8:11]
  v_exp_f32_e32 v77, v77
  v_mfma_f32_16x16x32_bf16 a[12:15], a[200:203], v[56:59], a[12:15]
  v_exp_f32_e32 v78, v78
  v_mfma_f32_16x16x32_bf16 a[16:19], a[204:207], v[32:35], a[16:19]
  v_exp_f32_e32 v79, v79
  v_mfma_f32_16x16x32_bf16 a[20:23], a[204:207], v[40:43], a[20:23]
  v_add_f32_e32 v0, v0, v72
  v_add_f32_e32 v0, v0, v73
  v_mfma_f32_16x16x32_bf16 a[24:27], a[204:207], v[48:51], a[24:27]
  v_cvt_pk_bf16_f32 v72, v72, v73
  v_add_f32_e32 v0, v0, v74
  v_mfma_f32_16x16x32_bf16 a[28:31], a[204:207], v[56:59], a[28:31]
  v_add_f32_e32 v0, v0, v75
  v_cvt_pk_bf16_f32 v73, v74, v75
  v_mfma_f32_16x16x32_bf16 v[32:35], a[160:163], a[32:35], 0
  s_waitcnt lgkmcnt(1)
  v_cvt_pk_bf16_f32 v74, v76, v77
  v_cvt_pk_bf16_f32 v75, v78, v79
  v_mfma_f32_16x16x32_bf16 v[32:35], a[164:167], a[36:39], v[32:35]
  v_fma_f32 v80, v80, s35, -v16
  v_fma_f32 v81, v81, s35, -v16
  v_mfma_f32_16x16x32_bf16 v[32:35], a[168:171], a[40:43], v[32:35]
  v_exp_f32_e32 v80, v80
  v_mfma_f32_16x16x32_bf16 v[32:35], a[172:175], a[44:47], v[32:35]
  v_exp_f32_e32 v81, v81
  v_mfma_f32_16x16x32_bf16 v[32:35], a[176:179], a[128:131], v[32:35]
  s_waitcnt lgkmcnt(0)
  v_fma_f32 v82, v82, s35, -v16
  v_fma_f32 v83, v83, s35, -v16
  v_mfma_f32_16x16x32_bf16 v[32:35], a[180:183], a[132:135], v[32:35]
  v_exp_f32_e32 v82, v82
  v_mfma_f32_16x16x32_bf16 v[40:43], a[160:163], a[56:59], 0
  v_exp_f32_e32 v83, v83
  v_mfma_f32_16x16x32_bf16 v[40:43], a[164:167], a[60:63], v[40:43]
  ds_read_b128 a[184:187], v2 offset:30720
  v_fma_f32 v84, v84, s35, -v16
  v_mfma_f32_16x16x32_bf16 v[40:43], a[168:171], a[64:67], v[40:43]
  v_exp_f32_e32 v84, v84
  v_mfma_f32_16x16x32_bf16 v[40:43], a[172:175], a[68:71], v[40:43]
  ds_read_b128 a[188:191], v3 offset:30720
  v_fma_f32 v85, v85, s35, -v16
  v_mfma_f32_16x16x32_bf16 v[40:43], a[176:179], a[136:139], v[40:43]
  v_exp_f32_e32 v85, v85
  v_mfma_f32_16x16x32_bf16 v[40:43], a[180:183], a[140:143], v[40:43]
  ds_read_b128 a[192:195], v2 offset:30848
  v_fma_f32 v86, v86, s35, -v16
  v_mfma_f32_16x16x32_bf16 v[48:51], a[160:163], a[80:83], 0
  v_exp_f32_e32 v86, v86
  v_mfma_f32_16x16x32_bf16 v[48:51], a[164:167], a[84:87], v[48:51]
  ds_read_b128 a[196:199], v3 offset:30848
  v_fma_f32 v87, v87, s35, -v16
  v_mfma_f32_16x16x32_bf16 v[48:51], a[168:171], a[88:91], v[48:51]
  v_exp_f32_e32 v87, v87
  v_mfma_f32_16x16x32_bf16 v[48:51], a[172:175], a[92:95], v[48:51]
  ds_read_b128 a[200:203], v2 offset:30976
  v_add_f32_e32 v30, v30, v80
  v_mfma_f32_16x16x32_bf16 v[48:51], a[176:179], a[144:147], v[48:51]
  v_add_f32_e32 v30, v30, v81
  v_cvt_pk_bf16_f32 v80, v80, v81
  v_mfma_f32_16x16x32_bf16 v[48:51], a[180:183], a[148:151], v[48:51]
  ds_read_b128 a[204:207], v3 offset:30976
  v_add_f32_e32 v30, v30, v82
  v_mfma_f32_16x16x32_bf16 v[56:59], a[160:163], a[104:107], 0
  s_waitcnt vmcnt(12)
  s_barrier
  v_mfma_f32_16x16x32_bf16 v[56:59], a[164:167], a[108:111], v[56:59]
  s_add_u32 m0, s34, 12288
  v_add_f32_e32 v30, v30, v83
  v_cvt_pk_bf16_f32 v81, v82, v83
  v_mfma_f32_16x16x32_bf16 v[56:59], a[168:171], a[112:115], v[56:59]
  s_mov_b32 s32, 307200
  v_cvt_pk_bf16_f32 v82, v84, v85
  v_cvt_pk_bf16_f32 v83, v86, v87
  v_mfma_f32_16x16x32_bf16 v[56:59], a[172:175], a[116:119], v[56:59]
  buffer_load_dwordx4 v8, s[8:11], s32 offen nt lds
  v_mfma_f32_16x16x32_bf16 v[56:59], a[176:179], a[152:155], v[56:59]
  v_fma_f32 v88, v88, s35, -v17
  v_fma_f32 v89, v89, s35, -v17
  v_mfma_f32_16x16x32_bf16 v[56:59], a[180:183], a[156:159], v[56:59]
  s_waitcnt lgkmcnt(1)
  v_exp_f32_e32 v88, v88
  v_mfma_f32_16x16x32_bf16 v[36:39], a[184:187], a[32:35], 0
  v_exp_f32_e32 v89, v89
  v_mfma_f32_16x16x32_bf16 v[36:39], a[188:191], a[36:39], v[36:39]
  v_fma_f32 v90, v90, s35, -v17
  v_fma_f32 v91, v91, s35, -v17
  v_mfma_f32_16x16x32_bf16 v[36:39], a[192:195], a[40:43], v[36:39]
  v_exp_f32_e32 v90, v90
  v_mfma_f32_16x16x32_bf16 v[36:39], a[196:199], a[44:47], v[36:39]
  v_exp_f32_e32 v91, v91
  v_mfma_f32_16x16x32_bf16 v[36:39], a[200:203], a[128:131], v[36:39]
  s_waitcnt lgkmcnt(0)
  v_fma_f32 v92, v92, s35, -v17
  v_fma_f32 v93, v93, s35, -v17
  v_mfma_f32_16x16x32_bf16 v[36:39], a[204:207], a[132:135], v[36:39]
  v_exp_f32_e32 v92, v92
  v_mfma_f32_16x16x32_bf16 v[44:47], a[184:187], a[56:59], 0
  v_exp_f32_e32 v93, v93
  v_mfma_f32_16x16x32_bf16 v[44:47], a[188:191], a[60:63], v[44:47]
  v_fma_f32 v94, v94, s35, -v17
  v_fma_f32 v95, v95, s35, -v17
  v_mfma_f32_16x16x32_bf16 v[44:47], a[192:195], a[64:67], v[44:47]
  ds_read_b64_tr_b16 a[160:161], v4 offset:12288
  v_add_f32_e32 v31, v31, v88
  v_mfma_f32_16x16x32_bf16 v[44:47], a[196:199], a[68:71], v[44:47]
  buffer_load_dwordx4 v9, s[8:11], s32 offen offset:1024 nt lds
  v_mfma_f32_16x16x32_bf16 v[44:47], a[200:203], a[136:139], v[44:47]
  ds_read_b64_tr_b16 a[162:163], v4 offset:18432
  v_add_f32_e32 v31, v31, v89
  v_mfma_f32_16x16x32_bf16 v[44:47], a[204:207], a[140:143], v[44:47]
  v_exp_f32_e32 v94, v94
  v_mfma_f32_16x16x32_bf16 v[52:55], a[184:187], a[80:83], 0
  ds_read_b64_tr_b16 a[164:165], v5 offset:12288
  v_cvt_pk_bf16_f32 v88, v88, v89
  v_mfma_f32_16x16x32_bf16 v[52:55], a[188:191], a[84:87], v[52:55]
  v_exp_f32_e32 v95, v95
  v_mfma_f32_16x16x32_bf16 v[52:55], a[192:195], a[88:91], v[52:55]
  ds_read_b64_tr_b16 a[166:167], v5 offset:18432
  v_add_f32_e32 v31, v31, v90
  v_mfma_f32_16x16x32_bf16 v[52:55], a[196:199], a[92:95], v[52:55]
  buffer_store_dwordx4 a[52:55], v11, s[16:19], s80 offen offset:3200 nt
  v_mfma_f32_16x16x32_bf16 v[52:55], a[200:203], a[144:147], v[52:55]
  ds_read_b64_tr_b16 a[168:169], v6 offset:12288
  v_add_f32_e32 v31, v31, v91
  v_mfma_f32_16x16x32_bf16 v[52:55], a[204:207], a[148:151], v[52:55]
  v_cvt_pk_bf16_f32 v89, v90, v91
  v_cvt_pk_bf16_f32 v90, v92, v93
  v_mfma_f32_16x16x32_bf16 v[60:63], a[184:187], a[104:107], 0
  ds_read_b64_tr_b16 a[170:171], v6 offset:18432
  v_cvt_pk_bf16_f32 v91, v94, v95
  v_mfma_f32_16x16x32_bf16 v[60:63], a[188:191], a[108:111], v[60:63]
L_hop10:
  s_cbranch_execz L_hop14
  v_add_f32_e32 v0, v0, v76
  v_add_f32_e32 v0, v0, v77
  v_mfma_f32_16x16x32_bf16 v[60:63], a[192:195], a[112:115], v[60:63]
  ds_read_b64_tr_b16 a[172:173], v7 offset:12288
  v_add_f32_e32 v0, v0, v78
  v_mfma_f32_16x16x32_bf16 v[60:63], a[196:199], a[116:119], v[60:63]
  buffer_load_dwordx4 v10, s[8:11], s32 offen offset:2048 nt lds
  v_mfma_f32_16x16x32_bf16 v[60:63], a[200:203], a[152:155], v[60:63]
  ds_read_b64_tr_b16 a[174:175], v7 offset:18432
  v_add_f32_e32 v0, v0, v79
  v_mfma_f32_16x16x32_bf16 v[60:63], a[204:207], a[156:159], v[60:63]
  v_add_f32_e32 v30, v30, v84
  v_add_f32_e32 v30, v30, v85
  v_mfma_f32_16x16x32_bf16 a[240:243], v[18:21], v[64:67], a[240:243]
  s_waitcnt lgkmcnt(4)
  ds_read_b64_tr_b16 a[176:177], v4 offset:12416
  v_add_f32_e32 v30, v30, v86
  v_mfma_f32_16x16x32_bf16 v[96:99], a[160:163], v[64:67], v[96:99]
  v_add_f32_e32 v30, v30, v87
  v_add_f32_e32 v31, v31, v92
  v_mfma_f32_16x16x32_bf16 v[100:103], a[160:163], v[72:75], v[100:103]
  ds_read_b64_tr_b16 a[178:179], v4 offset:18560
  v_add_f32_e32 v31, v31, v93
  v_mfma_f32_16x16x32_bf16 v[104:107], a[160:163], v[80:83], v[104:107]
  v_add_f32_e32 v31, v31, v94
  v_add_f32_e32 v31, v31, v95
  v_mfma_f32_16x16x32_bf16 v[108:111], a[160:163], v[88:91], v[108:111]
  ds_read_b64_tr_b16 a[180:181], v5 offset:12416
  v_fma_f32 v32, v32, s35, -v14
  v_mfma_f32_16x16x32_bf16 v[112:115], a[164:167], v[64:67], v[112:115]
  v_exp_f32_e32 v32, v32
  v_mfma_f32_16x16x32_bf16 v[116:119], a[164:167], v[72:75], v[116:119]
  ds_read_b64_tr_b16 a[182:183], v5 offset:18560
  v_fma_f32 v33, v33, s35, -v14
  v_mfma_f32_16x16x32_bf16 v[120:123], a[164:167], v[80:83], v[120:123]
  s_add_u32 m0, s34, 49152
  v_exp_f32_e32 v33, v33
  v_mfma_f32_16x16x32_bf16 v[124:127], a[164:167], v[88:91], v[124:127]
  s_waitcnt lgkmcnt(4)
  ds_read_b64_tr_b16 a[184:185], v6 offset:12416
  v_fma_f32 v34, v34, s35, -v14
  v_mfma_f32_16x16x32_bf16 v[128:131], a[168:171], v[64:67], v[128:131]
  s_mov_b32 s33, 294912
  v_exp_f32_e32 v34, v34
  v_mfma_f32_16x16x32_bf16 v[132:135], a[168:171], v[72:75], v[132:135]
  ds_read_b64_tr_b16 a[186:187], v6 offset:18560
  v_fma_f32 v35, v35, s35, -v14
  v_mfma_f32_16x16x32_bf16 v[136:139], a[168:171], v[80:83], v[136:139]
  buffer_load_dwordx4 v8, s[12:15], s33 offen nt lds
  v_mfma_f32_16x16x32_bf16 v[140:143], a[168:171], v[88:91], v[140:143]
  ds_read_b64_tr_b16 a[188:189], v7 offset:12416
  v_fma_f32 v36, v36, s35, -v14
  v_mfma_f32_16x16x32_bf16 v[144:147], a[172:175], v[64:67], v[144:147]
  v_exp_f32_e32 v35, v35
  v_mfma_f32_16x16x32_bf16 v[148:151], a[172:175], v[72:75], v[148:151]
  ds_read_b64_tr_b16 a[190:191], v7 offset:18560
  v_fma_f32 v37, v37, s35, -v14
  v_mfma_f32_16x16x32_bf16 v[152:155], a[172:175], v[80:83], v[152:155]
  v_exp_f32_e32 v36, v36
  v_mfma_f32_16x16x32_bf16 v[156:159], a[172:175], v[88:91], v[156:159]
  s_waitcnt lgkmcnt(4)
  ds_read_b64_tr_b16 a[192:193], v4 offset:12544
  v_fma_f32 v38, v38, s35, -v14
  v_mfma_f32_16x16x32_bf16 v[160:163], a[176:179], v[64:67], v[160:163]
  v_exp_f32_e32 v37, v37
  v_mfma_f32_16x16x32_bf16 v[164:167], a[176:179], v[72:75], v[164:167]
  ds_read_b64_tr_b16 a[194:195], v4 offset:18688
  v_fma_f32 v39, v39, s35, -v14
  v_mfma_f32_16x16x32_bf16 v[168:171], a[176:179], v[80:83], v[168:171]
  v_exp_f32_e32 v38, v38
  v_mfma_f32_16x16x32_bf16 v[172:175], a[176:179], v[88:91], v[172:175]
  ds_read_b64_tr_b16 a[196:197], v5 offset:12544
  v_cvt_pk_bf16_f32 v32, v32, v33
  v_mfma_f32_16x16x32_bf16 v[176:179], a[180:183], v[64:67], v[176:179]
  v_exp_f32_e32 v39, v39
  v_mfma_f32_16x16x32_bf16 v[180:183], a[180:183], v[72:75], v[180:183]
  ds_read_b64_tr_b16 a[198:199], v5 offset:18688
  v_cvt_pk_bf16_f32 v33, v34, v35
  v_mfma_f32_16x16x32_bf16 v[184:187], a[180:183], v[80:83], v[184:187]
  buffer_load_dwordx4 v9, s[12:15], s33 offen offset:1024 nt lds
  v_mfma_f32_16x16x32_bf16 v[188:191], a[180:183], v[88:91], v[188:191]
  s_waitcnt lgkmcnt(4)
  ds_read_b64_tr_b16 a[200:201], v6 offset:12544
  v_cvt_pk_bf16_f32 v34, v36, v37
  v_mfma_f32_16x16x32_bf16 v[192:195], a[184:187], v[64:67], v[192:195]
  v_cvt_pk_bf16_f32 v35, v38, v39
  v_fma_f32 v40, v40, s35, -v15
  v_mfma_f32_16x16x32_bf16 v[196:199], a[184:187], v[72:75], v[196:199]
  ds_read_b64_tr_b16 a[202:203], v6 offset:18688
  v_fma_f32 v41, v41, s35, -v15
  v_mfma_f32_16x16x32_bf16 v[200:203], a[184:187], v[80:83], v[200:203]
  v_exp_f32_e32 v40, v40
  v_mfma_f32_16x16x32_bf16 v[204:207], a[184:187], v[88:91], v[204:207]
  ds_read_b64_tr_b16 a[204:205], v7 offset:12544
  v_fma_f32 v42, v42, s35, -v15
  v_mfma_f32_16x16x32_bf16 v[208:211], a[188:191], v[64:67], v[208:211]
  v_exp_f32_e32 v41, v41
  v_mfma_f32_16x16x32_bf16 v[212:215], a[188:191], v[72:75], v[212:215]
  ds_read_b64_tr_b16 a[206:207], v7 offset:18688
  v_fma_f32 v43, v43, s35, -v15
  v_mfma_f32_16x16x32_bf16 v[216:219], a[188:191], v[80:83], v[216:219]
  v_exp_f32_e32 v42, v42
  v_mfma_f32_16x16x32_bf16 v[220:223], a[188:191], v[88:91], v[220:223]
  s_waitcnt lgkmcnt(4)
  ds_read_b128 a[160:163], v2 offset:36864
  v_fma_f32 v44, v44, s35, -v15
  v_mfma_f32_16x16x32_bf16 v[224:227], a[192:195], v[64:67], v[224:227]
  v_exp_f32_e32 v43, v43
  v_mfma_f32_16x16x32_bf16 v[228:231], a[192:195], v[72:75], v[228:231]
  ds_read_b128 a[164:167], v3 offset:36864
  v_fma_f32 v45, v45, s35, -v15
  v_mfma_f32_16x16x32_bf16 v[232:235], a[192:195], v[80:83], v[232:235]
  buffer_load_dwordx4 v10, s[12:15], s33 offen offset:2048 nt lds
  v_mfma_f32_16x16x32_bf16 v[236:239], a[192:195], v[88:91], v[236:239]
  ds_read_b128 a[168:171], v2 offset:36992
  v_fma_f32 v46, v46, s35, -v15
  v_mfma_f32_16x16x32_bf16 v[240:243], a[196:199], v[64:67], v[240:243]
  v_exp_f32_e32 v44, v44
  v_mfma_f32_16x16x32_bf16 v[244:247], a[196:199], v[72:75], v[244:247]
  ds_read_b128 a[172:175], v3 offset:36992
  v_fma_f32 v47, v47, s35, -v15
  v_mfma_f32_16x16x32_bf16 v[248:251], a[196:199], v[80:83], v[248:251]
  buffer_store_dwordx4 a[72:75], v11, s[16:19], s81 offen offset:128 nt
  v_mfma_f32_16x16x32_bf16 v[252:255], a[196:199], v[88:91], v[252:255]
  s_waitcnt lgkmcnt(3)
  ds_read_b128 a[176:179], v2 offset:37120
  v_add_f32_e32 v0, v0, v40
  v_mfma_f32_16x16x32_bf16 a[0:3], a[200:203], v[64:67], a[0:3]
  v_exp_f32_e32 v45, v45
  v_mfma_f32_16x16x32_bf16 a[4:7], a[200:203], v[72:75], a[4:7]
  ds_read_b128 a[180:183], v3 offset:37120
  v_add_f32_e32 v0, v0, v41
  v_mfma_f32_16x16x32_bf16 a[8:11], a[200:203], v[80:83], a[8:11]
  v_exp_f32_e32 v46, v46
  v_mfma_f32_16x16x32_bf16 a[12:15], a[200:203], v[88:91], a[12:15]
  v_exp_f32_e32 v47, v47
  v_mfma_f32_16x16x32_bf16 a[16:19], a[204:207], v[64:67], a[16:19]
  v_cvt_pk_bf16_f32 v40, v40, v41
  v_add_f32_e32 v0, v0, v42
  v_mfma_f32_16x16x32_bf16 a[20:23], a[204:207], v[72:75], a[20:23]
  v_add_f32_e32 v0, v0, v43
  v_cvt_pk_bf16_f32 v41, v42, v43
  v_mfma_f32_16x16x32_bf16 a[24:27], a[204:207], v[80:83], a[24:27]
  v_cvt_pk_bf16_f32 v42, v44, v45
  v_cvt_pk_bf16_f32 v43, v46, v47
  v_mfma_f32_16x16x32_bf16 a[28:31], a[204:207], v[88:91], a[28:31]
  v_fma_f32 v48, v48, s35, -v16
  v_fma_f32 v49, v49, s35, -v16
  v_mfma_f32_16x16x32_bf16 v[64:67], a[160:163], a[32:35], 0
  s_waitcnt lgkmcnt(1)
  v_exp_f32_e32 v48, v48
  v_mfma_f32_16x16x32_bf16 v[64:67], a[164:167], a[36:39], v[64:67]
  v_exp_f32_e32 v49, v49
  v_mfma_f32_16x16x32_bf16 v[64:67], a[168:171], a[40:43], v[64:67]
  v_fma_f32 v50, v50, s35, -v16
  v_fma_f32 v51, v51, s35, -v16
  v_mfma_f32_16x16x32_bf16 v[64:67], a[172:175], a[44:47], v[64:67]
  v_exp_f32_e32 v50, v50
  v_mfma_f32_16x16x32_bf16 v[64:67], a[176:179], a[128:131], v[64:67]
  s_waitcnt lgkmcnt(0)
  v_exp_f32_e32 v51, v51
  v_mfma_f32_16x16x32_bf16 v[64:67], a[180:183], a[132:135], v[64:67]
  v_fma_f32 v52, v52, s35, -v16
  v_fma_f32 v53, v53, s35, -v16
  v_mfma_f32_16x16x32_bf16 v[72:75], a[160:163], a[56:59], 0
  v_exp_f32_e32 v52, v52
  v_mfma_f32_16x16x32_bf16 v[72:75], a[164:167], a[60:63], v[72:75]
  ds_read_b128 a[184:187], v2 offset:43008
  v_fma_f32 v54, v54, s35, -v16
  v_mfma_f32_16x16x32_bf16 v[72:75], a[168:171], a[64:67], v[72:75]
  v_exp_f32_e32 v53, v53
  v_mfma_f32_16x16x32_bf16 v[72:75], a[172:175], a[68:71], v[72:75]
  ds_read_b128 a[188:191], v3 offset:43008
  v_fma_f32 v55, v55, s35, -v16
  v_mfma_f32_16x16x32_bf16 v[72:75], a[176:179], a[136:139], v[72:75]
  v_exp_f32_e32 v54, v54
  v_mfma_f32_16x16x32_bf16 v[72:75], a[180:183], a[140:143], v[72:75]
  ds_read_b128 a[192:195], v2 offset:43136
  v_add_f32_e32 v30, v30, v48
  v_mfma_f32_16x16x32_bf16 v[80:83], a[160:163], a[80:83], 0
  v_exp_f32_e32 v55, v55
  v_mfma_f32_16x16x32_bf16 v[80:83], a[164:167], a[84:87], v[80:83]
  ds_read_b128 a[196:199], v3 offset:43136
  v_add_f32_e32 v30, v30, v49
  v_mfma_f32_16x16x32_bf16 v[80:83], a[168:171], a[88:91], v[80:83]
  v_cvt_pk_bf16_f32 v48, v48, v49
  v_add_f32_e32 v30, v30, v50
  v_mfma_f32_16x16x32_bf16 v[80:83], a[172:175], a[92:95], v[80:83]
  ds_read_b128 a[200:203], v2 offset:43264
  v_add_f32_e32 v30, v30, v51
  v_mfma_f32_16x16x32_bf16 v[80:83], a[176:179], a[144:147], v[80:83]
  v_cvt_pk_bf16_f32 v49, v50, v51
  v_cvt_pk_bf16_f32 v50, v52, v53
  v_mfma_f32_16x16x32_bf16 v[80:83], a[180:183], a[148:151], v[80:83]
  ds_read_b128 a[204:207], v3 offset:43264
  v_cvt_pk_bf16_f32 v51, v54, v55
  v_mfma_f32_16x16x32_bf16 v[88:91], a[160:163], a[104:107], 0
  s_waitcnt vmcnt(12)
  s_barrier
  v_mfma_f32_16x16x32_bf16 v[88:91], a[164:167], a[108:111], v[88:91]
  s_add_u32 m0, s34, 24576
  v_fma_f32 v56, v56, s35, -v17
  v_fma_f32 v57, v57, s35, -v17
  v_mfma_f32_16x16x32_bf16 v[88:91], a[168:171], a[112:115], v[88:91]
  s_mov_b32 s32, 319488
  v_exp_f32_e32 v56, v56
  v_mfma_f32_16x16x32_bf16 v[88:91], a[172:175], a[116:119], v[88:91]
  buffer_load_dwordx4 v8, s[8:11], s32 offen nt lds
  v_mfma_f32_16x16x32_bf16 v[88:91], a[176:179], a[152:155], v[88:91]
  v_exp_f32_e32 v57, v57
  v_mfma_f32_16x16x32_bf16 v[88:91], a[180:183], a[156:159], v[88:91]
  s_waitcnt lgkmcnt(1)
  v_fma_f32 v58, v58, s35, -v17
  v_fma_f32 v59, v59, s35, -v17
  v_mfma_f32_16x16x32_bf16 v[68:71], a[184:187], a[32:35], 0
  v_exp_f32_e32 v58, v58
  v_mfma_f32_16x16x32_bf16 v[68:71], a[188:191], a[36:39], v[68:71]
  v_exp_f32_e32 v59, v59
  v_mfma_f32_16x16x32_bf16 v[68:71], a[192:195], a[40:43], v[68:71]
  v_fma_f32 v60, v60, s35, -v17
  v_fma_f32 v61, v61, s35, -v17
  v_mfma_f32_16x16x32_bf16 v[68:71], a[196:199], a[44:47], v[68:71]
  v_exp_f32_e32 v60, v60
  v_mfma_f32_16x16x32_bf16 v[68:71], a[200:203], a[128:131], v[68:71]
  s_waitcnt lgkmcnt(0)
  v_exp_f32_e32 v61, v61
  v_mfma_f32_16x16x32_bf16 v[68:71], a[204:207], a[132:135], v[68:71]
  v_fma_f32 v62, v62, s35, -v17
  v_fma_f32 v63, v63, s35, -v17
  v_mfma_f32_16x16x32_bf16 v[76:79], a[184:187], a[56:59], 0
  v_exp_f32_e32 v62, v62
  v_mfma_f32_16x16x32_bf16 v[76:79], a[188:191], a[60:63], v[76:79]
  v_exp_f32_e32 v63, v63
  v_mfma_f32_16x16x32_bf16 v[76:79], a[192:195], a[64:67], v[76:79]
  ds_read_b64_tr_b16 a[160:161], v4 offset:24576
  v_add_f32_e32 v31, v31, v56
  v_mfma_f32_16x16x32_bf16 v[76:79], a[196:199], a[68:71], v[76:79]
  buffer_load_dwordx4 v9, s[8:11], s32 offen offset:1024 nt lds
  v_mfma_f32_16x16x32_bf16 v[76:79], a[200:203], a[136:139], v[76:79]
  ds_read_b64_tr_b16 a[162:163], v4 offset:30720
  v_add_f32_e32 v31, v31, v57
  v_mfma_f32_16x16x32_bf16 v[76:79], a[204:207], a[140:143], v[76:79]
  v_cvt_pk_bf16_f32 v56, v56, v57
  v_add_f32_e32 v31, v31, v58
  v_mfma_f32_16x16x32_bf16 v[84:87], a[184:187], a[80:83], 0
  ds_read_b64_tr_b16 a[164:165], v5 offset:24576
  v_add_f32_e32 v31, v31, v59
  v_mfma_f32_16x16x32_bf16 v[84:87], a[188:191], a[84:87], v[84:87]
  v_cvt_pk_bf16_f32 v57, v58, v59
  v_cvt_pk_bf16_f32 v58, v60, v61
  v_mfma_f32_16x16x32_bf16 v[84:87], a[192:195], a[88:91], v[84:87]
  ds_read_b64_tr_b16 a[166:167], v5 offset:30720
  v_cvt_pk_bf16_f32 v59, v62, v63
  v_mfma_f32_16x16x32_bf16 v[84:87], a[196:199], a[92:95], v[84:87]
  buffer_store_dwordx4 a[76:79], v11, s[16:19], s81 offen offset:3200 nt
  v_mfma_f32_16x16x32_bf16 v[84:87], a[200:203], a[144:147], v[84:87]
  ds_read_b64_tr_b16 a[168:169], v6 offset:24576
  v_add_f32_e32 v0, v0, v44
  v_mfma_f32_16x16x32_bf16 v[84:87], a[204:207], a[148:151], v[84:87]
  v_add_f32_e32 v0, v0, v45
  v_add_f32_e32 v0, v0, v46
  v_mfma_f32_16x16x32_bf16 v[92:95], a[184:187], a[104:107], 0
  ds_read_b64_tr_b16 a[170:171], v6 offset:30720
  v_add_f32_e32 v0, v0, v47
  v_mfma_f32_16x16x32_bf16 v[92:95], a[188:191], a[108:111], v[92:95]
  v_add_f32_e32 v30, v30, v52
  v_add_f32_e32 v30, v30, v53
  v_mfma_f32_16x16x32_bf16 v[92:95], a[192:195], a[112:115], v[92:95]
  ds_read_b64_tr_b16 a[172:173], v7 offset:24576
  v_add_f32_e32 v30, v30, v54
  v_mfma_f32_16x16x32_bf16 v[92:95], a[196:199], a[116:119], v[92:95]
  buffer_load_dwordx4 v10, s[8:11], s32 offen offset:2048 nt lds
  v_mfma_f32_16x16x32_bf16 v[92:95], a[200:203], a[152:155], v[92:95]
  ds_read_b64_tr_b16 a[174:175], v7 offset:30720
  v_add_f32_e32 v30, v30, v55
  v_mfma_f32_16x16x32_bf16 v[92:95], a[204:207], a[156:159], v[92:95]
  v_add_f32_e32 v31, v31, v60
  v_add_f32_e32 v31, v31, v61
  v_mfma_f32_16x16x32_bf16 a[240:243], v[18:21], v[32:35], a[240:243]
  s_waitcnt lgkmcnt(4)
  ds_read_b64_tr_b16 a[176:177], v4 offset:24704
  v_add_f32_e32 v31, v31, v62
  v_mfma_f32_16x16x32_bf16 v[96:99], a[160:163], v[32:35], v[96:99]
  v_add_f32_e32 v31, v31, v63
  v_fma_f32 v64, v64, s35, -v14
  v_mfma_f32_16x16x32_bf16 v[100:103], a[160:163], v[40:43], v[100:103]
  ds_read_b64_tr_b16 a[178:179], v4 offset:30848
  v_fma_f32 v65, v65, s35, -v14
  v_mfma_f32_16x16x32_bf16 v[104:107], a[160:163], v[48:51], v[104:107]
  v_exp_f32_e32 v64, v64
  v_mfma_f32_16x16x32_bf16 v[108:111], a[160:163], v[56:59], v[108:111]
  ds_read_b64_tr_b16 a[180:181], v5 offset:24704
  v_fma_f32 v66, v66, s35, -v14
  v_mfma_f32_16x16x32_bf16 v[112:115], a[164:167], v[32:35], v[112:115]
  v_exp_f32_e32 v65, v65
  v_mfma_f32_16x16x32_bf16 v[116:119], a[164:167], v[40:43], v[116:119]
  ds_read_b64_tr_b16 a[182:183], v5 offset:30848
  v_fma_f32 v67, v67, s35, -v14
  v_mfma_f32_16x16x32_bf16 v[120:123], a[164:167], v[48:51], v[120:123]
  s_add_u32 m0, s34, 61440
  v_exp_f32_e32 v66, v66
  v_mfma_f32_16x16x32_bf16 v[124:127], a[164:167], v[56:59], v[124:127]
  s_waitcnt lgkmcnt(4)
  ds_read_b64_tr_b16 a[184:185], v6 offset:24704
  v_fma_f32 v68, v68, s35, -v14
  v_mfma_f32_16x16x32_bf16 v[128:131], a[168:171], v[32:35], v[128:131]
  s_mov_b32 s33, 307200
  v_exp_f32_e32 v67, v67
  v_mfma_f32_16x16x32_bf16 v[132:135], a[168:171], v[40:43], v[132:135]
  ds_read_b64_tr_b16 a[186:187], v6 offset:30848
  v_fma_f32 v69, v69, s35, -v14
  v_mfma_f32_16x16x32_bf16 v[136:139], a[168:171], v[48:51], v[136:139]
  buffer_load_dwordx4 v8, s[12:15], s33 offen nt lds
  v_mfma_f32_16x16x32_bf16 v[140:143], a[168:171], v[56:59], v[140:143]
  ds_read_b64_tr_b16 a[188:189], v7 offset:24704
  v_fma_f32 v70, v70, s35, -v14
  v_mfma_f32_16x16x32_bf16 v[144:147], a[172:175], v[32:35], v[144:147]
  v_exp_f32_e32 v68, v68
  v_mfma_f32_16x16x32_bf16 v[148:151], a[172:175], v[40:43], v[148:151]
  ds_read_b64_tr_b16 a[190:191], v7 offset:30848
  v_fma_f32 v71, v71, s35, -v14
  v_mfma_f32_16x16x32_bf16 v[152:155], a[172:175], v[48:51], v[152:155]
  v_exp_f32_e32 v69, v69
  v_mfma_f32_16x16x32_bf16 v[156:159], a[172:175], v[56:59], v[156:159]
  s_waitcnt lgkmcnt(4)
  ds_read_b64_tr_b16 a[192:193], v4 offset:24832
  v_cvt_pk_bf16_f32 v64, v64, v65
  v_mfma_f32_16x16x32_bf16 v[160:163], a[176:179], v[32:35], v[160:163]
  v_exp_f32_e32 v70, v70
  v_mfma_f32_16x16x32_bf16 v[164:167], a[176:179], v[40:43], v[164:167]
  ds_read_b64_tr_b16 a[194:195], v4 offset:30976
  v_cvt_pk_bf16_f32 v65, v66, v67
  v_mfma_f32_16x16x32_bf16 v[168:171], a[176:179], v[48:51], v[168:171]
  v_exp_f32_e32 v71, v71
  v_mfma_f32_16x16x32_bf16 v[172:175], a[176:179], v[56:59], v[172:175]
  ds_read_b64_tr_b16 a[196:197], v5 offset:24832
  v_cvt_pk_bf16_f32 v66, v68, v69
  v_mfma_f32_16x16x32_bf16 v[176:179], a[180:183], v[32:35], v[176:179]
  v_cvt_pk_bf16_f32 v67, v70, v71
  v_fma_f32 v72, v72, s35, -v15
  v_mfma_f32_16x16x32_bf16 v[180:183], a[180:183], v[40:43], v[180:183]
  ds_read_b64_tr_b16 a[198:199], v5 offset:30976
  v_fma_f32 v73, v73, s35, -v15
  v_mfma_f32_16x16x32_bf16 v[184:187], a[180:183], v[48:51], v[184:187]
  buffer_load_dwordx4 v9, s[12:15], s33 offen offset:1024 nt lds
  v_mfma_f32_16x16x32_bf16 v[188:191], a[180:183], v[56:59], v[188:191]
  s_waitcnt lgkmcnt(4)
  ds_read_b64_tr_b16 a[200:201], v6 offset:24832
  v_fma_f32 v74, v74, s35, -v15
  v_mfma_f32_16x16x32_bf16 v[192:195], a[184:187], v[32:35], v[192:195]
  v_exp_f32_e32 v72, v72
  v_mfma_f32_16x16x32_bf16 v[196:199], a[184:187], v[40:43], v[196:199]
  ds_read_b64_tr_b16 a[202:203], v6 offset:30976
  v_fma_f32 v75, v75, s35, -v15
  v_mfma_f32_16x16x32_bf16 v[200:203], a[184:187], v[48:51], v[200:203]
  v_exp_f32_e32 v73, v73
  v_mfma_f32_16x16x32_bf16 v[204:207], a[184:187], v[56:59], v[204:207]
  ds_read_b64_tr_b16 a[204:205], v7 offset:24832
  v_fma_f32 v76, v76, s35, -v15
  v_mfma_f32_16x16x32_bf16 v[208:211], a[188:191], v[32:35], v[208:211]
  v_exp_f32_e32 v74, v74
  v_mfma_f32_16x16x32_bf16 v[212:215], a[188:191], v[40:43], v[212:215]
  ds_read_b64_tr_b16 a[206:207], v7 offset:30976
  v_fma_f32 v77, v77, s35, -v15
  v_mfma_f32_16x16x32_bf16 v[216:219], a[188:191], v[48:51], v[216:219]
  v_exp_f32_e32 v75, v75
  v_mfma_f32_16x16x32_bf16 v[220:223], a[188:191], v[56:59], v[220:223]
  s_waitcnt lgkmcnt(4)
  ds_read_b128 a[160:163], v2 offset:0
  v_fma_f32 v78, v78, s35, -v15
  v_mfma_f32_16x16x32_bf16 v[224:227], a[192:195], v[32:35], v[224:227]
  v_exp_f32_e32 v76, v76
  v_mfma_f32_16x16x32_bf16 v[228:231], a[192:195], v[40:43], v[228:231]
  ds_read_b128 a[164:167], v3 offset:0
  v_fma_f32 v79, v79, s35, -v15
  v_mfma_f32_16x16x32_bf16 v[232:235], a[192:195], v[48:51], v[232:235]
  buffer_load_dwordx4 v10, s[12:15], s33 offen offset:2048 nt lds
  v_mfma_f32_16x16x32_bf16 v[236:239], a[192:195], v[56:59], v[236:239]
  ds_read_b128 a[168:171], v2 offset:128
  v_add_f32_e32 v0, v0, v72
  v_mfma_f32_16x16x32_bf16 v[240:243], a[196:199], v[32:35], v[240:243]
  v_exp_f32_e32 v77, v77
  v_mfma_f32_16x16x32_bf16 v[244:247], a[196:199], v[40:43], v[244:247]
  ds_read_b128 a[172:175], v3 offset:128
  v_add_f32_e32 v0, v0, v73
  v_mfma_f32_16x16x32_bf16 v[248:251], a[196:199], v[48:51], v[248:251]
  buffer_store_dwordx4 a[96:99], v11, s[16:19], s82 offen offset:128 nt
  v_mfma_f32_16x16x32_bf16 v[252:255], a[196:199], v[56:59], v[252:255]
  s_waitcnt lgkmcnt(3)
  ds_read_b128 a[176:179], v2 offset:256
  v_cvt_pk_bf16_f32 v72, v72, v73
  v_mfma_f32_16x16x32_bf16 a[0:3], a[200:203], v[32:35], a[0:3]
  v_exp_f32_e32 v78, v78
  v_mfma_f32_16x16x32_bf16 a[4:7], a[200:203], v[40:43], a[4:7]
  ds_read_b128 a[180:183], v3 offset:256
  v_add_f32_e32 v0, v0, v74
  v_mfma_f32_16x16x32_bf16 a[8:11], a[200:203], v[48:51], a[8:11]
  v_exp_f32_e32 v79, v79
  v_mfma_f32_16x16x32_bf16 a[12:15], a[200:203], v[56:59], a[12:15]
  v_add_f32_e32 v0, v0, v75
  v_cvt_pk_bf16_f32 v73, v74, v75
  v_mfma_f32_16x16x32_bf16 a[16:19], a[204:207], v[32:35], a[16:19]
  v_cvt_pk_bf16_f32 v74, v76, v77
  v_cvt_pk_bf16_f32 v75, v78, v79
  v_mfma_f32_16x16x32_bf16 a[20:23], a[204:207], v[40:43], a[20:23]
  v_fma_f32 v80, v80, s35, -v16
  v_fma_f32 v81, v81, s35, -v16
  v_mfma_f32_16x16x32_bf16 a[24:27], a[204:207], v[48:51], a[24:27]
  v_exp_f32_e32 v80, v80
  v_mfma_f32_16x16x32_bf16 a[28:31], a[204:207], v[56:59], a[28:31]
  v_exp_f32_e32 v81, v81
  v_mfma_f32_16x16x32_bf16 v[32:35], a[160:163], a[32:35], 0
  s_waitcnt lgkmcnt(1)
  v_fma_f32 v82, v82, s35, -v16
  v_fma_f32 v83, v83, s35, -v16
  v_mfma_f32_16x16x32_bf16 v[32:35], a[164:167], a[36:39], v[32:35]
  v_exp_f32_e32 v82, v82
  v_mfma_f32_16x16x32_bf16 v[32:35], a[168:171], a[40:43], v[32:35]
  v_exp_f32_e32 v83, v83
  v_mfma_f32_16x16x32_bf16 v[32:35], a[172:175], a[44:47], v[32:35]
  v_fma_f32 v84, v84, s35, -v16
  v_fma_f32 v85, v85, s35, -v16
  v_mfma_f32_16x16x32_bf16 v[32:35], a[176:179], a[128:131], v[32:35]
  s_waitcnt lgkmcnt(0)
  v_exp_f32_e32 v84, v84
  v_mfma_f32_16x16x32_bf16 v[32:35], a[180:183], a[132:135], v[32:35]
  v_exp_f32_e32 v85, v85
  v_mfma_f32_16x16x32_bf16 v[40:43], a[160:163], a[56:59], 0
  v_fma_f32 v86, v86, s35, -v16
  v_fma_f32 v87, v87, s35, -v16
  v_mfma_f32_16x16x32_bf16 v[40:43], a[164:167], a[60:63], v[40:43]
  ds_read_b128 a[184:187], v2 offset:6144
  v_add_f32_e32 v30, v30, v80
  v_mfma_f32_16x16x32_bf16 v[40:43], a[168:171], a[64:67], v[40:43]
  v_exp_f32_e32 v86, v86
  v_mfma_f32_16x16x32_bf16 v[40:43], a[172:175], a[68:71], v[40:43]
  ds_read_b128 a[188:191], v3 offset:6144
  v_add_f32_e32 v30, v30, v81
  v_mfma_f32_16x16x32_bf16 v[40:43], a[176:179], a[136:139], v[40:43]
  v_exp_f32_e32 v87, v87
  v_mfma_f32_16x16x32_bf16 v[40:43], a[180:183], a[140:143], v[40:43]
  ds_read_b128 a[192:195], v2 offset:6272
  v_cvt_pk_bf16_f32 v80, v80, v81
  v_mfma_f32_16x16x32_bf16 v[48:51], a[160:163], a[80:83], 0
  v_add_f32_e32 v30, v30, v82
  v_add_f32_e32 v30, v30, v83
  v_mfma_f32_16x16x32_bf16 v[48:51], a[164:167], a[84:87], v[48:51]
  ds_read_b128 a[196:199], v3 offset:6272
  v_cvt_pk_bf16_f32 v81, v82, v83
  v_mfma_f32_16x16x32_bf16 v[48:51], a[168:171], a[88:91], v[48:51]
  v_cvt_pk_bf16_f32 v82, v84, v85
  v_cvt_pk_bf16_f32 v83, v86, v87
  v_mfma_f32_16x16x32_bf16 v[48:51], a[172:175], a[92:95], v[48:51]
  ds_read_b128 a[200:203], v2 offset:6400
  v_fma_f32 v88, v88, s35, -v17
  v_mfma_f32_16x16x32_bf16 v[48:51], a[176:179], a[144:147], v[48:51]
  v_exp_f32_e32 v88, v88
  v_mfma_f32_16x16x32_bf16 v[48:51], a[180:183], a[148:151], v[48:51]
  ds_read_b128 a[204:207], v3 offset:6400
  v_fma_f32 v89, v89, s35, -v17
  v_mfma_f32_16x16x32_bf16 v[56:59], a[160:163], a[104:107], 0
  s_waitcnt vmcnt(12)
  s_barrier
  v_mfma_f32_16x16x32_bf16 v[56:59], a[164:167], a[108:111], v[56:59]
  s_add_u32 m0, s34, 36864
  v_exp_f32_e32 v89, v89
  v_mfma_f32_16x16x32_bf16 v[56:59], a[168:171], a[112:115], v[56:59]
  s_mov_b32 s32, 331776
  v_fma_f32 v90, v90, s35, -v17
  v_fma_f32 v91, v91, s35, -v17
  v_mfma_f32_16x16x32_bf16 v[56:59], a[172:175], a[116:119], v[56:59]
  buffer_load_dwordx4 v8, s[8:11], s32 offen nt lds
  v_mfma_f32_16x16x32_bf16 v[56:59], a[176:179], a[152:155], v[56:59]
  v_exp_f32_e32 v90, v90
  v_mfma_f32_16x16x32_bf16 v[56:59], a[180:183], a[156:159], v[56:59]
  s_waitcnt lgkmcnt(1)
  v_exp_f32_e32 v91, v91
  v_mfma_f32_16x16x32_bf16 v[36:39], a[184:187], a[32:35], 0
  v_fma_f32 v92, v92, s35, -v17
  v_fma_f32 v93, v93, s35, -v17
  v_mfma_f32_16x16x32_bf16 v[36:39], a[188:191], a[36:39], v[36:39]
  v_exp_f32_e32 v92, v92
  v_mfma_f32_16x16x32_bf16 v[36:39], a[192:195], a[40:43], v[36:39]
  v_exp_f32_e32 v93, v93
  v_mfma_f32_16x16x32_bf16 v[36:39], a[196:199], a[44:47], v[36:39]
  v_fma_f32 v94, v94, s35, -v17
  v_fma_f32 v95, v95, s35, -v17
  v_mfma_f32_16x16x32_bf16 v[36:39], a[200:203], a[128:131], v[36:39]
  s_waitcnt lgkmcnt(0)
  v_exp_f32_e32 v94, v94
  v_mfma_f32_16x16x32_bf16 v[36:39], a[204:207], a[132:135], v[36:39]
  v_exp_f32_e32 v95, v95
  v_mfma_f32_16x16x32_bf16 v[44:47], a[184:187], a[56:59], 0
  v_add_f32_e32 v31, v31, v88
  v_add_f32_e32 v31, v31, v89
  v_mfma_f32_16x16x32_bf16 v[44:47], a[188:191], a[60:63], v[44:47]
  v_cvt_pk_bf16_f32 v88, v88, v89
  v_add_f32_e32 v31, v31, v90
  v_mfma_f32_16x16x32_bf16 v[44:47], a[192:195], a[64:67], v[44:47]
  ds_read_b64_tr_b16 a[160:161], v4 offset:36864
  v_add_f32_e32 v31, v31, v91
  v_mfma_f32_16x16x32_bf16 v[44:47], a[196:199], a[68:71], v[44:47]
  buffer_load_dwordx4 v9, s[8:11], s32 offen offset:1024 nt lds
  v_mfma_f32_16x16x32_bf16 v[44:47], a[200:203], a[136:139], v[44:47]
  ds_read_b64_tr_b16 a[162:163], v4 offset:43008
  v_cvt_pk_bf16_f32 v89, v90, v91
  v_mfma_f32_16x16x32_bf16 v[44:47], a[204:207], a[140:143], v[44:47]
  v_cvt_pk_bf16_f32 v90, v92, v93
  v_cvt_pk_bf16_f32 v91, v94, v95
  v_mfma_f32_16x16x32_bf16 v[52:55], a[184:187], a[80:83], 0
  ds_read_b64_tr_b16 a[164:165], v5 offset:36864
  v_add_f32_e32 v0, v0, v76
  v_mfma_f32_16x16x32_bf16 v[52:55], a[188:191], a[84:87], v[52:55]
  v_add_f32_e32 v0, v0, v77
  v_add_f32_e32 v0, v0, v78
  v_mfma_f32_16x16x32_bf16 v[52:55], a[192:195], a[88:91], v[52:55]
  ds_read_b64_tr_b16 a[166:167], v5 offset:43008
  v_add_f32_e32 v0, v0, v79
  v_mfma_f32_16x16x32_bf16 v[52:55], a[196:199], a[92:95], v[52:55]
  buffer_store_dwordx4 a[100:103], v11, s[16:19], s82 offen offset:3200 nt
  v_mfma_f32_16x16x32_bf16 v[52:55], a[200:203], a[144:147], v[52:55]
  ds_read_b64_tr_b16 a[168:169], v6 offset:36864
  v_add_f32_e32 v30, v30, v84
  v_mfma_f32_16x16x32_bf16 v[52:55], a[204:207], a[148:151], v[52:55]
  v_add_f32_e32 v30, v30, v85
  v_add_f32_e32 v30, v30, v86
  v_mfma_f32_16x16x32_bf16 v[60:63], a[184:187], a[104:107], 0
  ds_read_b64_tr_b16 a[170:171], v6 offset:43008
  v_add_f32_e32 v30, v30, v87
  v_mfma_f32_16x16x32_bf16 v[60:63], a[188:191], a[108:111], v[60:63]
  v_add_f32_e32 v31, v31, v92
  v_add_f32_e32 v31, v31, v93
  v_mfma_f32_16x16x32_bf16 v[60:63], a[192:195], a[112:115], v[60:63]
  ds_read_b64_tr_b16 a[172:173], v7 offset:36864
  v_add_f32_e32 v31, v31, v94
  v_mfma_f32_16x16x32_bf16 v[60:63], a[196:199], a[116:119], v[60:63]
  buffer_load_dwordx4 v10, s[8:11], s32 offen offset:2048 nt lds
  v_mfma_f32_16x16x32_bf16 v[60:63], a[200:203], a[152:155], v[60:63]
  ds_read_b64_tr_b16 a[174:175], v7 offset:43008
  v_add_f32_e32 v31, v31, v95
  v_mfma_f32_16x16x32_bf16 v[60:63], a[204:207], a[156:159], v[60:63]
  v_fma_f32 v32, v32, s35, -v14
  v_fma_f32 v33, v33, s35, -v14
  v_mfma_f32_16x16x32_bf16 a[240:243], v[18:21], v[64:67], a[240:243]
  s_waitcnt lgkmcnt(4)
  ds_read_b64_tr_b16 a[176:177], v4 offset:36992
  v_fma_f32 v34, v34, s35, -v14
  v_mfma_f32_16x16x32_bf16 v[96:99], a[160:163], v[64:67], v[96:99]
  v_exp_f32_e32 v32, v32
  v_mfma_f32_16x16x32_bf16 v[100:103], a[160:163], v[72:75], v[100:103]
  ds_read_b64_tr_b16 a[178:179], v4 offset:43136
  v_fma_f32 v35, v35, s35, -v14
  v_mfma_f32_16x16x32_bf16 v[104:107], a[160:163], v[80:83], v[104:107]
  v_exp_f32_e32 v33, v33
  v_mfma_f32_16x16x32_bf16 v[108:111], a[160:163], v[88:91], v[108:111]
  ds_read_b64_tr_b16 a[180:181], v5 offset:36992
  v_fma_f32 v36, v36, s35, -v14
  v_mfma_f32_16x16x32_bf16 v[112:115], a[164:167], v[64:67], v[112:115]
  v_exp_f32_e32 v34, v34
  v_mfma_f32_16x16x32_bf16 v[116:119], a[164:167], v[72:75], v[116:119]
  ds_read_b64_tr_b16 a[182:183], v5 offset:43136
  v_fma_f32 v37, v37, s35, -v14
  v_mfma_f32_16x16x32_bf16 v[120:123], a[164:167], v[80:83], v[120:123]
  s_add_u32 m0, s34, 73728
  v_exp_f32_e32 v35, v35
  v_mfma_f32_16x16x32_bf16 v[124:127], a[164:167], v[88:91], v[124:127]
  s_waitcnt lgkmcnt(4)
  ds_read_b64_tr_b16 a[184:185], v6 offset:36992
  v_fma_f32 v38, v38, s35, -v14
  v_mfma_f32_16x16x32_bf16 v[128:131], a[168:171], v[64:67], v[128:131]
  s_mov_b32 s33, 319488
  v_exp_f32_e32 v36, v36
  v_mfma_f32_16x16x32_bf16 v[132:135], a[168:171], v[72:75], v[132:135]
  ds_read_b64_tr_b16 a[186:187], v6 offset:43136
  v_fma_f32 v39, v39, s35, -v14
  v_mfma_f32_16x16x32_bf16 v[136:139], a[168:171], v[80:83], v[136:139]
  buffer_load_dwordx4 v8, s[12:15], s33 offen nt lds
  v_mfma_f32_16x16x32_bf16 v[140:143], a[168:171], v[88:91], v[140:143]
  ds_read_b64_tr_b16 a[188:189], v7 offset:36992
  v_cvt_pk_bf16_f32 v32, v32, v33
  v_mfma_f32_16x16x32_bf16 v[144:147], a[172:175], v[64:67], v[144:147]
  v_exp_f32_e32 v37, v37
  v_mfma_f32_16x16x32_bf16 v[148:151], a[172:175], v[72:75], v[148:151]
  ds_read_b64_tr_b16 a[190:191], v7 offset:43136
  v_cvt_pk_bf16_f32 v33, v34, v35
  v_mfma_f32_16x16x32_bf16 v[152:155], a[172:175], v[80:83], v[152:155]
  v_exp_f32_e32 v38, v38
  v_mfma_f32_16x16x32_bf16 v[156:159], a[172:175], v[88:91], v[156:159]
  s_waitcnt lgkmcnt(4)
  ds_read_b64_tr_b16 a[192:193], v4 offset:37120
L_hop11:
  s_cbranch_execz L_hop15
  v_cvt_pk_bf16_f32 v34, v36, v37
  v_mfma_f32_16x16x32_bf16 v[160:163], a[176:179], v[64:67], v[160:163]
  v_exp_f32_e32 v39, v39
  v_mfma_f32_16x16x32_bf16 v[164:167], a[176:179], v[72:75], v[164:167]
  ds_read_b64_tr_b16 a[194:195], v4 offset:43264
  v_cvt_pk_bf16_f32 v35, v38, v39
  v_mfma_f32_16x16x32_bf16 v[168:171], a[176:179], v[80:83], v[168:171]
  v_fma_f32 v40, v40, s35, -v15
  v_fma_f32 v41, v41, s35, -v15
  v_mfma_f32_16x16x32_bf16 v[172:175], a[176:179], v[88:91], v[172:175]
  ds_read_b64_tr_b16 a[196:197], v5 offset:37120
  v_fma_f32 v42, v42, s35, -v15
  v_mfma_f32_16x16x32_bf16 v[176:179], a[180:183], v[64:67], v[176:179]
  v_exp_f32_e32 v40, v40
  v_mfma_f32_16x16x32_bf16 v[180:183], a[180:183], v[72:75], v[180:183]
  ds_read_b64_tr_b16 a[198:199], v5 offset:43264
  v_fma_f32 v43, v43, s35, -v15
  v_mfma_f32_16x16x32_bf16 v[184:187], a[180:183], v[80:83], v[184:187]
  buffer_load_dwordx4 v9, s[12:15], s33 offen offset:1024 nt lds
  v_mfma_f32_16x16x32_bf16 v[188:191], a[180:183], v[88:91], v[188:191]
  s_waitcnt lgkmcnt(4)
  ds_read_b64_tr_b16 a[200:201], v6 offset:37120
  v_fma_f32 v44, v44, s35, -v15
  v_mfma_f32_16x16x32_bf16 v[192:195], a[184:187], v[64:67], v[192:195]
  v_exp_f32_e32 v41, v41
  v_mfma_f32_16x16x32_bf16 v[196:199], a[184:187], v[72:75], v[196:199]
  ds_read_b64_tr_b16 a[202:203], v6 offset:43264
  v_fma_f32 v45, v45, s35, -v15
  v_mfma_f32_16x16x32_bf16 v[200:203], a[184:187], v[80:83], v[200:203]
  v_exp_f32_e32 v42, v42
  v_mfma_f32_16x16x32_bf16 v[204:207], a[184:187], v[88:91], v[204:207]
  ds_read_b64_tr_b16 a[204:205], v7 offset:37120
  v_fma_f32 v46, v46, s35, -v15
  v_mfma_f32_16x16x32_bf16 v[208:211], a[188:191], v[64:67], v[208:211]
  v_exp_f32_e32 v43, v43
  v_mfma_f32_16x16x32_bf16 v[212:215], a[188:191], v[72:75], v[212:215]
  ds_read_b64_tr_b16 a[206:207], v7 offset:43264
  v_fma_f32 v47, v47, s35, -v15
  v_mfma_f32_16x16x32_bf16 v[216:219], a[188:191], v[80:83], v[216:219]
  v_exp_f32_e32 v44, v44
  v_mfma_f32_16x16x32_bf16 v[220:223], a[188:191], v[88:91], v[220:223]
  s_waitcnt lgkmcnt(4)
  ds_read_b128 a[160:163], v2 offset:12288
  v_add_f32_e32 v0, v0, v40
  v_mfma_f32_16x16x32_bf16 v[224:227], a[192:195], v[64:67], v[224:227]
  v_exp_f32_e32 v45, v45
  v_mfma_f32_16x16x32_bf16 v[228:231], a[192:195], v[72:75], v[228:231]
  ds_read_b128 a[164:167], v3 offset:12288
  v_add_f32_e32 v0, v0, v41
  v_mfma_f32_16x16x32_bf16 v[232:235], a[192:195], v[80:83], v[232:235]
  buffer_load_dwordx4 v10, s[12:15], s33 offen offset:2048 nt lds
  v_mfma_f32_16x16x32_bf16 v[236:239], a[192:195], v[88:91], v[236:239]
  ds_read_b128 a[168:171], v2 offset:12416
  v_cvt_pk_bf16_f32 v40, v40, v41
  v_mfma_f32_16x16x32_bf16 v[240:243], a[196:199], v[64:67], v[240:243]
  v_exp_f32_e32 v46, v46
  v_mfma_f32_16x16x32_bf16 v[244:247], a[196:199], v[72:75], v[244:247]
  ds_read_b128 a[172:175], v3 offset:12416
  v_add_f32_e32 v0, v0, v42
  v_mfma_f32_16x16x32_bf16 v[248:251], a[196:199], v[80:83], v[248:251]
  buffer_store_dwordx4 a[120:123], v11, s[16:19], s83 offen offset:128 nt
  v_mfma_f32_16x16x32_bf16 v[252:255], a[196:199], v[88:91], v[252:255]
  s_waitcnt lgkmcnt(3)
  ds_read_b128 a[176:179], v2 offset:12544
  v_add_f32_e32 v0, v0, v43
  v_mfma_f32_16x16x32_bf16 a[0:3], a[200:203], v[64:67], a[0:3]
  v_exp_f32_e32 v47, v47
  v_mfma_f32_16x16x32_bf16 a[4:7], a[200:203], v[72:75], a[4:7]
  ds_read_b128 a[180:183], v3 offset:12544
  v_cvt_pk_bf16_f32 v41, v42, v43
  v_mfma_f32_16x16x32_bf16 a[8:11], a[200:203], v[80:83], a[8:11]
  v_cvt_pk_bf16_f32 v42, v44, v45
  v_cvt_pk_bf16_f32 v43, v46, v47
  v_mfma_f32_16x16x32_bf16 a[12:15], a[200:203], v[88:91], a[12:15]
  v_fma_f32 v48, v48, s35, -v16
  v_fma_f32 v49, v49, s35, -v16
  v_mfma_f32_16x16x32_bf16 a[16:19], a[204:207], v[64:67], a[16:19]
  v_exp_f32_e32 v48, v48
  v_mfma_f32_16x16x32_bf16 a[20:23], a[204:207], v[72:75], a[20:23]
  v_exp_f32_e32 v49, v49
  v_mfma_f32_16x16x32_bf16 a[24:27], a[204:207], v[80:83], a[24:27]
  v_fma_f32 v50, v50, s35, -v16
  v_fma_f32 v51, v51, s35, -v16
  v_mfma_f32_16x16x32_bf16 a[28:31], a[204:207], v[88:91], a[28:31]
  v_exp_f32_e32 v50, v50
  v_mfma_f32_16x16x32_bf16 v[64:67], a[160:163], a[32:35], 0
  s_waitcnt lgkmcnt(1)
  v_exp_f32_e32 v51, v51
  v_mfma_f32_16x16x32_bf16 v[64:67], a[164:167], a[36:39], v[64:67]
  v_fma_f32 v52, v52, s35, -v16
  v_fma_f32 v53, v53, s35, -v16
  v_mfma_f32_16x16x32_bf16 v[64:67], a[168:171], a[40:43], v[64:67]
  v_exp_f32_e32 v52, v52
  v_mfma_f32_16x16x32_bf16 v[64:67], a[172:175], a[44:47], v[64:67]
  v_exp_f32_e32 v53, v53
  v_mfma_f32_16x16x32_bf16 v[64:67], a[176:179], a[128:131], v[64:67]
  s_waitcnt lgkmcnt(0)
  v_fma_f32 v54, v54, s35, -v16
  v_fma_f32 v55, v55, s35, -v16
  v_mfma_f32_16x16x32_bf16 v[64:67], a[180:183], a[132:135], v[64:67]
  v_exp_f32_e32 v54, v54
  v_mfma_f32_16x16x32_bf16 v[72:75], a[160:163], a[56:59], 0
  v_exp_f32_e32 v55, v55
  v_mfma_f32_16x16x32_bf16 v[72:75], a[164:167], a[60:63], v[72:75]
  ds_read_b128 a[184:187], v2 offset:18432
  v_add_f32_e32 v30, v30, v48
  v_mfma_f32_16x16x32_bf16 v[72:75], a[168:171], a[64:67], v[72:75]
  v_add_f32_e32 v30, v30, v49
  v_cvt_pk_bf16_f32 v48, v48, v49
  v_mfma_f32_16x16x32_bf16 v[72:75], a[172:175], a[68:71], v[72:75]
  ds_read_b128 a[188:191], v3 offset:18432
  v_add_f32_e32 v30, v30, v50
  v_mfma_f32_16x16x32_bf16 v[72:75], a[176:179], a[136:139], v[72:75]
  v_add_f32_e32 v30, v30, v51
  v_cvt_pk_bf16_f32 v49, v50, v51
  v_mfma_f32_16x16x32_bf16 v[72:75], a[180:183], a[140:143], v[72:75]
  ds_read_b128 a[192:195], v2 offset:18560
  v_cvt_pk_bf16_f32 v50, v52, v53
  v_mfma_f32_16x16x32_bf16 v[80:83], a[160:163], a[80:83], 0
  v_cvt_pk_bf16_f32 v51, v54, v55
  v_fma_f32 v56, v56, s35, -v17
  v_mfma_f32_16x16x32_bf16 v[80:83], a[164:167], a[84:87], v[80:83]
  ds_read_b128 a[196:199], v3 offset:18560
  v_fma_f32 v57, v57, s35, -v17
  v_mfma_f32_16x16x32_bf16 v[80:83], a[168:171], a[88:91], v[80:83]
  v_exp_f32_e32 v56, v56
  v_mfma_f32_16x16x32_bf16 v[80:83], a[172:175], a[92:95], v[80:83]
  ds_read_b128 a[200:203], v2 offset:18688
  v_fma_f32 v58, v58, s35, -v17
  v_mfma_f32_16x16x32_bf16 v[80:83], a[176:179], a[144:147], v[80:83]
  v_exp_f32_e32 v57, v57
  v_mfma_f32_16x16x32_bf16 v[80:83], a[180:183], a[148:151], v[80:83]
  ds_read_b128 a[204:207], v3 offset:18688
  v_fma_f32 v59, v59, s35, -v17
  v_mfma_f32_16x16x32_bf16 v[88:91], a[160:163], a[104:107], 0
  s_waitcnt vmcnt(12)
  s_barrier
  v_mfma_f32_16x16x32_bf16 v[88:91], a[164:167], a[108:111], v[88:91]
  s_add_u32 m0, s34, 0
  v_exp_f32_e32 v58, v58
  v_mfma_f32_16x16x32_bf16 v[88:91], a[168:171], a[112:115], v[88:91]
  s_mov_b32 s32, 344064
  v_exp_f32_e32 v59, v59
  v_mfma_f32_16x16x32_bf16 v[88:91], a[172:175], a[116:119], v[88:91]
  buffer_load_dwordx4 v8, s[8:11], s32 offen nt lds
  v_mfma_f32_16x16x32_bf16 v[88:91], a[176:179], a[152:155], v[88:91]
  v_fma_f32 v60, v60, s35, -v17
  v_fma_f32 v61, v61, s35, -v17
  v_mfma_f32_16x16x32_bf16 v[88:91], a[180:183], a[156:159], v[88:91]
  s_waitcnt lgkmcnt(1)
  v_exp_f32_e32 v60, v60
  v_mfma_f32_16x16x32_bf16 v[68:71], a[184:187], a[32:35], 0
  v_exp_f32_e32 v61, v61
  v_mfma_f32_16x16x32_bf16 v[68:71], a[188:191], a[36:39], v[68:71]
  v_fma_f32 v62, v62, s35, -v17
  v_fma_f32 v63, v63, s35, -v17
  v_mfma_f32_16x16x32_bf16 v[68:71], a[192:195], a[40:43], v[68:71]
  v_exp_f32_e32 v62, v62
  v_mfma_f32_16x16x32_bf16 v[68:71], a[196:199], a[44:47], v[68:71]
  v_exp_f32_e32 v63, v63
  v_mfma_f32_16x16x32_bf16 v[68:71], a[200:203], a[128:131], v[68:71]
  s_waitcnt lgkmcnt(0)
  v_add_f32_e32 v31, v31, v56
  v_add_f32_e32 v31, v31, v57
  v_mfma_f32_16x16x32_bf16 v[68:71], a[204:207], a[132:135], v[68:71]
  v_cvt_pk_bf16_f32 v56, v56, v57
  v_add_f32_e32 v31, v31, v58
  v_mfma_f32_16x16x32_bf16 v[76:79], a[184:187], a[56:59], 0
  v_add_f32_e32 v31, v31, v59
  v_cvt_pk_bf16_f32 v57, v58, v59
  v_mfma_f32_16x16x32_bf16 v[76:79], a[188:191], a[60:63], v[76:79]
  v_cvt_pk_bf16_f32 v58, v60, v61
  v_cvt_pk_bf16_f32 v59, v62, v63
  v_mfma_f32_16x16x32_bf16 v[76:79], a[192:195], a[64:67], v[76:79]
  ds_read_b64_tr_b16 a[160:161], v4 offset:0
  v_add_f32_e32 v0, v0, v44
  v_mfma_f32_16x16x32_bf16 v[76:79], a[196:199], a[68:71], v[76:79]
  buffer_load_dwordx4 v9, s[8:11], s32 offen offset:1024 nt lds
  v_mfma_f32_16x16x32_bf16 v[76:79], a[200:203], a[136:139], v[76:79]
  ds_read_b64_tr_b16 a[162:163], v4 offset:6144
  v_add_f32_e32 v0, v0, v45
  v_mfma_f32_16x16x32_bf16 v[76:79], a[204:207], a[140:143], v[76:79]
  v_add_f32_e32 v0, v0, v46
  v_add_f32_e32 v0, v0, v47
  v_mfma_f32_16x16x32_bf16 v[84:87], a[184:187], a[80:83], 0
  ds_read_b64_tr_b16 a[164:165], v5 offset:0
  v_add_f32_e32 v30, v30, v52
  v_mfma_f32_16x16x32_bf16 v[84:87], a[188:191], a[84:87], v[84:87]
  v_add_f32_e32 v30, v30, v53
  v_add_f32_e32 v30, v30, v54
  v_mfma_f32_16x16x32_bf16 v[84:87], a[192:195], a[88:91], v[84:87]
  ds_read_b64_tr_b16 a[166:167], v5 offset:6144
  v_add_f32_e32 v30, v30, v55
  v_mfma_f32_16x16x32_bf16 v[84:87], a[196:199], a[92:95], v[84:87]
  buffer_store_dwordx4 a[124:127], v11, s[16:19], s83 offen offset:3200 nt
  v_mfma_f32_16x16x32_bf16 v[84:87], a[200:203], a[144:147], v[84:87]
  ds_read_b64_tr_b16 a[168:169], v6 offset:0
  v_add_f32_e32 v31, v31, v60
  v_mfma_f32_16x16x32_bf16 v[84:87], a[204:207], a[148:151], v[84:87]
  v_add_f32_e32 v31, v31, v61
  v_add_f32_e32 v31, v31, v62
  v_mfma_f32_16x16x32_bf16 v[92:95], a[184:187], a[104:107], 0
  ds_read_b64_tr_b16 a[170:171], v6 offset:6144
  v_add_f32_e32 v31, v31, v63
  v_mfma_f32_16x16x32_bf16 v[92:95], a[188:191], a[108:111], v[92:95]
  v_fma_f32 v64, v64, s35, -v14
  v_fma_f32 v65, v65, s35, -v14
  v_mfma_f32_16x16x32_bf16 v[92:95], a[192:195], a[112:115], v[92:95]
  ds_read_b64_tr_b16 a[172:173], v7 offset:0
  v_fma_f32 v66, v66, s35, -v14
  v_mfma_f32_16x16x32_bf16 v[92:95], a[196:199], a[116:119], v[92:95]
  buffer_load_dwordx4 v10, s[8:11], s32 offen offset:2048 nt lds
  v_mfma_f32_16x16x32_bf16 v[92:95], a[200:203], a[152:155], v[92:95]
  ds_read_b64_tr_b16 a[174:175], v7 offset:6144
  v_fma_f32 v67, v67, s35, -v14
  v_mfma_f32_16x16x32_bf16 v[92:95], a[204:207], a[156:159], v[92:95]
  v_exp_f32_e32 v64, v64
  v_mfma_f32_16x16x32_bf16 a[240:243], v[18:21], v[32:35], a[240:243]
  s_waitcnt lgkmcnt(4)
  ds_read_b64_tr_b16 a[176:177], v4 offset:128
  v_fma_f32 v68, v68, s35, -v14
  v_mfma_f32_16x16x32_bf16 v[96:99], a[160:163], v[32:35], v[96:99]
  v_exp_f32_e32 v65, v65
  v_mfma_f32_16x16x32_bf16 v[100:103], a[160:163], v[40:43], v[100:103]
  ds_read_b64_tr_b16 a[178:179], v4 offset:6272
  v_fma_f32 v69, v69, s35, -v14
  v_mfma_f32_16x16x32_bf16 v[104:107], a[160:163], v[48:51], v[104:107]
  v_exp_f32_e32 v66, v66
  v_mfma_f32_16x16x32_bf16 v[108:111], a[160:163], v[56:59], v[108:111]
  ds_read_b64_tr_b16 a[180:181], v5 offset:128
  v_fma_f32 v70, v70, s35, -v14
  v_mfma_f32_16x16x32_bf16 v[112:115], a[164:167], v[32:35], v[112:115]
  v_exp_f32_e32 v67, v67
  v_mfma_f32_16x16x32_bf16 v[116:119], a[164:167], v[40:43], v[116:119]
  ds_read_b64_tr_b16 a[182:183], v5 offset:6272
  v_fma_f32 v71, v71, s35, -v14
  v_mfma_f32_16x16x32_bf16 v[120:123], a[164:167], v[48:51], v[120:123]
  s_add_u32 m0, s34, 86016
  v_exp_f32_e32 v68, v68
  v_mfma_f32_16x16x32_bf16 v[124:127], a[164:167], v[56:59], v[124:127]
  s_waitcnt lgkmcnt(4)
  ds_read_b64_tr_b16 a[184:185], v6 offset:128
  v_cvt_pk_bf16_f32 v64, v64, v65
  v_mfma_f32_16x16x32_bf16 v[128:131], a[168:171], v[32:35], v[128:131]
  s_mov_b32 s33, 331776
  v_exp_f32_e32 v69, v69
  v_mfma_f32_16x16x32_bf16 v[132:135], a[168:171], v[40:43], v[132:135]
  ds_read_b64_tr_b16 a[186:187], v6 offset:6272
  v_cvt_pk_bf16_f32 v65, v66, v67
  v_mfma_f32_16x16x32_bf16 v[136:139], a[168:171], v[48:51], v[136:139]
  buffer_load_dwordx4 v8, s[12:15], s33 offen nt lds
  v_mfma_f32_16x16x32_bf16 v[140:143], a[168:171], v[56:59], v[140:143]
  ds_read_b64_tr_b16 a[188:189], v7 offset:128
  v_cvt_pk_bf16_f32 v66, v68, v69
  v_mfma_f32_16x16x32_bf16 v[144:147], a[172:175], v[32:35], v[144:147]
  v_exp_f32_e32 v70, v70
  v_mfma_f32_16x16x32_bf16 v[148:151], a[172:175], v[40:43], v[148:151]
  ds_read_b64_tr_b16 a[190:191], v7 offset:6272
  v_fma_f32 v72, v72, s35, -v15
  v_mfma_f32_16x16x32_bf16 v[152:155], a[172:175], v[48:51], v[152:155]
  v_exp_f32_e32 v71, v71
  v_mfma_f32_16x16x32_bf16 v[156:159], a[172:175], v[56:59], v[156:159]
  s_waitcnt lgkmcnt(4)
  ds_read_b64_tr_b16 a[192:193], v4 offset:256
  v_cvt_pk_bf16_f32 v67, v70, v71
  v_mfma_f32_16x16x32_bf16 v[160:163], a[176:179], v[32:35], v[160:163]
  v_exp_f32_e32 v72, v72
  v_mfma_f32_16x16x32_bf16 v[164:167], a[176:179], v[40:43], v[164:167]
  ds_read_b64_tr_b16 a[194:195], v4 offset:6400
  v_fma_f32 v73, v73, s35, -v15
  v_mfma_f32_16x16x32_bf16 v[168:171], a[176:179], v[48:51], v[168:171]
  v_exp_f32_e32 v73, v73
  v_mfma_f32_16x16x32_bf16 v[172:175], a[176:179], v[56:59], v[172:175]
  ds_read_b64_tr_b16 a[196:197], v5 offset:256
  v_fma_f32 v74, v74, s35, -v15
  v_mfma_f32_16x16x32_bf16 v[176:179], a[180:183], v[32:35], v[176:179]
  v_exp_f32_e32 v74, v74
  v_mfma_f32_16x16x32_bf16 v[180:183], a[180:183], v[40:43], v[180:183]
  ds_read_b64_tr_b16 a[198:199], v5 offset:6400
  v_fma_f32 v75, v75, s35, -v15
  v_mfma_f32_16x16x32_bf16 v[184:187], a[180:183], v[48:51], v[184:187]
  buffer_load_dwordx4 v9, s[12:15], s33 offen offset:1024 nt lds
  v_mfma_f32_16x16x32_bf16 v[188:191], a[180:183], v[56:59], v[188:191]
  s_waitcnt lgkmcnt(4)
  ds_read_b64_tr_b16 a[200:201], v6 offset:256
  v_fma_f32 v76, v76, s35, -v15
  v_mfma_f32_16x16x32_bf16 v[192:195], a[184:187], v[32:35], v[192:195]
  v_exp_f32_e32 v75, v75
  v_mfma_f32_16x16x32_bf16 v[196:199], a[184:187], v[40:43], v[196:199]
  ds_read_b64_tr_b16 a[202:203], v6 offset:6400
  v_fma_f32 v77, v77, s35, -v15
  v_mfma_f32_16x16x32_bf16 v[200:203], a[184:187], v[48:51], v[200:203]
  v_exp_f32_e32 v76, v76
  v_mfma_f32_16x16x32_bf16 v[204:207], a[184:187], v[56:59], v[204:207]
  ds_read_b64_tr_b16 a[204:205], v7 offset:256
  v_fma_f32 v78, v78, s35, -v15
  v_mfma_f32_16x16x32_bf16 v[208:211], a[188:191], v[32:35], v[208:211]
  v_exp_f32_e32 v77, v77
  v_mfma_f32_16x16x32_bf16 v[212:215], a[188:191], v[40:43], v[212:215]
  ds_read_b64_tr_b16 a[206:207], v7 offset:6400
  v_fma_f32 v79, v79, s35, -v15
  v_mfma_f32_16x16x32_bf16 v[216:219], a[188:191], v[48:51], v[216:219]
  v_exp_f32_e32 v78, v78
  v_mfma_f32_16x16x32_bf16 v[220:223], a[188:191], v[56:59], v[220:223]
  s_waitcnt lgkmcnt(4)
  ds_read_b128 a[160:163], v2 offset:24576
  v_add_f32_e32 v0, v0, v72
  v_mfma_f32_16x16x32_bf16 v[224:227], a[192:195], v[32:35], v[224:227]
  v_exp_f32_e32 v79, v79
  v_mfma_f32_16x16x32_bf16 v[228:231], a[192:195], v[40:43], v[228:231]
  ds_read_b128 a[164:167], v3 offset:24576
  v_add_f32_e32 v0, v0, v73
  v_mfma_f32_16x16x32_bf16 v[232:235], a[192:195], v[48:51], v[232:235]
  buffer_load_dwordx4 v10, s[12:15], s33 offen offset:2048 nt lds
  v_mfma_f32_16x16x32_bf16 v[236:239], a[192:195], v[56:59], v[236:239]
  ds_read_b128 a[168:171], v2 offset:24704
  v_cvt_pk_bf16_f32 v72, v72, v73
  v_mfma_f32_16x16x32_bf16 v[240:243], a[196:199], v[32:35], v[240:243]
  v_add_f32_e32 v0, v0, v74
  v_add_f32_e32 v0, v0, v75
  v_mfma_f32_16x16x32_bf16 v[244:247], a[196:199], v[40:43], v[244:247]
  ds_read_b128 a[172:175], v3 offset:24704
  v_cvt_pk_bf16_f32 v73, v74, v75
  v_mfma_f32_16x16x32_bf16 v[248:251], a[196:199], v[48:51], v[248:251]
  buffer_store_dwordx4 a[208:211], v11, s[16:19], s80 offen offset:256 nt
  v_mfma_f32_16x16x32_bf16 v[252:255], a[196:199], v[56:59], v[252:255]
  s_waitcnt lgkmcnt(3)
  ds_read_b128 a[176:179], v2 offset:24832
  v_cvt_pk_bf16_f32 v74, v76, v77
  v_mfma_f32_16x16x32_bf16 a[0:3], a[200:203], v[32:35], a[0:3]
  v_cvt_pk_bf16_f32 v75, v78, v79
  v_fma_f32 v80, v80, s35, -v16
  v_mfma_f32_16x16x32_bf16 a[4:7], a[200:203], v[40:43], a[4:7]
  ds_read_b128 a[180:183], v3 offset:24832
  v_fma_f32 v81, v81, s35, -v16
  v_mfma_f32_16x16x32_bf16 a[8:11], a[200:203], v[48:51], a[8:11]
  v_exp_f32_e32 v80, v80
  v_mfma_f32_16x16x32_bf16 a[12:15], a[200:203], v[56:59], a[12:15]
  v_exp_f32_e32 v81, v81
  v_mfma_f32_16x16x32_bf16 a[16:19], a[204:207], v[32:35], a[16:19]
  v_fma_f32 v82, v82, s35, -v16
  v_fma_f32 v83, v83, s35, -v16
  v_mfma_f32_16x16x32_bf16 a[20:23], a[204:207], v[40:43], a[20:23]
  v_exp_f32_e32 v82, v82
  v_mfma_f32_16x16x32_bf16 a[24:27], a[204:207], v[48:51], a[24:27]
  v_exp_f32_e32 v83, v83
  v_mfma_f32_16x16x32_bf16 a[28:31], a[204:207], v[56:59], a[28:31]
  v_fma_f32 v84, v84, s35, -v16
  v_fma_f32 v85, v85, s35, -v16
  v_mfma_f32_16x16x32_bf16 v[32:35], a[160:163], a[32:35], 0
  s_waitcnt lgkmcnt(1)
  v_exp_f32_e32 v84, v84
  v_mfma_f32_16x16x32_bf16 v[32:35], a[164:167], a[36:39], v[32:35]
  v_exp_f32_e32 v85, v85
  v_mfma_f32_16x16x32_bf16 v[32:35], a[168:171], a[40:43], v[32:35]
  v_fma_f32 v86, v86, s35, -v16
  v_fma_f32 v87, v87, s35, -v16
  v_mfma_f32_16x16x32_bf16 v[32:35], a[172:175], a[44:47], v[32:35]
  v_exp_f32_e32 v86, v86
  v_mfma_f32_16x16x32_bf16 v[32:35], a[176:179], a[128:131], v[32:35]
  s_waitcnt lgkmcnt(0)
  v_exp_f32_e32 v87, v87
  v_mfma_f32_16x16x32_bf16 v[32:35], a[180:183], a[132:135], v[32:35]
  v_add_f32_e32 v30, v30, v80
  v_add_f32_e32 v30, v30, v81
  v_mfma_f32_16x16x32_bf16 v[40:43], a[160:163], a[56:59], 0
  v_cvt_pk_bf16_f32 v80, v80, v81
  v_add_f32_e32 v30, v30, v82
  v_mfma_f32_16x16x32_bf16 v[40:43], a[164:167], a[60:63], v[40:43]
  ds_read_b128 a[184:187], v2 offset:30720
  v_add_f32_e32 v30, v30, v83
  v_mfma_f32_16x16x32_bf16 v[40:43], a[168:171], a[64:67], v[40:43]
  v_cvt_pk_bf16_f32 v81, v82, v83
  v_cvt_pk_bf16_f32 v82, v84, v85
  v_mfma_f32_16x16x32_bf16 v[40:43], a[172:175], a[68:71], v[40:43]
  ds_read_b128 a[188:191], v3 offset:30720
  v_cvt_pk_bf16_f32 v83, v86, v87
  v_mfma_f32_16x16x32_bf16 v[40:43], a[176:179], a[136:139], v[40:43]
  v_fma_f32 v88, v88, s35, -v17
  v_fma_f32 v89, v89, s35, -v17
  v_mfma_f32_16x16x32_bf16 v[40:43], a[180:183], a[140:143], v[40:43]
  ds_read_b128 a[192:195], v2 offset:30848
  v_fma_f32 v90, v90, s35, -v17
  v_mfma_f32_16x16x32_bf16 v[48:51], a[160:163], a[80:83], 0
  v_exp_f32_e32 v88, v88
  v_mfma_f32_16x16x32_bf16 v[48:51], a[164:167], a[84:87], v[48:51]
  ds_read_b128 a[196:199], v3 offset:30848
  v_fma_f32 v91, v91, s35, -v17
  v_mfma_f32_16x16x32_bf16 v[48:51], a[168:171], a[88:91], v[48:51]
  v_exp_f32_e32 v89, v89
  v_mfma_f32_16x16x32_bf16 v[48:51], a[172:175], a[92:95], v[48:51]
  ds_read_b128 a[200:203], v2 offset:30976
  v_fma_f32 v92, v92, s35, -v17
  v_mfma_f32_16x16x32_bf16 v[48:51], a[176:179], a[144:147], v[48:51]
  v_exp_f32_e32 v90, v90
  v_mfma_f32_16x16x32_bf16 v[48:51], a[180:183], a[148:151], v[48:51]
  ds_read_b128 a[204:207], v3 offset:30976
  v_fma_f32 v93, v93, s35, -v17
  v_mfma_f32_16x16x32_bf16 v[56:59], a[160:163], a[104:107], 0
  s_waitcnt vmcnt(12)
  s_barrier
  v_mfma_f32_16x16x32_bf16 v[56:59], a[164:167], a[108:111], v[56:59]
  s_add_u32 m0, s34, 12288
  v_exp_f32_e32 v91, v91
  v_mfma_f32_16x16x32_bf16 v[56:59], a[168:171], a[112:115], v[56:59]
  s_mov_b32 s32, 356352
  v_exp_f32_e32 v92, v92
  v_mfma_f32_16x16x32_bf16 v[56:59], a[172:175], a[116:119], v[56:59]
  buffer_load_dwordx4 v8, s[8:11], s32 offen nt lds
  v_mfma_f32_16x16x32_bf16 v[56:59], a[176:179], a[152:155], v[56:59]
  v_exp_f32_e32 v93, v93
  v_mfma_f32_16x16x32_bf16 v[56:59], a[180:183], a[156:159], v[56:59]
  s_waitcnt lgkmcnt(1)
  v_fma_f32 v94, v94, s35, -v17
  v_fma_f32 v95, v95, s35, -v17
  v_mfma_f32_16x16x32_bf16 v[36:39], a[184:187], a[32:35], 0
  v_exp_f32_e32 v94, v94
  v_mfma_f32_16x16x32_bf16 v[36:39], a[188:191], a[36:39], v[36:39]
  v_exp_f32_e32 v95, v95
  v_mfma_f32_16x16x32_bf16 v[36:39], a[192:195], a[40:43], v[36:39]
  v_add_f32_e32 v31, v31, v88
  v_add_f32_e32 v31, v31, v89
  v_mfma_f32_16x16x32_bf16 v[36:39], a[196:199], a[44:47], v[36:39]
  v_cvt_pk_bf16_f32 v88, v88, v89
  v_add_f32_e32 v31, v31, v90
  v_mfma_f32_16x16x32_bf16 v[36:39], a[200:203], a[128:131], v[36:39]
  s_waitcnt lgkmcnt(0)
  v_add_f32_e32 v31, v31, v91
  v_cvt_pk_bf16_f32 v89, v90, v91
  v_mfma_f32_16x16x32_bf16 v[36:39], a[204:207], a[132:135], v[36:39]
  v_cvt_pk_bf16_f32 v90, v92, v93
  v_cvt_pk_bf16_f32 v91, v94, v95
  v_mfma_f32_16x16x32_bf16 v[44:47], a[184:187], a[56:59], 0
  v_add_f32_e32 v0, v0, v76
  v_add_f32_e32 v0, v0, v77
  v_mfma_f32_16x16x32_bf16 v[44:47], a[188:191], a[60:63], v[44:47]
  v_add_f32_e32 v0, v0, v78
  v_add_f32_e32 v0, v0, v79
  v_mfma_f32_16x16x32_bf16 v[44:47], a[192:195], a[64:67], v[44:47]
  ds_read_b64_tr_b16 a[160:161], v4 offset:12288
  v_add_f32_e32 v30, v30, v84
  v_mfma_f32_16x16x32_bf16 v[44:47], a[196:199], a[68:71], v[44:47]
  buffer_load_dwordx4 v9, s[8:11], s32 offen offset:1024 nt lds
  v_mfma_f32_16x16x32_bf16 v[44:47], a[200:203], a[136:139], v[44:47]
  ds_read_b64_tr_b16 a[162:163], v4 offset:18432
  v_add_f32_e32 v30, v30, v85
  v_mfma_f32_16x16x32_bf16 v[44:47], a[204:207], a[140:143], v[44:47]
  v_add_f32_e32 v30, v30, v86
  v_add_f32_e32 v30, v30, v87
  v_mfma_f32_16x16x32_bf16 v[52:55], a[184:187], a[80:83], 0
  ds_read_b64_tr_b16 a[164:165], v5 offset:12288
  v_add_f32_e32 v31, v31, v92
  v_mfma_f32_16x16x32_bf16 v[52:55], a[188:191], a[84:87], v[52:55]
  v_add_f32_e32 v31, v31, v93
  v_add_f32_e32 v31, v31, v94
  v_mfma_f32_16x16x32_bf16 v[52:55], a[192:195], a[88:91], v[52:55]
  ds_read_b64_tr_b16 a[166:167], v5 offset:18432
  v_add_f32_e32 v31, v31, v95
  v_mfma_f32_16x16x32_bf16 v[52:55], a[196:199], a[92:95], v[52:55]
  buffer_store_dwordx4 a[212:215], v11, s[16:19], s80 offen offset:3328 nt
  v_mfma_f32_16x16x32_bf16 v[52:55], a[200:203], a[144:147], v[52:55]
  ds_read_b64_tr_b16 a[168:169], v6 offset:12288
  v_fma_f32 v32, v32, s35, -v14
  v_mfma_f32_16x16x32_bf16 v[52:55], a[204:207], a[148:151], v[52:55]
  v_exp_f32_e32 v32, v32
  v_mfma_f32_16x16x32_bf16 v[60:63], a[184:187], a[104:107], 0
  ds_read_b64_tr_b16 a[170:171], v6 offset:18432
  v_fma_f32 v33, v33, s35, -v14
  v_mfma_f32_16x16x32_bf16 v[60:63], a[188:191], a[108:111], v[60:63]
  v_exp_f32_e32 v33, v33
  v_mfma_f32_16x16x32_bf16 v[60:63], a[192:195], a[112:115], v[60:63]
  ds_read_b64_tr_b16 a[172:173], v7 offset:12288
  v_fma_f32 v34, v34, s35, -v14
  v_mfma_f32_16x16x32_bf16 v[60:63], a[196:199], a[116:119], v[60:63]
  buffer_load_dwordx4 v10, s[8:11], s32 offen offset:2048 nt lds
  v_mfma_f32_16x16x32_bf16 v[60:63], a[200:203], a[152:155], v[60:63]
  ds_read_b64_tr_b16 a[174:175], v7 offset:18432
  v_fma_f32 v35, v35, s35, -v14
  v_mfma_f32_16x16x32_bf16 v[60:63], a[204:207], a[156:159], v[60:63]
  v_exp_f32_e32 v34, v34
  v_mfma_f32_16x16x32_bf16 a[240:243], v[18:21], v[64:67], a[240:243]
  s_waitcnt lgkmcnt(4)
  ds_read_b64_tr_b16 a[176:177], v4 offset:12416
  v_fma_f32 v36, v36, s35, -v14
  v_mfma_f32_16x16x32_bf16 v[96:99], a[160:163], v[64:67], v[96:99]
  v_exp_f32_e32 v35, v35
  v_mfma_f32_16x16x32_bf16 v[100:103], a[160:163], v[72:75], v[100:103]
  ds_read_b64_tr_b16 a[178:179], v4 offset:18560
  v_fma_f32 v37, v37, s35, -v14
  v_mfma_f32_16x16x32_bf16 v[104:107], a[160:163], v[80:83], v[104:107]
  v_exp_f32_e32 v36, v36
  v_mfma_f32_16x16x32_bf16 v[108:111], a[160:163], v[88:91], v[108:111]
  ds_read_b64_tr_b16 a[180:181], v5 offset:12416
  v_fma_f32 v38, v38, s35, -v14
  v_mfma_f32_16x16x32_bf16 v[112:115], a[164:167], v[64:67], v[112:115]
  v_exp_f32_e32 v37, v37
  v_mfma_f32_16x16x32_bf16 v[116:119], a[164:167], v[72:75], v[116:119]
  ds_read_b64_tr_b16 a[182:183], v5 offset:18560
  v_fma_f32 v39, v39, s35, -v14
  v_mfma_f32_16x16x32_bf16 v[120:123], a[164:167], v[80:83], v[120:123]
  s_add_u32 m0, s34, 49152
  v_exp_f32_e32 v38, v38
  v_mfma_f32_16x16x32_bf16 v[124:127], a[164:167], v[88:91], v[124:127]
  s_waitcnt lgkmcnt(4)
  ds_read_b64_tr_b16 a[184:185], v6 offset:12416
  v_cvt_pk_bf16_f32 v32, v32, v33
  v_mfma_f32_16x16x32_bf16 v[128:131], a[168:171], v[64:67], v[128:131]
  s_mov_b32 s33, 344064
  v_exp_f32_e32 v39, v39
  v_mfma_f32_16x16x32_bf16 v[132:135], a[168:171], v[72:75], v[132:135]
  ds_read_b64_tr_b16 a[186:187], v6 offset:18560
  v_cvt_pk_bf16_f32 v33, v34, v35
  v_mfma_f32_16x16x32_bf16 v[136:139], a[168:171], v[80:83], v[136:139]
  buffer_load_dwordx4 v8, s[12:15], s33 offen nt lds
  v_mfma_f32_16x16x32_bf16 v[140:143], a[168:171], v[88:91], v[140:143]
  ds_read_b64_tr_b16 a[188:189], v7 offset:12416
  v_cvt_pk_bf16_f32 v34, v36, v37
  v_mfma_f32_16x16x32_bf16 v[144:147], a[172:175], v[64:67], v[144:147]
  v_cvt_pk_bf16_f32 v35, v38, v39
  v_fma_f32 v40, v40, s35, -v15
  v_mfma_f32_16x16x32_bf16 v[148:151], a[172:175], v[72:75], v[148:151]
  ds_read_b64_tr_b16 a[190:191], v7 offset:18560
  v_fma_f32 v41, v41, s35, -v15
  v_mfma_f32_16x16x32_bf16 v[152:155], a[172:175], v[80:83], v[152:155]
  v_exp_f32_e32 v40, v40
  v_mfma_f32_16x16x32_bf16 v[156:159], a[172:175], v[88:91], v[156:159]
  s_waitcnt lgkmcnt(4)
  ds_read_b64_tr_b16 a[192:193], v4 offset:12544
  v_fma_f32 v42, v42, s35, -v15
  v_mfma_f32_16x16x32_bf16 v[160:163], a[176:179], v[64:67], v[160:163]
  v_exp_f32_e32 v41, v41
  v_mfma_f32_16x16x32_bf16 v[164:167], a[176:179], v[72:75], v[164:167]
  ds_read_b64_tr_b16 a[194:195], v4 offset:18688
  v_fma_f32 v43, v43, s35, -v15
  v_mfma_f32_16x16x32_bf16 v[168:171], a[176:179], v[80:83], v[168:171]
  v_exp_f32_e32 v42, v42
  v_mfma_f32_16x16x32_bf16 v[172:175], a[176:179], v[88:91], v[172:175]
  ds_read_b64_tr_b16 a[196:197], v5 offset:12544
  v_fma_f32 v44, v44, s35, -v15
  v_mfma_f32_16x16x32_bf16 v[176:179], a[180:183], v[64:67], v[176:179]
  v_exp_f32_e32 v43, v43
  v_mfma_f32_16x16x32_bf16 v[180:183], a[180:183], v[72:75], v[180:183]
  ds_read_b64_tr_b16 a[198:199], v5 offset:18688
  v_fma_f32 v45, v45, s35, -v15
  v_mfma_f32_16x16x32_bf16 v[184:187], a[180:183], v[80:83], v[184:187]
  buffer_load_dwordx4 v9, s[12:15], s33 offen offset:1024 nt lds
  v_mfma_f32_16x16x32_bf16 v[188:191], a[180:183], v[88:91], v[188:191]
  s_waitcnt lgkmcnt(4)
  ds_read_b64_tr_b16 a[200:201], v6 offset:12544
  v_fma_f32 v46, v46, s35, -v15
  v_mfma_f32_16x16x32_bf16 v[192:195], a[184:187], v[64:67], v[192:195]
  v_exp_f32_e32 v44, v44
  v_mfma_f32_16x16x32_bf16 v[196:199], a[184:187], v[72:75], v[196:199]
  ds_read_b64_tr_b16 a[202:203], v6 offset:18688
  v_fma_f32 v47, v47, s35, -v15
  v_mfma_f32_16x16x32_bf16 v[200:203], a[184:187], v[80:83], v[200:203]
  v_exp_f32_e32 v45, v45
  v_mfma_f32_16x16x32_bf16 v[204:207], a[184:187], v[88:91], v[204:207]
  ds_read_b64_tr_b16 a[204:205], v7 offset:12544
  v_add_f32_e32 v0, v0, v40
  v_mfma_f32_16x16x32_bf16 v[208:211], a[188:191], v[64:67], v[208:211]
  v_exp_f32_e32 v46, v46
  v_mfma_f32_16x16x32_bf16 v[212:215], a[188:191], v[72:75], v[212:215]
  ds_read_b64_tr_b16 a[206:207], v7 offset:18688
  v_add_f32_e32 v0, v0, v41
  v_mfma_f32_16x16x32_bf16 v[216:219], a[188:191], v[80:83], v[216:219]
  v_exp_f32_e32 v47, v47
  v_mfma_f32_16x16x32_bf16 v[220:223], a[188:191], v[88:91], v[220:223]
  s_waitcnt lgkmcnt(4)
  ds_read_b128 a[160:163], v2 offset:36864
  v_cvt_pk_bf16_f32 v40, v40, v41
  v_mfma_f32_16x16x32_bf16 v[224:227], a[192:195], v[64:67], v[224:227]
  v_add_f32_e32 v0, v0, v42
  v_add_f32_e32 v0, v0, v43
  v_mfma_f32_16x16x32_bf16 v[228:231], a[192:195], v[72:75], v[228:231]
  ds_read_b128 a[164:167], v3 offset:36864
  v_cvt_pk_bf16_f32 v41, v42, v43
  v_mfma_f32_16x16x32_bf16 v[232:235], a[192:195], v[80:83], v[232:235]
  buffer_load_dwordx4 v10, s[12:15], s33 offen offset:2048 nt lds
  v_mfma_f32_16x16x32_bf16 v[236:239], a[192:195], v[88:91], v[236:239]
  ds_read_b128 a[168:171], v2 offset:36992
  v_cvt_pk_bf16_f32 v42, v44, v45
  v_mfma_f32_16x16x32_bf16 v[240:243], a[196:199], v[64:67], v[240:243]
  v_cvt_pk_bf16_f32 v43, v46, v47
  v_fma_f32 v48, v48, s35, -v16
  v_mfma_f32_16x16x32_bf16 v[244:247], a[196:199], v[72:75], v[244:247]
  ds_read_b128 a[172:175], v3 offset:36992
  v_fma_f32 v49, v49, s35, -v16
L_hop12:
  s_cbranch_execz L_walkdone
  v_mfma_f32_16x16x32_bf16 v[248:251], a[196:199], v[80:83], v[248:251]
  buffer_store_dwordx4 a[216:219], v11, s[16:19], s81 offen offset:256 nt
  v_mfma_f32_16x16x32_bf16 v[252:255], a[196:199], v[88:91], v[252:255]
  s_waitcnt lgkmcnt(3)
  ds_read_b128 a[176:179], v2 offset:37120
  v_fma_f32 v50, v50, s35, -v16
  v_mfma_f32_16x16x32_bf16 a[0:3], a[200:203], v[64:67], a[0:3]
  v_exp_f32_e32 v48, v48
  v_mfma_f32_16x16x32_bf16 a[4:7], a[200:203], v[72:75], a[4:7]
  ds_read_b128 a[180:183], v3 offset:37120
  v_fma_f32 v51, v51, s35, -v16
  v_mfma_f32_16x16x32_bf16 a[8:11], a[200:203], v[80:83], a[8:11]
  v_exp_f32_e32 v49, v49
  v_mfma_f32_16x16x32_bf16 a[12:15], a[200:203], v[88:91], a[12:15]
  v_exp_f32_e32 v50, v50
  v_mfma_f32_16x16x32_bf16 a[16:19], a[204:207], v[64:67], a[16:19]
  v_exp_f32_e32 v51, v51
  v_mfma_f32_16x16x32_bf16 a[20:23], a[204:207], v[72:75], a[20:23]
  v_fma_f32 v52, v52, s35, -v16
  v_fma_f32 v53, v53, s35, -v16
  v_mfma_f32_16x16x32_bf16 a[24:27], a[204:207], v[80:83], a[24:27]
  v_exp_f32_e32 v52, v52
  v_mfma_f32_16x16x32_bf16 a[28:31], a[204:207], v[88:91], a[28:31]
  v_exp_f32_e32 v53, v53
  v_mfma_f32_16x16x32_bf16 v[64:67], a[160:163], a[32:35], 0
  s_waitcnt lgkmcnt(1)
  v_fma_f32 v54, v54, s35, -v16
  v_fma_f32 v55, v55, s35, -v16
  v_mfma_f32_16x16x32_bf16 v[64:67], a[164:167], a[36:39], v[64:67]
  v_exp_f32_e32 v54, v54
  v_mfma_f32_16x16x32_bf16 v[64:67], a[168:171], a[40:43], v[64:67]
  v_exp_f32_e32 v55, v55
  v_mfma_f32_16x16x32_bf16 v[64:67], a[172:175], a[44:47], v[64:67]
  v_add_f32_e32 v30, v30, v48
  v_add_f32_e32 v30, v30, v49
  v_mfma_f32_16x16x32_bf16 v[64:67], a[176:179], a[128:131], v[64:67]
  s_waitcnt lgkmcnt(0)
  v_cvt_pk_bf16_f32 v48, v48, v49
  v_add_f32_e32 v30, v30, v50
  v_mfma_f32_16x16x32_bf16 v[64:67], a[180:183], a[132:135], v[64:67]
  v_add_f32_e32 v30, v30, v51
  v_cvt_pk_bf16_f32 v49, v50, v51
  v_mfma_f32_16x16x32_bf16 v[72:75], a[160:163], a[56:59], 0
  v_cvt_pk_bf16_f32 v50, v52, v53
  v_cvt_pk_bf16_f32 v51, v54, v55
  v_mfma_f32_16x16x32_bf16 v[72:75], a[164:167], a[60:63], v[72:75]
  ds_read_b128 a[184:187], v2 offset:43008
  v_fma_f32 v56, v56, s35, -v17
  v_mfma_f32_16x16x32_bf16 v[72:75], a[168:171], a[64:67], v[72:75]
  v_exp_f32_e32 v56, v56
  v_mfma_f32_16x16x32_bf16 v[72:75], a[172:175], a[68:71], v[72:75]
  ds_read_b128 a[188:191], v3 offset:43008
  v_fma_f32 v57, v57, s35, -v17
  v_mfma_f32_16x16x32_bf16 v[72:75], a[176:179], a[136:139], v[72:75]
  v_exp_f32_e32 v57, v57
  v_mfma_f32_16x16x32_bf16 v[72:75], a[180:183], a[140:143], v[72:75]
  ds_read_b128 a[192:195], v2 offset:43136
  v_fma_f32 v58, v58, s35, -v17
  v_mfma_f32_16x16x32_bf16 v[80:83], a[160:163], a[80:83], 0
  v_exp_f32_e32 v58, v58
  v_mfma_f32_16x16x32_bf16 v[80:83], a[164:167], a[84:87], v[80:83]
  ds_read_b128 a[196:199], v3 offset:43136
  v_fma_f32 v59, v59, s35, -v17
  v_mfma_f32_16x16x32_bf16 v[80:83], a[168:171], a[88:91], v[80:83]
  v_exp_f32_e32 v59, v59
  v_mfma_f32_16x16x32_bf16 v[80:83], a[172:175], a[92:95], v[80:83]
  ds_read_b128 a[200:203], v2 offset:43264
  v_fma_f32 v60, v60, s35, -v17
  v_mfma_f32_16x16x32_bf16 v[80:83], a[176:179], a[144:147], v[80:83]
  v_exp_f32_e32 v60, v60
  v_mfma_f32_16x16x32_bf16 v[80:83], a[180:183], a[148:151], v[80:83]
  ds_read_b128 a[204:207], v3 offset:43264
  v_fma_f32 v61, v61, s35, -v17
  v_mfma_f32_16x16x32_bf16 v[88:91], a[160:163], a[104:107], 0
  s_waitcnt vmcnt(12)
  s_barrier
  v_mfma_f32_16x16x32_bf16 v[88:91], a[164:167], a[108:111], v[88:91]
  s_add_u32 m0, s34, 24576
  v_exp_f32_e32 v61, v61
  v_mfma_f32_16x16x32_bf16 v[88:91], a[168:171], a[112:115], v[88:91]
  s_mov_b32 s32, 368640
  v_fma_f32 v62, v62, s35, -v17
  v_fma_f32 v63, v63, s35, -v17
  v_mfma_f32_16x16x32_bf16 v[88:91], a[172:175], a[116:119], v[88:91]
  buffer_load_dwordx4 v8, s[8:11], s32 offen nt lds
  v_mfma_f32_16x16x32_bf16 v[88:91], a[176:179], a[152:155], v[88:91]
  v_exp_f32_e32 v62, v62
  v_mfma_f32_16x16x32_bf16 v[88:91], a[180:183], a[156:159], v[88:91]
  s_waitcnt lgkmcnt(1)
  v_exp_f32_e32 v63, v63
  v_mfma_f32_16x16x32_bf16 v[68:71], a[184:187], a[32:35], 0
  v_add_f32_e32 v31, v31, v56
  v_add_f32_e32 v31, v31, v57
  v_mfma_f32_16x16x32_bf16 v[68:71], a[188:191], a[36:39], v[68:71]
  v_cvt_pk_bf16_f32 v56, v56, v57
  v_add_f32_e32 v31, v31, v58
  v_mfma_f32_16x16x32_bf16 v[68:71], a[192:195], a[40:43], v[68:71]
  v_add_f32_e32 v31, v31, v59
  v_cvt_pk_bf16_f32 v57, v58, v59
  v_mfma_f32_16x16x32_bf16 v[68:71], a[196:199], a[44:47], v[68:71]
  v_cvt_pk_bf16_f32 v58, v60, v61
  v_cvt_pk_bf16_f32 v59, v62, v63
  v_mfma_f32_16x16x32_bf16 v[68:71], a[200:203], a[128:131], v[68:71]
  s_waitcnt lgkmcnt(0)
  v_add_f32_e32 v0, v0, v44
  v_add_f32_e32 v0, v0, v45
  v_mfma_f32_16x16x32_bf16 v[68:71], a[204:207], a[132:135], v[68:71]
  v_add_f32_e32 v0, v0, v46
  v_add_f32_e32 v0, v0, v47
  v_mfma_f32_16x16x32_bf16 v[76:79], a[184:187], a[56:59], 0
  v_add_f32_e32 v30, v30, v52
  v_add_f32_e32 v30, v30, v53
  v_mfma_f32_16x16x32_bf16 v[76:79], a[188:191], a[60:63], v[76:79]
  v_add_f32_e32 v30, v30, v54
  v_add_f32_e32 v30, v30, v55
  v_mfma_f32_16x16x32_bf16 v[76:79], a[192:195], a[64:67], v[76:79]
  ds_read_b64_tr_b16 a[160:161], v4 offset:24576
  v_add_f32_e32 v31, v31, v60
  v_mfma_f32_16x16x32_bf16 v[76:79], a[196:199], a[68:71], v[76:79]
  buffer_load_dwordx4 v9, s[8:11], s32 offen offset:1024 nt lds
  v_mfma_f32_16x16x32_bf16 v[76:79], a[200:203], a[136:139], v[76:79]
  ds_read_b64_tr_b16 a[162:163], v4 offset:30720
  v_add_f32_e32 v31, v31, v61
  v_mfma_f32_16x16x32_bf16 v[76:79], a[204:207], a[140:143], v[76:79]
  v_add_f32_e32 v31, v31, v62
  v_add_f32_e32 v31, v31, v63
  v_mfma_f32_16x16x32_bf16 v[84:87], a[184:187], a[80:83], 0
  ds_read_b64_tr_b16 a[164:165], v5 offset:24576
  v_fma_f32 v64, v64, s35, -v14
  v_mfma_f32_16x16x32_bf16 v[84:87], a[188:191], a[84:87], v[84:87]
  v_exp_f32_e32 v64, v64
  v_mfma_f32_16x16x32_bf16 v[84:87], a[192:195], a[88:91], v[84:87]
  ds_read_b64_tr_b16 a[166:167], v5 offset:30720
  v_fma_f32 v65, v65, s35, -v14
  v_mfma_f32_16x16x32_bf16 v[84:87], a[196:199], a[92:95], v[84:87]
  buffer_store_dwordx4 a[220:223], v11, s[16:19], s81 offen offset:3328 nt
  v_mfma_f32_16x16x32_bf16 v[84:87], a[200:203], a[144:147], v[84:87]
  ds_read_b64_tr_b16 a[168:169], v6 offset:24576
  v_fma_f32 v66, v66, s35, -v14
  v_mfma_f32_16x16x32_bf16 v[84:87], a[204:207], a[148:151], v[84:87]
  v_exp_f32_e32 v65, v65
  v_mfma_f32_16x16x32_bf16 v[92:95], a[184:187], a[104:107], 0
  ds_read_b64_tr_b16 a[170:171], v6 offset:30720
  v_fma_f32 v67, v67, s35, -v14
  v_mfma_f32_16x16x32_bf16 v[92:95], a[188:191], a[108:111], v[92:95]
  v_exp_f32_e32 v66, v66
  v_mfma_f32_16x16x32_bf16 v[92:95], a[192:195], a[112:115], v[92:95]
  ds_read_b64_tr_b16 a[172:173], v7 offset:24576
  v_fma_f32 v68, v68, s35, -v14
  v_mfma_f32_16x16x32_bf16 v[92:95], a[196:199], a[116:119], v[92:95]
  buffer_load_dwordx4 v10, s[8:11], s32 offen offset:2048 nt lds
  v_mfma_f32_16x16x32_bf16 v[92:95], a[200:203], a[152:155], v[92:95]
  ds_read_b64_tr_b16 a[174:175], v7 offset:30720
  v_fma_f32 v69, v69, s35, -v14
  v_mfma_f32_16x16x32_bf16 v[92:95], a[204:207], a[156:159], v[92:95]
  v_exp_f32_e32 v67, v67
  v_mfma_f32_16x16x32_bf16 a[240:243], v[18:21], v[32:35], a[240:243]
  s_waitcnt lgkmcnt(4)
  ds_read_b64_tr_b16 a[176:177], v4 offset:24704
  v_fma_f32 v70, v70, s35, -v14
  v_mfma_f32_16x16x32_bf16 v[96:99], a[160:163], v[32:35], v[96:99]
  v_exp_f32_e32 v68, v68
  v_mfma_f32_16x16x32_bf16 v[100:103], a[160:163], v[40:43], v[100:103]
  ds_read_b64_tr_b16 a[178:179], v4 offset:30848
  v_fma_f32 v71, v71, s35, -v14
  v_mfma_f32_16x16x32_bf16 v[104:107], a[160:163], v[48:51], v[104:107]
  v_exp_f32_e32 v69, v69
  v_mfma_f32_16x16x32_bf16 v[108:111], a[160:163], v[56:59], v[108:111]
  ds_read_b64_tr_b16 a[180:181], v5 offset:24704
  v_cvt_pk_bf16_f32 v64, v64, v65
  v_mfma_f32_16x16x32_bf16 v[112:115], a[164:167], v[32:35], v[112:115]
  v_exp_f32_e32 v70, v70
  v_mfma_f32_16x16x32_bf16 v[116:119], a[164:167], v[40:43], v[116:119]
  ds_read_b64_tr_b16 a[182:183], v5 offset:30848
  v_cvt_pk_bf16_f32 v65, v66, v67
  v_mfma_f32_16x16x32_bf16 v[120:123], a[164:167], v[48:51], v[120:123]
  s_add_u32 m0, s34, 61440
  v_exp_f32_e32 v71, v71
  v_mfma_f32_16x16x32_bf16 v[124:127], a[164:167], v[56:59], v[124:127]
  s_waitcnt lgkmcnt(4)
  ds_read_b64_tr_b16 a[184:185], v6 offset:24704
  v_cvt_pk_bf16_f32 v66, v68, v69
  v_mfma_f32_16x16x32_bf16 v[128:131], a[168:171], v[32:35], v[128:131]
  s_mov_b32 s33, 356352
  v_cvt_pk_bf16_f32 v67, v70, v71
  v_fma_f32 v72, v72, s35, -v15
  v_mfma_f32_16x16x32_bf16 v[132:135], a[168:171], v[40:43], v[132:135]
  ds_read_b64_tr_b16 a[186:187], v6 offset:30848
  v_fma_f32 v73, v73, s35, -v15
  v_mfma_f32_16x16x32_bf16 v[136:139], a[168:171], v[48:51], v[136:139]
  buffer_load_dwordx4 v8, s[12:15], s33 offen nt lds
  v_mfma_f32_16x16x32_bf16 v[140:143], a[168:171], v[56:59], v[140:143]
  ds_read_b64_tr_b16 a[188:189], v7 offset:24704
  v_fma_f32 v74, v74, s35, -v15
  v_mfma_f32_16x16x32_bf16 v[144:147], a[172:175], v[32:35], v[144:147]
  v_exp_f32_e32 v72, v72
  v_mfma_f32_16x16x32_bf16 v[148:151], a[172:175], v[40:43], v[148:151]
  ds_read_b64_tr_b16 a[190:191], v7 offset:30848
  v_fma_f32 v75, v75, s35, -v15
  v_mfma_f32_16x16x32_bf16 v[152:155], a[172:175], v[48:51], v[152:155]
  v_exp_f32_e32 v73, v73
  v_mfma_f32_16x16x32_bf16 v[156:159], a[172:175], v[56:59], v[156:159]
  s_waitcnt lgkmcnt(4)
  ds_read_b64_tr_b16 a[192:193], v4 offset:24832
  v_fma_f32 v76, v76, s35, -v15
  v_mfma_f32_16x16x32_bf16 v[160:163], a[176:179], v[32:35], v[160:163]
  v_exp_f32_e32 v74, v74
  v_mfma_f32_16x16x32_bf16 v[164:167], a[176:179], v[40:43], v[164:167]
  ds_read_b64_tr_b16 a[194:195], v4 offset:30976
  v_fma_f32 v77, v77, s35, -v15
  v_mfma_f32_16x16x32_bf16 v[168:171], a[176:179], v[48:51], v[168:171]
  v_exp_f32_e32 v75, v75
  v_mfma_f32_16x16x32_bf16 v[172:175], a[176:179], v[56:59], v[172:175]
  ds_read_b64_tr_b16 a[196:197], v5 offset:24832
  v_fma_f32 v78, v78, s35, -v15
  v_mfma_f32_16x16x32_bf16 v[176:179], a[180:183], v[32:35], v[176:179]
  v_exp_f32_e32 v76, v76
  v_mfma_f32_16x16x32_bf16 v[180:183], a[180:183], v[40:43], v[180:183]
  ds_read_b64_tr_b16 a[198:199], v5 offset:30976
  v_fma_f32 v79, v79, s35, -v15
  v_mfma_f32_16x16x32_bf16 v[184:187], a[180:183], v[48:51], v[184:187]
  buffer_load_dwordx4 v9, s[12:15], s33 offen offset:1024 nt lds
  v_mfma_f32_16x16x32_bf16 v[188:191], a[180:183], v[56:59], v[188:191]
  s_waitcnt lgkmcnt(4)
  ds_read_b64_tr_b16 a[200:201], v6 offset:24832
  v_add_f32_e32 v0, v0, v72
  v_mfma_f32_16x16x32_bf16 v[192:195], a[184:187], v[32:35], v[192:195]
  v_exp_f32_e32 v77, v77
  v_mfma_f32_16x16x32_bf16 v[196:199], a[184:187], v[40:43], v[196:199]
  ds_read_b64_tr_b16 a[202:203], v6 offset:30976
  v_add_f32_e32 v0, v0, v73
  v_mfma_f32_16x16x32_bf16 v[200:203], a[184:187], v[48:51], v[200:203]
  v_exp_f32_e32 v78, v78
  v_mfma_f32_16x16x32_bf16 v[204:207], a[184:187], v[56:59], v[204:207]
  ds_read_b64_tr_b16 a[204:205], v7 offset:24832
  v_cvt_pk_bf16_f32 v72, v72, v73
  v_mfma_f32_16x16x32_bf16 v[208:211], a[188:191], v[32:35], v[208:211]
  v_exp_f32_e32 v79, v79
  v_mfma_f32_16x16x32_bf16 v[212:215], a[188:191], v[40:43], v[212:215]
  ds_read_b64_tr_b16 a[206:207], v7 offset:30976
  v_add_f32_e32 v0, v0, v74
  v_mfma_f32_16x16x32_bf16 v[216:219], a[188:191], v[48:51], v[216:219]
  v_add_f32_e32 v0, v0, v75
  v_cvt_pk_bf16_f32 v73, v74, v75
  v_mfma_f32_16x16x32_bf16 v[220:223], a[188:191], v[56:59], v[220:223]
  s_waitcnt lgkmcnt(4)
  ds_read_b128 a[160:163], v2 offset:0
  v_cvt_pk_bf16_f32 v74, v76, v77
  v_mfma_f32_16x16x32_bf16 v[224:227], a[192:195], v[32:35], v[224:227]
  v_cvt_pk_bf16_f32 v75, v78, v79
  v_fma_f32 v80, v80, s35, -v16
  v_mfma_f32_16x16x32_bf16 v[228:231], a[192:195], v[40:43], v[228:231]
  ds_read_b128 a[164:167], v3 offset:0
  v_fma_f32 v81, v81, s35, -v16
  v_mfma_f32_16x16x32_bf16 v[232:235], a[192:195], v[48:51], v[232:235]
  buffer_load_dwordx4 v10, s[12:15], s33 offen offset:2048 nt lds
  v_mfma_f32_16x16x32_bf16 v[236:239], a[192:195], v[56:59], v[236:239]
  ds_read_b128 a[168:171], v2 offset:128
  v_fma_f32 v82, v82, s35, -v16
  v_mfma_f32_16x16x32_bf16 v[240:243], a[196:199], v[32:35], v[240:243]
  v_exp_f32_e32 v80, v80
  v_mfma_f32_16x16x32_bf16 v[244:247], a[196:199], v[40:43], v[244:247]
  ds_read_b128 a[172:175], v3 offset:128
  v_fma_f32 v83, v83, s35, -v16
  v_mfma_f32_16x16x32_bf16 v[248:251], a[196:199], v[48:51], v[248:251]
  buffer_store_dwordx4 a[224:227], v11, s[16:19], s82 offen offset:256 nt
  v_mfma_f32_16x16x32_bf16 v[252:255], a[196:199], v[56:59], v[252:255]
  s_waitcnt lgkmcnt(3)
  ds_read_b128 a[176:179], v2 offset:256
  v_fma_f32 v84, v84, s35, -v16
  v_mfma_f32_16x16x32_bf16 a[0:3], a[200:203], v[32:35], a[0:3]
  v_exp_f32_e32 v81, v81
  v_mfma_f32_16x16x32_bf16 a[4:7], a[200:203], v[40:43], a[4:7]
  ds_read_b128 a[180:183], v3 offset:256
  v_fma_f32 v85, v85, s35, -v16
  v_mfma_f32_16x16x32_bf16 a[8:11], a[200:203], v[48:51], a[8:11]
  v_exp_f32_e32 v82, v82
  v_mfma_f32_16x16x32_bf16 a[12:15], a[200:203], v[56:59], a[12:15]
  v_exp_f32_e32 v83, v83
  v_mfma_f32_16x16x32_bf16 a[16:19], a[204:207], v[32:35], a[16:19]
  v_exp_f32_e32 v84, v84
  v_mfma_f32_16x16x32_bf16 a[20:23], a[204:207], v[40:43], a[20:23]
  v_exp_f32_e32 v85, v85
  v_mfma_f32_16x16x32_bf16 a[24:27], a[204:207], v[48:51], a[24:27]
  v_fma_f32 v86, v86, s35, -v16
  v_fma_f32 v87, v87, s35, -v16
  v_mfma_f32_16x16x32_bf16 a[28:31], a[204:207], v[56:59], a[28:31]
  v_exp_f32_e32 v86, v86
  v_mfma_f32_16x16x32_bf16 v[32:35], a[160:163], a[32:35], 0
  s_waitcnt lgkmcnt(1)
  v_exp_f32_e32 v87, v87
  v_mfma_f32_16x16x32_bf16 v[32:35], a[164:167], a[36:39], v[32:35]
  v_add_f32_e32 v30, v30, v80
  v_add_f32_e32 v30, v30, v81
  v_mfma_f32_16x16x32_bf16 v[32:35], a[168:171], a[40:43], v[32:35]
  v_cvt_pk_bf16_f32 v80, v80, v81
  v_add_f32_e32 v30, v30, v82
  v_mfma_f32_16x16x32_bf16 v[32:35], a[172:175], a[44:47], v[32:35]
  v_add_f32_e32 v30, v30, v83
  v_cvt_pk_bf16_f32 v81, v82, v83
  v_mfma_f32_16x16x32_bf16 v[32:35], a[176:179], a[128:131], v[32:35]
  s_waitcnt lgkmcnt(0)
  v_cvt_pk_bf16_f32 v82, v84, v85
  v_cvt_pk_bf16_f32 v83, v86, v87
  v_mfma_f32_16x16x32_bf16 v[32:35], a[180:183], a[132:135], v[32:35]
  v_fma_f32 v88, v88, s35, -v17
  v_fma_f32 v89, v89, s35, -v17
  v_mfma_f32_16x16x32_bf16 v[40:43], a[160:163], a[56:59], 0
  v_exp_f32_e32 v88, v88
  v_mfma_f32_16x16x32_bf16 v[40:43], a[164:167], a[60:63], v[40:43]
  ds_read_b128 a[184:187], v2 offset:6144
  v_fma_f32 v90, v90, s35, -v17
  v_mfma_f32_16x16x32_bf16 v[40:43], a[168:171], a[64:67], v[40:43]
  v_exp_f32_e32 v89, v89
  v_mfma_f32_16x16x32_bf16 v[40:43], a[172:175], a[68:71], v[40:43]
  ds_read_b128 a[188:191], v3 offset:6144
  v_fma_f32 v91, v91, s35, -v17
  v_mfma_f32_16x16x32_bf16 v[40:43], a[176:179], a[136:139], v[40:43]
  v_exp_f32_e32 v90, v90
  v_mfma_f32_16x16x32_bf16 v[40:43], a[180:183], a[140:143], v[40:43]
  ds_read_b128 a[192:195], v2 offset:6272
  v_fma_f32 v92, v92, s35, -v17
  v_mfma_f32_16x16x32_bf16 v[48:51], a[160:163], a[80:83], 0
  v_exp_f32_e32 v91, v91
  v_mfma_f32_16x16x32_bf16 v[48:51], a[164:167], a[84:87], v[48:51]
  ds_read_b128 a[196:199], v3 offset:6272
  v_fma_f32 v93, v93, s35, -v17
  v_mfma_f32_16x16x32_bf16 v[48:51], a[168:171], a[88:91], v[48:51]
  v_exp_f32_e32 v92, v92
  v_mfma_f32_16x16x32_bf16 v[48:51], a[172:175], a[92:95], v[48:51]
  ds_read_b128 a[200:203], v2 offset:6400
  v_fma_f32 v94, v94, s35, -v17
  v_mfma_f32_16x16x32_bf16 v[48:51], a[176:179], a[144:147], v[48:51]
  v_exp_f32_e32 v93, v93
  v_mfma_f32_16x16x32_bf16 v[48:51], a[180:183], a[148:151], v[48:51]
  ds_read_b128 a[204:207], v3 offset:6400
  v_fma_f32 v95, v95, s35, -v17
  v_mfma_f32_16x16x32_bf16 v[56:59], a[160:163], a[104:107], 0
  s_waitcnt vmcnt(12)
  s_barrier
  v_mfma_f32_16x16x32_bf16 v[56:59], a[164:167], a[108:111], v[56:59]
  s_add_u32 m0, s34, 36864
  v_exp_f32_e32 v94, v94
  v_mfma_f32_16x16x32_bf16 v[56:59], a[168:171], a[112:115], v[56:59]
  s_mov_b32 s32, 380928
  v_exp_f32_e32 v95, v95
  v_mfma_f32_16x16x32_bf16 v[56:59], a[172:175], a[116:119], v[56:59]
  buffer_load_dwordx4 v8, s[8:11], s32 offen nt lds
  v_mfma_f32_16x16x32_bf16 v[56:59], a[176:179], a[152:155], v[56:59]
  v_add_f32_e32 v31, v31, v88
  v_add_f32_e32 v31, v31, v89
  v_mfma_f32_16x16x32_bf16 v[56:59], a[180:183], a[156:159], v[56:59]
  s_waitcnt lgkmcnt(1)
  v_cvt_pk_bf16_f32 v88, v88, v89
  v_add_f32_e32 v31, v31, v90
  v_mfma_f32_16x16x32_bf16 v[36:39], a[184:187], a[32:35], 0
  v_add_f32_e32 v31, v31, v91
  v_cvt_pk_bf16_f32 v89, v90, v91
  v_mfma_f32_16x16x32_bf16 v[36:39], a[188:191], a[36:39], v[36:39]
  v_cvt_pk_bf16_f32 v90, v92, v93
  v_cvt_pk_bf16_f32 v91, v94, v95
  v_mfma_f32_16x16x32_bf16 v[36:39], a[192:195], a[40:43], v[36:39]
  v_add_f32_e32 v0, v0, v76
  v_add_f32_e32 v0, v0, v77
  v_mfma_f32_16x16x32_bf16 v[36:39], a[196:199], a[44:47], v[36:39]
  v_add_f32_e32 v0, v0, v78
  v_add_f32_e32 v0, v0, v79
  v_mfma_f32_16x16x32_bf16 v[36:39], a[200:203], a[128:131], v[36:39]
  s_waitcnt lgkmcnt(0)
  v_add_f32_e32 v30, v30, v84
  v_add_f32_e32 v30, v30, v85
  v_mfma_f32_16x16x32_bf16 v[36:39], a[204:207], a[132:135], v[36:39]
  v_add_f32_e32 v30, v30, v86
  v_add_f32_e32 v30, v30, v87
  v_mfma_f32_16x16x32_bf16 v[44:47], a[184:187], a[56:59], 0
  v_add_f32_e32 v31, v31, v92
  v_add_f32_e32 v31, v31, v93
  v_mfma_f32_16x16x32_bf16 v[44:47], a[188:191], a[60:63], v[44:47]
  v_add_f32_e32 v31, v31, v94
  v_add_f32_e32 v31, v31, v95
  v_mfma_f32_16x16x32_bf16 v[44:47], a[192:195], a[64:67], v[44:47]
  ds_read_b64_tr_b16 a[160:161], v4 offset:36864
  v_fma_f32 v32, v32, s35, -v14
  v_mfma_f32_16x16x32_bf16 v[44:47], a[196:199], a[68:71], v[44:47]
  buffer_load_dwordx4 v9, s[8:11], s32 offen offset:1024 nt lds
  v_mfma_f32_16x16x32_bf16 v[44:47], a[200:203], a[136:139], v[44:47]
  ds_read_b64_tr_b16 a[162:163], v4 offset:43008
  v_fma_f32 v33, v33, s35, -v14
  v_mfma_f32_16x16x32_bf16 v[44:47], a[204:207], a[140:143], v[44:47]
  v_exp_f32_e32 v32, v32
  v_mfma_f32_16x16x32_bf16 v[52:55], a[184:187], a[80:83], 0
  ds_read_b64_tr_b16 a[164:165], v5 offset:36864
  v_fma_f32 v34, v34, s35, -v14
  v_mfma_f32_16x16x32_bf16 v[52:55], a[188:191], a[84:87], v[52:55]
  v_exp_f32_e32 v33, v33
  v_mfma_f32_16x16x32_bf16 v[52:55], a[192:195], a[88:91], v[52:55]
  ds_read_b64_tr_b16 a[166:167], v5 offset:43008
  v_fma_f32 v35, v35, s35, -v14
  v_mfma_f32_16x16x32_bf16 v[52:55], a[196:199], a[92:95], v[52:55]
  buffer_store_dwordx4 a[228:231], v11, s[16:19], s82 offen offset:3328 nt
  v_mfma_f32_16x16x32_bf16 v[52:55], a[200:203], a[144:147], v[52:55]
  ds_read_b64_tr_b16 a[168:169], v6 offset:36864
  v_fma_f32 v36, v36, s35, -v14
  v_mfma_f32_16x16x32_bf16 v[52:55], a[204:207], a[148:151], v[52:55]
  v_exp_f32_e32 v34, v34
  v_mfma_f32_16x16x32_bf16 v[60:63], a[184:187], a[104:107], 0
  ds_read_b64_tr_b16 a[170:171], v6 offset:43008
  v_fma_f32 v37, v37, s35, -v14
  v_mfma_f32_16x16x32_bf16 v[60:63], a[188:191], a[108:111], v[60:63]
  v_exp_f32_e32 v35, v35
  v_mfma_f32_16x16x32_bf16 v[60:63], a[192:195], a[112:115], v[60:63]
  ds_read_b64_tr_b16 a[172:173], v7 offset:36864
  v_fma_f32 v38, v38, s35, -v14
  v_mfma_f32_16x16x32_bf16 v[60:63], a[196:199], a[116:119], v[60:63]
  buffer_load_dwordx4 v10, s[8:11], s32 offen offset:2048 nt lds
  v_mfma_f32_16x16x32_bf16 v[60:63], a[200:203], a[152:155], v[60:63]
  ds_read_b64_tr_b16 a[174:175], v7 offset:43008
  v_fma_f32 v39, v39, s35, -v14
  v_mfma_f32_16x16x32_bf16 v[60:63], a[204:207], a[156:159], v[60:63]
  v_exp_f32_e32 v36, v36
  v_mfma_f32_16x16x32_bf16 a[240:243], v[18:21], v[64:67], a[240:243]
  s_waitcnt lgkmcnt(4)
  ds_read_b64_tr_b16 a[176:177], v4 offset:36992
  v_cvt_pk_bf16_f32 v32, v32, v33
  v_mfma_f32_16x16x32_bf16 v[96:99], a[160:163], v[64:67], v[96:99]
  v_exp_f32_e32 v37, v37
  v_mfma_f32_16x16x32_bf16 v[100:103], a[160:163], v[72:75], v[100:103]
  ds_read_b64_tr_b16 a[178:179], v4 offset:43136
  v_cvt_pk_bf16_f32 v33, v34, v35
  v_mfma_f32_16x16x32_bf16 v[104:107], a[160:163], v[80:83], v[104:107]
  v_exp_f32_e32 v38, v38
  v_mfma_f32_16x16x32_bf16 v[108:111], a[160:163], v[88:91], v[108:111]
  ds_read_b64_tr_b16 a[180:181], v5 offset:36992
  v_cvt_pk_bf16_f32 v34, v36, v37
  v_mfma_f32_16x16x32_bf16 v[112:115], a[164:167], v[64:67], v[112:115]
  v_exp_f32_e32 v39, v39
  v_mfma_f32_16x16x32_bf16 v[116:119], a[164:167], v[72:75], v[116:119]
  ds_read_b64_tr_b16 a[182:183], v5 offset:43136
  v_cvt_pk_bf16_f32 v35, v38, v39
  v_mfma_f32_16x16x32_bf16 v[120:123], a[164:167], v[80:83], v[120:123]
  s_add_u32 m0, s34, 73728
  v_fma_f32 v40, v40, s35, -v15
  v_fma_f32 v41, v41, s35, -v15
  v_mfma_f32_16x16x32_bf16 v[124:127], a[164:167], v[88:91], v[124:127]
  s_waitcnt lgkmcnt(4)
  ds_read_b64_tr_b16 a[184:185], v6 offset:36992
  v_fma_f32 v42, v42, s35, -v15
  v_mfma_f32_16x16x32_bf16 v[128:131], a[168:171], v[64:67], v[128:131]
  s_mov_b32 s33, 368640
  v_exp_f32_e32 v40, v40
  v_mfma_f32_16x16x32_bf16 v[132:135], a[168:171], v[72:75], v[132:135]
  ds_read_b64_tr_b16 a[186:187], v6 offset:43136
  v_fma_f32 v43, v43, s35, -v15
  v_mfma_f32_16x16x32_bf16 v[136:139], a[168:171], v[80:83], v[136:139]
  buffer_load_dwordx4 v8, s[12:15], s33 offen nt lds
  v_mfma_f32_16x16x32_bf16 v[140:143], a[168:171], v[88:91], v[140:143]
  ds_read_b64_tr_b16 a[188:189], v7 offset:36992
  v_fma_f32 v44, v44, s35, -v15
  v_mfma_f32_16x16x32_bf16 v[144:147], a[172:175], v[64:67], v[144:147]
  v_exp_f32_e32 v41, v41
  v_mfma_f32_16x16x32_bf16 v[148:151], a[172:175], v[72:75], v[148:151]
  ds_read_b64_tr_b16 a[190:191], v7 offset:43136
  v_fma_f32 v45, v45, s35, -v15
  v_mfma_f32_16x16x32_bf16 v[152:155], a[172:175], v[80:83], v[152:155]
  v_exp_f32_e32 v42, v42
  v_mfma_f32_16x16x32_bf16 v[156:159], a[172:175], v[88:91], v[156:159]
  s_waitcnt lgkmcnt(4)
  ds_read_b64_tr_b16 a[192:193], v4 offset:37120
  v_fma_f32 v46, v46, s35, -v15
  v_mfma_f32_16x16x32_bf16 v[160:163], a[176:179], v[64:67], v[160:163]
  v_exp_f32_e32 v43, v43
  v_mfma_f32_16x16x32_bf16 v[164:167], a[176:179], v[72:75], v[164:167]
  ds_read_b64_tr_b16 a[194:195], v4 offset:43264
  v_fma_f32 v47, v47, s35, -v15
  v_mfma_f32_16x16x32_bf16 v[168:171], a[176:179], v[80:83], v[168:171]
  v_exp_f32_e32 v44, v44
  v_mfma_f32_16x16x32_bf16 v[172:175], a[176:179], v[88:91], v[172:175]
  ds_read_b64_tr_b16 a[196:197], v5 offset:37120
  v_add_f32_e32 v0, v0, v40
  v_mfma_f32_16x16x32_bf16 v[176:179], a[180:183], v[64:67], v[176:179]
  v_exp_f32_e32 v45, v45
  v_mfma_f32_16x16x32_bf16 v[180:183], a[180:183], v[72:75], v[180:183]
  ds_read_b64_tr_b16 a[198:199], v5 offset:43264
  v_add_f32_e32 v0, v0, v41
  v_mfma_f32_16x16x32_bf16 v[184:187], a[180:183], v[80:83], v[184:187]
  buffer_load_dwordx4 v9, s[12:15], s33 offen offset:1024 nt lds
  v_mfma_f32_16x16x32_bf16 v[188:191], a[180:183], v[88:91], v[188:191]
  s_waitcnt lgkmcnt(4)
  ds_read_b64_tr_b16 a[200:201], v6 offset:37120
  v_cvt_pk_bf16_f32 v40, v40, v41
  v_mfma_f32_16x16x32_bf16 v[192:195], a[184:187], v[64:67], v[192:195]
  v_exp_f32_e32 v46, v46
  v_mfma_f32_16x16x32_bf16 v[196:199], a[184:187], v[72:75], v[196:199]
  ds_read_b64_tr_b16 a[202:203], v6 offset:43264
  v_add_f32_e32 v0, v0, v42
  v_mfma_f32_16x16x32_bf16 v[200:203], a[184:187], v[80:83], v[200:203]
  v_exp_f32_e32 v47, v47
  v_mfma_f32_16x16x32_bf16 v[204:207], a[184:187], v[88:91], v[204:207]
  ds_read_b64_tr_b16 a[204:205], v7 offset:37120
  v_add_f32_e32 v0, v0, v43
  v_mfma_f32_16x16x32_bf16 v[208:211], a[188:191], v[64:67], v[208:211]
  v_cvt_pk_bf16_f32 v41, v42, v43
  v_cvt_pk_bf16_f32 v42, v44, v45
  v_mfma_f32_16x16x32_bf16 v[212:215], a[188:191], v[72:75], v[212:215]
  ds_read_b64_tr_b16 a[206:207], v7 offset:43264
  v_cvt_pk_bf16_f32 v43, v46, v47
  v_mfma_f32_16x16x32_bf16 v[216:219], a[188:191], v[80:83], v[216:219]
  v_fma_f32 v48, v48, s35, -v16
  v_fma_f32 v49, v49, s35, -v16
  v_mfma_f32_16x16x32_bf16 v[220:223], a[188:191], v[88:91], v[220:223]
  s_waitcnt lgkmcnt(4)
  ds_read_b128 a[160:163], v2 offset:12288
  v_fma_f32 v50, v50, s35, -v16
  v_mfma_f32_16x16x32_bf16 v[224:227], a[192:195], v[64:67], v[224:227]
  v_exp_f32_e32 v48, v48
  v_mfma_f32_16x16x32_bf16 v[228:231], a[192:195], v[72:75], v[228:231]
  ds_read_b128 a[164:167], v3 offset:12288
  v_fma_f32 v51, v51, s35, -v16
  v_mfma_f32_16x16x32_bf16 v[232:235], a[192:195], v[80:83], v[232:235]
  buffer_load_dwordx4 v10, s[12:15], s33 offen offset:2048 nt lds
  v_mfma_f32_16x16x32_bf16 v[236:239], a[192:195], v[88:91], v[236:239]
  ds_read_b128 a[168:171], v2 offset:12416
  v_fma_f32 v52, v52, s35, -v16
  v_mfma_f32_16x16x32_bf16 v[240:243], a[196:199], v[64:67], v[240:243]
  v_exp_f32_e32 v49, v49
  v_mfma_f32_16x16x32_bf16 v[244:247], a[196:199], v[72:75], v[244:247]
  ds_read_b128 a[172:175], v3 offset:12416
  v_fma_f32 v53, v53, s35, -v16
  v_mfma_f32_16x16x32_bf16 v[248:251], a[196:199], v[80:83], v[248:251]
  buffer_store_dwordx4 a[232:235], v11, s[16:19], s83 offen offset:256 nt
  v_mfma_f32_16x16x32_bf16 v[252:255], a[196:199], v[88:91], v[252:255]
  s_waitcnt lgkmcnt(3)
  ds_read_b128 a[176:179], v2 offset:12544
  v_fma_f32 v54, v54, s35, -v16
  v_mfma_f32_16x16x32_bf16 a[0:3], a[200:203], v[64:67], a[0:3]
  v_exp_f32_e32 v50, v50
  v_mfma_f32_16x16x32_bf16 a[4:7], a[200:203], v[72:75], a[4:7]
  ds_read_b128 a[180:183], v3 offset:12544
  v_fma_f32 v55, v55, s35, -v16
  v_mfma_f32_16x16x32_bf16 a[8:11], a[200:203], v[80:83], a[8:11]
  v_exp_f32_e32 v51, v51
  v_mfma_f32_16x16x32_bf16 a[12:15], a[200:203], v[88:91], a[12:15]
  v_exp_f32_e32 v52, v52
  v_mfma_f32_16x16x32_bf16 a[16:19], a[204:207], v[64:67], a[16:19]
  v_exp_f32_e32 v53, v53
  v_mfma_f32_16x16x32_bf16 a[20:23], a[204:207], v[72:75], a[20:23]
  v_exp_f32_e32 v54, v54
  v_mfma_f32_16x16x32_bf16 a[24:27], a[204:207], v[80:83], a[24:27]
  v_exp_f32_e32 v55, v55
  v_mfma_f32_16x16x32_bf16 a[28:31], a[204:207], v[88:91], a[28:31]
  v_add_f32_e32 v30, v30, v48
  v_add_f32_e32 v30, v30, v49
  v_mfma_f32_16x16x32_bf16 v[64:67], a[160:163], a[32:35], 0
  s_waitcnt lgkmcnt(1)
  v_cvt_pk_bf16_f32 v48, v48, v49
  v_add_f32_e32 v30, v30, v50
  v_mfma_f32_16x16x32_bf16 v[64:67], a[164:167], a[36:39], v[64:67]
  v_add_f32_e32 v30, v30, v51
  v_cvt_pk_bf16_f32 v49, v50, v51
  v_mfma_f32_16x16x32_bf16 v[64:67], a[168:171], a[40:43], v[64:67]
  v_cvt_pk_bf16_f32 v50, v52, v53
  v_cvt_pk_bf16_f32 v51, v54, v55
  v_mfma_f32_16x16x32_bf16 v[64:67], a[172:175], a[44:47], v[64:67]
  v_fma_f32 v56, v56, s35, -v17
  v_fma_f32 v57, v57, s35, -v17
  v_mfma_f32_16x16x32_bf16 v[64:67], a[176:179], a[128:131], v[64:67]
  s_waitcnt lgkmcnt(0)
  v_exp_f32_e32 v56, v56
  v_mfma_f32_16x16x32_bf16 v[64:67], a[180:183], a[132:135], v[64:67]
  v_exp_f32_e32 v57, v57
  v_mfma_f32_16x16x32_bf16 v[72:75], a[160:163], a[56:59], 0
  v_fma_f32 v58, v58, s35, -v17
  v_fma_f32 v59, v59, s35, -v17
  v_mfma_f32_16x16x32_bf16 v[72:75], a[164:167], a[60:63], v[72:75]
  ds_read_b128 a[184:187], v2 offset:18432
  v_fma_f32 v60, v60, s35, -v17
  v_mfma_f32_16x16x32_bf16 v[72:75], a[168:171], a[64:67], v[72:75]
  v_exp_f32_e32 v58, v58
  v_mfma_f32_16x16x32_bf16 v[72:75], a[172:175], a[68:71], v[72:75]
  ds_read_b128 a[188:191], v3 offset:18432
  v_fma_f32 v61, v61, s35, -v17
  v_mfma_f32_16x16x32_bf16 v[72:75], a[176:179], a[136:139], v[72:75]
  v_exp_f32_e32 v59, v59
  v_mfma_f32_16x16x32_bf16 v[72:75], a[180:183], a[140:143], v[72:75]
  ds_read_b128 a[192:195], v2 offset:18560
  v_fma_f32 v62, v62, s35, -v17
  v_mfma_f32_16x16x32_bf16 v[80:83], a[160:163], a[80:83], 0
  v_exp_f32_e32 v60, v60
  v_mfma_f32_16x16x32_bf16 v[80:83], a[164:167], a[84:87], v[80:83]
L_hop13:
  s_cbranch_execz L_walkdone
  ds_read_b128 a[196:199], v3 offset:18560
  v_fma_f32 v63, v63, s35, -v17
  v_mfma_f32_16x16x32_bf16 v[80:83], a[168:171], a[88:91], v[80:83]
  v_exp_f32_e32 v61, v61
  v_mfma_f32_16x16x32_bf16 v[80:83], a[172:175], a[92:95], v[80:83]
  ds_read_b128 a[200:203], v2 offset:18688
  v_exp_f32_e32 v62, v62
  v_mfma_f32_16x16x32_bf16 v[80:83], a[176:179], a[144:147], v[80:83]
  v_exp_f32_e32 v63, v63
  v_mfma_f32_16x16x32_bf16 v[80:83], a[180:183], a[148:151], v[80:83]
  ds_read_b128 a[204:207], v3 offset:18688
  v_add_f32_e32 v31, v31, v56
  v_mfma_f32_16x16x32_bf16 v[88:91], a[160:163], a[104:107], 0
  v_add_f32_e32 v31, v31, v57
  v_cvt_pk_bf16_f32 v56, v56, v57
  v_mfma_f32_16x16x32_bf16 v[88:91], a[164:167], a[108:111], v[88:91]
  v_add_f32_e32 v31, v31, v58
  v_add_f32_e32 v31, v31, v59
  v_mfma_f32_16x16x32_bf16 v[88:91], a[168:171], a[112:115], v[88:91]
  v_cvt_pk_bf16_f32 v57, v58, v59
  v_cvt_pk_bf16_f32 v58, v60, v61
  v_mfma_f32_16x16x32_bf16 v[88:91], a[172:175], a[116:119], v[88:91]
  v_cvt_pk_bf16_f32 v59, v62, v63
  v_accvgpr_write_b32 a208, v32
  v_mfma_f32_16x16x32_bf16 v[88:91], a[176:179], a[152:155], v[88:91]
  v_accvgpr_write_b32 a209, v33
  v_accvgpr_write_b32 a210, v34
  v_mfma_f32_16x16x32_bf16 v[88:91], a[180:183], a[156:159], v[88:91]
  s_waitcnt lgkmcnt(1)
  v_accvgpr_write_b32 a211, v35
  v_accvgpr_write_b32 a212, v40
  v_mfma_f32_16x16x32_bf16 v[68:71], a[184:187], a[32:35], 0
  v_accvgpr_write_b32 a213, v41
  v_accvgpr_write_b32 a214, v42
  v_mfma_f32_16x16x32_bf16 v[68:71], a[188:191], a[36:39], v[68:71]
  v_accvgpr_write_b32 a215, v43
  v_accvgpr_write_b32 a216, v48
  v_mfma_f32_16x16x32_bf16 v[68:71], a[192:195], a[40:43], v[68:71]
  v_accvgpr_write_b32 a217, v49
  v_accvgpr_write_b32 a218, v50
  v_mfma_f32_16x16x32_bf16 v[68:71], a[196:199], a[44:47], v[68:71]
  v_accvgpr_write_b32 a219, v51
  v_accvgpr_write_b32 a220, v56
  v_mfma_f32_16x16x32_bf16 v[68:71], a[200:203], a[128:131], v[68:71]
  s_waitcnt lgkmcnt(0)
  v_accvgpr_write_b32 a221, v57
  v_accvgpr_write_b32 a222, v58
  v_mfma_f32_16x16x32_bf16 v[68:71], a[204:207], a[132:135], v[68:71]
  v_accvgpr_write_b32 a223, v59
  v_add_f32_e32 v0, v0, v44
  v_mfma_f32_16x16x32_bf16 v[76:79], a[184:187], a[56:59], 0
  v_add_f32_e32 v0, v0, v45
  v_add_f32_e32 v0, v0, v46
  v_mfma_f32_16x16x32_bf16 v[76:79], a[188:191], a[60:63], v[76:79]
  s_waitcnt vmcnt(12)
  s_barrier
  v_mfma_f32_16x16x32_bf16 v[76:79], a[192:195], a[64:67], v[76:79]
  s_add_u32 m0, s34, 86016
  ds_read_b64_tr_b16 a[160:161], v4 offset:0
  v_add_f32_e32 v0, v0, v47
  v_mfma_f32_16x16x32_bf16 v[76:79], a[196:199], a[68:71], v[76:79]
  s_mov_b32 s33, 380928
  v_add_f32_e32 v30, v30, v52
  v_add_f32_e32 v30, v30, v53
  v_mfma_f32_16x16x32_bf16 v[76:79], a[200:203], a[136:139], v[76:79]
  ds_read_b64_tr_b16 a[162:163], v4 offset:6144
  v_add_f32_e32 v30, v30, v54
  v_mfma_f32_16x16x32_bf16 v[76:79], a[204:207], a[140:143], v[76:79]
  buffer_load_dwordx4 v8, s[12:15], s33 offen nt lds
  v_mfma_f32_16x16x32_bf16 v[84:87], a[184:187], a[80:83], 0
  ds_read_b64_tr_b16 a[164:165], v5 offset:0
  v_add_f32_e32 v30, v30, v55
  v_mfma_f32_16x16x32_bf16 v[84:87], a[188:191], a[84:87], v[84:87]
  v_add_f32_e32 v31, v31, v60
  v_add_f32_e32 v31, v31, v61
  v_mfma_f32_16x16x32_bf16 v[84:87], a[192:195], a[88:91], v[84:87]
  ds_read_b64_tr_b16 a[166:167], v5 offset:6144
  v_add_f32_e32 v31, v31, v62
  v_mfma_f32_16x16x32_bf16 v[84:87], a[196:199], a[92:95], v[84:87]
  buffer_store_dwordx4 a[236:239], v11, s[16:19], s83 offen offset:3328 nt
  v_mfma_f32_16x16x32_bf16 v[84:87], a[200:203], a[144:147], v[84:87]
  ds_read_b64_tr_b16 a[168:169], v6 offset:0
  v_add_f32_e32 v31, v31, v63
  v_mfma_f32_16x16x32_bf16 v[84:87], a[204:207], a[148:151], v[84:87]
  v_fma_f32 v64, v64, s35, -v14
  v_exp_f32_e32 v64, v64
  v_mfma_f32_16x16x32_bf16 v[92:95], a[184:187], a[104:107], 0
  ds_read_b64_tr_b16 a[170:171], v6 offset:6144
  v_fma_f32 v65, v65, s35, -v14
  v_mfma_f32_16x16x32_bf16 v[92:95], a[188:191], a[108:111], v[92:95]
  v_exp_f32_e32 v65, v65
  v_mfma_f32_16x16x32_bf16 v[92:95], a[192:195], a[112:115], v[92:95]
  ds_read_b64_tr_b16 a[172:173], v7 offset:0
  v_fma_f32 v66, v66, s35, -v14
  v_mfma_f32_16x16x32_bf16 v[92:95], a[196:199], a[116:119], v[92:95]
  v_exp_f32_e32 v66, v66
  v_mfma_f32_16x16x32_bf16 v[92:95], a[200:203], a[152:155], v[92:95]
  ds_read_b64_tr_b16 a[174:175], v7 offset:6144
  v_fma_f32 v67, v67, s35, -v14
  v_mfma_f32_16x16x32_bf16 v[92:95], a[204:207], a[156:159], v[92:95]
  buffer_load_dwordx4 v9, s[12:15], s33 offen offset:1024 nt lds
  v_mfma_f32_16x16x32_bf16 a[240:243], v[18:21], v[32:35], a[240:243]
  s_waitcnt lgkmcnt(4)
  ds_read_b128 a[176:179], v2 offset:24576
  v_fma_f32 v68, v68, s35, -v14
  v_mfma_f32_16x16x32_bf16 v[96:99], a[160:163], v[32:35], v[96:99]
  v_exp_f32_e32 v67, v67
  v_mfma_f32_16x16x32_bf16 v[100:103], a[160:163], v[40:43], v[100:103]
  ds_read_b128 a[180:183], v3 offset:24576
  v_fma_f32 v69, v69, s35, -v14
  v_mfma_f32_16x16x32_bf16 v[104:107], a[160:163], v[48:51], v[104:107]
  v_exp_f32_e32 v68, v68
  v_mfma_f32_16x16x32_bf16 v[108:111], a[160:163], v[56:59], v[108:111]
  ds_read_b128 a[184:187], v2 offset:24704
  v_fma_f32 v70, v70, s35, -v14
  v_mfma_f32_16x16x32_bf16 v[112:115], a[164:167], v[32:35], v[112:115]
  v_exp_f32_e32 v69, v69
  v_mfma_f32_16x16x32_bf16 v[116:119], a[164:167], v[40:43], v[116:119]
  ds_read_b128 a[188:191], v3 offset:24704
  v_fma_f32 v71, v71, s35, -v14
  v_mfma_f32_16x16x32_bf16 v[120:123], a[164:167], v[48:51], v[120:123]
  v_exp_f32_e32 v70, v70
  v_mfma_f32_16x16x32_bf16 v[124:127], a[164:167], v[56:59], v[124:127]
  s_waitcnt lgkmcnt(3)
  ds_read_b128 a[192:195], v2 offset:24832
  v_cvt_pk_bf16_f32 v64, v64, v65
  v_mfma_f32_16x16x32_bf16 v[128:131], a[168:171], v[32:35], v[128:131]
  v_exp_f32_e32 v71, v71
  v_mfma_f32_16x16x32_bf16 v[132:135], a[168:171], v[40:43], v[132:135]
  ds_read_b128 a[196:199], v3 offset:24832
  v_cvt_pk_bf16_f32 v65, v66, v67
  v_cvt_pk_bf16_f32 v66, v68, v69
  v_mfma_f32_16x16x32_bf16 v[136:139], a[168:171], v[48:51], v[136:139]
  buffer_load_dwordx4 v10, s[12:15], s33 offen offset:2048 nt lds
  v_mfma_f32_16x16x32_bf16 v[140:143], a[168:171], v[56:59], v[140:143]
  v_cvt_pk_bf16_f32 v67, v70, v71
  v_fma_f32 v72, v72, s35, -v15
  v_mfma_f32_16x16x32_bf16 v[144:147], a[172:175], v[32:35], v[144:147]
  v_exp_f32_e32 v72, v72
  v_mfma_f32_16x16x32_bf16 v[148:151], a[172:175], v[40:43], v[148:151]
  v_fma_f32 v73, v73, s35, -v15
  v_fma_f32 v74, v74, s35, -v15
  v_mfma_f32_16x16x32_bf16 v[152:155], a[172:175], v[48:51], v[152:155]
  v_exp_f32_e32 v73, v73
  v_mfma_f32_16x16x32_bf16 v[156:159], a[172:175], v[56:59], v[156:159]
  v_exp_f32_e32 v74, v74
  v_mfma_f32_16x16x32_bf16 v[32:35], a[176:179], a[32:35], 0
  s_waitcnt lgkmcnt(1)
  v_fma_f32 v75, v75, s35, -v15
  v_fma_f32 v76, v76, s35, -v15
  v_mfma_f32_16x16x32_bf16 v[32:35], a[180:183], a[36:39], v[32:35]
  v_exp_f32_e32 v75, v75
  v_mfma_f32_16x16x32_bf16 v[32:35], a[184:187], a[40:43], v[32:35]
  v_exp_f32_e32 v76, v76
  v_mfma_f32_16x16x32_bf16 v[32:35], a[188:191], a[44:47], v[32:35]
  v_fma_f32 v77, v77, s35, -v15
  v_fma_f32 v78, v78, s35, -v15
  v_mfma_f32_16x16x32_bf16 v[32:35], a[192:195], a[128:131], v[32:35]
  s_waitcnt lgkmcnt(0)
  v_exp_f32_e32 v77, v77
  v_mfma_f32_16x16x32_bf16 v[32:35], a[196:199], a[132:135], v[32:35]
  v_exp_f32_e32 v78, v78
  v_mfma_f32_16x16x32_bf16 v[40:43], a[176:179], a[56:59], 0
  v_fma_f32 v79, v79, s35, -v15
  v_add_f32_e32 v0, v0, v72
  v_mfma_f32_16x16x32_bf16 v[40:43], a[180:183], a[60:63], v[40:43]
  ds_read_b128 a[200:203], v2 offset:30720
  v_add_f32_e32 v0, v0, v73
  v_mfma_f32_16x16x32_bf16 v[40:43], a[184:187], a[64:67], v[40:43]
  v_exp_f32_e32 v79, v79
  v_mfma_f32_16x16x32_bf16 v[40:43], a[188:191], a[68:71], v[40:43]
  ds_read_b128 a[204:207], v3 offset:30720
  v_cvt_pk_bf16_f32 v72, v72, v73
  v_add_f32_e32 v0, v0, v74
  v_mfma_f32_16x16x32_bf16 v[40:43], a[192:195], a[136:139], v[40:43]
  v_add_f32_e32 v0, v0, v75
  v_cvt_pk_bf16_f32 v73, v74, v75
  v_mfma_f32_16x16x32_bf16 v[40:43], a[196:199], a[140:143], v[40:43]
  ds_read_b128 a[160:163], v2 offset:30848
  v_cvt_pk_bf16_f32 v74, v76, v77
  v_mfma_f32_16x16x32_bf16 v[48:51], a[176:179], a[80:83], 0
  v_cvt_pk_bf16_f32 v75, v78, v79
  v_fma_f32 v80, v80, s35, -v16
  v_mfma_f32_16x16x32_bf16 v[48:51], a[180:183], a[84:87], v[48:51]
  ds_read_b128 a[164:167], v3 offset:30848
  v_fma_f32 v81, v81, s35, -v16
  v_mfma_f32_16x16x32_bf16 v[48:51], a[184:187], a[88:91], v[48:51]
  v_exp_f32_e32 v80, v80
  v_mfma_f32_16x16x32_bf16 v[48:51], a[188:191], a[92:95], v[48:51]
  ds_read_b128 a[168:171], v2 offset:30976
  v_fma_f32 v82, v82, s35, -v16
  v_mfma_f32_16x16x32_bf16 v[48:51], a[192:195], a[144:147], v[48:51]
  v_exp_f32_e32 v81, v81
  v_fma_f32 v83, v83, s35, -v16
  v_mfma_f32_16x16x32_bf16 v[48:51], a[196:199], a[148:151], v[48:51]
  ds_read_b128 a[172:175], v3 offset:30976
  v_fma_f32 v84, v84, s35, -v16
  v_mfma_f32_16x16x32_bf16 v[56:59], a[176:179], a[104:107], 0
  v_exp_f32_e32 v82, v82
  v_fma_f32 v85, v85, s35, -v16
  v_mfma_f32_16x16x32_bf16 v[56:59], a[180:183], a[108:111], v[56:59]
  v_exp_f32_e32 v83, v83
  v_mfma_f32_16x16x32_bf16 v[56:59], a[184:187], a[112:115], v[56:59]
  v_exp_f32_e32 v84, v84
  v_fma_f32 v86, v86, s35, -v16
  v_mfma_f32_16x16x32_bf16 v[56:59], a[188:191], a[116:119], v[56:59]
  v_exp_f32_e32 v85, v85
  v_mfma_f32_16x16x32_bf16 v[56:59], a[192:195], a[152:155], v[56:59]
  v_exp_f32_e32 v86, v86
  v_fma_f32 v87, v87, s35, -v16
  v_mfma_f32_16x16x32_bf16 v[56:59], a[196:199], a[156:159], v[56:59]
  s_waitcnt lgkmcnt(1)
  v_exp_f32_e32 v87, v87
  v_mfma_f32_16x16x32_bf16 v[36:39], a[200:203], a[32:35], 0
  v_add_f32_e32 v30, v30, v80
  v_add_f32_e32 v30, v30, v81
  v_cvt_pk_bf16_f32 v80, v80, v81
  v_mfma_f32_16x16x32_bf16 v[36:39], a[204:207], a[36:39], v[36:39]
  v_add_f32_e32 v30, v30, v82
  v_add_f32_e32 v30, v30, v83
  v_mfma_f32_16x16x32_bf16 v[36:39], a[160:163], a[40:43], v[36:39]
  v_cvt_pk_bf16_f32 v81, v82, v83
  v_cvt_pk_bf16_f32 v82, v84, v85
  v_cvt_pk_bf16_f32 v83, v86, v87
  v_mfma_f32_16x16x32_bf16 v[36:39], a[164:167], a[44:47], v[36:39]
  v_fma_f32 v88, v88, s35, -v17
  v_fma_f32 v89, v89, s35, -v17
  v_mfma_f32_16x16x32_bf16 v[36:39], a[168:171], a[128:131], v[36:39]
  s_waitcnt lgkmcnt(0)
  v_exp_f32_e32 v88, v88
  v_fma_f32 v90, v90, s35, -v17
  v_mfma_f32_16x16x32_bf16 v[36:39], a[172:175], a[132:135], v[36:39]
  v_exp_f32_e32 v89, v89
  v_mfma_f32_16x16x32_bf16 v[44:47], a[200:203], a[56:59], 0
  v_exp_f32_e32 v90, v90
  v_fma_f32 v91, v91, s35, -v17
  v_mfma_f32_16x16x32_bf16 v[44:47], a[204:207], a[60:63], v[44:47]
  s_waitcnt vmcnt(8)
  s_barrier
  v_fma_f32 v92, v92, s35, -v17
  v_mfma_f32_16x16x32_bf16 v[44:47], a[160:163], a[64:67], v[44:47]
  ds_read_b64_tr_b16 a[176:177], v4 offset:12288
  v_exp_f32_e32 v91, v91
  v_fma_f32 v93, v93, s35, -v17
  v_mfma_f32_16x16x32_bf16 v[44:47], a[164:167], a[68:71], v[44:47]
  v_exp_f32_e32 v92, v92
  v_fma_f32 v94, v94, s35, -v17
  v_mfma_f32_16x16x32_bf16 v[44:47], a[168:171], a[136:139], v[44:47]
  ds_read_b64_tr_b16 a[178:179], v4 offset:18432
  v_exp_f32_e32 v93, v93
  v_fma_f32 v95, v95, s35, -v17
  v_mfma_f32_16x16x32_bf16 v[44:47], a[172:175], a[140:143], v[44:47]
  v_exp_f32_e32 v94, v94
  v_add_f32_e32 v31, v31, v88
  v_mfma_f32_16x16x32_bf16 v[52:55], a[200:203], a[80:83], 0
  ds_read_b64_tr_b16 a[180:181], v5 offset:12288
  v_exp_f32_e32 v95, v95
  v_add_f32_e32 v31, v31, v89
  v_mfma_f32_16x16x32_bf16 v[52:55], a[204:207], a[84:87], v[52:55]
  v_cvt_pk_bf16_f32 v88, v88, v89
  v_add_f32_e32 v31, v31, v90
  v_add_f32_e32 v31, v31, v91
  v_mfma_f32_16x16x32_bf16 v[52:55], a[160:163], a[88:91], v[52:55]
  ds_read_b64_tr_b16 a[182:183], v5 offset:18432
  v_cvt_pk_bf16_f32 v89, v90, v91
  v_cvt_pk_bf16_f32 v90, v92, v93
  v_cvt_pk_bf16_f32 v91, v94, v95
  v_mfma_f32_16x16x32_bf16 v[52:55], a[164:167], a[92:95], v[52:55]
  v_accvgpr_write_b32 a224, v64
  v_accvgpr_write_b32 a225, v65
  v_accvgpr_write_b32 a226, v66
  v_mfma_f32_16x16x32_bf16 v[52:55], a[168:171], a[144:147], v[52:55]
  ds_read_b64_tr_b16 a[184:185], v6 offset:12288
  v_accvgpr_write_b32 a227, v67
  v_accvgpr_write_b32 a228, v72
  v_accvgpr_write_b32 a229, v73
  v_mfma_f32_16x16x32_bf16 v[52:55], a[172:175], a[148:151], v[52:55]
  v_accvgpr_write_b32 a230, v74
  v_accvgpr_write_b32 a231, v75
  v_accvgpr_write_b32 a232, v80
  v_mfma_f32_16x16x32_bf16 v[60:63], a[200:203], a[104:107], 0
  ds_read_b64_tr_b16 a[186:187], v6 offset:18432
  v_accvgpr_write_b32 a233, v81
  v_accvgpr_write_b32 a234, v82
  v_accvgpr_write_b32 a235, v83
  v_mfma_f32_16x16x32_bf16 v[60:63], a[204:207], a[108:111], v[60:63]
  v_accvgpr_write_b32 a236, v88
  v_accvgpr_write_b32 a237, v89
  v_accvgpr_write_b32 a238, v90
  v_mfma_f32_16x16x32_bf16 v[60:63], a[160:163], a[112:115], v[60:63]
  ds_read_b64_tr_b16 a[188:189], v7 offset:12288
  v_accvgpr_write_b32 a239, v91
  v_add_f32_e32 v0, v0, v76
  v_add_f32_e32 v0, v0, v77
  v_mfma_f32_16x16x32_bf16 v[60:63], a[164:167], a[116:119], v[60:63]
  v_add_f32_e32 v0, v0, v78
  v_add_f32_e32 v0, v0, v79
  v_add_f32_e32 v30, v30, v84
  v_add_f32_e32 v30, v30, v85
  v_mfma_f32_16x16x32_bf16 v[60:63], a[168:171], a[152:155], v[60:63]
  ds_read_b64_tr_b16 a[190:191], v7 offset:18432
  v_add_f32_e32 v30, v30, v86
  v_add_f32_e32 v30, v30, v87
  v_mfma_f32_16x16x32_bf16 v[60:63], a[172:175], a[156:159], v[60:63]
  v_add_f32_e32 v31, v31, v92
  v_add_f32_e32 v31, v31, v93
  v_add_f32_e32 v31, v31, v94
  v_add_f32_e32 v31, v31, v95
  v_mfma_f32_16x16x32_bf16 a[240:243], v[18:21], v[64:67], a[240:243]
  s_waitcnt lgkmcnt(4)
  ds_read_b128 a[192:195], v2 offset:36864
  v_fma_f32 v32, v32, s35, -v14
  v_exp_f32_e32 v32, v32
  v_mfma_f32_16x16x32_bf16 v[96:99], a[176:179], v[64:67], v[96:99]
  v_fma_f32 v33, v33, s35, -v14
  v_exp_f32_e32 v33, v33
  v_fma_f32 v34, v34, s35, -v14
  v_mfma_f32_16x16x32_bf16 v[100:103], a[176:179], v[72:75], v[100:103]
  ds_read_b128 a[196:199], v3 offset:36864
  v_exp_f32_e32 v34, v34
  v_fma_f32 v35, v35, s35, -v14
  v_mfma_f32_16x16x32_bf16 v[104:107], a[176:179], v[80:83], v[104:107]
  v_exp_f32_e32 v35, v35
  v_fma_f32 v36, v36, s35, -v14
  v_fma_f32 v37, v37, s35, -v14
  v_mfma_f32_16x16x32_bf16 v[108:111], a[176:179], v[88:91], v[108:111]
  ds_read_b128 a[200:203], v2 offset:36992
  v_exp_f32_e32 v36, v36
  v_fma_f32 v38, v38, s35, -v14
  v_mfma_f32_16x16x32_bf16 v[112:115], a[180:183], v[64:67], v[112:115]
  v_exp_f32_e32 v37, v37
  v_exp_f32_e32 v38, v38
  v_mfma_f32_16x16x32_bf16 v[116:119], a[180:183], v[72:75], v[116:119]
  ds_read_b128 a[204:207], v3 offset:36992
  v_fma_f32 v39, v39, s35, -v14
  v_exp_f32_e32 v39, v39
  v_mfma_f32_16x16x32_bf16 v[120:123], a[180:183], v[80:83], v[120:123]
  v_cvt_pk_bf16_f32 v32, v32, v33
  v_cvt_pk_bf16_f32 v33, v34, v35
  v_cvt_pk_bf16_f32 v34, v36, v37
  v_cvt_pk_bf16_f32 v35, v38, v39
  v_mfma_f32_16x16x32_bf16 v[124:127], a[180:183], v[88:91], v[124:127]
  s_waitcnt lgkmcnt(3)
  ds_read_b128 a[160:163], v2 offset:37120
  v_fma_f32 v40, v40, s35, -v15
  v_exp_f32_e32 v40, v40
  v_fma_f32 v41, v41, s35, -v15
  v_mfma_f32_16x16x32_bf16 v[128:131], a[184:187], v[64:67], v[128:131]
  v_exp_f32_e32 v41, v41
  v_fma_f32 v42, v42, s35, -v15
  v_fma_f32 v43, v43, s35, -v15
  v_mfma_f32_16x16x32_bf16 v[132:135], a[184:187], v[72:75], v[132:135]
  ds_read_b128 a[164:167], v3 offset:37120
  v_exp_f32_e32 v42, v42
  v_fma_f32 v44, v44, s35, -v15
  v_mfma_f32_16x16x32_bf16 v[136:139], a[184:187], v[80:83], v[136:139]
  v_exp_f32_e32 v43, v43
  v_exp_f32_e32 v44, v44
  v_fma_f32 v45, v45, s35, -v15
  v_mfma_f32_16x16x32_bf16 v[140:143], a[184:187], v[88:91], v[140:143]
  v_exp_f32_e32 v45, v45
  v_fma_f32 v46, v46, s35, -v15
  v_fma_f32 v47, v47, s35, -v15
  v_mfma_f32_16x16x32_bf16 v[144:147], a[188:191], v[64:67], v[144:147]
  v_exp_f32_e32 v46, v46
  v_exp_f32_e32 v47, v47
  v_add_f32_e32 v0, v0, v40
  v_mfma_f32_16x16x32_bf16 v[148:151], a[188:191], v[72:75], v[148:151]
  v_add_f32_e32 v0, v0, v41
  v_cvt_pk_bf16_f32 v40, v40, v41
  v_add_f32_e32 v0, v0, v42
  v_add_f32_e32 v0, v0, v43
  v_mfma_f32_16x16x32_bf16 v[152:155], a[188:191], v[80:83], v[152:155]
  v_cvt_pk_bf16_f32 v41, v42, v43
  v_cvt_pk_bf16_f32 v42, v44, v45
  v_cvt_pk_bf16_f32 v43, v46, v47
  v_fma_f32 v48, v48, s35, -v16
  v_fma_f32 v49, v49, s35, -v16
  v_mfma_f32_16x16x32_bf16 v[156:159], a[188:191], v[88:91], v[156:159]
  v_exp_f32_e32 v48, v48
  v_exp_f32_e32 v49, v49
  v_mfma_f32_16x16x32_bf16 v[64:67], a[192:195], a[32:35], 0
  s_waitcnt lgkmcnt(1)
  v_fma_f32 v50, v50, s35, -v16
  v_exp_f32_e32 v50, v50
  v_fma_f32 v51, v51, s35, -v16
  v_fma_f32 v52, v52, s35, -v16
  v_mfma_f32_16x16x32_bf16 v[64:67], a[196:199], a[36:39], v[64:67]
  v_exp_f32_e32 v51, v51
  v_exp_f32_e32 v52, v52
  v_mfma_f32_16x16x32_bf16 v[64:67], a[200:203], a[40:43], v[64:67]
  v_fma_f32 v53, v53, s35, -v16
  v_exp_f32_e32 v53, v53
  v_fma_f32 v54, v54, s35, -v16
  v_fma_f32 v55, v55, s35, -v16
  v_mfma_f32_16x16x32_bf16 v[64:67], a[204:207], a[44:47], v[64:67]
  v_exp_f32_e32 v54, v54
  v_exp_f32_e32 v55, v55
  v_mfma_f32_16x16x32_bf16 v[64:67], a[160:163], a[128:131], v[64:67]
  s_waitcnt lgkmcnt(0)
  v_add_f32_e32 v30, v30, v48
  v_add_f32_e32 v30, v30, v49
  v_cvt_pk_bf16_f32 v48, v48, v49
  v_add_f32_e32 v30, v30, v50
  v_add_f32_e32 v30, v30, v51
  v_mfma_f32_16x16x32_bf16 v[64:67], a[164:167], a[132:135], v[64:67]
  v_cvt_pk_bf16_f32 v49, v50, v51
  v_cvt_pk_bf16_f32 v50, v52, v53
  v_cvt_pk_bf16_f32 v51, v54, v55
  v_fma_f32 v56, v56, s35, -v17
  v_mfma_f32_16x16x32_bf16 v[72:75], a[192:195], a[56:59], 0
  v_exp_f32_e32 v56, v56
  v_fma_f32 v57, v57, s35, -v17
  v_exp_f32_e32 v57, v57
  v_mfma_f32_16x16x32_bf16 v[72:75], a[196:199], a[60:63], v[72:75]
  ds_read_b128 a[168:171], v2 offset:43008
  v_fma_f32 v58, v58, s35, -v17
  v_exp_f32_e32 v58, v58
  v_mfma_f32_16x16x32_bf16 v[72:75], a[200:203], a[64:67], v[72:75]
  v_fma_f32 v59, v59, s35, -v17
  v_exp_f32_e32 v59, v59
  v_fma_f32 v60, v60, s35, -v17
  v_fma_f32 v61, v61, s35, -v17
  v_mfma_f32_16x16x32_bf16 v[72:75], a[204:207], a[68:71], v[72:75]
  ds_read_b128 a[172:175], v3 offset:43008
  v_exp_f32_e32 v60, v60
  v_fma_f32 v62, v62, s35, -v17
  v_mfma_f32_16x16x32_bf16 v[72:75], a[160:163], a[136:139], v[72:75]
  v_exp_f32_e32 v61, v61
  v_exp_f32_e32 v62, v62
  v_fma_f32 v63, v63, s35, -v17
  v_mfma_f32_16x16x32_bf16 v[72:75], a[164:167], a[140:143], v[72:75]
  ds_read_b128 a[176:179], v2 offset:43136
  v_exp_f32_e32 v63, v63
  v_add_f32_e32 v31, v31, v56
  v_mfma_f32_16x16x32_bf16 v[80:83], a[192:195], a[80:83], 0
  v_add_f32_e32 v31, v31, v57
  v_cvt_pk_bf16_f32 v56, v56, v57
  v_add_f32_e32 v31, v31, v58
  v_add_f32_e32 v31, v31, v59
  v_cvt_pk_bf16_f32 v57, v58, v59
  v_mfma_f32_16x16x32_bf16 v[80:83], a[196:199], a[84:87], v[80:83]
  ds_read_b128 a[180:183], v3 offset:43136
  v_cvt_pk_bf16_f32 v58, v60, v61
  v_cvt_pk_bf16_f32 v59, v62, v63
  v_fma_f32 v64, v64, s35, -v14
  v_mfma_f32_16x16x32_bf16 v[80:83], a[200:203], a[88:91], v[80:83]
  v_exp_f32_e32 v64, v64
  v_fma_f32 v65, v65, s35, -v14
  v_exp_f32_e32 v65, v65
  v_mfma_f32_16x16x32_bf16 v[80:83], a[204:207], a[92:95], v[80:83]
  ds_read_b128 a[184:187], v2 offset:43264
  v_fma_f32 v66, v66, s35, -v14
  v_exp_f32_e32 v66, v66
  v_mfma_f32_16x16x32_bf16 v[80:83], a[160:163], a[144:147], v[80:83]
  v_fma_f32 v67, v67, s35, -v14
  v_exp_f32_e32 v67, v67
  v_cvt_pk_bf16_f32 v64, v64, v65
  v_cvt_pk_bf16_f32 v65, v66, v67
  v_mfma_f32_16x16x32_bf16 v[80:83], a[164:167], a[148:151], v[80:83]
  ds_read_b128 a[188:191], v3 offset:43264
  v_add_f32_e32 v0, v0, v44
  v_add_f32_e32 v0, v0, v45
  v_add_f32_e32 v0, v0, v46
  v_mfma_f32_16x16x32_bf16 v[88:91], a[192:195], a[104:107], 0
  v_add_f32_e32 v0, v0, v47
  v_fma_f32 v72, v72, s35, -v15
  v_exp_f32_e32 v72, v72
  v_fma_f32 v73, v73, s35, -v15
  v_mfma_f32_16x16x32_bf16 v[88:91], a[196:199], a[108:111], v[88:91]
  v_exp_f32_e32 v73, v73
  v_fma_f32 v74, v74, s35, -v15
  v_fma_f32 v75, v75, s35, -v15
  v_mfma_f32_16x16x32_bf16 v[88:91], a[200:203], a[112:115], v[88:91]
  v_exp_f32_e32 v74, v74
  v_exp_f32_e32 v75, v75
  v_add_f32_e32 v0, v0, v72
  v_mfma_f32_16x16x32_bf16 v[88:91], a[204:207], a[116:119], v[88:91]
  v_add_f32_e32 v0, v0, v73
  v_cvt_pk_bf16_f32 v72, v72, v73
  v_add_f32_e32 v0, v0, v74
  v_add_f32_e32 v0, v0, v75
  v_mfma_f32_16x16x32_bf16 v[88:91], a[160:163], a[152:155], v[88:91]
  v_cvt_pk_bf16_f32 v73, v74, v75
  v_add_f32_e32 v30, v30, v52
  v_add_f32_e32 v30, v30, v53
  v_add_f32_e32 v30, v30, v54
  v_add_f32_e32 v30, v30, v55
  v_mfma_f32_16x16x32_bf16 v[88:91], a[164:167], a[156:159], v[88:91]
  s_waitcnt lgkmcnt(1)
  v_fma_f32 v80, v80, s35, -v16
  v_exp_f32_e32 v80, v80
  v_fma_f32 v81, v81, s35, -v16
  v_mfma_f32_16x16x32_bf16 v[68:71], a[168:171], a[32:35], 0
  v_exp_f32_e32 v81, v81
  v_fma_f32 v82, v82, s35, -v16
  v_exp_f32_e32 v82, v82
  v_mfma_f32_16x16x32_bf16 v[68:71], a[172:175], a[36:39], v[68:71]
  v_fma_f32 v83, v83, s35, -v16
  v_exp_f32_e32 v83, v83
  v_add_f32_e32 v30, v30, v80
  v_mfma_f32_16x16x32_bf16 v[68:71], a[176:179], a[40:43], v[68:71]
  s_waitcnt vmcnt(5)
  s_barrier
  v_add_f32_e32 v30, v30, v81
  v_cvt_pk_bf16_f32 v80, v80, v81
  v_add_f32_e32 v30, v30, v82
  v_mfma_f32_16x16x32_bf16 v[68:71], a[180:183], a[44:47], v[68:71]
  ds_read_b64_tr_b16 a[192:193], v4 offset:24576
  v_add_f32_e32 v30, v30, v83
  v_cvt_pk_bf16_f32 v81, v82, v83
  v_add_f32_e32 v31, v31, v60
  v_mfma_f32_16x16x32_bf16 v[68:71], a[184:187], a[128:131], v[68:71]
  s_waitcnt lgkmcnt(1)
  v_add_f32_e32 v31, v31, v61
  v_add_f32_e32 v31, v31, v62
  v_add_f32_e32 v31, v31, v63
  v_fma_f32 v88, v88, s35, -v17
  v_fma_f32 v89, v89, s35, -v17
  v_mfma_f32_16x16x32_bf16 v[68:71], a[188:191], a[132:135], v[68:71]
  ds_read_b64_tr_b16 a[194:195], v4 offset:30720
  v_exp_f32_e32 v88, v88
  v_fma_f32 v90, v90, s35, -v17
  v_mfma_f32_16x16x32_bf16 v[76:79], a[168:171], a[56:59], 0
  v_exp_f32_e32 v89, v89
  v_exp_f32_e32 v90, v90
  v_fma_f32 v91, v91, s35, -v17
  v_mfma_f32_16x16x32_bf16 v[76:79], a[172:175], a[60:63], v[76:79]
  ds_read_b64_tr_b16 a[196:197], v5 offset:24576
  v_exp_f32_e32 v91, v91
  v_add_f32_e32 v31, v31, v88
  v_mfma_f32_16x16x32_bf16 v[76:79], a[176:179], a[64:67], v[76:79]
  v_add_f32_e32 v31, v31, v89
  v_cvt_pk_bf16_f32 v88, v88, v89
  v_add_f32_e32 v31, v31, v90
  v_add_f32_e32 v31, v31, v91
  v_cvt_pk_bf16_f32 v89, v90, v91
  v_mfma_f32_16x16x32_bf16 v[76:79], a[180:183], a[68:71], v[76:79]
  ds_read_b64_tr_b16 a[198:199], v5 offset:30720
  v_mfma_f32_16x16x32_bf16 v[76:79], a[184:187], a[136:139], v[76:79]
  v_fma_f32 v68, v68, s35, -v14
  v_exp_f32_e32 v68, v68
  v_fma_f32 v69, v69, s35, -v14
  v_exp_f32_e32 v69, v69
  v_mfma_f32_16x16x32_bf16 v[76:79], a[188:191], a[140:143], v[76:79]
  ds_read_b64_tr_b16 a[200:201], v6 offset:24576
  v_fma_f32 v70, v70, s35, -v14
  v_exp_f32_e32 v70, v70
  v_fma_f32 v71, v71, s35, -v14
  v_mfma_f32_16x16x32_bf16 v[84:87], a[168:171], a[80:83], 0
  v_exp_f32_e32 v71, v71
  v_cvt_pk_bf16_f32 v66, v68, v69
  v_cvt_pk_bf16_f32 v67, v70, v71
  v_mfma_f32_16x16x32_bf16 v[84:87], a[172:175], a[84:87], v[84:87]
  ds_read_b64_tr_b16 a[202:203], v6 offset:30720
  v_mfma_f32_16x16x32_bf16 v[84:87], a[176:179], a[88:91], v[84:87]
  v_mfma_f32_16x16x32_bf16 v[84:87], a[180:183], a[92:95], v[84:87]
  ds_read_b64_tr_b16 a[204:205], v7 offset:24576
  v_mfma_f32_16x16x32_bf16 v[84:87], a[184:187], a[144:147], v[84:87]
  v_fma_f32 v76, v76, s35, -v15
  v_exp_f32_e32 v76, v76
  v_fma_f32 v77, v77, s35, -v15
  v_exp_f32_e32 v77, v77
  v_mfma_f32_16x16x32_bf16 v[84:87], a[188:191], a[148:151], v[84:87]
  ds_read_b64_tr_b16 a[206:207], v7 offset:30720
  v_fma_f32 v78, v78, s35, -v15
  v_exp_f32_e32 v78, v78
  v_fma_f32 v79, v79, s35, -v15
  v_mfma_f32_16x16x32_bf16 v[92:95], a[168:171], a[104:107], 0
  s_waitcnt vmcnt(0)
  s_barrier
  v_exp_f32_e32 v79, v79
  v_cvt_pk_bf16_f32 v74, v76, v77
  v_mfma_f32_16x16x32_bf16 v[92:95], a[172:175], a[108:111], v[92:95]
  ds_read_b64_tr_b16 a[160:161], v4 offset:36864
  v_cvt_pk_bf16_f32 v75, v78, v79
  v_add_f32_e32 v0, v0, v76
  v_add_f32_e32 v0, v0, v77
  v_mfma_f32_16x16x32_bf16 v[92:95], a[176:179], a[112:115], v[92:95]
  v_add_f32_e32 v0, v0, v78
  v_add_f32_e32 v0, v0, v79
  v_mov_b32_e32 v23, v0
  v_mov_b32_e32 v0, v23
  v_mfma_f32_16x16x32_bf16 v[92:95], a[180:183], a[116:119], v[92:95]
  ds_read_b64_tr_b16 a[162:163], v4 offset:43008
  v_permlane32_swap_b32_e32 v23, v0
  v_add_f32_e32 v23, v23, v0
  v_mov_b32_e32 v0, v23
  v_mfma_f32_16x16x32_bf16 v[92:95], a[184:187], a[152:155], v[92:95]
  s_nop 0
  v_permlane16_swap_b32_e32 v23, v0
  v_fma_f32 v84, v84, s35, -v16
  v_exp_f32_e32 v84, v84
  v_fma_f32 v85, v85, s35, -v16
  v_mfma_f32_16x16x32_bf16 v[92:95], a[188:191], a[156:159], v[92:95]
  ds_read_b64_tr_b16 a[164:165], v5 offset:36864
  v_exp_f32_e32 v85, v85
  v_fma_f32 v86, v86, s35, -v16
  v_mfma_f32_16x16x32_bf16 a[240:243], v[18:21], v[32:35], a[240:243]
  s_waitcnt lgkmcnt(5)
  v_exp_f32_e32 v86, v86
  v_fma_f32 v87, v87, s35, -v16
  v_exp_f32_e32 v87, v87
  v_mfma_f32_16x16x32_bf16 v[96:99], a[192:195], v[32:35], v[96:99]
  ds_read_b64_tr_b16 a[166:167], v5 offset:43008
  v_cvt_pk_bf16_f32 v82, v84, v85
  v_cvt_pk_bf16_f32 v83, v86, v87
  v_add_f32_e32 v23, v23, v0
  v_add_f32_e32 v30, v30, v84
  v_mfma_f32_16x16x32_bf16 v[100:103], a[192:195], v[40:43], v[100:103]
  v_add_f32_e32 v30, v30, v85
  v_add_f32_e32 v30, v30, v86
  v_add_f32_e32 v30, v30, v87
  v_mov_b32_e32 v24, v30
  v_mfma_f32_16x16x32_bf16 v[104:107], a[192:195], v[48:51], v[104:107]
  ds_read_b64_tr_b16 a[168:169], v6 offset:36864
  v_mov_b32_e32 v30, v24
  v_mfma_f32_16x16x32_bf16 v[108:111], a[192:195], v[56:59], v[108:111]
L_hop14:
  s_cbranch_execz L_walkdone
  s_nop 0
  v_permlane32_swap_b32_e32 v24, v30
  v_fma_f32 v92, v92, s35, -v17
  v_exp_f32_e32 v92, v92
  v_fma_f32 v93, v93, s35, -v17
  v_mfma_f32_16x16x32_bf16 v[112:115], a[196:199], v[32:35], v[112:115]
  ds_read_b64_tr_b16 a[170:171], v6 offset:43008
  v_exp_f32_e32 v93, v93
  v_fma_f32 v94, v94, s35, -v17
  v_fma_f32 v95, v95, s35, -v17
  v_mfma_f32_16x16x32_bf16 v[116:119], a[196:199], v[40:43], v[116:119]
  v_exp_f32_e32 v94, v94
  v_exp_f32_e32 v95, v95
  v_cvt_pk_bf16_f32 v90, v92, v93
  v_mfma_f32_16x16x32_bf16 v[120:123], a[196:199], v[48:51], v[120:123]
  ds_read_b64_tr_b16 a[172:173], v7 offset:36864
  v_cvt_pk_bf16_f32 v91, v94, v95
  v_add_f32_e32 v24, v24, v30
  v_mov_b32_e32 v30, v24
  v_mfma_f32_16x16x32_bf16 v[124:127], a[196:199], v[56:59], v[124:127]
  s_nop 0
  v_permlane16_swap_b32_e32 v24, v30
  v_add_f32_e32 v24, v24, v30
  v_add_f32_e32 v31, v31, v92
  v_add_f32_e32 v31, v31, v93
  v_mfma_f32_16x16x32_bf16 v[128:131], a[200:203], v[32:35], v[128:131]
  ds_read_b64_tr_b16 a[174:175], v7 offset:43008
  v_add_f32_e32 v31, v31, v94
  v_add_f32_e32 v31, v31, v95
  v_mov_b32_e32 v25, v31
  v_mov_b32_e32 v31, v25
  v_mfma_f32_16x16x32_bf16 v[132:135], a[200:203], v[40:43], v[132:135]
  s_nop 0
  v_permlane32_swap_b32_e32 v25, v31
  v_add_f32_e32 v25, v25, v31
  v_mov_b32_e32 v31, v25
  v_mfma_f32_16x16x32_bf16 v[136:139], a[200:203], v[48:51], v[136:139]
  ds_read_b64_tr_b16 a[176:177], v4 offset:128
  v_permlane16_swap_b32_e32 v25, v31
  v_add_f32_e32 v25, v25, v31
  v_mfma_f32_16x16x32_bf16 v[140:143], a[200:203], v[56:59], v[140:143]
  s_waitcnt lgkmcnt(5)
  v_mfma_f32_16x16x32_bf16 v[144:147], a[204:207], v[32:35], v[144:147]
  ds_read_b64_tr_b16 a[178:179], v4 offset:6272
  v_mfma_f32_16x16x32_bf16 v[148:151], a[204:207], v[40:43], v[148:151]
  v_mfma_f32_16x16x32_bf16 v[152:155], a[204:207], v[48:51], v[152:155]
  ds_read_b64_tr_b16 a[180:181], v4 offset:12416
  v_mfma_f32_16x16x32_bf16 v[156:159], a[204:207], v[56:59], v[156:159]
  v_mfma_f32_16x16x32_bf16 a[240:243], v[18:21], v[64:67], a[240:243]
  ds_read_b64_tr_b16 a[182:183], v4 offset:18560
  v_mfma_f32_16x16x32_bf16 v[96:99], a[160:163], v[64:67], v[96:99]
  v_mfma_f32_16x16x32_bf16 v[100:103], a[160:163], v[72:75], v[100:103]
  ds_read_b64_tr_b16 a[184:185], v4 offset:24704
  v_mfma_f32_16x16x32_bf16 v[104:107], a[160:163], v[80:83], v[104:107]
  v_mfma_f32_16x16x32_bf16 v[108:111], a[160:163], v[88:91], v[108:111]
  ds_read_b64_tr_b16 a[186:187], v4 offset:30848
  v_mfma_f32_16x16x32_bf16 v[112:115], a[164:167], v[64:67], v[112:115]
  v_accvgpr_read_b32 v22, a240
  v_cmp_nge_f32_e32 vcc, s36, v22
  v_rcp_f32_e32 v22, v22
  v_mfma_f32_16x16x32_bf16 v[116:119], a[164:167], v[72:75], v[116:119]
  s_or_b64 s[42:43], s[42:43], vcc
  ds_read_b64_tr_b16 a[188:189], v4 offset:36992
  v_cmp_nge_f32_e32 vcc, s36, v23
  v_rcp_f32_e32 v23, v23
  v_mul_f32_e32 v96, v22, v96
  v_mul_f32_e32 v97, v22, v97
  v_mul_f32_e32 v98, v22, v98
  v_mul_f32_e32 v99, v22, v99
  v_mfma_f32_16x16x32_bf16 v[120:123], a[164:167], v[80:83], v[120:123]
  s_or_b64 s[42:43], s[42:43], vcc
  v_cmp_nge_f32_e32 vcc, s36, v24
  v_rcp_f32_e32 v24, v24
  v_cvt_pk_bf16_f32 v96, v96, v97
  v_cvt_pk_bf16_f32 v97, v98, v99
  v_mul_f32_e32 v100, v23, v100
  v_mfma_f32_16x16x32_bf16 v[124:127], a[164:167], v[88:91], v[124:127]
  s_waitcnt lgkmcnt(3)
  s_or_b64 s[42:43], s[42:43], vcc
  ds_read_b64_tr_b16 a[190:191], v4 offset:43136
  v_cmp_nge_f32_e32 vcc, s36, v25
  v_rcp_f32_e32 v25, v25
  v_mul_f32_e32 v101, v23, v101
  v_mul_f32_e32 v102, v23, v102
  v_mfma_f32_16x16x32_bf16 v[128:131], a[168:171], v[64:67], v[128:131]
  s_or_b64 s[42:43], s[42:43], vcc
  ds_write_b64 v12, v[96:97] offset:0
  v_mul_f32_e32 v103, v23, v103
  v_cvt_pk_bf16_f32 v100, v100, v101
  v_cvt_pk_bf16_f32 v101, v102, v103
  v_mul_f32_e32 v104, v24, v104
  v_mfma_f32_16x16x32_bf16 v[132:135], a[168:171], v[72:75], v[132:135]
  ds_read_b64_tr_b16 a[192:193], v5 offset:128
  v_mul_f32_e32 v105, v24, v105
  v_mul_f32_e32 v106, v24, v106
  v_mul_f32_e32 v107, v24, v107
  v_cvt_pk_bf16_f32 v104, v104, v105
  v_cvt_pk_bf16_f32 v105, v106, v107
  v_mul_f32_e32 v108, v25, v108
  v_mfma_f32_16x16x32_bf16 v[136:139], a[168:171], v[80:83], v[136:139]
  ds_write_b64 v12, v[100:101] offset:2304
  v_mul_f32_e32 v109, v25, v109
  v_mul_f32_e32 v110, v25, v110
  v_mul_f32_e32 v111, v25, v111
  v_cvt_pk_bf16_f32 v108, v108, v109
  v_mfma_f32_16x16x32_bf16 v[140:143], a[168:171], v[88:91], v[140:143]
  ds_read_b64_tr_b16 a[194:195], v5 offset:6272
  v_cvt_pk_bf16_f32 v109, v110, v111
  v_mul_f32_e32 v112, v22, v112
  v_mul_f32_e32 v113, v22, v113
  v_mul_f32_e32 v114, v22, v114
  v_mul_f32_e32 v115, v22, v115
  v_cvt_pk_bf16_f32 v112, v112, v113
  v_mfma_f32_16x16x32_bf16 v[144:147], a[172:175], v[64:67], v[144:147]
  ds_write_b64 v12, v[104:105] offset:4608
  v_cvt_pk_bf16_f32 v113, v114, v115
  v_mul_f32_e32 v116, v23, v116
  v_mul_f32_e32 v117, v23, v117
  v_mul_f32_e32 v118, v23, v118
  v_mfma_f32_16x16x32_bf16 v[148:151], a[172:175], v[72:75], v[148:151]
  ds_read_b64_tr_b16 a[196:197], v5 offset:12416
  v_mul_f32_e32 v119, v23, v119
  v_cvt_pk_bf16_f32 v116, v116, v117
  v_cvt_pk_bf16_f32 v117, v118, v119
  v_mul_f32_e32 v120, v24, v120
  v_mul_f32_e32 v121, v24, v121
  v_mfma_f32_16x16x32_bf16 v[152:155], a[172:175], v[80:83], v[152:155]
  ds_write_b64 v12, v[108:109] offset:6912
  v_mul_f32_e32 v122, v24, v122
  v_mul_f32_e32 v123, v24, v123
  v_cvt_pk_bf16_f32 v120, v120, v121
  v_cvt_pk_bf16_f32 v121, v122, v123
  v_mul_f32_e32 v124, v25, v124
  v_mfma_f32_16x16x32_bf16 v[156:159], a[172:175], v[88:91], v[156:159]
  ds_read_b64_tr_b16 a[198:199], v5 offset:18560
  v_mul_f32_e32 v125, v25, v125
  v_mul_f32_e32 v126, v25, v126
  v_mul_f32_e32 v127, v25, v127
  v_cvt_pk_bf16_f32 v124, v124, v125
  v_cvt_pk_bf16_f32 v125, v126, v127
  v_mfma_f32_16x16x32_bf16 v[160:163], a[176:179], a[208:211], v[160:163]
  ds_write_b64 v12, v[112:113] offset:32
  v_mul_f32_e32 v128, v22, v128
  v_mul_f32_e32 v129, v22, v129
  v_mul_f32_e32 v130, v22, v130
  v_mul_f32_e32 v131, v22, v131
  v_mfma_f32_16x16x32_bf16 v[160:163], a[180:183], a[224:227], v[160:163]
  s_waitcnt lgkmcnt(9)
  ds_read_b64_tr_b16 a[200:201], v5 offset:24704
  v_cvt_pk_bf16_f32 v128, v128, v129
  v_cvt_pk_bf16_f32 v129, v130, v131
  v_mul_f32_e32 v132, v23, v132
  v_mul_f32_e32 v133, v23, v133
  v_mul_f32_e32 v134, v23, v134
  v_mfma_f32_16x16x32_bf16 v[160:163], a[184:187], v[32:35], v[160:163]
  ds_write_b64 v12, v[116:117] offset:2336
  v_mul_f32_e32 v135, v23, v135
  v_cvt_pk_bf16_f32 v132, v132, v133
  v_cvt_pk_bf16_f32 v133, v134, v135
  v_mul_f32_e32 v136, v24, v136
  v_mul_f32_e32 v137, v24, v137
  v_mfma_f32_16x16x32_bf16 v[160:163], a[188:191], v[64:67], v[160:163]
  ds_read_b64_tr_b16 a[202:203], v5 offset:30848
  v_mul_f32_e32 v138, v24, v138
  v_mul_f32_e32 v139, v24, v139
  v_cvt_pk_bf16_f32 v136, v136, v137
  v_cvt_pk_bf16_f32 v137, v138, v139
  v_mul_f32_e32 v140, v25, v140
  v_mfma_f32_16x16x32_bf16 v[164:167], a[176:179], a[212:215], v[164:167]
  ds_write_b64 v12, v[120:121] offset:4640
  v_mul_f32_e32 v141, v25, v141
  v_mul_f32_e32 v142, v25, v142
  v_mul_f32_e32 v143, v25, v143
  v_cvt_pk_bf16_f32 v140, v140, v141
  v_mfma_f32_16x16x32_bf16 v[164:167], a[180:183], a[228:231], v[164:167]
  ds_read_b64_tr_b16 a[204:205], v5 offset:36992
  v_cvt_pk_bf16_f32 v141, v142, v143
  v_mul_f32_e32 v144, v22, v144
  v_mul_f32_e32 v145, v22, v145
  v_mul_f32_e32 v146, v22, v146
  v_mul_f32_e32 v147, v22, v147
  v_mfma_f32_16x16x32_bf16 v[164:167], a[184:187], v[40:43], v[164:167]
  ds_write_b64 v12, v[124:125] offset:6944
  v_cvt_pk_bf16_f32 v144, v144, v145
  v_cvt_pk_bf16_f32 v145, v146, v147
  v_mul_f32_e32 v148, v23, v148
  v_mul_f32_e32 v149, v23, v149
  v_mfma_f32_16x16x32_bf16 v[164:167], a[188:191], v[72:75], v[164:167]
  s_waitcnt lgkmcnt(10)
  ds_read_b64_tr_b16 a[206:207], v5 offset:43136
  ds_write_b64 v12, v[128:129] offset:64
  v_mul_f32_e32 v150, v23, v150
  v_mul_f32_e32 v151, v23, v151
  v_cvt_pk_bf16_f32 v148, v148, v149
  v_mfma_f32_16x16x32_bf16 v[168:171], a[176:179], a[216:219], v[168:171]
  ds_write_b64 v12, v[132:133] offset:2368
  v_cvt_pk_bf16_f32 v149, v150, v151
  v_mul_f32_e32 v152, v24, v152
  v_mul_f32_e32 v153, v24, v153
  v_mul_f32_e32 v154, v24, v154
  v_mfma_f32_16x16x32_bf16 v[168:171], a[180:183], a[232:235], v[168:171]
  ds_read_b64_tr_b16 a[160:161], v6 offset:128
  ds_write_b64 v12, v[136:137] offset:4672
  v_mul_f32_e32 v155, v24, v155
  v_cvt_pk_bf16_f32 v152, v152, v153
  v_cvt_pk_bf16_f32 v153, v154, v155
  v_mfma_f32_16x16x32_bf16 v[168:171], a[184:187], v[48:51], v[168:171]
  s_waitcnt lgkmcnt(10)
  ds_write_b64 v12, v[140:141] offset:6976
  v_mul_f32_e32 v156, v25, v156
  v_mul_f32_e32 v157, v25, v157
  v_mfma_f32_16x16x32_bf16 v[168:171], a[188:191], v[80:83], v[168:171]
  ds_read_b64_tr_b16 a[162:163], v6 offset:6272
  ds_write_b64 v12, v[144:145] offset:96
  v_mul_f32_e32 v158, v25, v158
  v_mul_f32_e32 v159, v25, v159
  v_cvt_pk_bf16_f32 v156, v156, v157
  v_mfma_f32_16x16x32_bf16 v[172:175], a[176:179], a[220:223], v[172:175]
  ds_write_b64 v12, v[148:149] offset:2400
  v_cvt_pk_bf16_f32 v157, v158, v159
  v_mfma_f32_16x16x32_bf16 v[172:175], a[180:183], a[236:239], v[172:175]
  ds_read_b64_tr_b16 a[164:165], v6 offset:12416
  s_waitcnt lgkmcnt(10)
  ds_write_b64 v12, v[152:153] offset:4704
  v_mul_f32_e32 v160, v22, v160
  v_mfma_f32_16x16x32_bf16 v[172:175], a[184:187], v[56:59], v[172:175]
  ds_write_b64 v12, v[156:157] offset:7008
  v_mul_f32_e32 v161, v22, v161
  v_mfma_f32_16x16x32_bf16 v[172:175], a[188:191], v[88:91], v[172:175]
  s_waitcnt lgkmcnt(11)
  ds_read_b64_tr_b16 a[166:167], v6 offset:18560
  ds_read_b128 a[32:35], v13 offset:0
  v_mul_f32_e32 v162, v22, v162
  v_mfma_f32_16x16x32_bf16 v[176:179], a[192:195], a[208:211], v[176:179]
  ds_read_b128 a[36:39], v13 offset:1152
  ds_read_b128 a[40:43], v13 offset:2304
  v_mul_f32_e32 v163, v22, v163
  v_mfma_f32_16x16x32_bf16 v[176:179], a[196:199], a[224:227], v[176:179]
  s_waitcnt lgkmcnt(10)
  ds_read_b64_tr_b16 a[168:169], v6 offset:24704
  ds_read_b128 a[44:47], v13 offset:3456
  v_cvt_pk_bf16_f32 v160, v160, v161
  v_cvt_pk_bf16_f32 v161, v162, v163
  v_mfma_f32_16x16x32_bf16 v[176:179], a[200:203], v[32:35], v[176:179]
  ds_write_b64 v12, v[160:161] offset:9216
  v_mul_f32_e32 v164, v23, v164
  v_mfma_f32_16x16x32_bf16 v[176:179], a[204:207], v[64:67], v[176:179]
  ds_read_b64_tr_b16 a[170:171], v6 offset:30848
  ds_read_b128 a[48:51], v13 offset:4608
  v_mul_f32_e32 v165, v23, v165
  v_mfma_f32_16x16x32_bf16 v[180:183], a[192:195], a[212:215], v[180:183]
  s_waitcnt lgkmcnt(10)
  ds_read_b128 a[52:55], v13 offset:5760
  ds_read_b128 a[56:59], v13 offset:6912
  v_mul_f32_e32 v166, v23, v166
  v_mfma_f32_16x16x32_bf16 v[180:183], a[196:199], a[228:231], v[180:183]
  ds_read_b64_tr_b16 a[172:173], v6 offset:36992
  ds_read_b128 a[60:63], v13 offset:8064
  v_mul_f32_e32 v167, v23, v167
  v_cvt_pk_bf16_f32 v164, v164, v165
  v_cvt_pk_bf16_f32 v165, v166, v167
  v_mfma_f32_16x16x32_bf16 v[180:183], a[200:203], v[40:43], v[180:183]
  ds_write_b64 v12, v[164:165] offset:11520
  v_mul_f32_e32 v168, v24, v168
  v_mfma_f32_16x16x32_bf16 v[180:183], a[204:207], v[72:75], v[180:183]
  s_waitcnt lgkmcnt(10)
  ds_read_b64_tr_b16 a[174:175], v6 offset:43136
  v_mul_f32_e32 v169, v24, v169
  v_mul_f32_e32 v170, v24, v170
  v_mfma_f32_16x16x32_bf16 v[184:187], a[192:195], a[216:219], v[184:187]
  buffer_store_dwordx4 a[32:35], v11, s[20:23], s84 offen nt
  v_mul_f32_e32 v171, v24, v171
  v_mfma_f32_16x16x32_bf16 v[184:187], a[196:199], a[232:235], v[184:187]
  ds_read_b64_tr_b16 a[176:177], v7 offset:128
  v_cvt_pk_bf16_f32 v168, v168, v169
  v_cvt_pk_bf16_f32 v169, v170, v171
  v_mfma_f32_16x16x32_bf16 v[184:187], a[200:203], v[48:51], v[184:187]
  ds_write_b64 v12, v[168:169] offset:0
  v_mfma_f32_16x16x32_bf16 v[184:187], a[204:207], v[80:83], v[184:187]
  ds_read_b64_tr_b16 a[178:179], v7 offset:6272
  v_mul_f32_e32 v172, v25, v172
  v_mul_f32_e32 v173, v25, v173
  v_mfma_f32_16x16x32_bf16 v[188:191], a[192:195], a[220:223], v[188:191]
  buffer_store_dwordx4 a[36:39], v11, s[20:23], s84 offen offset:3072 nt
  v_mul_f32_e32 v174, v25, v174
  v_mul_f32_e32 v175, v25, v175
  v_mfma_f32_16x16x32_bf16 v[188:191], a[196:199], a[236:239], v[188:191]
  ds_read_b64_tr_b16 a[180:181], v7 offset:12416
  v_cvt_pk_bf16_f32 v172, v172, v173
  v_cvt_pk_bf16_f32 v173, v174, v175
  v_mfma_f32_16x16x32_bf16 v[188:191], a[200:203], v[56:59], v[188:191]
  s_waitcnt lgkmcnt(10)
  ds_write_b64 v12, v[172:173] offset:2304
  v_mfma_f32_16x16x32_bf16 v[188:191], a[204:207], v[88:91], v[188:191]
  s_waitcnt lgkmcnt(5)
  ds_read_b64_tr_b16 a[182:183], v7 offset:18560
  v_mul_f32_e32 v176, v22, v176
  v_mul_f32_e32 v177, v22, v177
  v_mfma_f32_16x16x32_bf16 v[192:195], a[160:163], a[208:211], v[192:195]
  buffer_store_dwordx4 a[40:43], v11, s[20:23], s85 offen nt
  v_mul_f32_e32 v178, v22, v178
  v_mul_f32_e32 v179, v22, v179
  v_mfma_f32_16x16x32_bf16 v[192:195], a[164:167], a[224:227], v[192:195]
  ds_read_b64_tr_b16 a[184:185], v7 offset:24704
  v_cvt_pk_bf16_f32 v176, v176, v177
  v_cvt_pk_bf16_f32 v177, v178, v179
  v_mfma_f32_16x16x32_bf16 v[192:195], a[168:171], v[32:35], v[192:195]
  ds_write_b64 v12, v[176:177] offset:9248
  v_mfma_f32_16x16x32_bf16 v[192:195], a[172:175], v[64:67], v[192:195]
  ds_read_b64_tr_b16 a[186:187], v7 offset:30848
  v_mul_f32_e32 v180, v23, v180
  v_mul_f32_e32 v181, v23, v181
  v_mfma_f32_16x16x32_bf16 v[196:199], a[160:163], a[212:215], v[196:199]
  buffer_store_dwordx4 a[44:47], v11, s[20:23], s85 offen offset:3072 nt
  v_mul_f32_e32 v182, v23, v182
  v_mul_f32_e32 v183, v23, v183
  v_mfma_f32_16x16x32_bf16 v[196:199], a[164:167], a[228:231], v[196:199]
  ds_read_b64_tr_b16 a[188:189], v7 offset:36992
  v_cvt_pk_bf16_f32 v180, v180, v181
  v_cvt_pk_bf16_f32 v181, v182, v183
  v_mfma_f32_16x16x32_bf16 v[196:199], a[168:171], v[40:43], v[196:199]
  ds_write_b64 v12, v[180:181] offset:11552
  v_mfma_f32_16x16x32_bf16 v[196:199], a[172:175], v[72:75], v[196:199]
  ds_read_b64_tr_b16 a[190:191], v7 offset:43136
  v_mul_f32_e32 v184, v24, v184
  v_mul_f32_e32 v185, v24, v185
  v_mfma_f32_16x16x32_bf16 v[200:203], a[160:163], a[216:219], v[200:203]
  buffer_store_dwordx4 a[48:51], v11, s[20:23], s86 offen nt
  v_mul_f32_e32 v186, v24, v186
  v_mfma_f32_16x16x32_bf16 v[200:203], a[164:167], a[232:235], v[200:203]
  ds_read_b64_tr_b16 a[192:193], v4 offset:256
  v_mul_f32_e32 v187, v24, v187
  v_cvt_pk_bf16_f32 v184, v184, v185
  v_cvt_pk_bf16_f32 v185, v186, v187
  v_mfma_f32_16x16x32_bf16 v[200:203], a[168:171], v[48:51], v[200:203]
  ds_write_b64 v12, v[184:185] offset:32
  v_mul_f32_e32 v188, v25, v188
  v_mfma_f32_16x16x32_bf16 v[200:203], a[172:175], v[80:83], v[200:203]
  ds_read_b64_tr_b16 a[194:195], v4 offset:6400
  v_mul_f32_e32 v189, v25, v189
  v_mul_f32_e32 v190, v25, v190
  v_mfma_f32_16x16x32_bf16 v[204:207], a[160:163], a[220:223], v[204:207]
  buffer_store_dwordx4 a[52:55], v11, s[20:23], s86 offen offset:3072 nt
  v_mul_f32_e32 v191, v25, v191
  v_mfma_f32_16x16x32_bf16 v[204:207], a[164:167], a[236:239], v[204:207]
  s_waitcnt lgkmcnt(10)
  ds_read_b64_tr_b16 a[196:197], v4 offset:12544
  v_cvt_pk_bf16_f32 v188, v188, v189
  v_cvt_pk_bf16_f32 v189, v190, v191
  v_mfma_f32_16x16x32_bf16 v[204:207], a[168:171], v[56:59], v[204:207]
  ds_write_b64 v12, v[188:189] offset:2336
  v_mul_f32_e32 v192, v22, v192
  v_mfma_f32_16x16x32_bf16 v[204:207], a[172:175], v[88:91], v[204:207]
  s_waitcnt lgkmcnt(5)
  ds_read_b64_tr_b16 a[198:199], v4 offset:18688
  v_mul_f32_e32 v193, v22, v193
  v_mfma_f32_16x16x32_bf16 v[208:211], a[176:179], a[208:211], v[208:211]
  buffer_store_dwordx4 a[56:59], v11, s[20:23], s87 offen nt
  v_mul_f32_e32 v194, v22, v194
  v_mul_f32_e32 v195, v22, v195
  v_mfma_f32_16x16x32_bf16 v[208:211], a[180:183], a[224:227], v[208:211]
  ds_read_b64_tr_b16 a[200:201], v4 offset:24832
  v_cvt_pk_bf16_f32 v192, v192, v193
  v_cvt_pk_bf16_f32 v193, v194, v195
  v_mfma_f32_16x16x32_bf16 v[208:211], a[184:187], v[32:35], v[208:211]
  ds_write_b64 v12, v[192:193] offset:9280
  v_mul_f32_e32 v196, v23, v196
  v_mfma_f32_16x16x32_bf16 v[208:211], a[188:191], v[64:67], v[208:211]
  ds_read_b64_tr_b16 a[202:203], v4 offset:30976
  v_mul_f32_e32 v197, v23, v197
  v_mfma_f32_16x16x32_bf16 v[212:215], a[176:179], a[212:215], v[212:215]
  buffer_store_dwordx4 a[60:63], v11, s[20:23], s87 offen offset:3072 nt
  v_mul_f32_e32 v198, v23, v198
  v_mul_f32_e32 v199, v23, v199
  v_mfma_f32_16x16x32_bf16 v[212:215], a[180:183], a[228:231], v[212:215]
  ds_read_b64_tr_b16 a[204:205], v4 offset:37120
  v_cvt_pk_bf16_f32 v196, v196, v197
  v_cvt_pk_bf16_f32 v197, v198, v199
  v_mfma_f32_16x16x32_bf16 v[212:215], a[184:187], v[40:43], v[212:215]
  ds_write_b64 v12, v[196:197] offset:11584
  v_mul_f32_e32 v200, v24, v200
  v_mfma_f32_16x16x32_bf16 v[212:215], a[188:191], v[72:75], v[212:215]
  ds_read_b64_tr_b16 a[206:207], v4 offset:43264
  v_mul_f32_e32 v201, v24, v201
  v_mfma_f32_16x16x32_bf16 v[216:219], a[176:179], a[216:219], v[216:219]
  v_mul_f32_e32 v202, v24, v202
  v_mul_f32_e32 v203, v24, v203
  v_cvt_pk_bf16_f32 v200, v200, v201
  v_mfma_f32_16x16x32_bf16 v[216:219], a[180:183], a[232:235], v[216:219]
  ds_read_b64_tr_b16 a[160:161], v5 offset:256
  v_cvt_pk_bf16_f32 v201, v202, v203
  v_mul_f32_e32 v204, v25, v204
  v_mfma_f32_16x16x32_bf16 v[216:219], a[184:187], v[48:51], v[216:219]
  ds_write_b64 v12, v[200:201] offset:64
  v_mfma_f32_16x16x32_bf16 v[216:219], a[188:191], v[80:83], v[216:219]
  ds_read_b64_tr_b16 a[162:163], v5 offset:6400
  v_mul_f32_e32 v205, v25, v205
  v_mul_f32_e32 v206, v25, v206
  v_mfma_f32_16x16x32_bf16 v[220:223], a[176:179], a[220:223], v[220:223]
  v_mul_f32_e32 v207, v25, v207
  v_cvt_pk_bf16_f32 v204, v204, v205
  v_cvt_pk_bf16_f32 v205, v206, v207
  v_mfma_f32_16x16x32_bf16 v[220:223], a[180:183], a[236:239], v[220:223]
  s_waitcnt lgkmcnt(10)
  ds_read_b64_tr_b16 a[164:165], v5 offset:12544
  v_mul_f32_e32 v208, v22, v208
  v_mfma_f32_16x16x32_bf16 v[220:223], a[184:187], v[56:59], v[220:223]
  ds_write_b64 v12, v[204:205] offset:2368
  v_mul_f32_e32 v209, v22, v209
  v_mfma_f32_16x16x32_bf16 v[220:223], a[188:191], v[88:91], v[220:223]
  s_waitcnt lgkmcnt(5)
  ds_read_b64_tr_b16 a[166:167], v5 offset:18688
  v_mul_f32_e32 v210, v22, v210
  v_mul_f32_e32 v211, v22, v211
  v_mfma_f32_16x16x32_bf16 v[224:227], a[192:195], a[208:211], v[224:227]
  v_cvt_pk_bf16_f32 v208, v208, v209
  v_cvt_pk_bf16_f32 v209, v210, v211
  v_mfma_f32_16x16x32_bf16 v[224:227], a[196:199], a[224:227], v[224:227]
  ds_read_b64_tr_b16 a[168:169], v5 offset:24832
  v_mul_f32_e32 v212, v23, v212
  v_mul_f32_e32 v213, v23, v213
  v_mfma_f32_16x16x32_bf16 v[224:227], a[200:203], v[32:35], v[224:227]
  ds_write_b64 v12, v[208:209] offset:9312
  v_mfma_f32_16x16x32_bf16 v[224:227], a[204:207], v[64:67], v[224:227]
  ds_read_b64_tr_b16 a[170:171], v5 offset:30976
  v_mul_f32_e32 v214, v23, v214
  v_mul_f32_e32 v215, v23, v215
  v_mfma_f32_16x16x32_bf16 v[228:231], a[192:195], a[212:215], v[228:231]
  v_cvt_pk_bf16_f32 v212, v212, v213
  v_cvt_pk_bf16_f32 v213, v214, v215
  v_mul_f32_e32 v216, v24, v216
  v_mfma_f32_16x16x32_bf16 v[228:231], a[196:199], a[228:231], v[228:231]
  ds_read_b64_tr_b16 a[172:173], v5 offset:37120
  v_mul_f32_e32 v217, v24, v217
  v_mfma_f32_16x16x32_bf16 v[228:231], a[200:203], v[40:43], v[228:231]
  ds_write_b64 v12, v[212:213] offset:11616
  v_mul_f32_e32 v218, v24, v218
  v_mfma_f32_16x16x32_bf16 v[228:231], a[204:207], v[72:75], v[228:231]
  ds_read_b64_tr_b16 a[174:175], v5 offset:43264
  ds_read_b128 a[64:67], v13 offset:9216
  v_mfma_f32_16x16x32_bf16 v[232:235], a[192:195], a[216:219], v[232:235]
  ds_read_b128 a[68:71], v13 offset:10368
  ds_read_b128 a[72:75], v13 offset:11520
  v_mul_f32_e32 v219, v24, v219
  v_mfma_f32_16x16x32_bf16 v[232:235], a[196:199], a[232:235], v[232:235]
  s_waitcnt lgkmcnt(10)
  ds_read_b64_tr_b16 a[176:177], v6 offset:256
  ds_read_b128 a[76:79], v13 offset:12672
  v_cvt_pk_bf16_f32 v216, v216, v217
  v_cvt_pk_bf16_f32 v217, v218, v219
  v_mfma_f32_16x16x32_bf16 v[232:235], a[200:203], v[48:51], v[232:235]
  ds_write_b64 v12, v[216:217] offset:96
  v_mul_f32_e32 v220, v25, v220
  v_mfma_f32_16x16x32_bf16 v[232:235], a[204:207], v[80:83], v[232:235]
  ds_read_b64_tr_b16 a[178:179], v6 offset:6400
  v_mul_f32_e32 v221, v25, v221
  v_mfma_f32_16x16x32_bf16 v[236:239], a[192:195], a[220:223], v[236:239]
  v_mul_f32_e32 v222, v25, v222
  v_mul_f32_e32 v223, v25, v223
  v_cvt_pk_bf16_f32 v220, v220, v221
  v_mfma_f32_16x16x32_bf16 v[236:239], a[196:199], a[236:239], v[236:239]
  ds_read_b64_tr_b16 a[180:181], v6 offset:12544
  v_cvt_pk_bf16_f32 v221, v222, v223
  v_mfma_f32_16x16x32_bf16 v[236:239], a[200:203], v[56:59], v[236:239]
  s_waitcnt lgkmcnt(10)
  ds_write_b64 v12, v[220:221] offset:2400
  v_mfma_f32_16x16x32_bf16 v[236:239], a[204:207], v[88:91], v[236:239]
  s_waitcnt lgkmcnt(9)
  ds_read_b64_tr_b16 a[182:183], v6 offset:18688
  ds_read_b128 a[80:83], v13 offset:0
  v_mfma_f32_16x16x32_bf16 v[240:243], a[160:163], a[208:211], v[240:243]
  s_waitcnt lgkmcnt(10)
  buffer_store_dwordx4 a[64:67], v11, s[20:23], s84 offen offset:128 nt
  v_mfma_f32_16x16x32_bf16 v[240:243], a[164:167], a[224:227], v[240:243]
  ds_read_b64_tr_b16 a[184:185], v6 offset:24832
  ds_read_b128 a[84:87], v13 offset:1152
  v_mfma_f32_16x16x32_bf16 v[240:243], a[168:171], v[32:35], v[240:243]
  s_waitcnt lgkmcnt(11)
  buffer_store_dwordx4 a[68:71], v11, s[20:23], s84 offen offset:3200 nt
  v_mfma_f32_16x16x32_bf16 v[240:243], a[172:175], v[64:67], v[240:243]
  ds_read_b64_tr_b16 a[186:187], v6 offset:30976
  ds_read_b128 a[88:91], v13 offset:2304
  v_mfma_f32_16x16x32_bf16 v[244:247], a[160:163], a[212:215], v[244:247]
  s_waitcnt lgkmcnt(12)
  buffer_store_dwordx4 a[72:75], v11, s[20:23], s85 offen offset:128 nt
  v_mfma_f32_16x16x32_bf16 v[244:247], a[164:167], a[228:231], v[244:247]
  ds_read_b64_tr_b16 a[188:189], v6 offset:37120
  ds_read_b128 a[92:95], v13 offset:3456
  v_mfma_f32_16x16x32_bf16 v[244:247], a[168:171], v[40:43], v[244:247]
  s_waitcnt lgkmcnt(12)
  buffer_store_dwordx4 a[76:79], v11, s[20:23], s85 offen offset:3200 nt
  v_mfma_f32_16x16x32_bf16 v[244:247], a[172:175], v[72:75], v[244:247]
  ds_read_b64_tr_b16 a[190:191], v6 offset:43264
  v_mul_f32_e32 v224, v22, v224
  v_mfma_f32_16x16x32_bf16 v[248:251], a[160:163], a[216:219], v[248:251]
  s_waitcnt lgkmcnt(7)
  buffer_store_dwordx4 a[80:83], v11, s[20:23], s86 offen offset:128 nt
  v_mfma_f32_16x16x32_bf16 v[248:251], a[164:167], a[232:235], v[248:251]
  ds_read_b64_tr_b16 a[192:193], v7 offset:256
  v_mul_f32_e32 v225, v22, v225
  v_mfma_f32_16x16x32_bf16 v[248:251], a[168:171], v[48:51], v[248:251]
  s_waitcnt lgkmcnt(6)
  buffer_store_dwordx4 a[84:87], v11, s[20:23], s86 offen offset:3200 nt
  v_mfma_f32_16x16x32_bf16 v[248:251], a[172:175], v[80:83], v[248:251]
  ds_read_b64_tr_b16 a[194:195], v7 offset:6400
  v_mul_f32_e32 v226, v22, v226
  v_mfma_f32_16x16x32_bf16 v[252:255], a[160:163], a[220:223], v[252:255]
  s_waitcnt lgkmcnt(5)
  buffer_store_dwordx4 a[88:91], v11, s[20:23], s87 offen offset:128 nt
  v_mfma_f32_16x16x32_bf16 v[252:255], a[164:167], a[236:239], v[252:255]
  ds_read_b64_tr_b16 a[196:197], v7 offset:12544
  v_mul_f32_e32 v227, v22, v227
  v_mfma_f32_16x16x32_bf16 v[252:255], a[168:171], v[56:59], v[252:255]
  s_waitcnt lgkmcnt(4)
  buffer_store_dwordx4 a[92:95], v11, s[20:23], s87 offen offset:3200 nt
  v_mfma_f32_16x16x32_bf16 v[252:255], a[172:175], v[88:91], v[252:255]
  s_waitcnt lgkmcnt(3)
  ds_read_b64_tr_b16 a[198:199], v7 offset:18688
  v_cvt_pk_bf16_f32 v224, v224, v225
  v_mfma_f32_16x16x32_bf16 a[0:3], a[176:179], a[208:211], a[0:3]
  v_cvt_pk_bf16_f32 v225, v226, v227
  v_mul_f32_e32 v228, v23, v228
  v_mfma_f32_16x16x32_bf16 a[0:3], a[180:183], a[224:227], a[0:3]
  ds_read_b64_tr_b16 a[200:201], v7 offset:24832
  v_mul_f32_e32 v229, v23, v229
  v_mfma_f32_16x16x32_bf16 a[0:3], a[184:187], v[32:35], a[0:3]
  ds_write_b64 v12, v[224:225] offset:4608
  v_mfma_f32_16x16x32_bf16 a[0:3], a[188:191], v[64:67], a[0:3]
  ds_read_b64_tr_b16 a[202:203], v7 offset:30976
  v_mul_f32_e32 v230, v23, v230
  v_mfma_f32_16x16x32_bf16 a[4:7], a[176:179], a[212:215], a[4:7]
  v_mul_f32_e32 v231, v23, v231
  v_cvt_pk_bf16_f32 v228, v228, v229
  v_mfma_f32_16x16x32_bf16 a[4:7], a[180:183], a[228:231], a[4:7]
  ds_read_b64_tr_b16 a[204:205], v7 offset:37120
  v_cvt_pk_bf16_f32 v229, v230, v231
  v_mfma_f32_16x16x32_bf16 a[4:7], a[184:187], v[40:43], a[4:7]
  ds_write_b64 v12, v[228:229] offset:6912
  v_mfma_f32_16x16x32_bf16 a[4:7], a[188:191], v[72:75], a[4:7]
  ds_read_b64_tr_b16 a[206:207], v7 offset:43264
  v_mul_f32_e32 v240, v22, v240
  v_mfma_f32_16x16x32_bf16 a[8:11], a[176:179], a[216:219], a[8:11]
  v_mul_f32_e32 v241, v22, v241
  v_mul_f32_e32 v242, v22, v242
  v_mfma_f32_16x16x32_bf16 a[8:11], a[180:183], a[232:235], a[8:11]
  v_mul_f32_e32 v243, v22, v243
  v_cvt_pk_bf16_f32 v240, v240, v241
  v_mfma_f32_16x16x32_bf16 a[8:11], a[184:187], v[48:51], a[8:11]
  v_cvt_pk_bf16_f32 v241, v242, v243
  v_mul_f32_e32 v244, v23, v244
  v_mfma_f32_16x16x32_bf16 a[8:11], a[188:191], v[80:83], a[8:11]
  ds_write_b64 v12, v[240:241] offset:4640
  v_mfma_f32_16x16x32_bf16 a[12:15], a[176:179], a[220:223], a[12:15]
  v_mul_f32_e32 v245, v23, v245
  v_mul_f32_e32 v246, v23, v246
  v_mfma_f32_16x16x32_bf16 a[12:15], a[180:183], a[236:239], a[12:15]
  v_mul_f32_e32 v247, v23, v247
  v_cvt_pk_bf16_f32 v244, v244, v245
  v_mfma_f32_16x16x32_bf16 a[12:15], a[184:187], v[56:59], a[12:15]
  v_cvt_pk_bf16_f32 v245, v246, v247
  v_accvgpr_read_b32 v224, a0
  v_mfma_f32_16x16x32_bf16 a[12:15], a[188:191], v[88:91], a[12:15]
  s_waitcnt lgkmcnt(1)
  ds_write_b64 v12, v[244:245] offset:6944
  v_mfma_f32_16x16x32_bf16 a[16:19], a[192:195], a[208:211], a[16:19]
  v_accvgpr_read_b32 v225, a1
  v_accvgpr_read_b32 v226, a2
  v_mfma_f32_16x16x32_bf16 a[16:19], a[196:199], a[224:227], a[16:19]
  v_accvgpr_read_b32 v227, a3
  v_mul_f32_e32 v224, v22, v224
  v_mfma_f32_16x16x32_bf16 a[16:19], a[200:203], v[32:35], a[16:19]
  v_mul_f32_e32 v225, v22, v225
  v_mul_f32_e32 v226, v22, v226
  v_mfma_f32_16x16x32_bf16 a[16:19], a[204:207], v[64:67], a[16:19]
  v_mul_f32_e32 v227, v22, v227
  v_cvt_pk_bf16_f32 v224, v224, v225
  v_mfma_f32_16x16x32_bf16 a[20:23], a[192:195], a[212:215], a[20:23]
  v_cvt_pk_bf16_f32 v225, v226, v227
  v_mul_f32_e32 v232, v24, v232
  v_mfma_f32_16x16x32_bf16 a[20:23], a[196:199], a[228:231], a[20:23]
  ds_write_b64 v12, v[224:225] offset:4672
  v_mfma_f32_16x16x32_bf16 a[20:23], a[200:203], v[40:43], a[20:23]
  v_mul_f32_e32 v233, v24, v233
  v_mul_f32_e32 v234, v24, v234
  v_mfma_f32_16x16x32_bf16 a[20:23], a[204:207], v[72:75], a[20:23]
  v_mul_f32_e32 v235, v24, v235
  v_cvt_pk_bf16_f32 v232, v232, v233
  v_mfma_f32_16x16x32_bf16 a[24:27], a[192:195], a[216:219], a[24:27]
  v_cvt_pk_bf16_f32 v233, v234, v235
  v_accvgpr_read_b32 v228, a4
  v_mfma_f32_16x16x32_bf16 a[24:27], a[196:199], a[232:235], a[24:27]
  ds_write_b64 v12, v[232:233] offset:9216
  v_mfma_f32_16x16x32_bf16 a[24:27], a[200:203], v[48:51], a[24:27]
  v_accvgpr_read_b32 v229, a5
  v_accvgpr_read_b32 v230, a6
  v_mfma_f32_16x16x32_bf16 a[24:27], a[204:207], v[80:83], a[24:27]
  v_accvgpr_read_b32 v231, a7
  v_mul_f32_e32 v228, v23, v228
  v_mfma_f32_16x16x32_bf16 a[28:31], a[192:195], a[220:223], a[28:31]
  v_mul_f32_e32 v229, v23, v229
  v_mul_f32_e32 v230, v23, v230
  v_mfma_f32_16x16x32_bf16 a[28:31], a[196:199], a[236:239], a[28:31]
  v_mul_f32_e32 v231, v23, v231
  v_cvt_pk_bf16_f32 v228, v228, v229
  v_mfma_f32_16x16x32_bf16 a[28:31], a[200:203], v[56:59], a[28:31]
  v_cvt_pk_bf16_f32 v229, v230, v231
  v_mul_f32_e32 v236, v25, v236
  v_mfma_f32_16x16x32_bf16 a[28:31], a[204:207], v[88:91], a[28:31]
  ds_write_b64 v12, v[228:229] offset:6976
  v_accvgpr_read_b32 v240, a16
  v_accvgpr_read_b32 v241, a17
  v_accvgpr_read_b32 v242, a18
  v_accvgpr_read_b32 v243, a19
  v_pk_mul_f32 v[240:241], v[240:241], v[22:23] op_sel_hi:[1,0]
  v_pk_mul_f32 v[242:243], v[242:243], v[22:23] op_sel_hi:[1,0]
  v_cvt_pk_bf16_f32 v240, v240, v241
  v_cvt_pk_bf16_f32 v241, v242, v243
  v_accvgpr_read_b32 v244, a20
  v_accvgpr_read_b32 v245, a21
  v_accvgpr_read_b32 v246, a22
  v_accvgpr_read_b32 v247, a23
  v_pk_mul_f32 v[244:245], v[244:245], v[22:23] op_sel:[0,1] op_sel_hi:[1,1]
L_hop15:
  s_cbranch_execz L_walkdone
  v_pk_mul_f32 v[246:247], v[246:247], v[22:23] op_sel:[0,1] op_sel_hi:[1,1]
  v_cvt_pk_bf16_f32 v244, v244, v245
  v_cvt_pk_bf16_f32 v245, v246, v247
  ds_write_b64 v12, v[240:241] offset:4704
  ds_write_b64 v12, v[244:245] offset:7008
  ds_read_b128 a[96:99], v13 offset:4608
  ds_read_b128 a[100:103], v13 offset:5760
  ds_read_b128 a[104:107], v13 offset:6912
  ds_read_b128 a[108:111], v13 offset:8064
  v_mul_f32_e32 v237, v25, v237
  v_pk_mul_f32 v[238:239], v[238:239], v[24:25] op_sel:[0,1] op_sel_hi:[1,1]
  v_cvt_pk_bf16_f32 v236, v236, v237
  v_cvt_pk_bf16_f32 v237, v238, v239
  v_pk_mul_f32 v[248:249], v[248:249], v[24:25] op_sel_hi:[1,0]
  v_pk_mul_f32 v[250:251], v[250:251], v[24:25] op_sel_hi:[1,0]
  v_cvt_pk_bf16_f32 v248, v248, v249
  v_cvt_pk_bf16_f32 v249, v250, v251
  v_pk_mul_f32 v[252:253], v[252:253], v[24:25] op_sel:[0,1] op_sel_hi:[1,1]
  v_pk_mul_f32 v[254:255], v[254:255], v[24:25] op_sel:[0,1] op_sel_hi:[1,1]
  v_cvt_pk_bf16_f32 v252, v252, v253
  v_cvt_pk_bf16_f32 v253, v254, v255
  v_accvgpr_read_b32 v232, a8
  v_accvgpr_read_b32 v233, a9
  v_accvgpr_read_b32 v234, a10
  v_accvgpr_read_b32 v235, a11
  v_pk_mul_f32 v[232:233], v[232:233], v[24:25] op_sel_hi:[1,0]
  v_pk_mul_f32 v[234:235], v[234:235], v[24:25] op_sel_hi:[1,0]
  v_cvt_pk_bf16_f32 v232, v232, v233
  v_cvt_pk_bf16_f32 v233, v234, v235
  v_accvgpr_read_b32 v238, a14
  v_accvgpr_read_b32 v239, a15
  v_pk_mul_f32 v[238:239], v[238:239], v[24:25] op_sel:[0,1] op_sel_hi:[1,1]
  v_accvgpr_read_b32 v250, a26
  v_accvgpr_read_b32 v251, a27
  v_pk_mul_f32 v[250:251], v[250:251], v[24:25] op_sel_hi:[1,0]
  v_accvgpr_read_b32 v254, a30
  v_accvgpr_read_b32 v255, a31
  v_pk_mul_f32 v[254:255], v[254:255], v[24:25] op_sel:[0,1] op_sel_hi:[1,1]
  s_waitcnt lgkmcnt(3)
  buffer_store_dwordx4 a[96:99], v11, s[20:23], s84 offen offset:256 nt
  s_waitcnt lgkmcnt(2)
  buffer_store_dwordx4 a[100:103], v11, s[20:23], s84 offen offset:3328 nt
  s_waitcnt lgkmcnt(1)
  buffer_store_dwordx4 a[104:107], v11, s[20:23], s85 offen offset:256 nt
  s_waitcnt lgkmcnt(0)
  buffer_store_dwordx4 a[108:111], v11, s[20:23], s85 offen offset:3328 nt
  ds_write_b64 v12, v[236:237] offset:11520
  ds_write_b64 v12, v[248:249] offset:9248
  ds_write_b64 v12, v[252:253] offset:11552
  ds_write_b64 v12, v[232:233] offset:9280
  v_accvgpr_read_b32 v236, a12
  v_accvgpr_read_b32 v237, a13
  v_pk_mul_f32 v[236:237], v[236:237], v[24:25] op_sel:[0,1] op_sel_hi:[1,1]
  v_cvt_pk_bf16_f32 v236, v236, v237
  v_cvt_pk_bf16_f32 v237, v238, v239
  v_accvgpr_read_b32 v248, a24
  v_accvgpr_read_b32 v249, a25
  v_pk_mul_f32 v[248:249], v[248:249], v[24:25] op_sel_hi:[1,0]
  v_cvt_pk_bf16_f32 v248, v248, v249
  v_cvt_pk_bf16_f32 v249, v250, v251
  v_accvgpr_read_b32 v252, a28
  v_accvgpr_read_b32 v253, a29
  v_pk_mul_f32 v[252:253], v[252:253], v[24:25] op_sel:[0,1] op_sel_hi:[1,1]
  v_cvt_pk_bf16_f32 v252, v252, v253
  v_cvt_pk_bf16_f32 v253, v254, v255
  ds_write_b64 v12, v[236:237] offset:11584
  ds_write_b64 v12, v[248:249] offset:9312
  ds_write_b64 v12, v[252:253] offset:11616
  ds_read_b128 a[112:115], v13 offset:9216
  ds_read_b128 a[116:119], v13 offset:10368
  ds_read_b128 a[120:123], v13 offset:11520
  ds_read_b128 a[124:127], v13 offset:12672
  s_waitcnt lgkmcnt(3)
  buffer_store_dwordx4 a[112:115], v11, s[20:23], s86 offen offset:256 nt
  s_waitcnt lgkmcnt(2)
  buffer_store_dwordx4 a[116:119], v11, s[20:23], s86 offen offset:3328 nt
  s_waitcnt lgkmcnt(1)
  buffer_store_dwordx4 a[120:123], v11, s[20:23], s87 offen offset:256 nt
  s_waitcnt lgkmcnt(0)
  buffer_store_dwordx4 a[124:127], v11, s[20:23], s87 offen offset:3328 nt
  s_cmp_lg_u64 s[42:43], 0
  s_cbranch_scc1 L_fallback
L_end:
  s_endpgm
L_fallback:
  s_waitcnt vmcnt(0) lgkmcnt(0)
  s_nop 15
  v_mov_b32_e32 v1, v11
  v_mov_b32_e32 v30, v12
  v_mov_b32_e32 v31, v13
  v_mbcnt_lo_u32_b32 v0, -1, 0
  v_mbcnt_hi_u32_b32 v0, -1, v0
  v_and_b32_e32 v64, 15, v0
  v_lshrrev_b32_e32 v65, 4, v0
  v_and_b32_e32 v66, 6, v64
  v_xor_b32_e32 v66, v65, v66
  v_lshlrev_b32_e32 v66, 4, v66
  v_add_u32_e32 v66, s28, v66
  v_mad_u32_u24 v2, v64, s53, v66
  v_xor_b32_e32 v3, 64, v2
  v_lshl_add_u32 v12, v64, 7, v66
  v_xor_b32_e32 v13, 64, v12
  v_lshrrev_b32_e32 v67, 2, v0
  v_mul_u32_u24_e32 v67, s53, v67
  v_bfe_u32 v68, v0, 3, 2
  v_lshl_add_u32 v67, v68, 5, v67
  v_and_b32_e32 v68, 3, v0
  v_lshl_add_u32 v67, v68, 3, v67
  v_add_u32_e32 v4, s28, v67
  v_xor_b32_e32 v5, 32, v4
  v_xor_b32_e32 v6, 64, v4
  v_xor_b32_e32 v7, 96, v4
  v_subrev_u32_e32 v8, s34, v8
  v_subrev_u32_e32 v9, s34, v9
  v_subrev_u32_e32 v10, s34, v10
  v_and_b32_e32 v64, 7, v0
  v_lshrrev_b32_e32 v65, 3, v0
  v_mul_u32_u24_e32 v66, s53, v65
  v_and_b32_e32 v65, 6, v65
  v_xor_b32_e32 v65, v65, v64
  v_lshl_add_u32 v11, v65, 4, v66
  s_waitcnt vmcnt(0) lgkmcnt(0)
  s_nop 15
  s_waitcnt vmcnt(0) lgkmcnt(0)
  s_nop 15
  s_add_u32 m0, s28, 0
  s_nop 0
  buffer_load_dwordx4 v11, s[4:7], s80 offen nt lds
  s_add_u32 m0, s28, 0xfffff800
  s_nop 0
  buffer_load_dwordx4 v11, s[4:7], s80 offen offset:3072 nt lds
  s_add_u32 m0, s28, 2048
  s_nop 0
  buffer_load_dwordx4 v11, s[4:7], s81 offen nt lds
  s_add_u32 m0, s28, 0
  s_nop 0
  buffer_load_dwordx4 v11, s[4:7], s81 offen offset:3072 nt lds
  s_add_u32 m0, s28, 3968
  s_nop 0
  buffer_load_dwordx4 v11, s[4:7], s80 offen offset:128 nt lds
  s_add_u32 m0, s28, 1920
  s_nop 0
  buffer_load_dwordx4 v11, s[4:7], s80 offen offset:3200 nt lds
  s_add_u32 m0, s28, 6016
  s_nop 0
  buffer_load_dwordx4 v11, s[4:7], s81 offen offset:128 nt lds
  s_add_u32 m0, s28, 3968
  s_nop 0
  buffer_load_dwordx4 v11, s[4:7], s81 offen offset:3200 nt lds
  s_add_u32 m0, s28, 7936
  s_nop 0
  buffer_load_dwordx4 v11, s[4:7], s80 offen offset:256 nt lds
  s_add_u32 m0, s28, 5888
  s_nop 0
  buffer_load_dwordx4 v11, s[4:7], s80 offen offset:3328 nt lds
  s_add_u32 m0, s28, 9984
  s_nop 0
  buffer_load_dwordx4 v11, s[4:7], s81 offen offset:256 nt lds
  s_add_u32 m0, s28, 7936
  s_nop 0
  buffer_load_dwordx4 v11, s[4:7], s81 offen offset:3328 nt lds
  s_waitcnt vmcnt(0) lgkmcnt(0)
  ds_read_b128 a[32:35], v12 offset:0
  ds_read_b128 a[36:39], v13 offset:0
  ds_read_b128 a[56:59], v12 offset:2048
  ds_read_b128 a[60:63], v13 offset:2048
  ds_read_b128 a[40:43], v12 offset:4096
  ds_read_b128 a[44:47], v13 offset:4096
  ds_read_b128 a[64:67], v12 offset:6144
  ds_read_b128 a[68:71], v13 offset:6144
  ds_read_b128 a[48:51], v12 offset:8192
  ds_read_b128 a[52:55], v13 offset:8192
  ds_read_b128 a[72:75], v12 offset:10240
  ds_read_b128 a[76:79], v13 offset:10240
  s_waitcnt vmcnt(0) lgkmcnt(0)
  s_add_u32 m0, s28, 0
  s_nop 0
  buffer_load_dwordx4 v11, s[4:7], s82 offen nt lds
  s_add_u32 m0, s28, 0xfffff800
  s_nop 0
  buffer_load_dwordx4 v11, s[4:7], s82 offen offset:3072 nt lds
  s_add_u32 m0, s28, 2048
  s_nop 0
  buffer_load_dwordx4 v11, s[4:7], s83 offen nt lds
  s_add_u32 m0, s28, 0
  s_nop 0
  buffer_load_dwordx4 v11, s[4:7], s83 offen offset:3072 nt lds
  s_add_u32 m0, s28, 3968
  s_nop 0
  buffer_load_dwordx4 v11, s[4:7], s82 offen offset:128 nt lds
  s_add_u32 m0, s28, 1920
  s_nop 0
  buffer_load_dwordx4 v11, s[4:7], s82 offen offset:3200 nt lds
  s_add_u32 m0, s28, 6016
  s_nop 0
  buffer_load_dwordx4 v11, s[4:7], s83 offen offset:128 nt lds
  s_add_u32 m0, s28, 3968
  s_nop 0
  buffer_load_dwordx4 v11, s[4:7], s83 offen offset:3200 nt lds
  s_add_u32 m0, s28, 7936
  s_nop 0
  buffer_load_dwordx4 v11, s[4:7], s82 offen offset:256 nt lds
  s_add_u32 m0, s28, 5888
  s_nop 0
  buffer_load_dwordx4 v11, s[4:7], s82 offen offset:3328 nt lds
  s_add_u32 m0, s28, 9984
  s_nop 0
  buffer_load_dwordx4 v11, s[4:7], s83 offen offset:256 nt lds
  s_add_u32 m0, s28, 7936
  s_nop 0
  buffer_load_dwordx4 v11, s[4:7], s83 offen offset:3328 nt lds
  s_waitcnt vmcnt(0) lgkmcnt(0)
  ds_read_b128 a[80:83], v12 offset:0
  ds_read_b128 a[84:87], v13 offset:0
  ds_read_b128 a[104:107], v12 offset:2048
  ds_read_b128 a[108:111], v13 offset:2048
  ds_read_b128 a[88:91], v12 offset:4096
  ds_read_b128 a[92:95], v13 offset:4096
  ds_read_b128 a[112:115], v12 offset:6144
  ds_read_b128 a[116:119], v13 offset:6144
  ds_read_b128 a[96:99], v12 offset:8192
  ds_read_b128 a[100:103], v13 offset:8192
  ds_read_b128 a[120:123], v12 offset:10240
  ds_read_b128 a[124:127], v13 offset:10240
  s_waitcnt vmcnt(0) lgkmcnt(0)
  v_mov_b32_e32 v14, 0xff000000
  v_mov_b32_e32 v18, 0
  v_mov_b32_e32 v15, 0xff000000
  v_mov_b32_e32 v19, 0
  v_mov_b32_e32 v16, 0xff000000
  v_mov_b32_e32 v20, 0
  v_mov_b32_e32 v17, 0xff000000
  v_mov_b32_e32 v21, 0
  v_mov_b32_e32 v96, 0
  v_mov_b32_e32 v97, 0
  v_mov_b32_e32 v98, 0
  v_mov_b32_e32 v99, 0
  v_mov_b32_e32 v100, 0
  v_mov_b32_e32 v101, 0
  v_mov_b32_e32 v102, 0
  v_mov_b32_e32 v103, 0
  v_mov_b32_e32 v104, 0
  v_mov_b32_e32 v105, 0
  v_mov_b32_e32 v106, 0
  v_mov_b32_e32 v107, 0
  v_mov_b32_e32 v108, 0
  v_mov_b32_e32 v109, 0
  v_mov_b32_e32 v110, 0
  v_mov_b32_e32 v111, 0
  v_mov_b32_e32 v112, 0
  v_mov_b32_e32 v113, 0
  v_mov_b32_e32 v114, 0
  v_mov_b32_e32 v115, 0
  v_mov_b32_e32 v116, 0
  v_mov_b32_e32 v117, 0
  v_mov_b32_e32 v118, 0
  v_mov_b32_e32 v119, 0
  v_mov_b32_e32 v120, 0
  v_mov_b32_e32 v121, 0
  v_mov_b32_e32 v122, 0
  v_mov_b32_e32 v123, 0
  v_mov_b32_e32 v124, 0
  v_mov_b32_e32 v125, 0
  v_mov_b32_e32 v126, 0
  v_mov_b32_e32 v127, 0
  v_mov_b32_e32 v128, 0
  v_mov_b32_e32 v129, 0
  v_mov_b32_e32 v130, 0
  v_mov_b32_e32 v131, 0
  v_mov_b32_e32 v132, 0
  v_mov_b32_e32 v133, 0
  v_mov_b32_e32 v134, 0
  v_mov_b32_e32 v135, 0
  v_mov_b32_e32 v136, 0
  v_mov_b32_e32 v137, 0
  v_mov_b32_e32 v138, 0
  v_mov_b32_e32 v139, 0
  v_mov_b32_e32 v140, 0
  v_mov_b32_e32 v141, 0
  v_mov_b32_e32 v142, 0
  v_mov_b32_e32 v143, 0
  v_mov_b32_e32 v144, 0
  v_mov_b32_e32 v145, 0
  v_mov_b32_e32 v146, 0
  v_mov_b32_e32 v147, 0
  v_mov_b32_e32 v148, 0
  v_mov_b32_e32 v149, 0
  v_mov_b32_e32 v150, 0
  v_mov_b32_e32 v151, 0
  v_mov_b32_e32 v152, 0
  v_mov_b32_e32 v153, 0
  v_mov_b32_e32 v154, 0
  v_mov_b32_e32 v155, 0
  v_mov_b32_e32 v156, 0
  v_mov_b32_e32 v157, 0
  v_mov_b32_e32 v158, 0
  v_mov_b32_e32 v159, 0
  v_mov_b32_e32 v160, 0
  v_mov_b32_e32 v161, 0
  v_mov_b32_e32 v162, 0
  v_mov_b32_e32 v163, 0
  v_mov_b32_e32 v164, 0
  v_mov_b32_e32 v165, 0
  v_mov_b32_e32 v166, 0
  v_mov_b32_e32 v167, 0
  v_mov_b32_e32 v168, 0
  v_mov_b32_e32 v169, 0
  v_mov_b32_e32 v170, 0
  v_mov_b32_e32 v171, 0
  v_mov_b32_e32 v172, 0
  v_mov_b32_e32 v173, 0
  v_mov_b32_e32 v174, 0
  v_mov_b32_e32 v175, 0
  v_mov_b32_e32 v176, 0
  v_mov_b32_e32 v177, 0
  v_mov_b32_e32 v178, 0
  v_mov_b32_e32 v179, 0
  v_mov_b32_e32 v180, 0
  v_mov_b32_e32 v181, 0
  v_mov_b32_e32 v182, 0
  v_mov_b32_e32 v183, 0
  v_mov_b32_e32 v184, 0
  v_mov_b32_e32 v185, 0
  v_mov_b32_e32 v186, 0
  v_mov_b32_e32 v187, 0
  v_mov_b32_e32 v188, 0
  v_mov_b32_e32 v189, 0
  v_mov_b32_e32 v190, 0
  v_mov_b32_e32 v191, 0
  v_mov_b32_e32 v192, 0
  v_mov_b32_e32 v193, 0
  v_mov_b32_e32 v194, 0
  v_mov_b32_e32 v195, 0
  v_mov_b32_e32 v196, 0
  v_mov_b32_e32 v197, 0
  v_mov_b32_e32 v198, 0
  v_mov_b32_e32 v199, 0
  v_mov_b32_e32 v200, 0
  v_mov_b32_e32 v201, 0
  v_mov_b32_e32 v202, 0
  v_mov_b32_e32 v203, 0
  v_mov_b32_e32 v204, 0
  v_mov_b32_e32 v205, 0
  v_mov_b32_e32 v206, 0
  v_mov_b32_e32 v207, 0
  v_mov_b32_e32 v208, 0
  v_mov_b32_e32 v209, 0
  v_mov_b32_e32 v210, 0
  v_mov_b32_e32 v211, 0
  v_mov_b32_e32 v212, 0
  v_mov_b32_e32 v213, 0
  v_mov_b32_e32 v214, 0
  v_mov_b32_e32 v215, 0
  v_mov_b32_e32 v216, 0
  v_mov_b32_e32 v217, 0
  v_mov_b32_e32 v218, 0
  v_mov_b32_e32 v219, 0
  v_mov_b32_e32 v220, 0
  v_mov_b32_e32 v221, 0
  v_mov_b32_e32 v222, 0
  v_mov_b32_e32 v223, 0
  v_mov_b32_e32 v224, 0
  v_mov_b32_e32 v225, 0
  v_mov_b32_e32 v226, 0
  v_mov_b32_e32 v227, 0
  v_mov_b32_e32 v228, 0
  v_mov_b32_e32 v229, 0
  v_mov_b32_e32 v230, 0
  v_mov_b32_e32 v231, 0
  v_mov_b32_e32 v232, 0
  v_mov_b32_e32 v233, 0
  v_mov_b32_e32 v234, 0
  v_mov_b32_e32 v235, 0
  v_mov_b32_e32 v236, 0
  v_mov_b32_e32 v237, 0
  v_mov_b32_e32 v238, 0
  v_mov_b32_e32 v239, 0
  v_mov_b32_e32 v240, 0
  v_mov_b32_e32 v241, 0
  v_mov_b32_e32 v242, 0
  v_mov_b32_e32 v243, 0
  v_mov_b32_e32 v244, 0
  v_mov_b32_e32 v245, 0
  v_mov_b32_e32 v246, 0
  v_mov_b32_e32 v247, 0
  v_mov_b32_e32 v248, 0
  v_mov_b32_e32 v249, 0
  v_mov_b32_e32 v250, 0
  v_mov_b32_e32 v251, 0
  v_mov_b32_e32 v252, 0
  v_mov_b32_e32 v253, 0
  v_mov_b32_e32 v254, 0
  v_mov_b32_e32 v255, 0
  v_accvgpr_write_b32 a0, 0
  v_accvgpr_write_b32 a1, 0
  v_accvgpr_write_b32 a2, 0
  v_accvgpr_write_b32 a3, 0
  v_accvgpr_write_b32 a4, 0
  v_accvgpr_write_b32 a5, 0
  v_accvgpr_write_b32 a6, 0
  v_accvgpr_write_b32 a7, 0
  v_accvgpr_write_b32 a8, 0
  v_accvgpr_write_b32 a9, 0
  v_accvgpr_write_b32 a10, 0
  v_accvgpr_write_b32 a11, 0
  v_accvgpr_write_b32 a12, 0
  v_accvgpr_write_b32 a13, 0
  v_accvgpr_write_b32 a14, 0
  v_accvgpr_write_b32 a15, 0
  v_accvgpr_write_b32 a16, 0
  v_accvgpr_write_b32 a17, 0
  v_accvgpr_write_b32 a18, 0
  v_accvgpr_write_b32 a19, 0
  v_accvgpr_write_b32 a20, 0
  v_accvgpr_write_b32 a21, 0
  v_accvgpr_write_b32 a22, 0
  v_accvgpr_write_b32 a23, 0
  v_accvgpr_write_b32 a24, 0
  v_accvgpr_write_b32 a25, 0
  v_accvgpr_write_b32 a26, 0
  v_accvgpr_write_b32 a27, 0
  v_accvgpr_write_b32 a28, 0
  v_accvgpr_write_b32 a29, 0
  v_accvgpr_write_b32 a30, 0
  v_accvgpr_write_b32 a31, 0
  s_mov_b32 s32, 0
  s_waitcnt vmcnt(0) lgkmcnt(0)
  s_nop 15
L_fb_loop0:
  s_waitcnt vmcnt(0) lgkmcnt(0)
  s_nop 15
  s_add_u32 m0, s28, 0
  s_add_u32 s33, s32, 0
  buffer_load_dwordx4 v8, s[8:11], s33 offen lds
  buffer_load_dwordx4 v9, s[8:11], s33 offen offset:1024 lds
  buffer_load_dwordx4 v10, s[8:11], s33 offen offset:2048 lds
  s_add_u32 m0, s28, 3072
  s_add_u32 s33, s32, 3072
  buffer_load_dwordx4 v8, s[8:11], s33 offen lds
  buffer_load_dwordx4 v9, s[8:11], s33 offen offset:1024 lds
  buffer_load_dwordx4 v10, s[8:11], s33 offen offset:2048 lds
  s_add_u32 m0, s28, 6144
  s_add_u32 s33, s32, 6144
  buffer_load_dwordx4 v8, s[8:11], s33 offen lds
  buffer_load_dwordx4 v9, s[8:11], s33 offen offset:1024 lds
  buffer_load_dwordx4 v10, s[8:11], s33 offen offset:2048 lds
  s_add_u32 m0, s28, 9216
  s_add_u32 s33, s32, 9216
  buffer_load_dwordx4 v8, s[8:11], s33 offen lds
  buffer_load_dwordx4 v9, s[8:11], s33 offen offset:1024 lds
  buffer_load_dwordx4 v10, s[8:11], s33 offen offset:2048 lds
  s_waitcnt vmcnt(0) lgkmcnt(0)
  ds_read_b128 a[160:163], v2 offset:0
  ds_read_b128 a[164:167], v3 offset:0
  ds_read_b128 a[168:171], v2 offset:128
  ds_read_b128 a[172:175], v3 offset:128
  ds_read_b128 a[176:179], v2 offset:256
  ds_read_b128 a[180:183], v3 offset:256
  ds_read_b128 a[184:187], v2 offset:6144
  ds_read_b128 a[188:191], v3 offset:6144
  ds_read_b128 a[192:195], v2 offset:6272
  ds_read_b128 a[196:199], v3 offset:6272
  ds_read_b128 a[200:203], v2 offset:6400
  ds_read_b128 a[204:207], v3 offset:6400
  s_waitcnt vmcnt(0) lgkmcnt(0)
  s_add_u32 m0, s28, 0
  s_add_u32 s33, s32, 0
  buffer_load_dwordx4 v8, s[12:15], s33 offen lds
  buffer_load_dwordx4 v9, s[12:15], s33 offen offset:1024 lds
  buffer_load_dwordx4 v10, s[12:15], s33 offen offset:2048 lds
  s_add_u32 m0, s28, 3072
  s_add_u32 s33, s32, 3072
  buffer_load_dwordx4 v8, s[12:15], s33 offen lds
  buffer_load_dwordx4 v9, s[12:15], s33 offen offset:1024 lds
  buffer_load_dwordx4 v10, s[12:15], s33 offen offset:2048 lds
  s_add_u32 m0, s28, 6144
  s_add_u32 s33, s32, 6144
  buffer_load_dwordx4 v8, s[12:15], s33 offen lds
  buffer_load_dwordx4 v9, s[12:15], s33 offen offset:1024 lds
  buffer_load_dwordx4 v10, s[12:15], s33 offen offset:2048 lds
  s_add_u32 m0, s28, 9216
  s_add_u32 s33, s32, 9216
  buffer_load_dwordx4 v8, s[12:15], s33 offen lds
  buffer_load_dwordx4 v9, s[12:15], s33 offen offset:1024 lds
  buffer_load_dwordx4 v10, s[12:15], s33 offen offset:2048 lds
  v_mfma_f32_16x16x32_bf16 v[32:35], a[160:163], a[32:35], 0
  v_mfma_f32_16x16x32_bf16 v[32:35], a[164:167], a[36:39], v[32:35]
  v_mfma_f32_16x16x32_bf16 v[32:35], a[168:171], a[40:43], v[32:35]
  v_mfma_f32_16x16x32_bf16 v[32:35], a[172:175], a[44:47], v[32:35]
  v_mfma_f32_16x16x32_bf16 v[32:35], a[176:179], a[48:51], v[32:35]
  v_mfma_f32_16x16x32_bf16 v[32:35], a[180:183], a[52:55], v[32:35]
  v_mfma_f32_16x16x32_bf16 v[40:43], a[160:163], a[56:59], 0
  v_mfma_f32_16x16x32_bf16 v[40:43], a[164:167], a[60:63], v[40:43]
  v_mfma_f32_16x16x32_bf16 v[40:43], a[168:171], a[64:67], v[40:43]
  v_mfma_f32_16x16x32_bf16 v[40:43], a[172:175], a[68:71], v[40:43]
  v_mfma_f32_16x16x32_bf16 v[40:43], a[176:179], a[72:75], v[40:43]
  v_mfma_f32_16x16x32_bf16 v[40:43], a[180:183], a[76:79], v[40:43]
  v_mfma_f32_16x16x32_bf16 v[48:51], a[160:163], a[80:83], 0
  v_mfma_f32_16x16x32_bf16 v[48:51], a[164:167], a[84:87], v[48:51]
  v_mfma_f32_16x16x32_bf16 v[48:51], a[168:171], a[88:91], v[48:51]
  v_mfma_f32_16x16x32_bf16 v[48:51], a[172:175], a[92:95], v[48:51]
  v_mfma_f32_16x16x32_bf16 v[48:51], a[176:179], a[96:99], v[48:51]
  v_mfma_f32_16x16x32_bf16 v[48:51], a[180:183], a[100:103], v[48:51]
  v_mfma_f32_16x16x32_bf16 v[56:59], a[160:163], a[104:107], 0
  v_mfma_f32_16x16x32_bf16 v[56:59], a[164:167], a[108:111], v[56:59]
  v_mfma_f32_16x16x32_bf16 v[56:59], a[168:171], a[112:115], v[56:59]
  v_mfma_f32_16x16x32_bf16 v[56:59], a[172:175], a[116:119], v[56:59]
  v_mfma_f32_16x16x32_bf16 v[56:59], a[176:179], a[120:123], v[56:59]
  v_mfma_f32_16x16x32_bf16 v[56:59], a[180:183], a[124:127], v[56:59]
  v_mfma_f32_16x16x32_bf16 v[36:39], a[184:187], a[32:35], 0
  v_mfma_f32_16x16x32_bf16 v[36:39], a[188:191], a[36:39], v[36:39]
  v_mfma_f32_16x16x32_bf16 v[36:39], a[192:195], a[40:43], v[36:39]
  v_mfma_f32_16x16x32_bf16 v[36:39], a[196:199], a[44:47], v[36:39]
  v_mfma_f32_16x16x32_bf16 v[36:39], a[200:203], a[48:51], v[36:39]
  v_mfma_f32_16x16x32_bf16 v[36:39], a[204:207], a[52:55], v[36:39]
  v_mfma_f32_16x16x32_bf16 v[44:47], a[184:187], a[56:59], 0
  v_mfma_f32_16x16x32_bf16 v[44:47], a[188:191], a[60:63], v[44:47]
  v_mfma_f32_16x16x32_bf16 v[44:47], a[192:195], a[64:67], v[44:47]
  v_mfma_f32_16x16x32_bf16 v[44:47], a[196:199], a[68:71], v[44:47]
  v_mfma_f32_16x16x32_bf16 v[44:47], a[200:203], a[72:75], v[44:47]
  v_mfma_f32_16x16x32_bf16 v[44:47], a[204:207], a[76:79], v[44:47]
  v_mfma_f32_16x16x32_bf16 v[52:55], a[184:187], a[80:83], 0
  v_mfma_f32_16x16x32_bf16 v[52:55], a[188:191], a[84:87], v[52:55]
  v_mfma_f32_16x16x32_bf16 v[52:55], a[192:195], a[88:91], v[52:55]
  v_mfma_f32_16x16x32_bf16 v[52:55], a[196:199], a[92:95], v[52:55]
  v_mfma_f32_16x16x32_bf16 v[52:55], a[200:203], a[96:99], v[52:55]
  v_mfma_f32_16x16x32_bf16 v[52:55], a[204:207], a[100:103], v[52:55]
  v_mfma_f32_16x16x32_bf16 v[60:63], a[184:187], a[104:107], 0
  v_mfma_f32_16x16x32_bf16 v[60:63], a[188:191], a[108:111], v[60:63]
  v_mfma_f32_16x16x32_bf16 v[60:63], a[192:195], a[112:115], v[60:63]
  v_mfma_f32_16x16x32_bf16 v[60:63], a[196:199], a[116:119], v[60:63]
  v_mfma_f32_16x16x32_bf16 v[60:63], a[200:203], a[120:123], v[60:63]
  v_mfma_f32_16x16x32_bf16 v[60:63], a[204:207], a[124:127], v[60:63]
  v_max3_f32 v22, v32, v33, v34
  v_max3_f32 v22, v22, v35, v36
  v_max3_f32 v22, v22, v37, v38
  v_max_f32_e32 v22, v22, v39
  v_max3_f32 v23, v40, v41, v42
  v_max3_f32 v23, v23, v43, v44
  v_max3_f32 v23, v23, v45, v46
  v_max_f32_e32 v23, v23, v47
  v_max3_f32 v24, v48, v49, v50
  v_max3_f32 v24, v24, v51, v52
  v_max3_f32 v24, v24, v53, v54
  v_max_f32_e32 v24, v24, v55
  v_max3_f32 v25, v56, v57, v58
  v_max3_f32 v25, v25, v59, v60
  v_max3_f32 v25, v25, v61, v62
  v_max_f32_e32 v25, v25, v63
  v_mov_b32_e32 v26, v22
  v_mov_b32_e32 v27, v23
  v_mov_b32_e32 v28, v24
  v_mov_b32_e32 v29, v25
  v_permlane32_swap_b32_e32 v22, v26
  v_permlane32_swap_b32_e32 v23, v27
  v_permlane32_swap_b32_e32 v24, v28
  v_permlane32_swap_b32_e32 v25, v29
  v_max_f32_e32 v22, v22, v26
  v_max_f32_e32 v23, v23, v27
  v_max_f32_e32 v24, v24, v28
  v_max_f32_e32 v25, v25, v29
  v_mov_b32_e32 v26, v22
  v_mov_b32_e32 v27, v23
  v_mov_b32_e32 v28, v24
  v_mov_b32_e32 v29, v25
  v_permlane16_swap_b32_e32 v22, v26
  v_permlane16_swap_b32_e32 v23, v27
  v_permlane16_swap_b32_e32 v24, v28
  v_permlane16_swap_b32_e32 v25, v29
  v_max_f32_e32 v22, v22, v26
  v_max_f32_e32 v23, v23, v27
  v_max_f32_e32 v24, v24, v28
  v_max_f32_e32 v25, v25, v29
  v_mul_f32_e32 v26, s35, v22
  v_max_f32_e32 v26, v26, v14
  v_sub_f32_e32 v22, v14, v26
  v_exp_f32_e32 v22, v22
  v_mov_b32_e32 v14, v26
  v_mul_f32_e32 v18, v18, v22
  v_fma_f32 v32, v32, s35, -v14
  v_fma_f32 v33, v33, s35, -v14
  v_fma_f32 v34, v34, s35, -v14
  v_fma_f32 v35, v35, s35, -v14
  v_fma_f32 v36, v36, s35, -v14
  v_fma_f32 v37, v37, s35, -v14
  v_fma_f32 v38, v38, s35, -v14
  v_fma_f32 v39, v39, s35, -v14
  v_exp_f32_e32 v32, v32
  v_exp_f32_e32 v33, v33
  v_exp_f32_e32 v34, v34
  v_exp_f32_e32 v35, v35
  v_exp_f32_e32 v36, v36
  v_exp_f32_e32 v37, v37
  v_exp_f32_e32 v38, v38
  v_exp_f32_e32 v39, v39
  v_add_f32_e32 v18, v18, v32
  v_add_f32_e32 v18, v18, v33
  v_add_f32_e32 v18, v18, v34
  v_add_f32_e32 v18, v18, v35
  v_add_f32_e32 v18, v18, v36
  v_add_f32_e32 v18, v18, v37
  v_add_f32_e32 v18, v18, v38
  v_add_f32_e32 v18, v18, v39
  v_cvt_pk_bf16_f32 v32, v32, v33
  v_cvt_pk_bf16_f32 v33, v34, v35
  v_cvt_pk_bf16_f32 v34, v36, v37
  v_cvt_pk_bf16_f32 v35, v38, v39
  v_mul_f32_e32 v27, s35, v23
  v_max_f32_e32 v27, v27, v15
  v_sub_f32_e32 v23, v15, v27
  v_exp_f32_e32 v23, v23
  v_mov_b32_e32 v15, v27
  v_mul_f32_e32 v19, v19, v23
  v_fma_f32 v40, v40, s35, -v15
  v_fma_f32 v41, v41, s35, -v15
  v_fma_f32 v42, v42, s35, -v15
  v_fma_f32 v43, v43, s35, -v15
  v_fma_f32 v44, v44, s35, -v15
  v_fma_f32 v45, v45, s35, -v15
  v_fma_f32 v46, v46, s35, -v15
  v_fma_f32 v47, v47, s35, -v15
  v_exp_f32_e32 v40, v40
  v_exp_f32_e32 v41, v41
  v_exp_f32_e32 v42, v42
  v_exp_f32_e32 v43, v43
  v_exp_f32_e32 v44, v44
  v_exp_f32_e32 v45, v45
  v_exp_f32_e32 v46, v46
  v_exp_f32_e32 v47, v47
  v_add_f32_e32 v19, v19, v40
  v_add_f32_e32 v19, v19, v41
  v_add_f32_e32 v19, v19, v42
  v_add_f32_e32 v19, v19, v43
  v_add_f32_e32 v19, v19, v44
  v_add_f32_e32 v19, v19, v45
  v_add_f32_e32 v19, v19, v46
  v_add_f32_e32 v19, v19, v47
  v_cvt_pk_bf16_f32 v40, v40, v41
  v_cvt_pk_bf16_f32 v41, v42, v43
  v_cvt_pk_bf16_f32 v42, v44, v45
  v_cvt_pk_bf16_f32 v43, v46, v47
  v_mul_f32_e32 v28, s35, v24
  v_max_f32_e32 v28, v28, v16
  v_sub_f32_e32 v24, v16, v28
  v_exp_f32_e32 v24, v24
  v_mov_b32_e32 v16, v28
  v_mul_f32_e32 v20, v20, v24
  v_fma_f32 v48, v48, s35, -v16
  v_fma_f32 v49, v49, s35, -v16
  v_fma_f32 v50, v50, s35, -v16
  v_fma_f32 v51, v51, s35, -v16
  v_fma_f32 v52, v52, s35, -v16
  v_fma_f32 v53, v53, s35, -v16
  v_fma_f32 v54, v54, s35, -v16
  v_fma_f32 v55, v55, s35, -v16
  v_exp_f32_e32 v48, v48
  v_exp_f32_e32 v49, v49
  v_exp_f32_e32 v50, v50
  v_exp_f32_e32 v51, v51
  v_exp_f32_e32 v52, v52
  v_exp_f32_e32 v53, v53
  v_exp_f32_e32 v54, v54
  v_exp_f32_e32 v55, v55
  v_add_f32_e32 v20, v20, v48
  v_add_f32_e32 v20, v20, v49
  v_add_f32_e32 v20, v20, v50
  v_add_f32_e32 v20, v20, v51
  v_add_f32_e32 v20, v20, v52
  v_add_f32_e32 v20, v20, v53
  v_add_f32_e32 v20, v20, v54
  v_add_f32_e32 v20, v20, v55
  v_cvt_pk_bf16_f32 v48, v48, v49
  v_cvt_pk_bf16_f32 v49, v50, v51
  v_cvt_pk_bf16_f32 v50, v52, v53
  v_cvt_pk_bf16_f32 v51, v54, v55
  v_mul_f32_e32 v29, s35, v25
  v_max_f32_e32 v29, v29, v17
  v_sub_f32_e32 v25, v17, v29
  v_exp_f32_e32 v25, v25
  v_mov_b32_e32 v17, v29
  v_mul_f32_e32 v21, v21, v25
  v_fma_f32 v56, v56, s35, -v17
  v_fma_f32 v57, v57, s35, -v17
  v_fma_f32 v58, v58, s35, -v17
  v_fma_f32 v59, v59, s35, -v17
  v_fma_f32 v60, v60, s35, -v17
  v_fma_f32 v61, v61, s35, -v17
  v_fma_f32 v62, v62, s35, -v17
  v_fma_f32 v63, v63, s35, -v17
  v_exp_f32_e32 v56, v56
  v_exp_f32_e32 v57, v57
  v_exp_f32_e32 v58, v58
  v_exp_f32_e32 v59, v59
  v_exp_f32_e32 v60, v60
  v_exp_f32_e32 v61, v61
  v_exp_f32_e32 v62, v62
  v_exp_f32_e32 v63, v63
  v_add_f32_e32 v21, v21, v56
  v_add_f32_e32 v21, v21, v57
  v_add_f32_e32 v21, v21, v58
  v_add_f32_e32 v21, v21, v59
  v_add_f32_e32 v21, v21, v60
  v_add_f32_e32 v21, v21, v61
  v_add_f32_e32 v21, v21, v62
  v_add_f32_e32 v21, v21, v63
  v_cvt_pk_bf16_f32 v56, v56, v57
  v_cvt_pk_bf16_f32 v57, v58, v59
  v_cvt_pk_bf16_f32 v58, v60, v61
  v_cvt_pk_bf16_f32 v59, v62, v63
  v_mul_f32_e32 v96, v22, v96
  v_mul_f32_e32 v97, v22, v97
  v_mul_f32_e32 v98, v22, v98
  v_mul_f32_e32 v99, v22, v99
  v_mul_f32_e32 v100, v23, v100
  v_mul_f32_e32 v101, v23, v101
  v_mul_f32_e32 v102, v23, v102
  v_mul_f32_e32 v103, v23, v103
  v_mul_f32_e32 v104, v24, v104
  v_mul_f32_e32 v105, v24, v105
  v_mul_f32_e32 v106, v24, v106
  v_mul_f32_e32 v107, v24, v107
  v_mul_f32_e32 v108, v25, v108
  v_mul_f32_e32 v109, v25, v109
  v_mul_f32_e32 v110, v25, v110
  v_mul_f32_e32 v111, v25, v111
  v_mul_f32_e32 v112, v22, v112
  v_mul_f32_e32 v113, v22, v113
  v_mul_f32_e32 v114, v22, v114
  v_mul_f32_e32 v115, v22, v115
  v_mul_f32_e32 v116, v23, v116
  v_mul_f32_e32 v117, v23, v117
  v_mul_f32_e32 v118, v23, v118
  v_mul_f32_e32 v119, v23, v119
  v_mul_f32_e32 v120, v24, v120
  v_mul_f32_e32 v121, v24, v121
  v_mul_f32_e32 v122, v24, v122
  v_mul_f32_e32 v123, v24, v123
  v_mul_f32_e32 v124, v25, v124
  v_mul_f32_e32 v125, v25, v125
  v_mul_f32_e32 v126, v25, v126
  v_mul_f32_e32 v127, v25, v127
  v_mul_f32_e32 v128, v22, v128
  v_mul_f32_e32 v129, v22, v129
  v_mul_f32_e32 v130, v22, v130
  v_mul_f32_e32 v131, v22, v131
  v_mul_f32_e32 v132, v23, v132
  v_mul_f32_e32 v133, v23, v133
  v_mul_f32_e32 v134, v23, v134
  v_mul_f32_e32 v135, v23, v135
  v_mul_f32_e32 v136, v24, v136
  v_mul_f32_e32 v137, v24, v137
  v_mul_f32_e32 v138, v24, v138
  v_mul_f32_e32 v139, v24, v139
  v_mul_f32_e32 v140, v25, v140
  v_mul_f32_e32 v141, v25, v141
  v_mul_f32_e32 v142, v25, v142
  v_mul_f32_e32 v143, v25, v143
  v_mul_f32_e32 v144, v22, v144
  v_mul_f32_e32 v145, v22, v145
  v_mul_f32_e32 v146, v22, v146
  v_mul_f32_e32 v147, v22, v147
  v_mul_f32_e32 v148, v23, v148
  v_mul_f32_e32 v149, v23, v149
  v_mul_f32_e32 v150, v23, v150
  v_mul_f32_e32 v151, v23, v151
  v_mul_f32_e32 v152, v24, v152
  v_mul_f32_e32 v153, v24, v153
  v_mul_f32_e32 v154, v24, v154
  v_mul_f32_e32 v155, v24, v155
  v_mul_f32_e32 v156, v25, v156
  v_mul_f32_e32 v157, v25, v157
  v_mul_f32_e32 v158, v25, v158
  v_mul_f32_e32 v159, v25, v159
  v_mul_f32_e32 v160, v22, v160
  v_mul_f32_e32 v161, v22, v161
  v_mul_f32_e32 v162, v22, v162
  v_mul_f32_e32 v163, v22, v163
  v_mul_f32_e32 v164, v23, v164
  v_mul_f32_e32 v165, v23, v165
  v_mul_f32_e32 v166, v23, v166
  v_mul_f32_e32 v167, v23, v167
  v_mul_f32_e32 v168, v24, v168
  v_mul_f32_e32 v169, v24, v169
  v_mul_f32_e32 v170, v24, v170
  v_mul_f32_e32 v171, v24, v171
  v_mul_f32_e32 v172, v25, v172
  v_mul_f32_e32 v173, v25, v173
  v_mul_f32_e32 v174, v25, v174
  v_mul_f32_e32 v175, v25, v175
  v_mul_f32_e32 v176, v22, v176
  v_mul_f32_e32 v177, v22, v177
  v_mul_f32_e32 v178, v22, v178
  v_mul_f32_e32 v179, v22, v179
  v_mul_f32_e32 v180, v23, v180
  v_mul_f32_e32 v181, v23, v181
  v_mul_f32_e32 v182, v23, v182
  v_mul_f32_e32 v183, v23, v183
  v_mul_f32_e32 v184, v24, v184
  v_mul_f32_e32 v185, v24, v185
  v_mul_f32_e32 v186, v24, v186
  v_mul_f32_e32 v187, v24, v187
  v_mul_f32_e32 v188, v25, v188
  v_mul_f32_e32 v189, v25, v189
  v_mul_f32_e32 v190, v25, v190
  v_mul_f32_e32 v191, v25, v191
  v_mul_f32_e32 v192, v22, v192
  v_mul_f32_e32 v193, v22, v193
  v_mul_f32_e32 v194, v22, v194
  v_mul_f32_e32 v195, v22, v195
  v_mul_f32_e32 v196, v23, v196
  v_mul_f32_e32 v197, v23, v197
  v_mul_f32_e32 v198, v23, v198
  v_mul_f32_e32 v199, v23, v199
  v_mul_f32_e32 v200, v24, v200
  v_mul_f32_e32 v201, v24, v201
  v_mul_f32_e32 v202, v24, v202
  v_mul_f32_e32 v203, v24, v203
  v_mul_f32_e32 v204, v25, v204
  v_mul_f32_e32 v205, v25, v205
  v_mul_f32_e32 v206, v25, v206
  v_mul_f32_e32 v207, v25, v207
  v_mul_f32_e32 v208, v22, v208
  v_mul_f32_e32 v209, v22, v209
  v_mul_f32_e32 v210, v22, v210
  v_mul_f32_e32 v211, v22, v211
  v_mul_f32_e32 v212, v23, v212
  v_mul_f32_e32 v213, v23, v213
  v_mul_f32_e32 v214, v23, v214
  v_mul_f32_e32 v215, v23, v215
  v_mul_f32_e32 v216, v24, v216
  v_mul_f32_e32 v217, v24, v217
  v_mul_f32_e32 v218, v24, v218
  v_mul_f32_e32 v219, v24, v219
  v_mul_f32_e32 v220, v25, v220
  v_mul_f32_e32 v221, v25, v221
  v_mul_f32_e32 v222, v25, v222
  v_mul_f32_e32 v223, v25, v223
  v_mul_f32_e32 v224, v22, v224
  v_mul_f32_e32 v225, v22, v225
  v_mul_f32_e32 v226, v22, v226
  v_mul_f32_e32 v227, v22, v227
  v_mul_f32_e32 v228, v23, v228
  v_mul_f32_e32 v229, v23, v229
  v_mul_f32_e32 v230, v23, v230
  v_mul_f32_e32 v231, v23, v231
  v_mul_f32_e32 v232, v24, v232
  v_mul_f32_e32 v233, v24, v233
  v_mul_f32_e32 v234, v24, v234
  v_mul_f32_e32 v235, v24, v235
  v_mul_f32_e32 v236, v25, v236
  v_mul_f32_e32 v237, v25, v237
  v_mul_f32_e32 v238, v25, v238
  v_mul_f32_e32 v239, v25, v239
  v_mul_f32_e32 v240, v22, v240
  v_mul_f32_e32 v241, v22, v241
  v_mul_f32_e32 v242, v22, v242
  v_mul_f32_e32 v243, v22, v243
  v_mul_f32_e32 v244, v23, v244
  v_mul_f32_e32 v245, v23, v245
  v_mul_f32_e32 v246, v23, v246
  v_mul_f32_e32 v247, v23, v247
  v_mul_f32_e32 v248, v24, v248
  v_mul_f32_e32 v249, v24, v249
  v_mul_f32_e32 v250, v24, v250
  v_mul_f32_e32 v251, v24, v251
  v_mul_f32_e32 v252, v25, v252
  v_mul_f32_e32 v253, v25, v253
  v_mul_f32_e32 v254, v25, v254
  v_mul_f32_e32 v255, v25, v255
  v_accvgpr_read_b32 v64, a0
  v_mul_f32_e32 v64, v22, v64
  v_accvgpr_write_b32 a0, v64
  v_accvgpr_read_b32 v64, a1
  v_mul_f32_e32 v64, v22, v64
  v_accvgpr_write_b32 a1, v64
  v_accvgpr_read_b32 v64, a2
  v_mul_f32_e32 v64, v22, v64
  v_accvgpr_write_b32 a2, v64
  v_accvgpr_read_b32 v64, a3
  v_mul_f32_e32 v64, v22, v64
  v_accvgpr_write_b32 a3, v64
  v_accvgpr_read_b32 v64, a4
  v_mul_f32_e32 v64, v23, v64
  v_accvgpr_write_b32 a4, v64
  v_accvgpr_read_b32 v64, a5
  v_mul_f32_e32 v64, v23, v64
  v_accvgpr_write_b32 a5, v64
  v_accvgpr_read_b32 v64, a6
  v_mul_f32_e32 v64, v23, v64
  v_accvgpr_write_b32 a6, v64
  v_accvgpr_read_b32 v64, a7
  v_mul_f32_e32 v64, v23, v64
  v_accvgpr_write_b32 a7, v64
  v_accvgpr_read_b32 v64, a8
  v_mul_f32_e32 v64, v24, v64
  v_accvgpr_write_b32 a8, v64
  v_accvgpr_read_b32 v64, a9
  v_mul_f32_e32 v64, v24, v64
  v_accvgpr_write_b32 a9, v64
  v_accvgpr_read_b32 v64, a10
  v_mul_f32_e32 v64, v24, v64
  v_accvgpr_write_b32 a10, v64
  v_accvgpr_read_b32 v64, a11
  v_mul_f32_e32 v64, v24, v64
  v_accvgpr_write_b32 a11, v64
  v_accvgpr_read_b32 v64, a12
  v_mul_f32_e32 v64, v25, v64
  v_accvgpr_write_b32 a12, v64
  v_accvgpr_read_b32 v64, a13
  v_mul_f32_e32 v64, v25, v64
  v_accvgpr_write_b32 a13, v64
  v_accvgpr_read_b32 v64, a14
  v_mul_f32_e32 v64, v25, v64
  v_accvgpr_write_b32 a14, v64
  v_accvgpr_read_b32 v64, a15
  v_mul_f32_e32 v64, v25, v64
  v_accvgpr_write_b32 a15, v64
  v_accvgpr_read_b32 v64, a16
  v_mul_f32_e32 v64, v22, v64
  v_accvgpr_write_b32 a16, v64
  v_accvgpr_read_b32 v64, a17
  v_mul_f32_e32 v64, v22, v64
  v_accvgpr_write_b32 a17, v64
  v_accvgpr_read_b32 v64, a18
  v_mul_f32_e32 v64, v22, v64
  v_accvgpr_write_b32 a18, v64
  v_accvgpr_read_b32 v64, a19
  v_mul_f32_e32 v64, v22, v64
  v_accvgpr_write_b32 a19, v64
  v_accvgpr_read_b32 v64, a20
  v_mul_f32_e32 v64, v23, v64
  v_accvgpr_write_b32 a20, v64
  v_accvgpr_read_b32 v64, a21
  v_mul_f32_e32 v64, v23, v64
  v_accvgpr_write_b32 a21, v64
  v_accvgpr_read_b32 v64, a22
  v_mul_f32_e32 v64, v23, v64
  v_accvgpr_write_b32 a22, v64
  v_accvgpr_read_b32 v64, a23
  v_mul_f32_e32 v64, v23, v64
  v_accvgpr_write_b32 a23, v64
  v_accvgpr_read_b32 v64, a24
  v_mul_f32_e32 v64, v24, v64
  v_accvgpr_write_b32 a24, v64
  v_accvgpr_read_b32 v64, a25
  v_mul_f32_e32 v64, v24, v64
  v_accvgpr_write_b32 a25, v64
  v_accvgpr_read_b32 v64, a26
  v_mul_f32_e32 v64, v24, v64
  v_accvgpr_write_b32 a26, v64
  v_accvgpr_read_b32 v64, a27
  v_mul_f32_e32 v64, v24, v64
  v_accvgpr_write_b32 a27, v64
  v_accvgpr_read_b32 v64, a28
  v_mul_f32_e32 v64, v25, v64
  v_accvgpr_write_b32 a28, v64
  v_accvgpr_read_b32 v64, a29
  v_mul_f32_e32 v64, v25, v64
  v_accvgpr_write_b32 a29, v64
  v_accvgpr_read_b32 v64, a30
  v_mul_f32_e32 v64, v25, v64
  v_accvgpr_write_b32 a30, v64
  v_accvgpr_read_b32 v64, a31
  v_mul_f32_e32 v64, v25, v64
  v_accvgpr_write_b32 a31, v64
  s_waitcnt vmcnt(0) lgkmcnt(0)
  ds_read_b64_tr_b16 a[160:161], v4 offset:0
  ds_read_b64_tr_b16 a[162:163], v4 offset:6144
  ds_read_b64_tr_b16 a[164:165], v5 offset:0
  ds_read_b64_tr_b16 a[166:167], v5 offset:6144
  ds_read_b64_tr_b16 a[168:169], v6 offset:0
  ds_read_b64_tr_b16 a[170:171], v6 offset:6144
  ds_read_b64_tr_b16 a[172:173], v7 offset:0
  ds_read_b64_tr_b16 a[174:175], v7 offset:6144
  ds_read_b64_tr_b16 a[176:177], v4 offset:128
  ds_read_b64_tr_b16 a[178:179], v4 offset:6272
  ds_read_b64_tr_b16 a[180:181], v5 offset:128
  ds_read_b64_tr_b16 a[182:183], v5 offset:6272
  ds_read_b64_tr_b16 a[184:185], v6 offset:128
  ds_read_b64_tr_b16 a[186:187], v6 offset:6272
  ds_read_b64_tr_b16 a[188:189], v7 offset:128
  s_waitcnt lgkmcnt(10)
  ds_read_b64_tr_b16 a[190:191], v7 offset:6272
  ds_read_b64_tr_b16 a[192:193], v4 offset:256
  ds_read_b64_tr_b16 a[194:195], v4 offset:6400
  ds_read_b64_tr_b16 a[196:197], v5 offset:256
  ds_read_b64_tr_b16 a[198:199], v5 offset:6400
  s_waitcnt lgkmcnt(10)
  ds_read_b64_tr_b16 a[200:201], v6 offset:256
  ds_read_b64_tr_b16 a[202:203], v6 offset:6400
  ds_read_b64_tr_b16 a[204:205], v7 offset:256
  ds_read_b64_tr_b16 a[206:207], v7 offset:6400
  v_mfma_f32_16x16x32_bf16 v[96:99], a[160:163], v[32:35], v[96:99]
  v_mfma_f32_16x16x32_bf16 v[100:103], a[160:163], v[40:43], v[100:103]
  v_mfma_f32_16x16x32_bf16 v[104:107], a[160:163], v[48:51], v[104:107]
  v_mfma_f32_16x16x32_bf16 v[108:111], a[160:163], v[56:59], v[108:111]
  v_mfma_f32_16x16x32_bf16 v[112:115], a[164:167], v[32:35], v[112:115]
  v_mfma_f32_16x16x32_bf16 v[116:119], a[164:167], v[40:43], v[116:119]
  v_mfma_f32_16x16x32_bf16 v[120:123], a[164:167], v[48:51], v[120:123]
  v_mfma_f32_16x16x32_bf16 v[124:127], a[164:167], v[56:59], v[124:127]
  v_mfma_f32_16x16x32_bf16 v[128:131], a[168:171], v[32:35], v[128:131]
  v_mfma_f32_16x16x32_bf16 v[132:135], a[168:171], v[40:43], v[132:135]
  v_mfma_f32_16x16x32_bf16 v[136:139], a[168:171], v[48:51], v[136:139]
  v_mfma_f32_16x16x32_bf16 v[140:143], a[168:171], v[56:59], v[140:143]
  v_mfma_f32_16x16x32_bf16 v[144:147], a[172:175], v[32:35], v[144:147]
  v_mfma_f32_16x16x32_bf16 v[148:151], a[172:175], v[40:43], v[148:151]
  v_mfma_f32_16x16x32_bf16 v[152:155], a[172:175], v[48:51], v[152:155]
  v_mfma_f32_16x16x32_bf16 v[156:159], a[172:175], v[56:59], v[156:159]
  v_mfma_f32_16x16x32_bf16 v[160:163], a[176:179], v[32:35], v[160:163]
  v_mfma_f32_16x16x32_bf16 v[164:167], a[176:179], v[40:43], v[164:167]
  v_mfma_f32_16x16x32_bf16 v[168:171], a[176:179], v[48:51], v[168:171]
  v_mfma_f32_16x16x32_bf16 v[172:175], a[176:179], v[56:59], v[172:175]
  s_waitcnt lgkmcnt(12)
  v_mfma_f32_16x16x32_bf16 v[176:179], a[180:183], v[32:35], v[176:179]
  v_mfma_f32_16x16x32_bf16 v[180:183], a[180:183], v[40:43], v[180:183]
  v_mfma_f32_16x16x32_bf16 v[184:187], a[180:183], v[48:51], v[184:187]
  v_mfma_f32_16x16x32_bf16 v[188:191], a[180:183], v[56:59], v[188:191]
  s_waitcnt lgkmcnt(10)
  v_mfma_f32_16x16x32_bf16 v[192:195], a[184:187], v[32:35], v[192:195]
  v_mfma_f32_16x16x32_bf16 v[196:199], a[184:187], v[40:43], v[196:199]
  v_mfma_f32_16x16x32_bf16 v[200:203], a[184:187], v[48:51], v[200:203]
  v_mfma_f32_16x16x32_bf16 v[204:207], a[184:187], v[56:59], v[204:207]
  s_waitcnt lgkmcnt(8)
  v_mfma_f32_16x16x32_bf16 v[208:211], a[188:191], v[32:35], v[208:211]
  v_mfma_f32_16x16x32_bf16 v[212:215], a[188:191], v[40:43], v[212:215]
  v_mfma_f32_16x16x32_bf16 v[216:219], a[188:191], v[48:51], v[216:219]
  v_mfma_f32_16x16x32_bf16 v[220:223], a[188:191], v[56:59], v[220:223]
  s_waitcnt lgkmcnt(6)
  v_mfma_f32_16x16x32_bf16 v[224:227], a[192:195], v[32:35], v[224:227]
  v_mfma_f32_16x16x32_bf16 v[228:231], a[192:195], v[40:43], v[228:231]
  v_mfma_f32_16x16x32_bf16 v[232:235], a[192:195], v[48:51], v[232:235]
  v_mfma_f32_16x16x32_bf16 v[236:239], a[192:195], v[56:59], v[236:239]
  s_waitcnt lgkmcnt(4)
  v_mfma_f32_16x16x32_bf16 v[240:243], a[196:199], v[32:35], v[240:243]
  v_mfma_f32_16x16x32_bf16 v[244:247], a[196:199], v[40:43], v[244:247]
  v_mfma_f32_16x16x32_bf16 v[248:251], a[196:199], v[48:51], v[248:251]
  v_mfma_f32_16x16x32_bf16 v[252:255], a[196:199], v[56:59], v[252:255]
  s_waitcnt lgkmcnt(2)
  v_mfma_f32_16x16x32_bf16 a[0:3], a[200:203], v[32:35], a[0:3]
  v_mfma_f32_16x16x32_bf16 a[4:7], a[200:203], v[40:43], a[4:7]
  v_mfma_f32_16x16x32_bf16 a[8:11], a[200:203], v[48:51], a[8:11]
  v_mfma_f32_16x16x32_bf16 a[12:15], a[200:203], v[56:59], a[12:15]
  s_waitcnt lgkmcnt(0)
  v_mfma_f32_16x16x32_bf16 a[16:19], a[204:207], v[32:35], a[16:19]
  v_mfma_f32_16x16x32_bf16 a[20:23], a[204:207], v[40:43], a[20:23]
  v_mfma_f32_16x16x32_bf16 a[24:27], a[204:207], v[48:51], a[24:27]
  v_mfma_f32_16x16x32_bf16 a[28:31], a[204:207], v[56:59], a[28:31]
  s_waitcnt vmcnt(0) lgkmcnt(0)
  s_nop 15
  s_add_u32 s32, s32, 12288
  s_cmp_lt_u32 s32, 196608
  s_cbranch_scc1 L_fb_loop0
  s_waitcnt vmcnt(0) lgkmcnt(0)
  s_nop 15
  v_mov_b32_e32 v26, v18
  v_mov_b32_e32 v27, v19
  v_mov_b32_e32 v28, v20
  v_mov_b32_e32 v29, v21
  v_permlane32_swap_b32_e32 v18, v26
  v_permlane32_swap_b32_e32 v19, v27
  v_permlane32_swap_b32_e32 v20, v28
  v_permlane32_swap_b32_e32 v21, v29
  v_add_f32_e32 v18, v18, v26
  v_add_f32_e32 v19, v19, v27
  v_add_f32_e32 v20, v20, v28
  v_add_f32_e32 v21, v21, v29
  v_mov_b32_e32 v26, v18
  v_mov_b32_e32 v27, v19
  v_mov_b32_e32 v28, v20
  v_mov_b32_e32 v29, v21
  v_permlane16_swap_b32_e32 v18, v26
  v_permlane16_swap_b32_e32 v19, v27
  v_permlane16_swap_b32_e32 v20, v28
  v_permlane16_swap_b32_e32 v21, v29
  v_add_f32_e32 v18, v18, v26
  v_add_f32_e32 v19, v19, v27
  v_add_f32_e32 v20, v20, v28
  v_add_f32_e32 v21, v21, v29
  v_rcp_f32_e32 v18, v18
  v_rcp_f32_e32 v19, v19
  v_rcp_f32_e32 v20, v20
  v_rcp_f32_e32 v21, v21
  v_mul_f32_e32 v96, v18, v96
  v_mul_f32_e32 v97, v18, v97
  v_mul_f32_e32 v98, v18, v98
  v_mul_f32_e32 v99, v18, v99
  v_mul_f32_e32 v100, v19, v100
  v_mul_f32_e32 v101, v19, v101
  v_mul_f32_e32 v102, v19, v102
  v_mul_f32_e32 v103, v19, v103
  v_mul_f32_e32 v104, v20, v104
  v_mul_f32_e32 v105, v20, v105
  v_mul_f32_e32 v106, v20, v106
  v_mul_f32_e32 v107, v20, v107
  v_mul_f32_e32 v108, v21, v108
  v_mul_f32_e32 v109, v21, v109
  v_mul_f32_e32 v110, v21, v110
  v_mul_f32_e32 v111, v21, v111
  v_mul_f32_e32 v112, v18, v112
  v_mul_f32_e32 v113, v18, v113
  v_mul_f32_e32 v114, v18, v114
  v_mul_f32_e32 v115, v18, v115
  v_mul_f32_e32 v116, v19, v116
  v_mul_f32_e32 v117, v19, v117
  v_mul_f32_e32 v118, v19, v118
  v_mul_f32_e32 v119, v19, v119
  v_mul_f32_e32 v120, v20, v120
  v_mul_f32_e32 v121, v20, v121
  v_mul_f32_e32 v122, v20, v122
  v_mul_f32_e32 v123, v20, v123
  v_mul_f32_e32 v124, v21, v124
  v_mul_f32_e32 v125, v21, v125
  v_mul_f32_e32 v126, v21, v126
  v_mul_f32_e32 v127, v21, v127
  v_mul_f32_e32 v128, v18, v128
  v_mul_f32_e32 v129, v18, v129
  v_mul_f32_e32 v130, v18, v130
  v_mul_f32_e32 v131, v18, v131
  v_mul_f32_e32 v132, v19, v132
  v_mul_f32_e32 v133, v19, v133
  v_mul_f32_e32 v134, v19, v134
  v_mul_f32_e32 v135, v19, v135
  v_mul_f32_e32 v136, v20, v136
  v_mul_f32_e32 v137, v20, v137
  v_mul_f32_e32 v138, v20, v138
  v_mul_f32_e32 v139, v20, v139
  v_mul_f32_e32 v140, v21, v140
  v_mul_f32_e32 v141, v21, v141
  v_mul_f32_e32 v142, v21, v142
  v_mul_f32_e32 v143, v21, v143
  v_mul_f32_e32 v144, v18, v144
  v_mul_f32_e32 v145, v18, v145
  v_mul_f32_e32 v146, v18, v146
  v_mul_f32_e32 v147, v18, v147
  v_mul_f32_e32 v148, v19, v148
  v_mul_f32_e32 v149, v19, v149
  v_mul_f32_e32 v150, v19, v150
  v_mul_f32_e32 v151, v19, v151
  v_mul_f32_e32 v152, v20, v152
  v_mul_f32_e32 v153, v20, v153
  v_mul_f32_e32 v154, v20, v154
  v_mul_f32_e32 v155, v20, v155
  v_mul_f32_e32 v156, v21, v156
  v_mul_f32_e32 v157, v21, v157
  v_mul_f32_e32 v158, v21, v158
  v_mul_f32_e32 v159, v21, v159
  v_mul_f32_e32 v160, v18, v160
  v_mul_f32_e32 v161, v18, v161
  v_mul_f32_e32 v162, v18, v162
  v_mul_f32_e32 v163, v18, v163
  v_mul_f32_e32 v164, v19, v164
  v_mul_f32_e32 v165, v19, v165
  v_mul_f32_e32 v166, v19, v166
  v_mul_f32_e32 v167, v19, v167
  v_mul_f32_e32 v168, v20, v168
  v_mul_f32_e32 v169, v20, v169
  v_mul_f32_e32 v170, v20, v170
  v_mul_f32_e32 v171, v20, v171
  v_mul_f32_e32 v172, v21, v172
  v_mul_f32_e32 v173, v21, v173
  v_mul_f32_e32 v174, v21, v174
  v_mul_f32_e32 v175, v21, v175
  v_mul_f32_e32 v176, v18, v176
  v_mul_f32_e32 v177, v18, v177
  v_mul_f32_e32 v178, v18, v178
  v_mul_f32_e32 v179, v18, v179
  v_mul_f32_e32 v180, v19, v180
  v_mul_f32_e32 v181, v19, v181
  v_mul_f32_e32 v182, v19, v182
  v_mul_f32_e32 v183, v19, v183
  v_mul_f32_e32 v184, v20, v184
  v_mul_f32_e32 v185, v20, v185
  v_mul_f32_e32 v186, v20, v186
  v_mul_f32_e32 v187, v20, v187
  v_mul_f32_e32 v188, v21, v188
  v_mul_f32_e32 v189, v21, v189
  v_mul_f32_e32 v190, v21, v190
  v_mul_f32_e32 v191, v21, v191
  v_mul_f32_e32 v192, v18, v192
  v_mul_f32_e32 v193, v18, v193
  v_mul_f32_e32 v194, v18, v194
  v_mul_f32_e32 v195, v18, v195
  v_mul_f32_e32 v196, v19, v196
  v_mul_f32_e32 v197, v19, v197
  v_mul_f32_e32 v198, v19, v198
  v_mul_f32_e32 v199, v19, v199
  v_mul_f32_e32 v200, v20, v200
  v_mul_f32_e32 v201, v20, v201
  v_mul_f32_e32 v202, v20, v202
  v_mul_f32_e32 v203, v20, v203
  v_mul_f32_e32 v204, v21, v204
  v_mul_f32_e32 v205, v21, v205
  v_mul_f32_e32 v206, v21, v206
  v_mul_f32_e32 v207, v21, v207
  v_mul_f32_e32 v208, v18, v208
  v_mul_f32_e32 v209, v18, v209
  v_mul_f32_e32 v210, v18, v210
  v_mul_f32_e32 v211, v18, v211
  v_mul_f32_e32 v212, v19, v212
  v_mul_f32_e32 v213, v19, v213
  v_mul_f32_e32 v214, v19, v214
  v_mul_f32_e32 v215, v19, v215
  v_mul_f32_e32 v216, v20, v216
  v_mul_f32_e32 v217, v20, v217
  v_mul_f32_e32 v218, v20, v218
  v_mul_f32_e32 v219, v20, v219
  v_mul_f32_e32 v220, v21, v220
  v_mul_f32_e32 v221, v21, v221
  v_mul_f32_e32 v222, v21, v222
  v_mul_f32_e32 v223, v21, v223
  v_mul_f32_e32 v224, v18, v224
  v_mul_f32_e32 v225, v18, v225
  v_mul_f32_e32 v226, v18, v226
  v_mul_f32_e32 v227, v18, v227
  v_mul_f32_e32 v228, v19, v228
  v_mul_f32_e32 v229, v19, v229
  v_mul_f32_e32 v230, v19, v230
  v_mul_f32_e32 v231, v19, v231
  v_mul_f32_e32 v232, v20, v232
  v_mul_f32_e32 v233, v20, v233
  v_mul_f32_e32 v234, v20, v234
  v_mul_f32_e32 v235, v20, v235
  v_mul_f32_e32 v236, v21, v236
  v_mul_f32_e32 v237, v21, v237
  v_mul_f32_e32 v238, v21, v238
  v_mul_f32_e32 v239, v21, v239
  v_mul_f32_e32 v240, v18, v240
  v_mul_f32_e32 v241, v18, v241
  v_mul_f32_e32 v242, v18, v242
  v_mul_f32_e32 v243, v18, v243
  v_mul_f32_e32 v244, v19, v244
  v_mul_f32_e32 v245, v19, v245
  v_mul_f32_e32 v246, v19, v246
  v_mul_f32_e32 v247, v19, v247
  v_mul_f32_e32 v248, v20, v248
  v_mul_f32_e32 v249, v20, v249
  v_mul_f32_e32 v250, v20, v250
  v_mul_f32_e32 v251, v20, v251
  v_mul_f32_e32 v252, v21, v252
  v_mul_f32_e32 v253, v21, v253
  v_mul_f32_e32 v254, v21, v254
  v_mul_f32_e32 v255, v21, v255
  v_accvgpr_read_b32 v64, a0
  v_mul_f32_e32 v64, v18, v64
  v_accvgpr_write_b32 a0, v64
  v_accvgpr_read_b32 v64, a1
  v_mul_f32_e32 v64, v18, v64
  v_accvgpr_write_b32 a1, v64
  v_accvgpr_read_b32 v64, a2
  v_mul_f32_e32 v64, v18, v64
  v_accvgpr_write_b32 a2, v64
  v_accvgpr_read_b32 v64, a3
  v_mul_f32_e32 v64, v18, v64
  v_accvgpr_write_b32 a3, v64
  v_accvgpr_read_b32 v64, a4
  v_mul_f32_e32 v64, v19, v64
  v_accvgpr_write_b32 a4, v64
  v_accvgpr_read_b32 v64, a5
  v_mul_f32_e32 v64, v19, v64
  v_accvgpr_write_b32 a5, v64
  v_accvgpr_read_b32 v64, a6
  v_mul_f32_e32 v64, v19, v64
  v_accvgpr_write_b32 a6, v64
  v_accvgpr_read_b32 v64, a7
  v_mul_f32_e32 v64, v19, v64
  v_accvgpr_write_b32 a7, v64
  v_accvgpr_read_b32 v64, a8
  v_mul_f32_e32 v64, v20, v64
  v_accvgpr_write_b32 a8, v64
  v_accvgpr_read_b32 v64, a9
  v_mul_f32_e32 v64, v20, v64
  v_accvgpr_write_b32 a9, v64
  v_accvgpr_read_b32 v64, a10
  v_mul_f32_e32 v64, v20, v64
  v_accvgpr_write_b32 a10, v64
  v_accvgpr_read_b32 v64, a11
  v_mul_f32_e32 v64, v20, v64
  v_accvgpr_write_b32 a11, v64
  v_accvgpr_read_b32 v64, a12
  v_mul_f32_e32 v64, v21, v64
  v_accvgpr_write_b32 a12, v64
  v_accvgpr_read_b32 v64, a13
  v_mul_f32_e32 v64, v21, v64
  v_accvgpr_write_b32 a13, v64
  v_accvgpr_read_b32 v64, a14
  v_mul_f32_e32 v64, v21, v64
  v_accvgpr_write_b32 a14, v64
  v_accvgpr_read_b32 v64, a15
  v_mul_f32_e32 v64, v21, v64
  v_accvgpr_write_b32 a15, v64
  v_accvgpr_read_b32 v64, a16
  v_mul_f32_e32 v64, v18, v64
  v_accvgpr_write_b32 a16, v64
  v_accvgpr_read_b32 v64, a17
  v_mul_f32_e32 v64, v18, v64
  v_accvgpr_write_b32 a17, v64
  v_accvgpr_read_b32 v64, a18
  v_mul_f32_e32 v64, v18, v64
  v_accvgpr_write_b32 a18, v64
  v_accvgpr_read_b32 v64, a19
  v_mul_f32_e32 v64, v18, v64
  v_accvgpr_write_b32 a19, v64
  v_accvgpr_read_b32 v64, a20
  v_mul_f32_e32 v64, v19, v64
  v_accvgpr_write_b32 a20, v64
  v_accvgpr_read_b32 v64, a21
  v_mul_f32_e32 v64, v19, v64
  v_accvgpr_write_b32 a21, v64
  v_accvgpr_read_b32 v64, a22
  v_mul_f32_e32 v64, v19, v64
  v_accvgpr_write_b32 a22, v64
  v_accvgpr_read_b32 v64, a23
  v_mul_f32_e32 v64, v19, v64
  v_accvgpr_write_b32 a23, v64
  v_accvgpr_read_b32 v64, a24
  v_mul_f32_e32 v64, v20, v64
  v_accvgpr_write_b32 a24, v64
  v_accvgpr_read_b32 v64, a25
  v_mul_f32_e32 v64, v20, v64
  v_accvgpr_write_b32 a25, v64
  v_accvgpr_read_b32 v64, a26
  v_mul_f32_e32 v64, v20, v64
  v_accvgpr_write_b32 a26, v64
  v_accvgpr_read_b32 v64, a27
  v_mul_f32_e32 v64, v20, v64
  v_accvgpr_write_b32 a27, v64
  v_accvgpr_read_b32 v64, a28
  v_mul_f32_e32 v64, v21, v64
  v_accvgpr_write_b32 a28, v64
  v_accvgpr_read_b32 v64, a29
  v_mul_f32_e32 v64, v21, v64
  v_accvgpr_write_b32 a29, v64
  v_accvgpr_read_b32 v64, a30
  v_mul_f32_e32 v64, v21, v64
  v_accvgpr_write_b32 a30, v64
  v_accvgpr_read_b32 v64, a31
  v_mul_f32_e32 v64, v21, v64
  v_accvgpr_write_b32 a31, v64
  v_cvt_pk_bf16_f32 v64, v96, v97
  v_cvt_pk_bf16_f32 v65, v98, v99
  ds_write_b64 v30, v[64:65] offset:0
  s_waitcnt vmcnt(0) lgkmcnt(0)
  v_cvt_pk_bf16_f32 v64, v100, v101
  v_cvt_pk_bf16_f32 v65, v102, v103
  ds_write_b64 v30, v[64:65] offset:2304
  s_waitcnt vmcnt(0) lgkmcnt(0)
  v_cvt_pk_bf16_f32 v64, v112, v113
  v_cvt_pk_bf16_f32 v65, v114, v115
  ds_write_b64 v30, v[64:65] offset:32
  s_waitcnt vmcnt(0) lgkmcnt(0)
  v_cvt_pk_bf16_f32 v64, v116, v117
  v_cvt_pk_bf16_f32 v65, v118, v119
  ds_write_b64 v30, v[64:65] offset:2336
  s_waitcnt vmcnt(0) lgkmcnt(0)
  v_cvt_pk_bf16_f32 v64, v128, v129
  v_cvt_pk_bf16_f32 v65, v130, v131
  ds_write_b64 v30, v[64:65] offset:64
  s_waitcnt vmcnt(0) lgkmcnt(0)
  v_cvt_pk_bf16_f32 v64, v132, v133
  v_cvt_pk_bf16_f32 v65, v134, v135
  ds_write_b64 v30, v[64:65] offset:2368
  s_waitcnt vmcnt(0) lgkmcnt(0)
  v_cvt_pk_bf16_f32 v64, v144, v145
  v_cvt_pk_bf16_f32 v65, v146, v147
  ds_write_b64 v30, v[64:65] offset:96
  s_waitcnt vmcnt(0) lgkmcnt(0)
  v_cvt_pk_bf16_f32 v64, v148, v149
  v_cvt_pk_bf16_f32 v65, v150, v151
  ds_write_b64 v30, v[64:65] offset:2400
  s_waitcnt vmcnt(0) lgkmcnt(0)
  ds_read_b128 a[208:211], v31 offset:0
  ds_read_b128 a[212:215], v31 offset:1152
  ds_read_b128 a[216:219], v31 offset:2304
  ds_read_b128 a[220:223], v31 offset:3456
  s_waitcnt lgkmcnt(3)
  buffer_store_dwordx4 a[208:211], v1, s[16:19], s80 offen
  s_waitcnt lgkmcnt(2)
  buffer_store_dwordx4 a[212:215], v1, s[16:19], s80 offen offset:3072
  s_waitcnt lgkmcnt(1)
  buffer_store_dwordx4 a[216:219], v1, s[16:19], s81 offen
  s_waitcnt lgkmcnt(0)
  buffer_store_dwordx4 a[220:223], v1, s[16:19], s81 offen offset:3072
  s_waitcnt vmcnt(0) lgkmcnt(0)
  v_cvt_pk_bf16_f32 v64, v104, v105
  v_cvt_pk_bf16_f32 v65, v106, v107
  ds_write_b64 v30, v[64:65] offset:0
  s_waitcnt vmcnt(0) lgkmcnt(0)
  v_cvt_pk_bf16_f32 v64, v108, v109
  v_cvt_pk_bf16_f32 v65, v110, v111
  ds_write_b64 v30, v[64:65] offset:2304
  s_waitcnt vmcnt(0) lgkmcnt(0)
  v_cvt_pk_bf16_f32 v64, v120, v121
  v_cvt_pk_bf16_f32 v65, v122, v123
  ds_write_b64 v30, v[64:65] offset:32
  s_waitcnt vmcnt(0) lgkmcnt(0)
  v_cvt_pk_bf16_f32 v64, v124, v125
  v_cvt_pk_bf16_f32 v65, v126, v127
  ds_write_b64 v30, v[64:65] offset:2336
  s_waitcnt vmcnt(0) lgkmcnt(0)
  v_cvt_pk_bf16_f32 v64, v136, v137
  v_cvt_pk_bf16_f32 v65, v138, v139
  ds_write_b64 v30, v[64:65] offset:64
  s_waitcnt vmcnt(0) lgkmcnt(0)
  v_cvt_pk_bf16_f32 v64, v140, v141
  v_cvt_pk_bf16_f32 v65, v142, v143
  ds_write_b64 v30, v[64:65] offset:2368
  s_waitcnt vmcnt(0) lgkmcnt(0)
  v_cvt_pk_bf16_f32 v64, v152, v153
  v_cvt_pk_bf16_f32 v65, v154, v155
  ds_write_b64 v30, v[64:65] offset:96
  s_waitcnt vmcnt(0) lgkmcnt(0)
  v_cvt_pk_bf16_f32 v64, v156, v157
  v_cvt_pk_bf16_f32 v65, v158, v159
  ds_write_b64 v30, v[64:65] offset:2400
  s_waitcnt vmcnt(0) lgkmcnt(0)
  ds_read_b128 a[208:211], v31 offset:0
  ds_read_b128 a[212:215], v31 offset:1152
  ds_read_b128 a[216:219], v31 offset:2304
  ds_read_b128 a[220:223], v31 offset:3456
  s_waitcnt lgkmcnt(3)
  buffer_store_dwordx4 a[208:211], v1, s[16:19], s82 offen
  s_waitcnt lgkmcnt(2)
  buffer_store_dwordx4 a[212:215], v1, s[16:19], s82 offen offset:3072
  s_waitcnt lgkmcnt(1)
  buffer_store_dwordx4 a[216:219], v1, s[16:19], s83 offen
  s_waitcnt lgkmcnt(0)
  buffer_store_dwordx4 a[220:223], v1, s[16:19], s83 offen offset:3072
  s_waitcnt vmcnt(0) lgkmcnt(0)
  v_cvt_pk_bf16_f32 v64, v160, v161
  v_cvt_pk_bf16_f32 v65, v162, v163
  ds_write_b64 v30, v[64:65] offset:0
  s_waitcnt vmcnt(0) lgkmcnt(0)
  v_cvt_pk_bf16_f32 v64, v164, v165
  v_cvt_pk_bf16_f32 v65, v166, v167
  ds_write_b64 v30, v[64:65] offset:2304
  s_waitcnt vmcnt(0) lgkmcnt(0)
  v_cvt_pk_bf16_f32 v64, v176, v177
  v_cvt_pk_bf16_f32 v65, v178, v179
  ds_write_b64 v30, v[64:65] offset:32
  s_waitcnt vmcnt(0) lgkmcnt(0)
  v_cvt_pk_bf16_f32 v64, v180, v181
  v_cvt_pk_bf16_f32 v65, v182, v183
  ds_write_b64 v30, v[64:65] offset:2336
  s_waitcnt vmcnt(0) lgkmcnt(0)
  v_cvt_pk_bf16_f32 v64, v192, v193
  v_cvt_pk_bf16_f32 v65, v194, v195
  ds_write_b64 v30, v[64:65] offset:64
  s_waitcnt vmcnt(0) lgkmcnt(0)
  v_cvt_pk_bf16_f32 v64, v196, v197
  v_cvt_pk_bf16_f32 v65, v198, v199
  ds_write_b64 v30, v[64:65] offset:2368
  s_waitcnt vmcnt(0) lgkmcnt(0)
  v_cvt_pk_bf16_f32 v64, v208, v209
  v_cvt_pk_bf16_f32 v65, v210, v211
  ds_write_b64 v30, v[64:65] offset:96
  s_waitcnt vmcnt(0) lgkmcnt(0)
  v_cvt_pk_bf16_f32 v64, v212, v213
  v_cvt_pk_bf16_f32 v65, v214, v215
  ds_write_b64 v30, v[64:65] offset:2400
  s_waitcnt vmcnt(0) lgkmcnt(0)
  ds_read_b128 a[208:211], v31 offset:0
  ds_read_b128 a[212:215], v31 offset:1152
  ds_read_b128 a[216:219], v31 offset:2304
  ds_read_b128 a[220:223], v31 offset:3456
  s_waitcnt lgkmcnt(3)
  buffer_store_dwordx4 a[208:211], v1, s[16:19], s80 offen offset:128
  s_waitcnt lgkmcnt(2)
  buffer_store_dwordx4 a[212:215], v1, s[16:19], s80 offen offset:3200
  s_waitcnt lgkmcnt(1)
  buffer_store_dwordx4 a[216:219], v1, s[16:19], s81 offen offset:128
  s_waitcnt lgkmcnt(0)
  buffer_store_dwordx4 a[220:223], v1, s[16:19], s81 offen offset:3200
  s_waitcnt vmcnt(0) lgkmcnt(0)
  v_cvt_pk_bf16_f32 v64, v168, v169
  v_cvt_pk_bf16_f32 v65, v170, v171
  ds_write_b64 v30, v[64:65] offset:0
  s_waitcnt vmcnt(0) lgkmcnt(0)
  v_cvt_pk_bf16_f32 v64, v172, v173
  v_cvt_pk_bf16_f32 v65, v174, v175
  ds_write_b64 v30, v[64:65] offset:2304
  s_waitcnt vmcnt(0) lgkmcnt(0)
  v_cvt_pk_bf16_f32 v64, v184, v185
  v_cvt_pk_bf16_f32 v65, v186, v187
  ds_write_b64 v30, v[64:65] offset:32
  s_waitcnt vmcnt(0) lgkmcnt(0)
  v_cvt_pk_bf16_f32 v64, v188, v189
  v_cvt_pk_bf16_f32 v65, v190, v191
  ds_write_b64 v30, v[64:65] offset:2336
  s_waitcnt vmcnt(0) lgkmcnt(0)
  v_cvt_pk_bf16_f32 v64, v200, v201
  v_cvt_pk_bf16_f32 v65, v202, v203
  ds_write_b64 v30, v[64:65] offset:64
  s_waitcnt vmcnt(0) lgkmcnt(0)
  v_cvt_pk_bf16_f32 v64, v204, v205
  v_cvt_pk_bf16_f32 v65, v206, v207
  ds_write_b64 v30, v[64:65] offset:2368
  s_waitcnt vmcnt(0) lgkmcnt(0)
  v_cvt_pk_bf16_f32 v64, v216, v217
  v_cvt_pk_bf16_f32 v65, v218, v219
  ds_write_b64 v30, v[64:65] offset:96
  s_waitcnt vmcnt(0) lgkmcnt(0)
  v_cvt_pk_bf16_f32 v64, v220, v221
  v_cvt_pk_bf16_f32 v65, v222, v223
  ds_write_b64 v30, v[64:65] offset:2400
  s_waitcnt vmcnt(0) lgkmcnt(0)
  ds_read_b128 a[208:211], v31 offset:0
  ds_read_b128 a[212:215], v31 offset:1152
  ds_read_b128 a[216:219], v31 offset:2304
  ds_read_b128 a[220:223], v31 offset:3456
  s_waitcnt lgkmcnt(3)
  buffer_store_dwordx4 a[208:211], v1, s[16:19], s82 offen offset:128
  s_waitcnt lgkmcnt(2)
  buffer_store_dwordx4 a[212:215], v1, s[16:19], s82 offen offset:3200
  s_waitcnt lgkmcnt(1)
  buffer_store_dwordx4 a[216:219], v1, s[16:19], s83 offen offset:128
  s_waitcnt lgkmcnt(0)
  buffer_store_dwordx4 a[220:223], v1, s[16:19], s83 offen offset:3200
  s_waitcnt vmcnt(0) lgkmcnt(0)
  v_cvt_pk_bf16_f32 v64, v224, v225
  v_cvt_pk_bf16_f32 v65, v226, v227
  ds_write_b64 v30, v[64:65] offset:0
  s_waitcnt vmcnt(0) lgkmcnt(0)
  v_cvt_pk_bf16_f32 v64, v228, v229
  v_cvt_pk_bf16_f32 v65, v230, v231
  ds_write_b64 v30, v[64:65] offset:2304
  s_waitcnt vmcnt(0) lgkmcnt(0)
  v_cvt_pk_bf16_f32 v64, v240, v241
  v_cvt_pk_bf16_f32 v65, v242, v243
  ds_write_b64 v30, v[64:65] offset:32
  s_waitcnt vmcnt(0) lgkmcnt(0)
  v_cvt_pk_bf16_f32 v64, v244, v245
  v_cvt_pk_bf16_f32 v65, v246, v247
  ds_write_b64 v30, v[64:65] offset:2336
  s_waitcnt vmcnt(0) lgkmcnt(0)
  v_accvgpr_read_b32 v68, a0
  v_accvgpr_read_b32 v69, a1
  v_accvgpr_read_b32 v70, a2
  v_accvgpr_read_b32 v71, a3
  v_cvt_pk_bf16_f32 v64, v68, v69
  v_cvt_pk_bf16_f32 v65, v70, v71
  ds_write_b64 v30, v[64:65] offset:64
  s_waitcnt vmcnt(0) lgkmcnt(0)
  v_accvgpr_read_b32 v68, a4
  v_accvgpr_read_b32 v69, a5
  v_accvgpr_read_b32 v70, a6
  v_accvgpr_read_b32 v71, a7
  v_cvt_pk_bf16_f32 v64, v68, v69
  v_cvt_pk_bf16_f32 v65, v70, v71
  ds_write_b64 v30, v[64:65] offset:2368
  s_waitcnt vmcnt(0) lgkmcnt(0)
  v_accvgpr_read_b32 v68, a16
  v_accvgpr_read_b32 v69, a17
  v_accvgpr_read_b32 v70, a18
  v_accvgpr_read_b32 v71, a19
  v_cvt_pk_bf16_f32 v64, v68, v69
  v_cvt_pk_bf16_f32 v65, v70, v71
  ds_write_b64 v30, v[64:65] offset:96
  s_waitcnt vmcnt(0) lgkmcnt(0)
  v_accvgpr_read_b32 v68, a20
  v_accvgpr_read_b32 v69, a21
  v_accvgpr_read_b32 v70, a22
  v_accvgpr_read_b32 v71, a23
  v_cvt_pk_bf16_f32 v64, v68, v69
  v_cvt_pk_bf16_f32 v65, v70, v71
  ds_write_b64 v30, v[64:65] offset:2400
  s_waitcnt vmcnt(0) lgkmcnt(0)
  ds_read_b128 a[208:211], v31 offset:0
  ds_read_b128 a[212:215], v31 offset:1152
  ds_read_b128 a[216:219], v31 offset:2304
  ds_read_b128 a[220:223], v31 offset:3456
  s_waitcnt lgkmcnt(3)
  buffer_store_dwordx4 a[208:211], v1, s[16:19], s80 offen offset:256
  s_waitcnt lgkmcnt(2)
  buffer_store_dwordx4 a[212:215], v1, s[16:19], s80 offen offset:3328
  s_waitcnt lgkmcnt(1)
  buffer_store_dwordx4 a[216:219], v1, s[16:19], s81 offen offset:256
  s_waitcnt lgkmcnt(0)
  buffer_store_dwordx4 a[220:223], v1, s[16:19], s81 offen offset:3328
  s_waitcnt vmcnt(0) lgkmcnt(0)
  v_cvt_pk_bf16_f32 v64, v232, v233
  v_cvt_pk_bf16_f32 v65, v234, v235
  ds_write_b64 v30, v[64:65] offset:0
  s_waitcnt vmcnt(0) lgkmcnt(0)
  v_cvt_pk_bf16_f32 v64, v236, v237
  v_cvt_pk_bf16_f32 v65, v238, v239
  ds_write_b64 v30, v[64:65] offset:2304
  s_waitcnt vmcnt(0) lgkmcnt(0)
  v_cvt_pk_bf16_f32 v64, v248, v249
  v_cvt_pk_bf16_f32 v65, v250, v251
  ds_write_b64 v30, v[64:65] offset:32
  s_waitcnt vmcnt(0) lgkmcnt(0)
  v_cvt_pk_bf16_f32 v64, v252, v253
  v_cvt_pk_bf16_f32 v65, v254, v255
  ds_write_b64 v30, v[64:65] offset:2336
  s_waitcnt vmcnt(0) lgkmcnt(0)
  v_accvgpr_read_b32 v68, a8
  v_accvgpr_read_b32 v69, a9
  v_accvgpr_read_b32 v70, a10
  v_accvgpr_read_b32 v71, a11
  v_cvt_pk_bf16_f32 v64, v68, v69
  v_cvt_pk_bf16_f32 v65, v70, v71
  ds_write_b64 v30, v[64:65] offset:64
  s_waitcnt vmcnt(0) lgkmcnt(0)
  v_accvgpr_read_b32 v68, a12
  v_accvgpr_read_b32 v69, a13
  v_accvgpr_read_b32 v70, a14
  v_accvgpr_read_b32 v71, a15
  v_cvt_pk_bf16_f32 v64, v68, v69
  v_cvt_pk_bf16_f32 v65, v70, v71
  ds_write_b64 v30, v[64:65] offset:2368
  s_waitcnt vmcnt(0) lgkmcnt(0)
  v_accvgpr_read_b32 v68, a24
  v_accvgpr_read_b32 v69, a25
  v_accvgpr_read_b32 v70, a26
  v_accvgpr_read_b32 v71, a27
  v_cvt_pk_bf16_f32 v64, v68, v69
  v_cvt_pk_bf16_f32 v65, v70, v71
  ds_write_b64 v30, v[64:65] offset:96
  s_waitcnt vmcnt(0) lgkmcnt(0)
  v_accvgpr_read_b32 v68, a28
  v_accvgpr_read_b32 v69, a29
  v_accvgpr_read_b32 v70, a30
  v_accvgpr_read_b32 v71, a31
  v_cvt_pk_bf16_f32 v64, v68, v69
  v_cvt_pk_bf16_f32 v65, v70, v71
  ds_write_b64 v30, v[64:65] offset:2400
  s_waitcnt vmcnt(0) lgkmcnt(0)
  ds_read_b128 a[208:211], v31 offset:0
  ds_read_b128 a[212:215], v31 offset:1152
  ds_read_b128 a[216:219], v31 offset:2304
  ds_read_b128 a[220:223], v31 offset:3456
  s_waitcnt lgkmcnt(3)
  buffer_store_dwordx4 a[208:211], v1, s[16:19], s82 offen offset:256
  s_waitcnt lgkmcnt(2)
  buffer_store_dwordx4 a[212:215], v1, s[16:19], s82 offen offset:3328
  s_waitcnt lgkmcnt(1)
  buffer_store_dwordx4 a[216:219], v1, s[16:19], s83 offen offset:256
  s_waitcnt lgkmcnt(0)
  buffer_store_dwordx4 a[220:223], v1, s[16:19], s83 offen offset:3328
  s_waitcnt vmcnt(0) lgkmcnt(0)
  s_waitcnt vmcnt(0) lgkmcnt(0)
  s_nop 15
  s_waitcnt vmcnt(0) lgkmcnt(0)
  s_nop 15
  s_add_u32 m0, s28, 0
  s_nop 0
  buffer_load_dwordx4 v11, s[24:27], s84 offen nt lds
  s_add_u32 m0, s28, 0xfffff800
  s_nop 0
  buffer_load_dwordx4 v11, s[24:27], s84 offen offset:3072 nt lds
  s_add_u32 m0, s28, 2048
  s_nop 0
  buffer_load_dwordx4 v11, s[24:27], s85 offen nt lds
  s_add_u32 m0, s28, 0
  s_nop 0
  buffer_load_dwordx4 v11, s[24:27], s85 offen offset:3072 nt lds
  s_add_u32 m0, s28, 3968
  s_nop 0
  buffer_load_dwordx4 v11, s[24:27], s84 offen offset:128 nt lds
  s_add_u32 m0, s28, 1920
  s_nop 0
  buffer_load_dwordx4 v11, s[24:27], s84 offen offset:3200 nt lds
  s_add_u32 m0, s28, 6016
  s_nop 0
  buffer_load_dwordx4 v11, s[24:27], s85 offen offset:128 nt lds
  s_add_u32 m0, s28, 3968
  s_nop 0
  buffer_load_dwordx4 v11, s[24:27], s85 offen offset:3200 nt lds
  s_add_u32 m0, s28, 7936
  s_nop 0
  buffer_load_dwordx4 v11, s[24:27], s84 offen offset:256 nt lds
  s_add_u32 m0, s28, 5888
  s_nop 0
  buffer_load_dwordx4 v11, s[24:27], s84 offen offset:3328 nt lds
  s_add_u32 m0, s28, 9984
  s_nop 0
  buffer_load_dwordx4 v11, s[24:27], s85 offen offset:256 nt lds
  s_add_u32 m0, s28, 7936
  s_nop 0
  buffer_load_dwordx4 v11, s[24:27], s85 offen offset:3328 nt lds
  s_waitcnt vmcnt(0) lgkmcnt(0)
  ds_read_b128 a[32:35], v12 offset:0
  ds_read_b128 a[36:39], v13 offset:0
  ds_read_b128 a[56:59], v12 offset:2048
  ds_read_b128 a[60:63], v13 offset:2048
  ds_read_b128 a[40:43], v12 offset:4096
  ds_read_b128 a[44:47], v13 offset:4096
  ds_read_b128 a[64:67], v12 offset:6144
  ds_read_b128 a[68:71], v13 offset:6144
  ds_read_b128 a[48:51], v12 offset:8192
  ds_read_b128 a[52:55], v13 offset:8192
  ds_read_b128 a[72:75], v12 offset:10240
  ds_read_b128 a[76:79], v13 offset:10240
  s_waitcnt vmcnt(0) lgkmcnt(0)
  s_add_u32 m0, s28, 0
  s_nop 0
  buffer_load_dwordx4 v11, s[24:27], s86 offen nt lds
  s_add_u32 m0, s28, 0xfffff800
  s_nop 0
  buffer_load_dwordx4 v11, s[24:27], s86 offen offset:3072 nt lds
  s_add_u32 m0, s28, 2048
  s_nop 0
  buffer_load_dwordx4 v11, s[24:27], s87 offen nt lds
  s_add_u32 m0, s28, 0
  s_nop 0
  buffer_load_dwordx4 v11, s[24:27], s87 offen offset:3072 nt lds
  s_add_u32 m0, s28, 3968
  s_nop 0
  buffer_load_dwordx4 v11, s[24:27], s86 offen offset:128 nt lds
  s_add_u32 m0, s28, 1920
  s_nop 0
  buffer_load_dwordx4 v11, s[24:27], s86 offen offset:3200 nt lds
  s_add_u32 m0, s28, 6016
  s_nop 0
  buffer_load_dwordx4 v11, s[24:27], s87 offen offset:128 nt lds
  s_add_u32 m0, s28, 3968
  s_nop 0
  buffer_load_dwordx4 v11, s[24:27], s87 offen offset:3200 nt lds
  s_add_u32 m0, s28, 7936
  s_nop 0
  buffer_load_dwordx4 v11, s[24:27], s86 offen offset:256 nt lds
  s_add_u32 m0, s28, 5888
  s_nop 0
  buffer_load_dwordx4 v11, s[24:27], s86 offen offset:3328 nt lds
  s_add_u32 m0, s28, 9984
  s_nop 0
  buffer_load_dwordx4 v11, s[24:27], s87 offen offset:256 nt lds
  s_add_u32 m0, s28, 7936
  s_nop 0
  buffer_load_dwordx4 v11, s[24:27], s87 offen offset:3328 nt lds
  s_waitcnt vmcnt(0) lgkmcnt(0)
  ds_read_b128 a[80:83], v12 offset:0
  ds_read_b128 a[84:87], v13 offset:0
  ds_read_b128 a[104:107], v12 offset:2048
  ds_read_b128 a[108:111], v13 offset:2048
  ds_read_b128 a[88:91], v12 offset:4096
  ds_read_b128 a[92:95], v13 offset:4096
  ds_read_b128 a[112:115], v12 offset:6144
  ds_read_b128 a[116:119], v13 offset:6144
  ds_read_b128 a[96:99], v12 offset:8192
  ds_read_b128 a[100:103], v13 offset:8192
  ds_read_b128 a[120:123], v12 offset:10240
  ds_read_b128 a[124:127], v13 offset:10240
  s_waitcnt vmcnt(0) lgkmcnt(0)
  v_mov_b32_e32 v14, 0xff000000
  v_mov_b32_e32 v18, 0
  v_mov_b32_e32 v15, 0xff000000
  v_mov_b32_e32 v19, 0
  v_mov_b32_e32 v16, 0xff000000
  v_mov_b32_e32 v20, 0
  v_mov_b32_e32 v17, 0xff000000
  v_mov_b32_e32 v21, 0
  v_mov_b32_e32 v96, 0
  v_mov_b32_e32 v97, 0
  v_mov_b32_e32 v98, 0
  v_mov_b32_e32 v99, 0
  v_mov_b32_e32 v100, 0
  v_mov_b32_e32 v101, 0
  v_mov_b32_e32 v102, 0
  v_mov_b32_e32 v103, 0
  v_mov_b32_e32 v104, 0
  v_mov_b32_e32 v105, 0
  v_mov_b32_e32 v106, 0
  v_mov_b32_e32 v107, 0
  v_mov_b32_e32 v108, 0
  v_mov_b32_e32 v109, 0
  v_mov_b32_e32 v110, 0
  v_mov_b32_e32 v111, 0
  v_mov_b32_e32 v112, 0
  v_mov_b32_e32 v113, 0
  v_mov_b32_e32 v114, 0
  v_mov_b32_e32 v115, 0
  v_mov_b32_e32 v116, 0
  v_mov_b32_e32 v117, 0
  v_mov_b32_e32 v118, 0
  v_mov_b32_e32 v119, 0
  v_mov_b32_e32 v120, 0
  v_mov_b32_e32 v121, 0
  v_mov_b32_e32 v122, 0
  v_mov_b32_e32 v123, 0
  v_mov_b32_e32 v124, 0
  v_mov_b32_e32 v125, 0
  v_mov_b32_e32 v126, 0
  v_mov_b32_e32 v127, 0
  v_mov_b32_e32 v128, 0
  v_mov_b32_e32 v129, 0
  v_mov_b32_e32 v130, 0
  v_mov_b32_e32 v131, 0
  v_mov_b32_e32 v132, 0
  v_mov_b32_e32 v133, 0
  v_mov_b32_e32 v134, 0
  v_mov_b32_e32 v135, 0
  v_mov_b32_e32 v136, 0
  v_mov_b32_e32 v137, 0
  v_mov_b32_e32 v138, 0
  v_mov_b32_e32 v139, 0
  v_mov_b32_e32 v140, 0
  v_mov_b32_e32 v141, 0
  v_mov_b32_e32 v142, 0
  v_mov_b32_e32 v143, 0
  v_mov_b32_e32 v144, 0
  v_mov_b32_e32 v145, 0
  v_mov_b32_e32 v146, 0
  v_mov_b32_e32 v147, 0
  v_mov_b32_e32 v148, 0
  v_mov_b32_e32 v149, 0
  v_mov_b32_e32 v150, 0
  v_mov_b32_e32 v151, 0
  v_mov_b32_e32 v152, 0
  v_mov_b32_e32 v153, 0
  v_mov_b32_e32 v154, 0
  v_mov_b32_e32 v155, 0
  v_mov_b32_e32 v156, 0
  v_mov_b32_e32 v157, 0
  v_mov_b32_e32 v158, 0
  v_mov_b32_e32 v159, 0
  v_mov_b32_e32 v160, 0
  v_mov_b32_e32 v161, 0
  v_mov_b32_e32 v162, 0
  v_mov_b32_e32 v163, 0
  v_mov_b32_e32 v164, 0
  v_mov_b32_e32 v165, 0
  v_mov_b32_e32 v166, 0
  v_mov_b32_e32 v167, 0
  v_mov_b32_e32 v168, 0
  v_mov_b32_e32 v169, 0
  v_mov_b32_e32 v170, 0
  v_mov_b32_e32 v171, 0
  v_mov_b32_e32 v172, 0
  v_mov_b32_e32 v173, 0
  v_mov_b32_e32 v174, 0
  v_mov_b32_e32 v175, 0
  v_mov_b32_e32 v176, 0
  v_mov_b32_e32 v177, 0
  v_mov_b32_e32 v178, 0
  v_mov_b32_e32 v179, 0
  v_mov_b32_e32 v180, 0
  v_mov_b32_e32 v181, 0
  v_mov_b32_e32 v182, 0
  v_mov_b32_e32 v183, 0
  v_mov_b32_e32 v184, 0
  v_mov_b32_e32 v185, 0
  v_mov_b32_e32 v186, 0
  v_mov_b32_e32 v187, 0
  v_mov_b32_e32 v188, 0
  v_mov_b32_e32 v189, 0
  v_mov_b32_e32 v190, 0
  v_mov_b32_e32 v191, 0
  v_mov_b32_e32 v192, 0
  v_mov_b32_e32 v193, 0
  v_mov_b32_e32 v194, 0
  v_mov_b32_e32 v195, 0
  v_mov_b32_e32 v196, 0
  v_mov_b32_e32 v197, 0
  v_mov_b32_e32 v198, 0
  v_mov_b32_e32 v199, 0
  v_mov_b32_e32 v200, 0
  v_mov_b32_e32 v201, 0
  v_mov_b32_e32 v202, 0
  v_mov_b32_e32 v203, 0
  v_mov_b32_e32 v204, 0
  v_mov_b32_e32 v205, 0
  v_mov_b32_e32 v206, 0
  v_mov_b32_e32 v207, 0
  v_mov_b32_e32 v208, 0
  v_mov_b32_e32 v209, 0
  v_mov_b32_e32 v210, 0
  v_mov_b32_e32 v211, 0
  v_mov_b32_e32 v212, 0
  v_mov_b32_e32 v213, 0
  v_mov_b32_e32 v214, 0
  v_mov_b32_e32 v215, 0
  v_mov_b32_e32 v216, 0
  v_mov_b32_e32 v217, 0
  v_mov_b32_e32 v218, 0
  v_mov_b32_e32 v219, 0
  v_mov_b32_e32 v220, 0
  v_mov_b32_e32 v221, 0
  v_mov_b32_e32 v222, 0
  v_mov_b32_e32 v223, 0
  v_mov_b32_e32 v224, 0
  v_mov_b32_e32 v225, 0
  v_mov_b32_e32 v226, 0
  v_mov_b32_e32 v227, 0
  v_mov_b32_e32 v228, 0
  v_mov_b32_e32 v229, 0
  v_mov_b32_e32 v230, 0
  v_mov_b32_e32 v231, 0
  v_mov_b32_e32 v232, 0
  v_mov_b32_e32 v233, 0
  v_mov_b32_e32 v234, 0
  v_mov_b32_e32 v235, 0
  v_mov_b32_e32 v236, 0
  v_mov_b32_e32 v237, 0
  v_mov_b32_e32 v238, 0
  v_mov_b32_e32 v239, 0
  v_mov_b32_e32 v240, 0
  v_mov_b32_e32 v241, 0
  v_mov_b32_e32 v242, 0
  v_mov_b32_e32 v243, 0
  v_mov_b32_e32 v244, 0
  v_mov_b32_e32 v245, 0
  v_mov_b32_e32 v246, 0
  v_mov_b32_e32 v247, 0
  v_mov_b32_e32 v248, 0
  v_mov_b32_e32 v249, 0
  v_mov_b32_e32 v250, 0
  v_mov_b32_e32 v251, 0
  v_mov_b32_e32 v252, 0
  v_mov_b32_e32 v253, 0
  v_mov_b32_e32 v254, 0
  v_mov_b32_e32 v255, 0
  v_accvgpr_write_b32 a0, 0
  v_accvgpr_write_b32 a1, 0
  v_accvgpr_write_b32 a2, 0
  v_accvgpr_write_b32 a3, 0
  v_accvgpr_write_b32 a4, 0
  v_accvgpr_write_b32 a5, 0
  v_accvgpr_write_b32 a6, 0
  v_accvgpr_write_b32 a7, 0
  v_accvgpr_write_b32 a8, 0
  v_accvgpr_write_b32 a9, 0
  v_accvgpr_write_b32 a10, 0
  v_accvgpr_write_b32 a11, 0
  v_accvgpr_write_b32 a12, 0
  v_accvgpr_write_b32 a13, 0
  v_accvgpr_write_b32 a14, 0
  v_accvgpr_write_b32 a15, 0
  v_accvgpr_write_b32 a16, 0
  v_accvgpr_write_b32 a17, 0
  v_accvgpr_write_b32 a18, 0
  v_accvgpr_write_b32 a19, 0
  v_accvgpr_write_b32 a20, 0
  v_accvgpr_write_b32 a21, 0
  v_accvgpr_write_b32 a22, 0
  v_accvgpr_write_b32 a23, 0
  v_accvgpr_write_b32 a24, 0
  v_accvgpr_write_b32 a25, 0
  v_accvgpr_write_b32 a26, 0
  v_accvgpr_write_b32 a27, 0
  v_accvgpr_write_b32 a28, 0
  v_accvgpr_write_b32 a29, 0
  v_accvgpr_write_b32 a30, 0
  v_accvgpr_write_b32 a31, 0
  s_mov_b32 s32, 196608
  s_waitcnt vmcnt(0) lgkmcnt(0)
  s_nop 15
L_fb_loop1:
  s_waitcnt vmcnt(0) lgkmcnt(0)
  s_nop 15
  s_add_u32 m0, s28, 0
  s_add_u32 s33, s32, 0
  buffer_load_dwordx4 v8, s[8:11], s33 offen lds
  buffer_load_dwordx4 v9, s[8:11], s33 offen offset:1024 lds
  buffer_load_dwordx4 v10, s[8:11], s33 offen offset:2048 lds
  s_add_u32 m0, s28, 3072
  s_add_u32 s33, s32, 3072
  buffer_load_dwordx4 v8, s[8:11], s33 offen lds
  buffer_load_dwordx4 v9, s[8:11], s33 offen offset:1024 lds
  buffer_load_dwordx4 v10, s[8:11], s33 offen offset:2048 lds
  s_add_u32 m0, s28, 6144
  s_add_u32 s33, s32, 6144
  buffer_load_dwordx4 v8, s[8:11], s33 offen lds
  buffer_load_dwordx4 v9, s[8:11], s33 offen offset:1024 lds
  buffer_load_dwordx4 v10, s[8:11], s33 offen offset:2048 lds
  s_add_u32 m0, s28, 9216
  s_add_u32 s33, s32, 9216
  buffer_load_dwordx4 v8, s[8:11], s33 offen lds
  buffer_load_dwordx4 v9, s[8:11], s33 offen offset:1024 lds
  buffer_load_dwordx4 v10, s[8:11], s33 offen offset:2048 lds
  s_waitcnt vmcnt(0) lgkmcnt(0)
  ds_read_b128 a[160:163], v2 offset:0
  ds_read_b128 a[164:167], v3 offset:0
  ds_read_b128 a[168:171], v2 offset:128
  ds_read_b128 a[172:175], v3 offset:128
  ds_read_b128 a[176:179], v2 offset:256
  ds_read_b128 a[180:183], v3 offset:256
  ds_read_b128 a[184:187], v2 offset:6144
  ds_read_b128 a[188:191], v3 offset:6144
  ds_read_b128 a[192:195], v2 offset:6272
  ds_read_b128 a[196:199], v3 offset:6272
  ds_read_b128 a[200:203], v2 offset:6400
  ds_read_b128 a[204:207], v3 offset:6400
  s_waitcnt vmcnt(0) lgkmcnt(0)
  s_add_u32 m0, s28, 0
  s_add_u32 s33, s32, 0
  buffer_load_dwordx4 v8, s[12:15], s33 offen lds
  buffer_load_dwordx4 v9, s[12:15], s33 offen offset:1024 lds
  buffer_load_dwordx4 v10, s[12:15], s33 offen offset:2048 lds
  s_add_u32 m0, s28, 3072
  s_add_u32 s33, s32, 3072
  buffer_load_dwordx4 v8, s[12:15], s33 offen lds
  buffer_load_dwordx4 v9, s[12:15], s33 offen offset:1024 lds
  buffer_load_dwordx4 v10, s[12:15], s33 offen offset:2048 lds
  s_add_u32 m0, s28, 6144
  s_add_u32 s33, s32, 6144
  buffer_load_dwordx4 v8, s[12:15], s33 offen lds
  buffer_load_dwordx4 v9, s[12:15], s33 offen offset:1024 lds
  buffer_load_dwordx4 v10, s[12:15], s33 offen offset:2048 lds
  s_add_u32 m0, s28, 9216
  s_add_u32 s33, s32, 9216
  buffer_load_dwordx4 v8, s[12:15], s33 offen lds
  buffer_load_dwordx4 v9, s[12:15], s33 offen offset:1024 lds
  buffer_load_dwordx4 v10, s[12:15], s33 offen offset:2048 lds
  v_mfma_f32_16x16x32_bf16 v[32:35], a[160:163], a[32:35], 0
  v_mfma_f32_16x16x32_bf16 v[32:35], a[164:167], a[36:39], v[32:35]
  v_mfma_f32_16x16x32_bf16 v[32:35], a[168:171], a[40:43], v[32:35]
  v_mfma_f32_16x16x32_bf16 v[32:35], a[172:175], a[44:47], v[32:35]
  v_mfma_f32_16x16x32_bf16 v[32:35], a[176:179], a[48:51], v[32:35]
  v_mfma_f32_16x16x32_bf16 v[32:35], a[180:183], a[52:55], v[32:35]
  v_mfma_f32_16x16x32_bf16 v[40:43], a[160:163], a[56:59], 0
  v_mfma_f32_16x16x32_bf16 v[40:43], a[164:167], a[60:63], v[40:43]
  v_mfma_f32_16x16x32_bf16 v[40:43], a[168:171], a[64:67], v[40:43]
  v_mfma_f32_16x16x32_bf16 v[40:43], a[172:175], a[68:71], v[40:43]
  v_mfma_f32_16x16x32_bf16 v[40:43], a[176:179], a[72:75], v[40:43]
  v_mfma_f32_16x16x32_bf16 v[40:43], a[180:183], a[76:79], v[40:43]
  v_mfma_f32_16x16x32_bf16 v[48:51], a[160:163], a[80:83], 0
  v_mfma_f32_16x16x32_bf16 v[48:51], a[164:167], a[84:87], v[48:51]
  v_mfma_f32_16x16x32_bf16 v[48:51], a[168:171], a[88:91], v[48:51]
  v_mfma_f32_16x16x32_bf16 v[48:51], a[172:175], a[92:95], v[48:51]
  v_mfma_f32_16x16x32_bf16 v[48:51], a[176:179], a[96:99], v[48:51]
  v_mfma_f32_16x16x32_bf16 v[48:51], a[180:183], a[100:103], v[48:51]
  v_mfma_f32_16x16x32_bf16 v[56:59], a[160:163], a[104:107], 0
  v_mfma_f32_16x16x32_bf16 v[56:59], a[164:167], a[108:111], v[56:59]
  v_mfma_f32_16x16x32_bf16 v[56:59], a[168:171], a[112:115], v[56:59]
  v_mfma_f32_16x16x32_bf16 v[56:59], a[172:175], a[116:119], v[56:59]
  v_mfma_f32_16x16x32_bf16 v[56:59], a[176:179], a[120:123], v[56:59]
  v_mfma_f32_16x16x32_bf16 v[56:59], a[180:183], a[124:127], v[56:59]
  v_mfma_f32_16x16x32_bf16 v[36:39], a[184:187], a[32:35], 0
  v_mfma_f32_16x16x32_bf16 v[36:39], a[188:191], a[36:39], v[36:39]
  v_mfma_f32_16x16x32_bf16 v[36:39], a[192:195], a[40:43], v[36:39]
  v_mfma_f32_16x16x32_bf16 v[36:39], a[196:199], a[44:47], v[36:39]
  v_mfma_f32_16x16x32_bf16 v[36:39], a[200:203], a[48:51], v[36:39]
  v_mfma_f32_16x16x32_bf16 v[36:39], a[204:207], a[52:55], v[36:39]
  v_mfma_f32_16x16x32_bf16 v[44:47], a[184:187], a[56:59], 0
  v_mfma_f32_16x16x32_bf16 v[44:47], a[188:191], a[60:63], v[44:47]
  v_mfma_f32_16x16x32_bf16 v[44:47], a[192:195], a[64:67], v[44:47]
  v_mfma_f32_16x16x32_bf16 v[44:47], a[196:199], a[68:71], v[44:47]
  v_mfma_f32_16x16x32_bf16 v[44:47], a[200:203], a[72:75], v[44:47]
  v_mfma_f32_16x16x32_bf16 v[44:47], a[204:207], a[76:79], v[44:47]
  v_mfma_f32_16x16x32_bf16 v[52:55], a[184:187], a[80:83], 0
  v_mfma_f32_16x16x32_bf16 v[52:55], a[188:191], a[84:87], v[52:55]
  v_mfma_f32_16x16x32_bf16 v[52:55], a[192:195], a[88:91], v[52:55]
  v_mfma_f32_16x16x32_bf16 v[52:55], a[196:199], a[92:95], v[52:55]
  v_mfma_f32_16x16x32_bf16 v[52:55], a[200:203], a[96:99], v[52:55]
  v_mfma_f32_16x16x32_bf16 v[52:55], a[204:207], a[100:103], v[52:55]
  v_mfma_f32_16x16x32_bf16 v[60:63], a[184:187], a[104:107], 0
  v_mfma_f32_16x16x32_bf16 v[60:63], a[188:191], a[108:111], v[60:63]
  v_mfma_f32_16x16x32_bf16 v[60:63], a[192:195], a[112:115], v[60:63]
  v_mfma_f32_16x16x32_bf16 v[60:63], a[196:199], a[116:119], v[60:63]
  v_mfma_f32_16x16x32_bf16 v[60:63], a[200:203], a[120:123], v[60:63]
  v_mfma_f32_16x16x32_bf16 v[60:63], a[204:207], a[124:127], v[60:63]
  v_max3_f32 v22, v32, v33, v34
  v_max3_f32 v22, v22, v35, v36
  v_max3_f32 v22, v22, v37, v38
  v_max_f32_e32 v22, v22, v39
  v_max3_f32 v23, v40, v41, v42
  v_max3_f32 v23, v23, v43, v44
  v_max3_f32 v23, v23, v45, v46
  v_max_f32_e32 v23, v23, v47
  v_max3_f32 v24, v48, v49, v50
  v_max3_f32 v24, v24, v51, v52
  v_max3_f32 v24, v24, v53, v54
  v_max_f32_e32 v24, v24, v55
  v_max3_f32 v25, v56, v57, v58
  v_max3_f32 v25, v25, v59, v60
  v_max3_f32 v25, v25, v61, v62
  v_max_f32_e32 v25, v25, v63
  v_mov_b32_e32 v26, v22
  v_mov_b32_e32 v27, v23
  v_mov_b32_e32 v28, v24
  v_mov_b32_e32 v29, v25
  v_permlane32_swap_b32_e32 v22, v26
  v_permlane32_swap_b32_e32 v23, v27
  v_permlane32_swap_b32_e32 v24, v28
  v_permlane32_swap_b32_e32 v25, v29
  v_max_f32_e32 v22, v22, v26
  v_max_f32_e32 v23, v23, v27
  v_max_f32_e32 v24, v24, v28
  v_max_f32_e32 v25, v25, v29
  v_mov_b32_e32 v26, v22
  v_mov_b32_e32 v27, v23
  v_mov_b32_e32 v28, v24
  v_mov_b32_e32 v29, v25
  v_permlane16_swap_b32_e32 v22, v26
  v_permlane16_swap_b32_e32 v23, v27
  v_permlane16_swap_b32_e32 v24, v28
  v_permlane16_swap_b32_e32 v25, v29
  v_max_f32_e32 v22, v22, v26
  v_max_f32_e32 v23, v23, v27
  v_max_f32_e32 v24, v24, v28
  v_max_f32_e32 v25, v25, v29
  v_mul_f32_e32 v26, s35, v22
  v_max_f32_e32 v26, v26, v14
  v_sub_f32_e32 v22, v14, v26
  v_exp_f32_e32 v22, v22
  v_mov_b32_e32 v14, v26
  v_mul_f32_e32 v18, v18, v22
  v_fma_f32 v32, v32, s35, -v14
  v_fma_f32 v33, v33, s35, -v14
  v_fma_f32 v34, v34, s35, -v14
  v_fma_f32 v35, v35, s35, -v14
  v_fma_f32 v36, v36, s35, -v14
  v_fma_f32 v37, v37, s35, -v14
  v_fma_f32 v38, v38, s35, -v14
  v_fma_f32 v39, v39, s35, -v14
  v_exp_f32_e32 v32, v32
  v_exp_f32_e32 v33, v33
  v_exp_f32_e32 v34, v34
  v_exp_f32_e32 v35, v35
  v_exp_f32_e32 v36, v36
  v_exp_f32_e32 v37, v37
  v_exp_f32_e32 v38, v38
  v_exp_f32_e32 v39, v39
  v_add_f32_e32 v18, v18, v32
  v_add_f32_e32 v18, v18, v33
  v_add_f32_e32 v18, v18, v34
  v_add_f32_e32 v18, v18, v35
  v_add_f32_e32 v18, v18, v36
  v_add_f32_e32 v18, v18, v37
  v_add_f32_e32 v18, v18, v38
  v_add_f32_e32 v18, v18, v39
  v_cvt_pk_bf16_f32 v32, v32, v33
  v_cvt_pk_bf16_f32 v33, v34, v35
  v_cvt_pk_bf16_f32 v34, v36, v37
  v_cvt_pk_bf16_f32 v35, v38, v39
  v_mul_f32_e32 v27, s35, v23
  v_max_f32_e32 v27, v27, v15
  v_sub_f32_e32 v23, v15, v27
  v_exp_f32_e32 v23, v23
  v_mov_b32_e32 v15, v27
  v_mul_f32_e32 v19, v19, v23
  v_fma_f32 v40, v40, s35, -v15
  v_fma_f32 v41, v41, s35, -v15
  v_fma_f32 v42, v42, s35, -v15
  v_fma_f32 v43, v43, s35, -v15
  v_fma_f32 v44, v44, s35, -v15
  v_fma_f32 v45, v45, s35, -v15
  v_fma_f32 v46, v46, s35, -v15
  v_fma_f32 v47, v47, s35, -v15
  v_exp_f32_e32 v40, v40
  v_exp_f32_e32 v41, v41
  v_exp_f32_e32 v42, v42
  v_exp_f32_e32 v43, v43
  v_exp_f32_e32 v44, v44
  v_exp_f32_e32 v45, v45
  v_exp_f32_e32 v46, v46
  v_exp_f32_e32 v47, v47
  v_add_f32_e32 v19, v19, v40
  v_add_f32_e32 v19, v19, v41
  v_add_f32_e32 v19, v19, v42
  v_add_f32_e32 v19, v19, v43
  v_add_f32_e32 v19, v19, v44
  v_add_f32_e32 v19, v19, v45
  v_add_f32_e32 v19, v19, v46
  v_add_f32_e32 v19, v19, v47
  v_cvt_pk_bf16_f32 v40, v40, v41
  v_cvt_pk_bf16_f32 v41, v42, v43
  v_cvt_pk_bf16_f32 v42, v44, v45
  v_cvt_pk_bf16_f32 v43, v46, v47
  v_mul_f32_e32 v28, s35, v24
  v_max_f32_e32 v28, v28, v16
  v_sub_f32_e32 v24, v16, v28
  v_exp_f32_e32 v24, v24
  v_mov_b32_e32 v16, v28
  v_mul_f32_e32 v20, v20, v24
  v_fma_f32 v48, v48, s35, -v16
  v_fma_f32 v49, v49, s35, -v16
  v_fma_f32 v50, v50, s35, -v16
  v_fma_f32 v51, v51, s35, -v16
  v_fma_f32 v52, v52, s35, -v16
  v_fma_f32 v53, v53, s35, -v16
  v_fma_f32 v54, v54, s35, -v16
  v_fma_f32 v55, v55, s35, -v16
  v_exp_f32_e32 v48, v48
  v_exp_f32_e32 v49, v49
  v_exp_f32_e32 v50, v50
  v_exp_f32_e32 v51, v51
  v_exp_f32_e32 v52, v52
  v_exp_f32_e32 v53, v53
  v_exp_f32_e32 v54, v54
  v_exp_f32_e32 v55, v55
  v_add_f32_e32 v20, v20, v48
  v_add_f32_e32 v20, v20, v49
  v_add_f32_e32 v20, v20, v50
  v_add_f32_e32 v20, v20, v51
  v_add_f32_e32 v20, v20, v52
  v_add_f32_e32 v20, v20, v53
  v_add_f32_e32 v20, v20, v54
  v_add_f32_e32 v20, v20, v55
  v_cvt_pk_bf16_f32 v48, v48, v49
  v_cvt_pk_bf16_f32 v49, v50, v51
  v_cvt_pk_bf16_f32 v50, v52, v53
  v_cvt_pk_bf16_f32 v51, v54, v55
  v_mul_f32_e32 v29, s35, v25
  v_max_f32_e32 v29, v29, v17
  v_sub_f32_e32 v25, v17, v29
  v_exp_f32_e32 v25, v25
  v_mov_b32_e32 v17, v29
  v_mul_f32_e32 v21, v21, v25
  v_fma_f32 v56, v56, s35, -v17
  v_fma_f32 v57, v57, s35, -v17
  v_fma_f32 v58, v58, s35, -v17
  v_fma_f32 v59, v59, s35, -v17
  v_fma_f32 v60, v60, s35, -v17
  v_fma_f32 v61, v61, s35, -v17
  v_fma_f32 v62, v62, s35, -v17
  v_fma_f32 v63, v63, s35, -v17
  v_exp_f32_e32 v56, v56
  v_exp_f32_e32 v57, v57
  v_exp_f32_e32 v58, v58
  v_exp_f32_e32 v59, v59
  v_exp_f32_e32 v60, v60
  v_exp_f32_e32 v61, v61
  v_exp_f32_e32 v62, v62
  v_exp_f32_e32 v63, v63
  v_add_f32_e32 v21, v21, v56
  v_add_f32_e32 v21, v21, v57
  v_add_f32_e32 v21, v21, v58
  v_add_f32_e32 v21, v21, v59
  v_add_f32_e32 v21, v21, v60
  v_add_f32_e32 v21, v21, v61
  v_add_f32_e32 v21, v21, v62
  v_add_f32_e32 v21, v21, v63
  v_cvt_pk_bf16_f32 v56, v56, v57
  v_cvt_pk_bf16_f32 v57, v58, v59
  v_cvt_pk_bf16_f32 v58, v60, v61
  v_cvt_pk_bf16_f32 v59, v62, v63
  v_mul_f32_e32 v96, v22, v96
  v_mul_f32_e32 v97, v22, v97
  v_mul_f32_e32 v98, v22, v98
  v_mul_f32_e32 v99, v22, v99
  v_mul_f32_e32 v100, v23, v100
  v_mul_f32_e32 v101, v23, v101
  v_mul_f32_e32 v102, v23, v102
  v_mul_f32_e32 v103, v23, v103
  v_mul_f32_e32 v104, v24, v104
  v_mul_f32_e32 v105, v24, v105
  v_mul_f32_e32 v106, v24, v106
  v_mul_f32_e32 v107, v24, v107
  v_mul_f32_e32 v108, v25, v108
  v_mul_f32_e32 v109, v25, v109
  v_mul_f32_e32 v110, v25, v110
  v_mul_f32_e32 v111, v25, v111
  v_mul_f32_e32 v112, v22, v112
  v_mul_f32_e32 v113, v22, v113
  v_mul_f32_e32 v114, v22, v114
  v_mul_f32_e32 v115, v22, v115
  v_mul_f32_e32 v116, v23, v116
  v_mul_f32_e32 v117, v23, v117
  v_mul_f32_e32 v118, v23, v118
  v_mul_f32_e32 v119, v23, v119
  v_mul_f32_e32 v120, v24, v120
  v_mul_f32_e32 v121, v24, v121
  v_mul_f32_e32 v122, v24, v122
  v_mul_f32_e32 v123, v24, v123
  v_mul_f32_e32 v124, v25, v124
  v_mul_f32_e32 v125, v25, v125
  v_mul_f32_e32 v126, v25, v126
  v_mul_f32_e32 v127, v25, v127
  v_mul_f32_e32 v128, v22, v128
  v_mul_f32_e32 v129, v22, v129
  v_mul_f32_e32 v130, v22, v130
  v_mul_f32_e32 v131, v22, v131
  v_mul_f32_e32 v132, v23, v132
  v_mul_f32_e32 v133, v23, v133
  v_mul_f32_e32 v134, v23, v134
  v_mul_f32_e32 v135, v23, v135
  v_mul_f32_e32 v136, v24, v136
  v_mul_f32_e32 v137, v24, v137
  v_mul_f32_e32 v138, v24, v138
  v_mul_f32_e32 v139, v24, v139
  v_mul_f32_e32 v140, v25, v140
  v_mul_f32_e32 v141, v25, v141
  v_mul_f32_e32 v142, v25, v142
  v_mul_f32_e32 v143, v25, v143
  v_mul_f32_e32 v144, v22, v144
  v_mul_f32_e32 v145, v22, v145
  v_mul_f32_e32 v146, v22, v146
  v_mul_f32_e32 v147, v22, v147
  v_mul_f32_e32 v148, v23, v148
  v_mul_f32_e32 v149, v23, v149
  v_mul_f32_e32 v150, v23, v150
  v_mul_f32_e32 v151, v23, v151
  v_mul_f32_e32 v152, v24, v152
  v_mul_f32_e32 v153, v24, v153
  v_mul_f32_e32 v154, v24, v154
  v_mul_f32_e32 v155, v24, v155
  v_mul_f32_e32 v156, v25, v156
  v_mul_f32_e32 v157, v25, v157
  v_mul_f32_e32 v158, v25, v158
  v_mul_f32_e32 v159, v25, v159
  v_mul_f32_e32 v160, v22, v160
  v_mul_f32_e32 v161, v22, v161
  v_mul_f32_e32 v162, v22, v162
  v_mul_f32_e32 v163, v22, v163
  v_mul_f32_e32 v164, v23, v164
  v_mul_f32_e32 v165, v23, v165
  v_mul_f32_e32 v166, v23, v166
  v_mul_f32_e32 v167, v23, v167
  v_mul_f32_e32 v168, v24, v168
  v_mul_f32_e32 v169, v24, v169
  v_mul_f32_e32 v170, v24, v170
  v_mul_f32_e32 v171, v24, v171
  v_mul_f32_e32 v172, v25, v172
  v_mul_f32_e32 v173, v25, v173
  v_mul_f32_e32 v174, v25, v174
  v_mul_f32_e32 v175, v25, v175
  v_mul_f32_e32 v176, v22, v176
  v_mul_f32_e32 v177, v22, v177
  v_mul_f32_e32 v178, v22, v178
  v_mul_f32_e32 v179, v22, v179
  v_mul_f32_e32 v180, v23, v180
  v_mul_f32_e32 v181, v23, v181
  v_mul_f32_e32 v182, v23, v182
  v_mul_f32_e32 v183, v23, v183
  v_mul_f32_e32 v184, v24, v184
  v_mul_f32_e32 v185, v24, v185
  v_mul_f32_e32 v186, v24, v186
  v_mul_f32_e32 v187, v24, v187
  v_mul_f32_e32 v188, v25, v188
  v_mul_f32_e32 v189, v25, v189
  v_mul_f32_e32 v190, v25, v190
  v_mul_f32_e32 v191, v25, v191
  v_mul_f32_e32 v192, v22, v192
  v_mul_f32_e32 v193, v22, v193
  v_mul_f32_e32 v194, v22, v194
  v_mul_f32_e32 v195, v22, v195
  v_mul_f32_e32 v196, v23, v196
  v_mul_f32_e32 v197, v23, v197
  v_mul_f32_e32 v198, v23, v198
  v_mul_f32_e32 v199, v23, v199
  v_mul_f32_e32 v200, v24, v200
  v_mul_f32_e32 v201, v24, v201
  v_mul_f32_e32 v202, v24, v202
  v_mul_f32_e32 v203, v24, v203
  v_mul_f32_e32 v204, v25, v204
  v_mul_f32_e32 v205, v25, v205
  v_mul_f32_e32 v206, v25, v206
  v_mul_f32_e32 v207, v25, v207
  v_mul_f32_e32 v208, v22, v208
  v_mul_f32_e32 v209, v22, v209
  v_mul_f32_e32 v210, v22, v210
  v_mul_f32_e32 v211, v22, v211
  v_mul_f32_e32 v212, v23, v212
  v_mul_f32_e32 v213, v23, v213
  v_mul_f32_e32 v214, v23, v214
  v_mul_f32_e32 v215, v23, v215
  v_mul_f32_e32 v216, v24, v216
  v_mul_f32_e32 v217, v24, v217
  v_mul_f32_e32 v218, v24, v218
  v_mul_f32_e32 v219, v24, v219
  v_mul_f32_e32 v220, v25, v220
  v_mul_f32_e32 v221, v25, v221
  v_mul_f32_e32 v222, v25, v222
  v_mul_f32_e32 v223, v25, v223
  v_mul_f32_e32 v224, v22, v224
  v_mul_f32_e32 v225, v22, v225
  v_mul_f32_e32 v226, v22, v226
  v_mul_f32_e32 v227, v22, v227
  v_mul_f32_e32 v228, v23, v228
  v_mul_f32_e32 v229, v23, v229
  v_mul_f32_e32 v230, v23, v230
  v_mul_f32_e32 v231, v23, v231
  v_mul_f32_e32 v232, v24, v232
  v_mul_f32_e32 v233, v24, v233
  v_mul_f32_e32 v234, v24, v234
  v_mul_f32_e32 v235, v24, v235
  v_mul_f32_e32 v236, v25, v236
  v_mul_f32_e32 v237, v25, v237
  v_mul_f32_e32 v238, v25, v238
  v_mul_f32_e32 v239, v25, v239
  v_mul_f32_e32 v240, v22, v240
  v_mul_f32_e32 v241, v22, v241
  v_mul_f32_e32 v242, v22, v242
  v_mul_f32_e32 v243, v22, v243
  v_mul_f32_e32 v244, v23, v244
  v_mul_f32_e32 v245, v23, v245
  v_mul_f32_e32 v246, v23, v246
  v_mul_f32_e32 v247, v23, v247
  v_mul_f32_e32 v248, v24, v248
  v_mul_f32_e32 v249, v24, v249
  v_mul_f32_e32 v250, v24, v250
  v_mul_f32_e32 v251, v24, v251
  v_mul_f32_e32 v252, v25, v252
  v_mul_f32_e32 v253, v25, v253
  v_mul_f32_e32 v254, v25, v254
  v_mul_f32_e32 v255, v25, v255
  v_accvgpr_read_b32 v64, a0
  v_mul_f32_e32 v64, v22, v64
  v_accvgpr_write_b32 a0, v64
  v_accvgpr_read_b32 v64, a1
  v_mul_f32_e32 v64, v22, v64
  v_accvgpr_write_b32 a1, v64
  v_accvgpr_read_b32 v64, a2
  v_mul_f32_e32 v64, v22, v64
  v_accvgpr_write_b32 a2, v64
  v_accvgpr_read_b32 v64, a3
  v_mul_f32_e32 v64, v22, v64
  v_accvgpr_write_b32 a3, v64
  v_accvgpr_read_b32 v64, a4
  v_mul_f32_e32 v64, v23, v64
  v_accvgpr_write_b32 a4, v64
  v_accvgpr_read_b32 v64, a5
  v_mul_f32_e32 v64, v23, v64
  v_accvgpr_write_b32 a5, v64
  v_accvgpr_read_b32 v64, a6
  v_mul_f32_e32 v64, v23, v64
  v_accvgpr_write_b32 a6, v64
  v_accvgpr_read_b32 v64, a7
  v_mul_f32_e32 v64, v23, v64
  v_accvgpr_write_b32 a7, v64
  v_accvgpr_read_b32 v64, a8
  v_mul_f32_e32 v64, v24, v64
  v_accvgpr_write_b32 a8, v64
  v_accvgpr_read_b32 v64, a9
  v_mul_f32_e32 v64, v24, v64
  v_accvgpr_write_b32 a9, v64
  v_accvgpr_read_b32 v64, a10
  v_mul_f32_e32 v64, v24, v64
  v_accvgpr_write_b32 a10, v64
  v_accvgpr_read_b32 v64, a11
  v_mul_f32_e32 v64, v24, v64
  v_accvgpr_write_b32 a11, v64
  v_accvgpr_read_b32 v64, a12
  v_mul_f32_e32 v64, v25, v64
  v_accvgpr_write_b32 a12, v64
  v_accvgpr_read_b32 v64, a13
  v_mul_f32_e32 v64, v25, v64
  v_accvgpr_write_b32 a13, v64
  v_accvgpr_read_b32 v64, a14
  v_mul_f32_e32 v64, v25, v64
  v_accvgpr_write_b32 a14, v64
  v_accvgpr_read_b32 v64, a15
  v_mul_f32_e32 v64, v25, v64
  v_accvgpr_write_b32 a15, v64
  v_accvgpr_read_b32 v64, a16
  v_mul_f32_e32 v64, v22, v64
  v_accvgpr_write_b32 a16, v64
  v_accvgpr_read_b32 v64, a17
  v_mul_f32_e32 v64, v22, v64
  v_accvgpr_write_b32 a17, v64
  v_accvgpr_read_b32 v64, a18
  v_mul_f32_e32 v64, v22, v64
  v_accvgpr_write_b32 a18, v64
  v_accvgpr_read_b32 v64, a19
  v_mul_f32_e32 v64, v22, v64
  v_accvgpr_write_b32 a19, v64
  v_accvgpr_read_b32 v64, a20
  v_mul_f32_e32 v64, v23, v64
  v_accvgpr_write_b32 a20, v64
  v_accvgpr_read_b32 v64, a21
  v_mul_f32_e32 v64, v23, v64
  v_accvgpr_write_b32 a21, v64
  v_accvgpr_read_b32 v64, a22
  v_mul_f32_e32 v64, v23, v64
  v_accvgpr_write_b32 a22, v64
  v_accvgpr_read_b32 v64, a23
  v_mul_f32_e32 v64, v23, v64
  v_accvgpr_write_b32 a23, v64
  v_accvgpr_read_b32 v64, a24
  v_mul_f32_e32 v64, v24, v64
  v_accvgpr_write_b32 a24, v64
  v_accvgpr_read_b32 v64, a25
  v_mul_f32_e32 v64, v24, v64
  v_accvgpr_write_b32 a25, v64
  v_accvgpr_read_b32 v64, a26
  v_mul_f32_e32 v64, v24, v64
  v_accvgpr_write_b32 a26, v64
  v_accvgpr_read_b32 v64, a27
  v_mul_f32_e32 v64, v24, v64
  v_accvgpr_write_b32 a27, v64
  v_accvgpr_read_b32 v64, a28
  v_mul_f32_e32 v64, v25, v64
  v_accvgpr_write_b32 a28, v64
  v_accvgpr_read_b32 v64, a29
  v_mul_f32_e32 v64, v25, v64
  v_accvgpr_write_b32 a29, v64
  v_accvgpr_read_b32 v64, a30
  v_mul_f32_e32 v64, v25, v64
  v_accvgpr_write_b32 a30, v64
  v_accvgpr_read_b32 v64, a31
  v_mul_f32_e32 v64, v25, v64
  v_accvgpr_write_b32 a31, v64
  s_waitcnt vmcnt(0) lgkmcnt(0)
  ds_read_b64_tr_b16 a[160:161], v4 offset:0
  ds_read_b64_tr_b16 a[162:163], v4 offset:6144
  ds_read_b64_tr_b16 a[164:165], v5 offset:0
  ds_read_b64_tr_b16 a[166:167], v5 offset:6144
  ds_read_b64_tr_b16 a[168:169], v6 offset:0
  ds_read_b64_tr_b16 a[170:171], v6 offset:6144
  ds_read_b64_tr_b16 a[172:173], v7 offset:0
  ds_read_b64_tr_b16 a[174:175], v7 offset:6144
  ds_read_b64_tr_b16 a[176:177], v4 offset:128
  ds_read_b64_tr_b16 a[178:179], v4 offset:6272
  ds_read_b64_tr_b16 a[180:181], v5 offset:128
  ds_read_b64_tr_b16 a[182:183], v5 offset:6272
  ds_read_b64_tr_b16 a[184:185], v6 offset:128
  ds_read_b64_tr_b16 a[186:187], v6 offset:6272
  ds_read_b64_tr_b16 a[188:189], v7 offset:128
  s_waitcnt lgkmcnt(10)
  ds_read_b64_tr_b16 a[190:191], v7 offset:6272
  ds_read_b64_tr_b16 a[192:193], v4 offset:256
  ds_read_b64_tr_b16 a[194:195], v4 offset:6400
  ds_read_b64_tr_b16 a[196:197], v5 offset:256
  ds_read_b64_tr_b16 a[198:199], v5 offset:6400
  s_waitcnt lgkmcnt(10)
  ds_read_b64_tr_b16 a[200:201], v6 offset:256
  ds_read_b64_tr_b16 a[202:203], v6 offset:6400
  ds_read_b64_tr_b16 a[204:205], v7 offset:256
  ds_read_b64_tr_b16 a[206:207], v7 offset:6400
  v_mfma_f32_16x16x32_bf16 v[96:99], a[160:163], v[32:35], v[96:99]
  v_mfma_f32_16x16x32_bf16 v[100:103], a[160:163], v[40:43], v[100:103]
  v_mfma_f32_16x16x32_bf16 v[104:107], a[160:163], v[48:51], v[104:107]
  v_mfma_f32_16x16x32_bf16 v[108:111], a[160:163], v[56:59], v[108:111]
  v_mfma_f32_16x16x32_bf16 v[112:115], a[164:167], v[32:35], v[112:115]
  v_mfma_f32_16x16x32_bf16 v[116:119], a[164:167], v[40:43], v[116:119]
  v_mfma_f32_16x16x32_bf16 v[120:123], a[164:167], v[48:51], v[120:123]
  v_mfma_f32_16x16x32_bf16 v[124:127], a[164:167], v[56:59], v[124:127]
  v_mfma_f32_16x16x32_bf16 v[128:131], a[168:171], v[32:35], v[128:131]
  v_mfma_f32_16x16x32_bf16 v[132:135], a[168:171], v[40:43], v[132:135]
  v_mfma_f32_16x16x32_bf16 v[136:139], a[168:171], v[48:51], v[136:139]
  v_mfma_f32_16x16x32_bf16 v[140:143], a[168:171], v[56:59], v[140:143]
  v_mfma_f32_16x16x32_bf16 v[144:147], a[172:175], v[32:35], v[144:147]
  v_mfma_f32_16x16x32_bf16 v[148:151], a[172:175], v[40:43], v[148:151]
  v_mfma_f32_16x16x32_bf16 v[152:155], a[172:175], v[48:51], v[152:155]
  v_mfma_f32_16x16x32_bf16 v[156:159], a[172:175], v[56:59], v[156:159]
  v_mfma_f32_16x16x32_bf16 v[160:163], a[176:179], v[32:35], v[160:163]
  v_mfma_f32_16x16x32_bf16 v[164:167], a[176:179], v[40:43], v[164:167]
  v_mfma_f32_16x16x32_bf16 v[168:171], a[176:179], v[48:51], v[168:171]
  v_mfma_f32_16x16x32_bf16 v[172:175], a[176:179], v[56:59], v[172:175]
  s_waitcnt lgkmcnt(12)
  v_mfma_f32_16x16x32_bf16 v[176:179], a[180:183], v[32:35], v[176:179]
  v_mfma_f32_16x16x32_bf16 v[180:183], a[180:183], v[40:43], v[180:183]
  v_mfma_f32_16x16x32_bf16 v[184:187], a[180:183], v[48:51], v[184:187]
  v_mfma_f32_16x16x32_bf16 v[188:191], a[180:183], v[56:59], v[188:191]
  s_waitcnt lgkmcnt(10)
  v_mfma_f32_16x16x32_bf16 v[192:195], a[184:187], v[32:35], v[192:195]
  v_mfma_f32_16x16x32_bf16 v[196:199], a[184:187], v[40:43], v[196:199]
  v_mfma_f32_16x16x32_bf16 v[200:203], a[184:187], v[48:51], v[200:203]
  v_mfma_f32_16x16x32_bf16 v[204:207], a[184:187], v[56:59], v[204:207]
  s_waitcnt lgkmcnt(8)
  v_mfma_f32_16x16x32_bf16 v[208:211], a[188:191], v[32:35], v[208:211]
  v_mfma_f32_16x16x32_bf16 v[212:215], a[188:191], v[40:43], v[212:215]
  v_mfma_f32_16x16x32_bf16 v[216:219], a[188:191], v[48:51], v[216:219]
  v_mfma_f32_16x16x32_bf16 v[220:223], a[188:191], v[56:59], v[220:223]
  s_waitcnt lgkmcnt(6)
  v_mfma_f32_16x16x32_bf16 v[224:227], a[192:195], v[32:35], v[224:227]
  v_mfma_f32_16x16x32_bf16 v[228:231], a[192:195], v[40:43], v[228:231]
  v_mfma_f32_16x16x32_bf16 v[232:235], a[192:195], v[48:51], v[232:235]
  v_mfma_f32_16x16x32_bf16 v[236:239], a[192:195], v[56:59], v[236:239]
  s_waitcnt lgkmcnt(4)
  v_mfma_f32_16x16x32_bf16 v[240:243], a[196:199], v[32:35], v[240:243]
  v_mfma_f32_16x16x32_bf16 v[244:247], a[196:199], v[40:43], v[244:247]
  v_mfma_f32_16x16x32_bf16 v[248:251], a[196:199], v[48:51], v[248:251]
  v_mfma_f32_16x16x32_bf16 v[252:255], a[196:199], v[56:59], v[252:255]
  s_waitcnt lgkmcnt(2)
  v_mfma_f32_16x16x32_bf16 a[0:3], a[200:203], v[32:35], a[0:3]
  v_mfma_f32_16x16x32_bf16 a[4:7], a[200:203], v[40:43], a[4:7]
  v_mfma_f32_16x16x32_bf16 a[8:11], a[200:203], v[48:51], a[8:11]
  v_mfma_f32_16x16x32_bf16 a[12:15], a[200:203], v[56:59], a[12:15]
  s_waitcnt lgkmcnt(0)
  v_mfma_f32_16x16x32_bf16 a[16:19], a[204:207], v[32:35], a[16:19]
  v_mfma_f32_16x16x32_bf16 a[20:23], a[204:207], v[40:43], a[20:23]
  v_mfma_f32_16x16x32_bf16 a[24:27], a[204:207], v[48:51], a[24:27]
  v_mfma_f32_16x16x32_bf16 a[28:31], a[204:207], v[56:59], a[28:31]
  s_waitcnt vmcnt(0) lgkmcnt(0)
  s_nop 15
  s_add_u32 s32, s32, 12288
  s_cmp_lt_u32 s32, 393216
  s_cbranch_scc1 L_fb_loop1
  s_waitcnt vmcnt(0) lgkmcnt(0)
  s_nop 15
  v_mov_b32_e32 v26, v18
  v_mov_b32_e32 v27, v19
  v_mov_b32_e32 v28, v20
  v_mov_b32_e32 v29, v21
  v_permlane32_swap_b32_e32 v18, v26
  v_permlane32_swap_b32_e32 v19, v27
  v_permlane32_swap_b32_e32 v20, v28
  v_permlane32_swap_b32_e32 v21, v29
  v_add_f32_e32 v18, v18, v26
  v_add_f32_e32 v19, v19, v27
  v_add_f32_e32 v20, v20, v28
  v_add_f32_e32 v21, v21, v29
  v_mov_b32_e32 v26, v18
  v_mov_b32_e32 v27, v19
  v_mov_b32_e32 v28, v20
  v_mov_b32_e32 v29, v21
  v_permlane16_swap_b32_e32 v18, v26
  v_permlane16_swap_b32_e32 v19, v27
  v_permlane16_swap_b32_e32 v20, v28
  v_permlane16_swap_b32_e32 v21, v29
  v_add_f32_e32 v18, v18, v26
  v_add_f32_e32 v19, v19, v27
  v_add_f32_e32 v20, v20, v28
  v_add_f32_e32 v21, v21, v29
  v_rcp_f32_e32 v18, v18
  v_rcp_f32_e32 v19, v19
  v_rcp_f32_e32 v20, v20
  v_rcp_f32_e32 v21, v21
  v_mul_f32_e32 v96, v18, v96
  v_mul_f32_e32 v97, v18, v97
  v_mul_f32_e32 v98, v18, v98
  v_mul_f32_e32 v99, v18, v99
  v_mul_f32_e32 v100, v19, v100
  v_mul_f32_e32 v101, v19, v101
  v_mul_f32_e32 v102, v19, v102
  v_mul_f32_e32 v103, v19, v103
  v_mul_f32_e32 v104, v20, v104
  v_mul_f32_e32 v105, v20, v105
  v_mul_f32_e32 v106, v20, v106
  v_mul_f32_e32 v107, v20, v107
  v_mul_f32_e32 v108, v21, v108
  v_mul_f32_e32 v109, v21, v109
  v_mul_f32_e32 v110, v21, v110
  v_mul_f32_e32 v111, v21, v111
  v_mul_f32_e32 v112, v18, v112
  v_mul_f32_e32 v113, v18, v113
  v_mul_f32_e32 v114, v18, v114
  v_mul_f32_e32 v115, v18, v115
  v_mul_f32_e32 v116, v19, v116
  v_mul_f32_e32 v117, v19, v117
  v_mul_f32_e32 v118, v19, v118
  v_mul_f32_e32 v119, v19, v119
  v_mul_f32_e32 v120, v20, v120
  v_mul_f32_e32 v121, v20, v121
  v_mul_f32_e32 v122, v20, v122
  v_mul_f32_e32 v123, v20, v123
  v_mul_f32_e32 v124, v21, v124
  v_mul_f32_e32 v125, v21, v125
  v_mul_f32_e32 v126, v21, v126
  v_mul_f32_e32 v127, v21, v127
  v_mul_f32_e32 v128, v18, v128
  v_mul_f32_e32 v129, v18, v129
  v_mul_f32_e32 v130, v18, v130
  v_mul_f32_e32 v131, v18, v131
  v_mul_f32_e32 v132, v19, v132
  v_mul_f32_e32 v133, v19, v133
  v_mul_f32_e32 v134, v19, v134
  v_mul_f32_e32 v135, v19, v135
  v_mul_f32_e32 v136, v20, v136
  v_mul_f32_e32 v137, v20, v137
  v_mul_f32_e32 v138, v20, v138
  v_mul_f32_e32 v139, v20, v139
  v_mul_f32_e32 v140, v21, v140
  v_mul_f32_e32 v141, v21, v141
  v_mul_f32_e32 v142, v21, v142
  v_mul_f32_e32 v143, v21, v143
  v_mul_f32_e32 v144, v18, v144
  v_mul_f32_e32 v145, v18, v145
  v_mul_f32_e32 v146, v18, v146
  v_mul_f32_e32 v147, v18, v147
  v_mul_f32_e32 v148, v19, v148
  v_mul_f32_e32 v149, v19, v149
  v_mul_f32_e32 v150, v19, v150
  v_mul_f32_e32 v151, v19, v151
  v_mul_f32_e32 v152, v20, v152
  v_mul_f32_e32 v153, v20, v153
  v_mul_f32_e32 v154, v20, v154
  v_mul_f32_e32 v155, v20, v155
  v_mul_f32_e32 v156, v21, v156
  v_mul_f32_e32 v157, v21, v157
  v_mul_f32_e32 v158, v21, v158
  v_mul_f32_e32 v159, v21, v159
  v_mul_f32_e32 v160, v18, v160
  v_mul_f32_e32 v161, v18, v161
  v_mul_f32_e32 v162, v18, v162
  v_mul_f32_e32 v163, v18, v163
  v_mul_f32_e32 v164, v19, v164
  v_mul_f32_e32 v165, v19, v165
  v_mul_f32_e32 v166, v19, v166
  v_mul_f32_e32 v167, v19, v167
  v_mul_f32_e32 v168, v20, v168
  v_mul_f32_e32 v169, v20, v169
  v_mul_f32_e32 v170, v20, v170
  v_mul_f32_e32 v171, v20, v171
  v_mul_f32_e32 v172, v21, v172
  v_mul_f32_e32 v173, v21, v173
  v_mul_f32_e32 v174, v21, v174
  v_mul_f32_e32 v175, v21, v175
  v_mul_f32_e32 v176, v18, v176
  v_mul_f32_e32 v177, v18, v177
  v_mul_f32_e32 v178, v18, v178
  v_mul_f32_e32 v179, v18, v179
  v_mul_f32_e32 v180, v19, v180
  v_mul_f32_e32 v181, v19, v181
  v_mul_f32_e32 v182, v19, v182
  v_mul_f32_e32 v183, v19, v183
  v_mul_f32_e32 v184, v20, v184
  v_mul_f32_e32 v185, v20, v185
  v_mul_f32_e32 v186, v20, v186
  v_mul_f32_e32 v187, v20, v187
  v_mul_f32_e32 v188, v21, v188
  v_mul_f32_e32 v189, v21, v189
  v_mul_f32_e32 v190, v21, v190
  v_mul_f32_e32 v191, v21, v191
  v_mul_f32_e32 v192, v18, v192
  v_mul_f32_e32 v193, v18, v193
  v_mul_f32_e32 v194, v18, v194
  v_mul_f32_e32 v195, v18, v195
  v_mul_f32_e32 v196, v19, v196
  v_mul_f32_e32 v197, v19, v197
  v_mul_f32_e32 v198, v19, v198
  v_mul_f32_e32 v199, v19, v199
  v_mul_f32_e32 v200, v20, v200
  v_mul_f32_e32 v201, v20, v201
  v_mul_f32_e32 v202, v20, v202
  v_mul_f32_e32 v203, v20, v203
  v_mul_f32_e32 v204, v21, v204
  v_mul_f32_e32 v205, v21, v205
  v_mul_f32_e32 v206, v21, v206
  v_mul_f32_e32 v207, v21, v207
  v_mul_f32_e32 v208, v18, v208
  v_mul_f32_e32 v209, v18, v209
  v_mul_f32_e32 v210, v18, v210
  v_mul_f32_e32 v211, v18, v211
  v_mul_f32_e32 v212, v19, v212
  v_mul_f32_e32 v213, v19, v213
  v_mul_f32_e32 v214, v19, v214
  v_mul_f32_e32 v215, v19, v215
  v_mul_f32_e32 v216, v20, v216
  v_mul_f32_e32 v217, v20, v217
  v_mul_f32_e32 v218, v20, v218
  v_mul_f32_e32 v219, v20, v219
  v_mul_f32_e32 v220, v21, v220
  v_mul_f32_e32 v221, v21, v221
  v_mul_f32_e32 v222, v21, v222
  v_mul_f32_e32 v223, v21, v223
  v_mul_f32_e32 v224, v18, v224
  v_mul_f32_e32 v225, v18, v225
  v_mul_f32_e32 v226, v18, v226
  v_mul_f32_e32 v227, v18, v227
  v_mul_f32_e32 v228, v19, v228
  v_mul_f32_e32 v229, v19, v229
  v_mul_f32_e32 v230, v19, v230
  v_mul_f32_e32 v231, v19, v231
  v_mul_f32_e32 v232, v20, v232
  v_mul_f32_e32 v233, v20, v233
  v_mul_f32_e32 v234, v20, v234
  v_mul_f32_e32 v235, v20, v235
  v_mul_f32_e32 v236, v21, v236
  v_mul_f32_e32 v237, v21, v237
  v_mul_f32_e32 v238, v21, v238
  v_mul_f32_e32 v239, v21, v239
  v_mul_f32_e32 v240, v18, v240
  v_mul_f32_e32 v241, v18, v241
  v_mul_f32_e32 v242, v18, v242
  v_mul_f32_e32 v243, v18, v243
  v_mul_f32_e32 v244, v19, v244
  v_mul_f32_e32 v245, v19, v245
  v_mul_f32_e32 v246, v19, v246
  v_mul_f32_e32 v247, v19, v247
  v_mul_f32_e32 v248, v20, v248
  v_mul_f32_e32 v249, v20, v249
  v_mul_f32_e32 v250, v20, v250
  v_mul_f32_e32 v251, v20, v251
  v_mul_f32_e32 v252, v21, v252
  v_mul_f32_e32 v253, v21, v253
  v_mul_f32_e32 v254, v21, v254
  v_mul_f32_e32 v255, v21, v255
  v_accvgpr_read_b32 v64, a0
  v_mul_f32_e32 v64, v18, v64
  v_accvgpr_write_b32 a0, v64
  v_accvgpr_read_b32 v64, a1
  v_mul_f32_e32 v64, v18, v64
  v_accvgpr_write_b32 a1, v64
  v_accvgpr_read_b32 v64, a2
  v_mul_f32_e32 v64, v18, v64
  v_accvgpr_write_b32 a2, v64
  v_accvgpr_read_b32 v64, a3
  v_mul_f32_e32 v64, v18, v64
  v_accvgpr_write_b32 a3, v64
  v_accvgpr_read_b32 v64, a4
  v_mul_f32_e32 v64, v19, v64
  v_accvgpr_write_b32 a4, v64
  v_accvgpr_read_b32 v64, a5
  v_mul_f32_e32 v64, v19, v64
  v_accvgpr_write_b32 a5, v64
  v_accvgpr_read_b32 v64, a6
  v_mul_f32_e32 v64, v19, v64
  v_accvgpr_write_b32 a6, v64
  v_accvgpr_read_b32 v64, a7
  v_mul_f32_e32 v64, v19, v64
  v_accvgpr_write_b32 a7, v64
  v_accvgpr_read_b32 v64, a8
  v_mul_f32_e32 v64, v20, v64
  v_accvgpr_write_b32 a8, v64
  v_accvgpr_read_b32 v64, a9
  v_mul_f32_e32 v64, v20, v64
  v_accvgpr_write_b32 a9, v64
  v_accvgpr_read_b32 v64, a10
  v_mul_f32_e32 v64, v20, v64
  v_accvgpr_write_b32 a10, v64
  v_accvgpr_read_b32 v64, a11
  v_mul_f32_e32 v64, v20, v64
  v_accvgpr_write_b32 a11, v64
  v_accvgpr_read_b32 v64, a12
  v_mul_f32_e32 v64, v21, v64
  v_accvgpr_write_b32 a12, v64
  v_accvgpr_read_b32 v64, a13
  v_mul_f32_e32 v64, v21, v64
  v_accvgpr_write_b32 a13, v64
  v_accvgpr_read_b32 v64, a14
  v_mul_f32_e32 v64, v21, v64
  v_accvgpr_write_b32 a14, v64
  v_accvgpr_read_b32 v64, a15
  v_mul_f32_e32 v64, v21, v64
  v_accvgpr_write_b32 a15, v64
  v_accvgpr_read_b32 v64, a16
  v_mul_f32_e32 v64, v18, v64
  v_accvgpr_write_b32 a16, v64
  v_accvgpr_read_b32 v64, a17
  v_mul_f32_e32 v64, v18, v64
  v_accvgpr_write_b32 a17, v64
  v_accvgpr_read_b32 v64, a18
  v_mul_f32_e32 v64, v18, v64
  v_accvgpr_write_b32 a18, v64
  v_accvgpr_read_b32 v64, a19
  v_mul_f32_e32 v64, v18, v64
  v_accvgpr_write_b32 a19, v64
  v_accvgpr_read_b32 v64, a20
  v_mul_f32_e32 v64, v19, v64
  v_accvgpr_write_b32 a20, v64
  v_accvgpr_read_b32 v64, a21
  v_mul_f32_e32 v64, v19, v64
  v_accvgpr_write_b32 a21, v64
  v_accvgpr_read_b32 v64, a22
  v_mul_f32_e32 v64, v19, v64
  v_accvgpr_write_b32 a22, v64
  v_accvgpr_read_b32 v64, a23
  v_mul_f32_e32 v64, v19, v64
  v_accvgpr_write_b32 a23, v64
  v_accvgpr_read_b32 v64, a24
  v_mul_f32_e32 v64, v20, v64
  v_accvgpr_write_b32 a24, v64
  v_accvgpr_read_b32 v64, a25
  v_mul_f32_e32 v64, v20, v64
  v_accvgpr_write_b32 a25, v64
  v_accvgpr_read_b32 v64, a26
  v_mul_f32_e32 v64, v20, v64
  v_accvgpr_write_b32 a26, v64
  v_accvgpr_read_b32 v64, a27
  v_mul_f32_e32 v64, v20, v64
  v_accvgpr_write_b32 a27, v64
  v_accvgpr_read_b32 v64, a28
  v_mul_f32_e32 v64, v21, v64
  v_accvgpr_write_b32 a28, v64
  v_accvgpr_read_b32 v64, a29
  v_mul_f32_e32 v64, v21, v64
  v_accvgpr_write_b32 a29, v64
  v_accvgpr_read_b32 v64, a30
  v_mul_f32_e32 v64, v21, v64
  v_accvgpr_write_b32 a30, v64
  v_accvgpr_read_b32 v64, a31
  v_mul_f32_e32 v64, v21, v64
  v_accvgpr_write_b32 a31, v64
  v_cvt_pk_bf16_f32 v64, v96, v97
  v_cvt_pk_bf16_f32 v65, v98, v99
  ds_write_b64 v30, v[64:65] offset:0
  s_waitcnt vmcnt(0) lgkmcnt(0)
  v_cvt_pk_bf16_f32 v64, v100, v101
  v_cvt_pk_bf16_f32 v65, v102, v103
  ds_write_b64 v30, v[64:65] offset:2304
  s_waitcnt vmcnt(0) lgkmcnt(0)
  v_cvt_pk_bf16_f32 v64, v112, v113
  v_cvt_pk_bf16_f32 v65, v114, v115
  ds_write_b64 v30, v[64:65] offset:32
  s_waitcnt vmcnt(0) lgkmcnt(0)
  v_cvt_pk_bf16_f32 v64, v116, v117
  v_cvt_pk_bf16_f32 v65, v118, v119
  ds_write_b64 v30, v[64:65] offset:2336
  s_waitcnt vmcnt(0) lgkmcnt(0)
  v_cvt_pk_bf16_f32 v64, v128, v129
  v_cvt_pk_bf16_f32 v65, v130, v131
  ds_write_b64 v30, v[64:65] offset:64
  s_waitcnt vmcnt(0) lgkmcnt(0)
  v_cvt_pk_bf16_f32 v64, v132, v133
  v_cvt_pk_bf16_f32 v65, v134, v135
  ds_write_b64 v30, v[64:65] offset:2368
  s_waitcnt vmcnt(0) lgkmcnt(0)
  v_cvt_pk_bf16_f32 v64, v144, v145
  v_cvt_pk_bf16_f32 v65, v146, v147
  ds_write_b64 v30, v[64:65] offset:96
  s_waitcnt vmcnt(0) lgkmcnt(0)
  v_cvt_pk_bf16_f32 v64, v148, v149
  v_cvt_pk_bf16_f32 v65, v150, v151
  ds_write_b64 v30, v[64:65] offset:2400
  s_waitcnt vmcnt(0) lgkmcnt(0)
  ds_read_b128 a[208:211], v31 offset:0
  ds_read_b128 a[212:215], v31 offset:1152
  ds_read_b128 a[216:219], v31 offset:2304
  ds_read_b128 a[220:223], v31 offset:3456
  s_waitcnt lgkmcnt(3)
  buffer_store_dwordx4 a[208:211], v1, s[20:23], s84 offen
  s_waitcnt lgkmcnt(2)
  buffer_store_dwordx4 a[212:215], v1, s[20:23], s84 offen offset:3072
  s_waitcnt lgkmcnt(1)
  buffer_store_dwordx4 a[216:219], v1, s[20:23], s85 offen
  s_waitcnt lgkmcnt(0)
  buffer_store_dwordx4 a[220:223], v1, s[20:23], s85 offen offset:3072
  s_waitcnt vmcnt(0) lgkmcnt(0)
  v_cvt_pk_bf16_f32 v64, v104, v105
  v_cvt_pk_bf16_f32 v65, v106, v107
  ds_write_b64 v30, v[64:65] offset:0
  s_waitcnt vmcnt(0) lgkmcnt(0)
  v_cvt_pk_bf16_f32 v64, v108, v109
  v_cvt_pk_bf16_f32 v65, v110, v111
  ds_write_b64 v30, v[64:65] offset:2304
  s_waitcnt vmcnt(0) lgkmcnt(0)
  v_cvt_pk_bf16_f32 v64, v120, v121
  v_cvt_pk_bf16_f32 v65, v122, v123
  ds_write_b64 v30, v[64:65] offset:32
  s_waitcnt vmcnt(0) lgkmcnt(0)
  v_cvt_pk_bf16_f32 v64, v124, v125
  v_cvt_pk_bf16_f32 v65, v126, v127
  ds_write_b64 v30, v[64:65] offset:2336
  s_waitcnt vmcnt(0) lgkmcnt(0)
  v_cvt_pk_bf16_f32 v64, v136, v137
  v_cvt_pk_bf16_f32 v65, v138, v139
  ds_write_b64 v30, v[64:65] offset:64
  s_waitcnt vmcnt(0) lgkmcnt(0)
  v_cvt_pk_bf16_f32 v64, v140, v141
  v_cvt_pk_bf16_f32 v65, v142, v143
  ds_write_b64 v30, v[64:65] offset:2368
  s_waitcnt vmcnt(0) lgkmcnt(0)
  v_cvt_pk_bf16_f32 v64, v152, v153
  v_cvt_pk_bf16_f32 v65, v154, v155
  ds_write_b64 v30, v[64:65] offset:96
  s_waitcnt vmcnt(0) lgkmcnt(0)
  v_cvt_pk_bf16_f32 v64, v156, v157
  v_cvt_pk_bf16_f32 v65, v158, v159
  ds_write_b64 v30, v[64:65] offset:2400
  s_waitcnt vmcnt(0) lgkmcnt(0)
  ds_read_b128 a[208:211], v31 offset:0
  ds_read_b128 a[212:215], v31 offset:1152
  ds_read_b128 a[216:219], v31 offset:2304
  ds_read_b128 a[220:223], v31 offset:3456
  s_waitcnt lgkmcnt(3)
  buffer_store_dwordx4 a[208:211], v1, s[20:23], s86 offen
  s_waitcnt lgkmcnt(2)
  buffer_store_dwordx4 a[212:215], v1, s[20:23], s86 offen offset:3072
  s_waitcnt lgkmcnt(1)
  buffer_store_dwordx4 a[216:219], v1, s[20:23], s87 offen
  s_waitcnt lgkmcnt(0)
  buffer_store_dwordx4 a[220:223], v1, s[20:23], s87 offen offset:3072
  s_waitcnt vmcnt(0) lgkmcnt(0)
  v_cvt_pk_bf16_f32 v64, v160, v161
  v_cvt_pk_bf16_f32 v65, v162, v163
  ds_write_b64 v30, v[64:65] offset:0
  s_waitcnt vmcnt(0) lgkmcnt(0)
  v_cvt_pk_bf16_f32 v64, v164, v165
  v_cvt_pk_bf16_f32 v65, v166, v167
  ds_write_b64 v30, v[64:65] offset:2304
  s_waitcnt vmcnt(0) lgkmcnt(0)
  v_cvt_pk_bf16_f32 v64, v176, v177
  v_cvt_pk_bf16_f32 v65, v178, v179
  ds_write_b64 v30, v[64:65] offset:32
  s_waitcnt vmcnt(0) lgkmcnt(0)
  v_cvt_pk_bf16_f32 v64, v180, v181
  v_cvt_pk_bf16_f32 v65, v182, v183
  ds_write_b64 v30, v[64:65] offset:2336
  s_waitcnt vmcnt(0) lgkmcnt(0)
  v_cvt_pk_bf16_f32 v64, v192, v193
  v_cvt_pk_bf16_f32 v65, v194, v195
  ds_write_b64 v30, v[64:65] offset:64
  s_waitcnt vmcnt(0) lgkmcnt(0)
  v_cvt_pk_bf16_f32 v64, v196, v197
  v_cvt_pk_bf16_f32 v65, v198, v199
  ds_write_b64 v30, v[64:65] offset:2368
  s_waitcnt vmcnt(0) lgkmcnt(0)
  v_cvt_pk_bf16_f32 v64, v208, v209
  v_cvt_pk_bf16_f32 v65, v210, v211
  ds_write_b64 v30, v[64:65] offset:96
  s_waitcnt vmcnt(0) lgkmcnt(0)
  v_cvt_pk_bf16_f32 v64, v212, v213
  v_cvt_pk_bf16_f32 v65, v214, v215
  ds_write_b64 v30, v[64:65] offset:2400
  s_waitcnt vmcnt(0) lgkmcnt(0)
  ds_read_b128 a[208:211], v31 offset:0
  ds_read_b128 a[212:215], v31 offset:1152
  ds_read_b128 a[216:219], v31 offset:2304
  ds_read_b128 a[220:223], v31 offset:3456
  s_waitcnt lgkmcnt(3)
  buffer_store_dwordx4 a[208:211], v1, s[20:23], s84 offen offset:128
  s_waitcnt lgkmcnt(2)
  buffer_store_dwordx4 a[212:215], v1, s[20:23], s84 offen offset:3200
  s_waitcnt lgkmcnt(1)
  buffer_store_dwordx4 a[216:219], v1, s[20:23], s85 offen offset:128
  s_waitcnt lgkmcnt(0)
  buffer_store_dwordx4 a[220:223], v1, s[20:23], s85 offen offset:3200
  s_waitcnt vmcnt(0) lgkmcnt(0)
  v_cvt_pk_bf16_f32 v64, v168, v169
  v_cvt_pk_bf16_f32 v65, v170, v171
  ds_write_b64 v30, v[64:65] offset:0
  s_waitcnt vmcnt(0) lgkmcnt(0)
  v_cvt_pk_bf16_f32 v64, v172, v173
  v_cvt_pk_bf16_f32 v65, v174, v175
  ds_write_b64 v30, v[64:65] offset:2304
  s_waitcnt vmcnt(0) lgkmcnt(0)
  v_cvt_pk_bf16_f32 v64, v184, v185
  v_cvt_pk_bf16_f32 v65, v186, v187
  ds_write_b64 v30, v[64:65] offset:32
  s_waitcnt vmcnt(0) lgkmcnt(0)
  v_cvt_pk_bf16_f32 v64, v188, v189
  v_cvt_pk_bf16_f32 v65, v190, v191
  ds_write_b64 v30, v[64:65] offset:2336
  s_waitcnt vmcnt(0) lgkmcnt(0)
  v_cvt_pk_bf16_f32 v64, v200, v201
  v_cvt_pk_bf16_f32 v65, v202, v203
  ds_write_b64 v30, v[64:65] offset:64
  s_waitcnt vmcnt(0) lgkmcnt(0)
  v_cvt_pk_bf16_f32 v64, v204, v205
  v_cvt_pk_bf16_f32 v65, v206, v207
  ds_write_b64 v30, v[64:65] offset:2368
  s_waitcnt vmcnt(0) lgkmcnt(0)
  v_cvt_pk_bf16_f32 v64, v216, v217
  v_cvt_pk_bf16_f32 v65, v218, v219
  ds_write_b64 v30, v[64:65] offset:96
  s_waitcnt vmcnt(0) lgkmcnt(0)
  v_cvt_pk_bf16_f32 v64, v220, v221
  v_cvt_pk_bf16_f32 v65, v222, v223
  ds_write_b64 v30, v[64:65] offset:2400
  s_waitcnt vmcnt(0) lgkmcnt(0)
  ds_read_b128 a[208:211], v31 offset:0
  ds_read_b128 a[212:215], v31 offset:1152
  ds_read_b128 a[216:219], v31 offset:2304
  ds_read_b128 a[220:223], v31 offset:3456
  s_waitcnt lgkmcnt(3)
  buffer_store_dwordx4 a[208:211], v1, s[20:23], s86 offen offset:128
  s_waitcnt lgkmcnt(2)
  buffer_store_dwordx4 a[212:215], v1, s[20:23], s86 offen offset:3200
  s_waitcnt lgkmcnt(1)
  buffer_store_dwordx4 a[216:219], v1, s[20:23], s87 offen offset:128
  s_waitcnt lgkmcnt(0)
  buffer_store_dwordx4 a[220:223], v1, s[20:23], s87 offen offset:3200
  s_waitcnt vmcnt(0) lgkmcnt(0)
  v_cvt_pk_bf16_f32 v64, v224, v225
  v_cvt_pk_bf16_f32 v65, v226, v227
  ds_write_b64 v30, v[64:65] offset:0
  s_waitcnt vmcnt(0) lgkmcnt(0)
  v_cvt_pk_bf16_f32 v64, v228, v229
  v_cvt_pk_bf16_f32 v65, v230, v231
  ds_write_b64 v30, v[64:65] offset:2304
  s_waitcnt vmcnt(0) lgkmcnt(0)
  v_cvt_pk_bf16_f32 v64, v240, v241
  v_cvt_pk_bf16_f32 v65, v242, v243
  ds_write_b64 v30, v[64:65] offset:32
  s_waitcnt vmcnt(0) lgkmcnt(0)
  v_cvt_pk_bf16_f32 v64, v244, v245
  v_cvt_pk_bf16_f32 v65, v246, v247
  ds_write_b64 v30, v[64:65] offset:2336
  s_waitcnt vmcnt(0) lgkmcnt(0)
  v_accvgpr_read_b32 v68, a0
  v_accvgpr_read_b32 v69, a1
  v_accvgpr_read_b32 v70, a2
  v_accvgpr_read_b32 v71, a3
  v_cvt_pk_bf16_f32 v64, v68, v69
  v_cvt_pk_bf16_f32 v65, v70, v71
  ds_write_b64 v30, v[64:65] offset:64
  s_waitcnt vmcnt(0) lgkmcnt(0)
  v_accvgpr_read_b32 v68, a4
  v_accvgpr_read_b32 v69, a5
  v_accvgpr_read_b32 v70, a6
  v_accvgpr_read_b32 v71, a7
  v_cvt_pk_bf16_f32 v64, v68, v69
  v_cvt_pk_bf16_f32 v65, v70, v71
  ds_write_b64 v30, v[64:65] offset:2368
  s_waitcnt vmcnt(0) lgkmcnt(0)
  v_accvgpr_read_b32 v68, a16
  v_accvgpr_read_b32 v69, a17
  v_accvgpr_read_b32 v70, a18
  v_accvgpr_read_b32 v71, a19
  v_cvt_pk_bf16_f32 v64, v68, v69
  v_cvt_pk_bf16_f32 v65, v70, v71
  ds_write_b64 v30, v[64:65] offset:96
  s_waitcnt vmcnt(0) lgkmcnt(0)
  v_accvgpr_read_b32 v68, a20
  v_accvgpr_read_b32 v69, a21
  v_accvgpr_read_b32 v70, a22
  v_accvgpr_read_b32 v71, a23
  v_cvt_pk_bf16_f32 v64, v68, v69
  v_cvt_pk_bf16_f32 v65, v70, v71
  ds_write_b64 v30, v[64:65] offset:2400
  s_waitcnt vmcnt(0) lgkmcnt(0)
  ds_read_b128 a[208:211], v31 offset:0
  ds_read_b128 a[212:215], v31 offset:1152
  ds_read_b128 a[216:219], v31 offset:2304
  ds_read_b128 a[220:223], v31 offset:3456
  s_waitcnt lgkmcnt(3)
  buffer_store_dwordx4 a[208:211], v1, s[20:23], s84 offen offset:256
  s_waitcnt lgkmcnt(2)
  buffer_store_dwordx4 a[212:215], v1, s[20:23], s84 offen offset:3328
  s_waitcnt lgkmcnt(1)
  buffer_store_dwordx4 a[216:219], v1, s[20:23], s85 offen offset:256
  s_waitcnt lgkmcnt(0)
  buffer_store_dwordx4 a[220:223], v1, s[20:23], s85 offen offset:3328
  s_waitcnt vmcnt(0) lgkmcnt(0)
  v_cvt_pk_bf16_f32 v64, v232, v233
  v_cvt_pk_bf16_f32 v65, v234, v235
  ds_write_b64 v30, v[64:65] offset:0
  s_waitcnt vmcnt(0) lgkmcnt(0)
  v_cvt_pk_bf16_f32 v64, v236, v237
  v_cvt_pk_bf16_f32 v65, v238, v239
  ds_write_b64 v30, v[64:65] offset:2304
  s_waitcnt vmcnt(0) lgkmcnt(0)
  v_cvt_pk_bf16_f32 v64, v248, v249
  v_cvt_pk_bf16_f32 v65, v250, v251
  ds_write_b64 v30, v[64:65] offset:32
  s_waitcnt vmcnt(0) lgkmcnt(0)
  v_cvt_pk_bf16_f32 v64, v252, v253
  v_cvt_pk_bf16_f32 v65, v254, v255
  ds_write_b64 v30, v[64:65] offset:2336
  s_waitcnt vmcnt(0) lgkmcnt(0)
  v_accvgpr_read_b32 v68, a8
  v_accvgpr_read_b32 v69, a9
  v_accvgpr_read_b32 v70, a10
  v_accvgpr_read_b32 v71, a11
  v_cvt_pk_bf16_f32 v64, v68, v69
  v_cvt_pk_bf16_f32 v65, v70, v71
  ds_write_b64 v30, v[64:65] offset:64
  s_waitcnt vmcnt(0) lgkmcnt(0)
  v_accvgpr_read_b32 v68, a12
  v_accvgpr_read_b32 v69, a13
  v_accvgpr_read_b32 v70, a14
  v_accvgpr_read_b32 v71, a15
  v_cvt_pk_bf16_f32 v64, v68, v69
  v_cvt_pk_bf16_f32 v65, v70, v71
  ds_write_b64 v30, v[64:65] offset:2368
  s_waitcnt vmcnt(0) lgkmcnt(0)
  v_accvgpr_read_b32 v68, a24
  v_accvgpr_read_b32 v69, a25
  v_accvgpr_read_b32 v70, a26
  v_accvgpr_read_b32 v71, a27
  v_cvt_pk_bf16_f32 v64, v68, v69
  v_cvt_pk_bf16_f32 v65, v70, v71
  ds_write_b64 v30, v[64:65] offset:96
  s_waitcnt vmcnt(0) lgkmcnt(0)
  v_accvgpr_read_b32 v68, a28
  v_accvgpr_read_b32 v69, a29
  v_accvgpr_read_b32 v70, a30
  v_accvgpr_read_b32 v71, a31
  v_cvt_pk_bf16_f32 v64, v68, v69
  v_cvt_pk_bf16_f32 v65, v70, v71
  ds_write_b64 v30, v[64:65] offset:2400
  s_waitcnt vmcnt(0) lgkmcnt(0)
  ds_read_b128 a[208:211], v31 offset:0
  ds_read_b128 a[212:215], v31 offset:1152
  ds_read_b128 a[216:219], v31 offset:2304
  ds_read_b128 a[220:223], v31 offset:3456
  s_waitcnt lgkmcnt(3)
  buffer_store_dwordx4 a[208:211], v1, s[20:23], s86 offen offset:256
  s_waitcnt lgkmcnt(2)
  buffer_store_dwordx4 a[212:215], v1, s[20:23], s86 offen offset:3328
  s_waitcnt lgkmcnt(1)
  buffer_store_dwordx4 a[216:219], v1, s[20:23], s87 offen offset:256
  s_waitcnt lgkmcnt(0)
  buffer_store_dwordx4 a[220:223], v1, s[20:23], s87 offen offset:3328
  s_waitcnt vmcnt(0) lgkmcnt(0)
  s_waitcnt vmcnt(0) lgkmcnt(0)
  s_nop 15
  s_endpgm
.section .rodata,"a"
.p2align 6
.amdhsa_kernel standalone__mha_softmax__near_ridge_kernel
  .amdhsa_next_free_vgpr 512
  .amdhsa_next_free_sgpr 96
  .amdhsa_accum_offset 256
  .amdhsa_group_segment_fixed_size 0
  .amdhsa_kernarg_size 48
  .amdhsa_user_sgpr_count 2
  .amdhsa_user_sgpr_kernarg_segment_ptr 1
  .amdhsa_system_sgpr_workgroup_id_x 1
.end_amdhsa_kernel
```
